```python
import torch

def _softmax(x, axis=-1):
    return torch.softmax(x, dim=axis)

def _gelu(x):
    return torch.nn.functional.gelu(x, approximate='tanh')

def _silu(x):
    return torch.nn.functional.silu(x)

def _sigmoid(x):
    return torch.sigmoid(x)

def _layernorm(x, axis=-1, eps=1e-05):
    m = x.mean(dim=axis, keepdim=True)
    v = x.var(dim=axis, keepdim=True, unbiased=False)
    return (x - m) / torch.sqrt(v + eps)

def _scatter_add(tgt, idx, src, axis=0):
    return tgt.clone().index_add_(axis, idx, src)

def _segment_sum(src, seg, n):
    out = torch.zeros((n,) + src.shape[1:], dtype=src.dtype)
    return out.index_add_(0, seg, src)

def _pad(x, pw):
    flat = tuple((v for pair in reversed(pw) for v in pair))
    return torch.nn.functional.pad(x, flat)
kernel_name = 'standalone__kv_cache_quant_pre_rope_vs_post_rope__decode'

def setup_inputs():

    _w = lambda a: (lambda t: t.to(torch.bfloat16) if t.is_floating_point() else t)(torch.as_tensor(a))
    B, Sq, Skv = (1, 1, 16384)
    H, Dh0 = (32, 192)
    G = -1 if -1 > 0 else Dh0
    G = max(2, G // 2 * 2)
    Dh = max(G, Dh0 // G * G)
    Skv = max(Skv, Sq)
    ng = Dh // G
    bits = 3 if 3 > 1 else 4
    bits = max(2, min(8, bits))
    qmax = (1 << bits) - 1
    half = Dh // 2
    inv = 1.0 / 10000.0 ** (torch.arange(half) / max(1, half))
    ang_k = torch.arange(Skv)[:, None] * inv[None, :]
    ang_q = torch.arange(Skv - Sq, Skv)[:, None] * inv[None, :]
    kc = torch.cat([torch.cos(ang_k), torch.cos(ang_k)], dim=-1)
    ks = torch.cat([torch.sin(ang_k), torch.sin(ang_k)], dim=-1)
    qc = torch.cat([torch.cos(ang_q), torch.cos(ang_q)], dim=-1)
    qs = torch.cat([torch.sin(ang_q), torch.sin(ang_q)], dim=-1)
    qk_i = torch.randint(0, qmax + 1, (B, H, Skv, Dh)).to(torch.int32)
    qv_i = torch.randint(0, qmax + 1, (B, H, Skv, Dh)).to(torch.int32)
    ksc = torch.abs((lambda *s: torch.randn(*s, dtype=torch.bfloat16) * 0.4)(B, H, Skv, ng)) * 0.1 + 0.01
    kzp = torch.full((B, H, Skv, ng), qmax / 2.0)
    vsc = torch.abs((lambda *s: torch.randn(*s, dtype=torch.bfloat16) * 0.4)(B, H, Skv, ng)) * 0.1 + 0.01
    vzp = torch.full((B, H, Skv, ng), qmax / 2.0)
    return {'q': _w((lambda *s: torch.randn(*s, dtype=torch.bfloat16) * 6.4)(B, H, Sq, Dh) * 0.5), 'qk': _w(qk_i), 'k_scales': _w(ksc), 'k_zeros': _w(kzp), 'qv': _w(qv_i), 'v_scales': _w(vsc), 'v_zeros': _w(vzp), 'q_cos': _w(qc), 'q_sin': _w(qs), 'k_cos': _w(kc), 'k_sin': _w(ks)}

def reference(q, qk, k_scales, k_zeros, qv, v_scales, v_zeros, q_cos, q_sin, k_cos, k_sin):
    B, H, Sq, Dh = q.shape
    ng = k_scales.shape[-1]
    G = Dh // ng
    half = Dh // 2
    ks = (lambda x, n, axis: torch.repeat_interleave(x, n, dim=axis))(k_scales, G, axis=-1)
    kz = (lambda x, n, axis: torch.repeat_interleave(x, n, dim=axis))(k_zeros, G, axis=-1)
    k = ((lambda x, dt: x.to(dt))(qk, q.dtype) - kz) * ks
    vs = (lambda x, n, axis: torch.repeat_interleave(x, n, dim=axis))(v_scales, G, axis=-1)
    vz = (lambda x, n, axis: torch.repeat_interleave(x, n, dim=axis))(v_zeros, G, axis=-1)
    v = ((lambda x, dt: x.to(dt))(qv, q.dtype) - vz) * vs
    k1 = k[..., :half].clone()
    k2 = k[..., half:].clone()
    krh = torch.concatenate([-k2, k1], axis=-1)
    kr = k * k_cos[None, None, :, :] + krh * k_sin[None, None, :, :]
    q1 = q[..., :half].clone()
    q2 = q[..., half:].clone()
    qrh = torch.concatenate([-q2, q1], axis=-1)
    qr = q * q_cos[None, None, :, :] + qrh * q_sin[None, None, :, :]
    logits = torch.einsum('bhqd,bhkd->bhqk', qr, kr) * float(Dh) ** (-0.5)
    attn = _softmax(logits, axis=-1)
    out = torch.einsum('bhqk,bhkd->bhqd', attn, v)
    return out
```

```asm
; @launch grid=(256,1,1) block=(512,1,1) lds=159168
.amdgcn_target "amdgcn-amd-amdhsa--gfx950"
.text
.globl standalone__kv_cache_quant_pre_rope_vs_post_rope__decode_kernel
.p2align 8
.type standalone__kv_cache_quant_pre_rope_vs_post_rope__decode_kernel,@function
standalone__kv_cache_quant_pre_rope_vs_post_rope__decode_kernel:
    s_cmp_ge_u32 s2, 256
    s_cbranch_scc1 L_end
    s_load_dwordx16 s[48:63], s[0:1], 0
    s_load_dwordx8 s[64:71], s[0:1], 64
    s_load_dwordx4 s[72:75], s[0:1], 96
    s_memrealtime s[84:85]
    v_lshrrev_b32 v4, 6, v0
    v_and_b32 v1, 63, v0
    v_readfirstlane_b32 s76, v4
    v_lshlrev_b32 v2, 4, v1
    v_mov_b32 v3, 158912
    s_lshl_b32 s76, s76, 2
    s_lshr_b32 s76, 0x65372104, s76
    s_and_b32 s76, s76, 7
    s_and_b32 s79, s2, 7
    s_lshr_b32 s80, s2, 3
    s_and_b32 s77, s80, 3
    s_lshr_b32 s80, s80, 2
    s_lshr_b32 s78, s80, 2
    s_lshl_b32 s78, s78, 3
    s_add_u32 s78, s78, s79
    s_lshl_b32 s78, s78, 2
    s_and_b32 s80, s80, 3
    s_add_u32 s78, s78, s80
    s_cmp_eq_u32 s76, 4
    s_cbranch_scc0 L_notld
    s_setprio 3
    s_mul_i32 s8, s77, 12582912
    s_mul_i32 s80, s78, 12288
    s_add_u32 s8, s8, s80
    s_mul_i32 s16, s77, 4
    s_mul_i32 s17, s77, 4
    s_and_b32 s80, s16, 15
    s_mul_i32 s9, s80, 786432
    s_add_u32 s9, s9, s8
    s_mov_b32 m0, 0
    s_mov_b32 s6, 402653184
    s_mov_b32 s7, 0x20000
    s_waitcnt lgkmcnt(0)
    s_mov_b32 s4, s50
    s_mov_b32 s5, s51
    buffer_load_dwordx4 v2, s[4:7], s9 offen offset:0 nt lds
    buffer_load_dwordx4 v2, s[4:7], s9 offen offset:1024 nt lds
    buffer_load_dwordx4 v2, s[4:7], s9 offen offset:2048 nt lds
    buffer_load_dwordx4 v2, s[4:7], s9 offen offset:3072 nt lds
    s_add_u32 s9, s9, 4096
    s_add_u32 m0, m0, 4096
    s_nop 0
    buffer_load_dwordx4 v2, s[4:7], s9 offen offset:0 nt lds
    buffer_load_dwordx4 v2, s[4:7], s9 offen offset:1024 nt lds
    buffer_load_dwordx4 v2, s[4:7], s9 offen offset:2048 nt lds
    buffer_load_dwordx4 v2, s[4:7], s9 offen offset:3072 nt lds
    s_add_u32 s9, s9, 4096
    s_add_u32 m0, m0, 4096
    s_nop 0
    buffer_load_dwordx4 v2, s[4:7], s9 offen offset:0 nt lds
    buffer_load_dwordx4 v2, s[4:7], s9 offen offset:1024 nt lds
    buffer_load_dwordx4 v2, s[4:7], s9 offen offset:2048 nt lds
    buffer_load_dwordx4 v2, s[4:7], s9 offen offset:3072 nt lds
    s_add_u32 s9, s9, 4096
    s_add_u32 m0, m0, 4096
    s_mov_b32 s10, 0
    v_mov_b32 v5, 12
    v_mov_b32 v7, 2325
    s_barrier
    s_nop 0
L_next:
    s_add_u32 s10, s10, 1
    s_cmp_eq_u32 m0, 110592
    s_cselect_b32 m0, 0, m0
    s_waitcnt lgkmcnt(4)
    v_readfirstlane_b32 s11, v7
    s_add_u32 s12, m0, 12288
    s_add_u32 s9, s9, 774144
    s_and_b32 s80, s10, 3
    s_cbranch_scc0 L_addr
L_aj:
    s_lshr_b32 s80, s11, 8
    ds_read_b32 v7, v3 offset:44
    s_cmp_gt_u32 s80, s10
    s_cbranch_scc0 L_full
    s_and_b32 s15, s11, 255
    s_cmp_ge_i32 s15, 26
    s_cbranch_scc1 L_t_26_36
    s_cmp_ge_i32 s15, 21
    s_cbranch_scc1 L_t_21_25
    s_cmp_ge_i32 s15, 18
    s_cbranch_scc1 L_t_18_20
    s_cmp_ge_i32 s15, 17
    s_cbranch_scc1 L_v17
    s_branch L_v16
L_t_18_20:
    s_cmp_ge_i32 s15, 19
    s_cbranch_scc1 L_t_19_20
    s_branch L_v18
L_t_19_20:
    s_cmp_ge_i32 s15, 20
    s_cbranch_scc1 L_v20
    s_branch L_v19
L_t_21_25:
    s_cmp_ge_i32 s15, 23
    s_cbranch_scc1 L_t_23_25
    s_cmp_ge_i32 s15, 22
    s_cbranch_scc1 L_v22
    s_branch L_v21
L_t_23_25:
    s_cmp_ge_i32 s15, 24
    s_cbranch_scc1 L_t_24_25
    s_branch L_v23
L_t_24_25:
    s_cmp_ge_i32 s15, 25
    s_cbranch_scc1 L_v25
    s_branch L_v24
L_t_26_36:
    s_cmp_ge_i32 s15, 31
    s_cbranch_scc1 L_t_31_36
    s_cmp_ge_i32 s15, 28
    s_cbranch_scc1 L_t_28_30
    s_cmp_ge_i32 s15, 27
    s_cbranch_scc1 L_v27
    s_branch L_v26
L_t_28_30:
    s_cmp_ge_i32 s15, 29
    s_cbranch_scc1 L_t_29_30
    s_branch L_v28
L_t_29_30:
    s_cmp_ge_i32 s15, 30
    s_cbranch_scc1 L_v30
    s_branch L_v29
L_t_31_36:
    s_cmp_ge_i32 s15, 34
    s_cbranch_scc1 L_t_34_36
    s_cmp_ge_i32 s15, 32
    s_cbranch_scc1 L_t_32_33
    s_branch L_v31
L_t_32_33:
    s_cmp_ge_i32 s15, 33
    s_cbranch_scc1 L_v33
    s_branch L_v32
L_t_34_36:
    s_cmp_ge_i32 s15, 35
    s_cbranch_scc1 L_t_35_36
    s_branch L_v34
L_t_35_36:
    s_cmp_ge_i32 s15, 36
    s_cbranch_scc1 L_v36
    s_branch L_v35
L_v16:
    s_waitcnt vmcnt(15)
    buffer_load_dwordx4 v2, s[4:7], s9 offen offset:0 nt lds
    s_waitcnt vmcnt(15)
    buffer_load_dwordx4 v2, s[4:7], s9 offen offset:1024 nt lds
    s_waitcnt vmcnt(15)
    buffer_load_dwordx4 v2, s[4:7], s9 offen offset:2048 nt lds
    v_subrev_u32 v6, 13, v5
    s_add_u32 m0, m0, 3072
    ds_write_b32 v3, v6 offset:16
    v_add_u32 v5, 3, v5
    s_add_u32 s9, s9, 3072
    s_cmp_lg_u32 m0, s12
    s_cbranch_scc1 L_v16
    s_branch L_next
L_v17:
    s_waitcnt vmcnt(16)
    buffer_load_dwordx4 v2, s[4:7], s9 offen offset:0 nt lds
    s_waitcnt vmcnt(16)
    buffer_load_dwordx4 v2, s[4:7], s9 offen offset:1024 nt lds
    s_waitcnt vmcnt(16)
    buffer_load_dwordx4 v2, s[4:7], s9 offen offset:2048 nt lds
    v_subrev_u32 v6, 14, v5
    s_add_u32 m0, m0, 3072
    ds_write_b32 v3, v6 offset:16
    v_add_u32 v5, 3, v5
    s_add_u32 s9, s9, 3072
    s_cmp_lg_u32 m0, s12
    s_cbranch_scc1 L_v17
    s_branch L_next
L_v18:
    s_waitcnt vmcnt(17)
    buffer_load_dwordx4 v2, s[4:7], s9 offen offset:0 nt lds
    s_waitcnt vmcnt(17)
    buffer_load_dwordx4 v2, s[4:7], s9 offen offset:1024 nt lds
    s_waitcnt vmcnt(17)
    buffer_load_dwordx4 v2, s[4:7], s9 offen offset:2048 nt lds
    v_subrev_u32 v6, 15, v5
    s_add_u32 m0, m0, 3072
    ds_write_b32 v3, v6 offset:16
    v_add_u32 v5, 3, v5
    s_add_u32 s9, s9, 3072
    s_cmp_lg_u32 m0, s12
    s_cbranch_scc1 L_v18
    s_branch L_next
L_v19:
    s_waitcnt vmcnt(18)
    buffer_load_dwordx4 v2, s[4:7], s9 offen offset:0 nt lds
    s_waitcnt vmcnt(18)
    buffer_load_dwordx4 v2, s[4:7], s9 offen offset:1024 nt lds
    s_waitcnt vmcnt(18)
    buffer_load_dwordx4 v2, s[4:7], s9 offen offset:2048 nt lds
    v_subrev_u32 v6, 16, v5
    s_add_u32 m0, m0, 3072
    ds_write_b32 v3, v6 offset:16
    v_add_u32 v5, 3, v5
    s_add_u32 s9, s9, 3072
    s_cmp_lg_u32 m0, s12
    s_cbranch_scc1 L_v19
    s_branch L_next
L_v20:
    s_waitcnt vmcnt(19)
    buffer_load_dwordx4 v2, s[4:7], s9 offen offset:0 nt lds
    s_waitcnt vmcnt(19)
    buffer_load_dwordx4 v2, s[4:7], s9 offen offset:1024 nt lds
    s_waitcnt vmcnt(19)
    buffer_load_dwordx4 v2, s[4:7], s9 offen offset:2048 nt lds
    v_subrev_u32 v6, 17, v5
    s_add_u32 m0, m0, 3072
    ds_write_b32 v3, v6 offset:16
    v_add_u32 v5, 3, v5
    s_add_u32 s9, s9, 3072
    s_cmp_lg_u32 m0, s12
    s_cbranch_scc1 L_v20
    s_branch L_next
L_v21:
    s_waitcnt vmcnt(20)
    buffer_load_dwordx4 v2, s[4:7], s9 offen offset:0 nt lds
    s_waitcnt vmcnt(20)
    buffer_load_dwordx4 v2, s[4:7], s9 offen offset:1024 nt lds
    s_waitcnt vmcnt(20)
    buffer_load_dwordx4 v2, s[4:7], s9 offen offset:2048 nt lds
    v_subrev_u32 v6, 18, v5
    s_add_u32 m0, m0, 3072
    ds_write_b32 v3, v6 offset:16
    v_add_u32 v5, 3, v5
    s_add_u32 s9, s9, 3072
    s_cmp_lg_u32 m0, s12
    s_cbranch_scc1 L_v21
    s_branch L_next
L_v22:
    s_waitcnt vmcnt(21)
    buffer_load_dwordx4 v2, s[4:7], s9 offen offset:0 nt lds
    s_waitcnt vmcnt(21)
    buffer_load_dwordx4 v2, s[4:7], s9 offen offset:1024 nt lds
    s_waitcnt vmcnt(21)
    buffer_load_dwordx4 v2, s[4:7], s9 offen offset:2048 nt lds
    v_subrev_u32 v6, 19, v5
    s_add_u32 m0, m0, 3072
    ds_write_b32 v3, v6 offset:16
    v_add_u32 v5, 3, v5
    s_add_u32 s9, s9, 3072
    s_cmp_lg_u32 m0, s12
    s_cbranch_scc1 L_v22
    s_branch L_next
L_v23:
    s_waitcnt vmcnt(22)
    buffer_load_dwordx4 v2, s[4:7], s9 offen offset:0 nt lds
    s_waitcnt vmcnt(22)
    buffer_load_dwordx4 v2, s[4:7], s9 offen offset:1024 nt lds
    s_waitcnt vmcnt(22)
    buffer_load_dwordx4 v2, s[4:7], s9 offen offset:2048 nt lds
    v_subrev_u32 v6, 20, v5
    s_add_u32 m0, m0, 3072
    ds_write_b32 v3, v6 offset:16
    v_add_u32 v5, 3, v5
    s_add_u32 s9, s9, 3072
    s_cmp_lg_u32 m0, s12
    s_cbranch_scc1 L_v23
    s_branch L_next
L_v24:
    s_waitcnt vmcnt(23)
    buffer_load_dwordx4 v2, s[4:7], s9 offen offset:0 nt lds
    s_waitcnt vmcnt(23)
    buffer_load_dwordx4 v2, s[4:7], s9 offen offset:1024 nt lds
    s_waitcnt vmcnt(23)
    buffer_load_dwordx4 v2, s[4:7], s9 offen offset:2048 nt lds
    v_subrev_u32 v6, 21, v5
    s_add_u32 m0, m0, 3072
    ds_write_b32 v3, v6 offset:16
    v_add_u32 v5, 3, v5
    s_add_u32 s9, s9, 3072
    s_cmp_lg_u32 m0, s12
    s_cbranch_scc1 L_v24
    s_branch L_next
L_v25:
    s_waitcnt vmcnt(24)
    buffer_load_dwordx4 v2, s[4:7], s9 offen offset:0 nt lds
    s_waitcnt vmcnt(24)
    buffer_load_dwordx4 v2, s[4:7], s9 offen offset:1024 nt lds
    s_waitcnt vmcnt(24)
    buffer_load_dwordx4 v2, s[4:7], s9 offen offset:2048 nt lds
    v_subrev_u32 v6, 22, v5
    s_add_u32 m0, m0, 3072
    ds_write_b32 v3, v6 offset:16
    v_add_u32 v5, 3, v5
    s_add_u32 s9, s9, 3072
    s_cmp_lg_u32 m0, s12
    s_cbranch_scc1 L_v25
    s_branch L_next
L_v26:
    s_waitcnt vmcnt(25)
    buffer_load_dwordx4 v2, s[4:7], s9 offen offset:0 nt lds
    s_waitcnt vmcnt(25)
    buffer_load_dwordx4 v2, s[4:7], s9 offen offset:1024 nt lds
    s_waitcnt vmcnt(25)
    buffer_load_dwordx4 v2, s[4:7], s9 offen offset:2048 nt lds
    v_subrev_u32 v6, 23, v5
    s_add_u32 m0, m0, 3072
    ds_write_b32 v3, v6 offset:16
    v_add_u32 v5, 3, v5
    s_add_u32 s9, s9, 3072
    s_cmp_lg_u32 m0, s12
    s_cbranch_scc1 L_v26
    s_branch L_next
L_v27:
    s_waitcnt vmcnt(26)
    buffer_load_dwordx4 v2, s[4:7], s9 offen offset:0 nt lds
    s_waitcnt vmcnt(26)
    buffer_load_dwordx4 v2, s[4:7], s9 offen offset:1024 nt lds
    s_waitcnt vmcnt(26)
    buffer_load_dwordx4 v2, s[4:7], s9 offen offset:2048 nt lds
    v_subrev_u32 v6, 24, v5
    s_add_u32 m0, m0, 3072
    ds_write_b32 v3, v6 offset:16
    v_add_u32 v5, 3, v5
    s_add_u32 s9, s9, 3072
    s_cmp_lg_u32 m0, s12
    s_cbranch_scc1 L_v27
    s_branch L_next
L_v28:
    s_waitcnt vmcnt(27)
    buffer_load_dwordx4 v2, s[4:7], s9 offen offset:0 nt lds
    s_waitcnt vmcnt(27)
    buffer_load_dwordx4 v2, s[4:7], s9 offen offset:1024 nt lds
    s_waitcnt vmcnt(27)
    buffer_load_dwordx4 v2, s[4:7], s9 offen offset:2048 nt lds
    v_subrev_u32 v6, 25, v5
    s_add_u32 m0, m0, 3072
    ds_write_b32 v3, v6 offset:16
    v_add_u32 v5, 3, v5
    s_add_u32 s9, s9, 3072
    s_cmp_lg_u32 m0, s12
    s_cbranch_scc1 L_v28
    s_branch L_next
L_v29:
    s_waitcnt vmcnt(28)
    buffer_load_dwordx4 v2, s[4:7], s9 offen offset:0 nt lds
    s_waitcnt vmcnt(28)
    buffer_load_dwordx4 v2, s[4:7], s9 offen offset:1024 nt lds
    s_waitcnt vmcnt(28)
    buffer_load_dwordx4 v2, s[4:7], s9 offen offset:2048 nt lds
    v_subrev_u32 v6, 26, v5
    s_add_u32 m0, m0, 3072
    ds_write_b32 v3, v6 offset:16
    v_add_u32 v5, 3, v5
    s_add_u32 s9, s9, 3072
    s_cmp_lg_u32 m0, s12
    s_cbranch_scc1 L_v29
    s_branch L_next
L_v30:
    s_waitcnt vmcnt(29)
    buffer_load_dwordx4 v2, s[4:7], s9 offen offset:0 nt lds
    s_waitcnt vmcnt(29)
    buffer_load_dwordx4 v2, s[4:7], s9 offen offset:1024 nt lds
    s_waitcnt vmcnt(29)
    buffer_load_dwordx4 v2, s[4:7], s9 offen offset:2048 nt lds
    v_subrev_u32 v6, 27, v5
    s_add_u32 m0, m0, 3072
    ds_write_b32 v3, v6 offset:16
    v_add_u32 v5, 3, v5
    s_add_u32 s9, s9, 3072
    s_cmp_lg_u32 m0, s12
    s_cbranch_scc1 L_v30
    s_branch L_next
L_v31:
    s_waitcnt vmcnt(30)
    buffer_load_dwordx4 v2, s[4:7], s9 offen offset:0 nt lds
    s_waitcnt vmcnt(30)
    buffer_load_dwordx4 v2, s[4:7], s9 offen offset:1024 nt lds
    s_waitcnt vmcnt(30)
    buffer_load_dwordx4 v2, s[4:7], s9 offen offset:2048 nt lds
    v_subrev_u32 v6, 28, v5
    s_add_u32 m0, m0, 3072
    ds_write_b32 v3, v6 offset:16
    v_add_u32 v5, 3, v5
    s_add_u32 s9, s9, 3072
    s_cmp_lg_u32 m0, s12
    s_cbranch_scc1 L_v31
    s_branch L_next
L_v32:
    s_waitcnt vmcnt(31)
    buffer_load_dwordx4 v2, s[4:7], s9 offen offset:0 nt lds
    s_waitcnt vmcnt(31)
    buffer_load_dwordx4 v2, s[4:7], s9 offen offset:1024 nt lds
    s_waitcnt vmcnt(31)
    buffer_load_dwordx4 v2, s[4:7], s9 offen offset:2048 nt lds
    v_subrev_u32 v6, 29, v5
    s_add_u32 m0, m0, 3072
    ds_write_b32 v3, v6 offset:16
    v_add_u32 v5, 3, v5
    s_add_u32 s9, s9, 3072
    s_cmp_lg_u32 m0, s12
    s_cbranch_scc1 L_v32
    s_branch L_next
L_v33:
    s_waitcnt vmcnt(32)
    buffer_load_dwordx4 v2, s[4:7], s9 offen offset:0 nt lds
    s_waitcnt vmcnt(32)
    buffer_load_dwordx4 v2, s[4:7], s9 offen offset:1024 nt lds
    s_waitcnt vmcnt(32)
    buffer_load_dwordx4 v2, s[4:7], s9 offen offset:2048 nt lds
    v_subrev_u32 v6, 30, v5
    s_add_u32 m0, m0, 3072
    ds_write_b32 v3, v6 offset:16
    v_add_u32 v5, 3, v5
    s_add_u32 s9, s9, 3072
    s_cmp_lg_u32 m0, s12
    s_cbranch_scc1 L_v33
    s_branch L_next
L_v34:
    s_waitcnt vmcnt(33)
    buffer_load_dwordx4 v2, s[4:7], s9 offen offset:0 nt lds
    s_waitcnt vmcnt(33)
    buffer_load_dwordx4 v2, s[4:7], s9 offen offset:1024 nt lds
    s_waitcnt vmcnt(33)
    buffer_load_dwordx4 v2, s[4:7], s9 offen offset:2048 nt lds
    v_subrev_u32 v6, 31, v5
    s_add_u32 m0, m0, 3072
    ds_write_b32 v3, v6 offset:16
    v_add_u32 v5, 3, v5
    s_add_u32 s9, s9, 3072
    s_cmp_lg_u32 m0, s12
    s_cbranch_scc1 L_v34
    s_branch L_next
L_v35:
    s_waitcnt vmcnt(34)
    buffer_load_dwordx4 v2, s[4:7], s9 offen offset:0 nt lds
    s_waitcnt vmcnt(34)
    buffer_load_dwordx4 v2, s[4:7], s9 offen offset:1024 nt lds
    s_waitcnt vmcnt(34)
    buffer_load_dwordx4 v2, s[4:7], s9 offen offset:2048 nt lds
    v_subrev_u32 v6, 32, v5
    s_add_u32 m0, m0, 3072
    ds_write_b32 v3, v6 offset:16
    v_add_u32 v5, 3, v5
    s_add_u32 s9, s9, 3072
    s_cmp_lg_u32 m0, s12
    s_cbranch_scc1 L_v35
    s_branch L_next
L_v36:
    s_waitcnt vmcnt(35)
    buffer_load_dwordx4 v2, s[4:7], s9 offen offset:0 nt lds
    s_waitcnt vmcnt(35)
    buffer_load_dwordx4 v2, s[4:7], s9 offen offset:1024 nt lds
    s_waitcnt vmcnt(35)
    buffer_load_dwordx4 v2, s[4:7], s9 offen offset:2048 nt lds
    v_subrev_u32 v6, 33, v5
    s_add_u32 m0, m0, 3072
    ds_write_b32 v3, v6 offset:16
    v_add_u32 v5, 3, v5
    s_add_u32 s9, s9, 3072
    s_cmp_lg_u32 m0, s12
    s_cbranch_scc1 L_v36
    s_branch L_next
L_full:
    s_waitcnt lgkmcnt(0)
    v_readfirstlane_b32 s11, v7
    s_nop 4
    s_branch L_aj
L_addr:
    s_cmp_lt_u32 s10, 128
    s_cbranch_scc0 L_av
    s_lshr_b32 s80, s10, 5
    s_lshl_b32 s80, s80, 2
    s_add_u32 s80, s80, s16
    s_bfe_u32 s81, s10, 0x30002
    s_bitcmp1_b32 s10, 5
    s_cselect_b32 s82, 7, 0
    s_xor_b32 s81, s81, s82
    s_branch L_ak
L_av:
    s_cmp_eq_u32 s10, 256
    s_cbranch_scc1 L_drain
    s_mov_b32 s4, s56
    s_mov_b32 s5, s57
    s_add_u32 s80, s10, s17
    s_bfe_u32 s81, s10, 0x30004
    s_xor_b32 s81, s81, 7
L_ak:
    s_and_b32 s80, s80, 15
    s_mul_i32 s80, s80, 786432
    s_mul_i32 s81, s81, 50331648
    s_add_u32 s9, s80, s81
    s_add_u32 s9, s9, s8
    s_branch L_aj
L_drain:
    v_mov_b32 v6, 3048
    s_waitcnt vmcnt(24)
    ds_write_b32 v3, v6 offset:16
    v_mov_b32 v6, 3060
    s_waitcnt vmcnt(12)
    ds_write_b32 v3, v6 offset:16
    v_mov_b32 v6, 3072
    s_waitcnt vmcnt(0)
    ds_write_b32 v3, v6 offset:16
    s_endpgm
L_notld:
    s_cmp_gt_u32 s76, 4
    s_cbranch_scc1 L_aux
    v_lshrrev_b32 v21, 4, v1
    v_and_b32 v22, 15, v1
    v_mul_u32_u24 v16, 384, v21
    v_lshl_add_u32 v16, v22, 3, v16
    v_cmp_gt_u32 vcc, 8, v22
    v_xor_b32 v17, 64, v16
    s_mul_i32 s24, s77, 4
    s_and_b32 s24, s24, 15
    s_lshl_b32 s80, s78, 2
    s_add_u32 s80, s80, s76
    s_mul_i32 s83, s80, 1536
    s_mul_i32 s16, s24, 393216
    s_add_u32 s16, s16, s83
    s_waitcnt lgkmcnt(0)
    s_mov_b32 s4, s66
    s_mov_b32 s5, s67
    s_mov_b32 s6, 6291456
    s_mov_b32 s7, 0x20000
    s_mov_b32 s8, s68
    s_mov_b32 s9, s69
    s_mov_b32 s10, 6291456
    s_mov_b32 s11, 0x20000
    buffer_load_dwordx2 v[120:121], v16, s[4:7], s16 offen offset:0
    buffer_load_dwordx2 v[126:127], v17, s[8:11], s16 offen offset:0
    buffer_load_dwordx2 v[122:123], v16, s[4:7], s16 offen offset:128
    buffer_load_dwordx2 v[128:129], v17, s[8:11], s16 offen offset:128
    buffer_load_dwordx2 v[124:125], v16, s[4:7], s16 offen offset:256
    buffer_load_dwordx2 v[130:131], v17, s[8:11], s16 offen offset:256
    s_add_u32 s16, s16, 393216
    buffer_load_dwordx2 v[132:133], v16, s[4:7], s16 offen offset:0
    buffer_load_dwordx2 v[138:139], v17, s[8:11], s16 offen offset:0
    buffer_load_dwordx2 v[134:135], v16, s[4:7], s16 offen offset:128
    buffer_load_dwordx2 v[140:141], v17, s[8:11], s16 offen offset:128
    buffer_load_dwordx2 v[136:137], v16, s[4:7], s16 offen offset:256
    buffer_load_dwordx2 v[142:143], v17, s[8:11], s16 offen offset:256
    s_add_u32 s16, s16, 393216
    buffer_load_dwordx2 v[144:145], v16, s[4:7], s16 offen offset:0
    buffer_load_dwordx2 v[150:151], v17, s[8:11], s16 offen offset:0
    buffer_load_dwordx2 v[146:147], v16, s[4:7], s16 offen offset:128
    buffer_load_dwordx2 v[152:153], v17, s[8:11], s16 offen offset:128
    buffer_load_dwordx2 v[148:149], v16, s[4:7], s16 offen offset:256
    buffer_load_dwordx2 v[154:155], v17, s[8:11], s16 offen offset:256
    s_add_u32 s16, s16, 393216
    buffer_load_dwordx2 v[156:157], v16, s[4:7], s16 offen offset:0
    buffer_load_dwordx2 v[162:163], v17, s[8:11], s16 offen offset:0
    buffer_load_dwordx2 v[158:159], v16, s[4:7], s16 offen offset:128
    buffer_load_dwordx2 v[164:165], v17, s[8:11], s16 offen offset:128
    buffer_load_dwordx2 v[160:161], v16, s[4:7], s16 offen offset:256
    buffer_load_dwordx2 v[166:167], v17, s[8:11], s16 offen offset:256
    s_add_u32 s16, s16, 393216
    s_mov_b32 s12, s74
    s_mov_b32 s13, s75
    s_mov_b32 s14, 1610612736
    s_mov_b32 s15, 0x20000
    s_mov_b32 s22, 0x05040100
    s_mov_b32 s23, 0x07060302
    s_lshl_b32 s80, s76, 2
    v_add_u32 v21, s80, v21
    v_mul_u32_u24 v5, 768, v21
    v_lshl_add_u32 v5, v22, 4, v5
    v_lshlrev_b32 v19, 3, v21
    v_add_u32 v19, 126976, v19
    v_lshlrev_b32 v18, 4, v22
    v_add_u32 v18, 151552, v18
    v_add_u32 v11, s80, v3
    v_mov_b32 v10, 0
    v_mov_b32 v23, 0xff
    s_mul_i32 s17, s76, 3
    s_add_u32 s17, s17, 3
    s_mov_b32 s18, 0
    s_mov_b32 s19, 0
    s_mov_b32 s20, 0
    s_mov_b32 s21, 0
    s_barrier
    s_waitcnt vmcnt(18)
    v_cndmask_b32 v24, v130, v128, vcc
    v_cndmask_b32 v25, v131, v129, vcc
    v_cndmask_b32 v26, v126, v130, vcc
    v_cndmask_b32 v27, v127, v131, vcc
    v_cndmask_b32 v28, v128, v126, vcc
    v_cndmask_b32 v29, v129, v127, vcc
    v_perm_b32 v72, v24, v120, s22
    v_perm_b32 v73, v24, v120, s23
    v_perm_b32 v74, v25, v121, s22
    v_perm_b32 v75, v25, v121, s23
    v_perm_b32 v76, v26, v122, s22
    v_perm_b32 v77, v26, v122, s23
    v_perm_b32 v78, v27, v123, s22
    v_perm_b32 v79, v27, v123, s23
    v_perm_b32 v80, v28, v124, s22
    v_perm_b32 v81, v28, v124, s23
    v_perm_b32 v82, v29, v125, s22
    v_perm_b32 v83, v29, v125, s23
    s_waitcnt vmcnt(12)
    v_cndmask_b32 v24, v142, v140, vcc
    v_cndmask_b32 v25, v143, v141, vcc
    v_cndmask_b32 v26, v138, v142, vcc
    v_cndmask_b32 v27, v139, v143, vcc
    v_cndmask_b32 v28, v140, v138, vcc
    v_cndmask_b32 v29, v141, v139, vcc
    v_perm_b32 v84, v24, v132, s22
    v_perm_b32 v85, v24, v132, s23
    v_perm_b32 v86, v25, v133, s22
    v_perm_b32 v87, v25, v133, s23
    v_perm_b32 v88, v26, v134, s22
    v_perm_b32 v89, v26, v134, s23
    v_perm_b32 v90, v27, v135, s22
    v_perm_b32 v91, v27, v135, s23
    v_perm_b32 v92, v28, v136, s22
    v_perm_b32 v93, v28, v136, s23
    v_perm_b32 v94, v29, v137, s22
    v_perm_b32 v95, v29, v137, s23
    s_waitcnt vmcnt(6)
    v_cndmask_b32 v24, v154, v152, vcc
    v_cndmask_b32 v25, v155, v153, vcc
    v_cndmask_b32 v26, v150, v154, vcc
    v_cndmask_b32 v27, v151, v155, vcc
    v_cndmask_b32 v28, v152, v150, vcc
    v_cndmask_b32 v29, v153, v151, vcc
    v_perm_b32 v96, v24, v144, s22
    v_perm_b32 v97, v24, v144, s23
    v_perm_b32 v98, v25, v145, s22
    v_perm_b32 v99, v25, v145, s23
    v_perm_b32 v100, v26, v146, s22
    v_perm_b32 v101, v26, v146, s23
    v_perm_b32 v102, v27, v147, s22
    v_perm_b32 v103, v27, v147, s23
    v_perm_b32 v104, v28, v148, s22
    v_perm_b32 v105, v28, v148, s23
    v_perm_b32 v106, v29, v149, s22
    v_perm_b32 v107, v29, v149, s23
    s_waitcnt vmcnt(0)
    v_cndmask_b32 v24, v166, v164, vcc
    v_cndmask_b32 v25, v167, v165, vcc
    v_cndmask_b32 v26, v162, v166, vcc
    v_cndmask_b32 v27, v163, v167, vcc
    v_cndmask_b32 v28, v164, v162, vcc
    v_cndmask_b32 v29, v165, v163, vcc
    v_perm_b32 v108, v24, v156, s22
    v_perm_b32 v109, v24, v156, s23
    v_perm_b32 v110, v25, v157, s22
    v_perm_b32 v111, v25, v157, s23
    v_perm_b32 v112, v26, v158, s22
    v_perm_b32 v113, v26, v158, s23
    v_perm_b32 v114, v27, v159, s22
    v_perm_b32 v115, v27, v159, s23
    v_perm_b32 v116, v28, v160, s22
    v_perm_b32 v117, v28, v160, s23
    v_perm_b32 v118, v29, v161, s22
    v_perm_b32 v119, v29, v161, s23
    s_nop 1
L_kvisit:
    s_and_b32 s80, s20, 1
    s_cselect_b32 s80, 4, s21
    s_cmp_lt_u32 s80, 3
    s_cbranch_scc0 L_nocs
    s_cmp_ge_u32 s16, 6291456
    s_cselect_b32 s80, 6291456, 0
    s_sub_u32 s16, s16, s80
    buffer_load_dwordx2 v[60:61], v16, s[4:7], s16 offen offset:0
    buffer_load_dwordx2 v[66:67], v17, s[8:11], s16 offen offset:0
    buffer_load_dwordx2 v[62:63], v16, s[4:7], s16 offen offset:128
    buffer_load_dwordx2 v[68:69], v17, s[8:11], s16 offen offset:128
    buffer_load_dwordx2 v[64:65], v16, s[4:7], s16 offen offset:256
    buffer_load_dwordx2 v[70:71], v17, s[8:11], s16 offen offset:256
    s_add_u32 s16, s16, 393216
L_nocs:
    s_bitcmp1_b32 s21, 0
    s_cselect_b32 s82, 7, 0
    s_xor_b32 s82, s82, s20
    s_mul_i32 s80, s82, 768
    v_add_u32 v6, s80, v18
    s_lshl_b32 s80, s82, 4
    s_add_u32 s80, s80, s24
    s_lshl_b32 s81, s80, 7
    v_add_u32 v8, s81, v19
    s_nop 1
L_qw:
    ds_read_b32 v4, v3 offset:32
    ds_read_b128 v[48:51], v6 offset:0
    ds_read_b128 v[52:55], v6 offset:256
    ds_read_b128 v[56:59], v6 offset:512
    s_waitcnt lgkmcnt(0)
    v_readfirstlane_b32 s80, v4
    s_nop 0
    s_cmp_gt_u32 s80, s82
    s_nop 2
    s_cbranch_scc1 L_qwg
    s_sleep 2
    s_branch L_qw
L_qwg:
    v_dot2_f32_bf16 v24, v72, v48, 0
    v_dot2_f32_bf16 v25, v73, v49, 0
    v_dot2_f32_bf16 v26, v74, v50, 0
    v_dot2_f32_bf16 v27, v75, v51, 0
    v_dot2_f32_bf16 v28, v76, v52, 0
    v_dot2_f32_bf16 v29, v77, v53, 0
    v_dot2_f32_bf16 v30, v78, v54, 0
    v_dot2_f32_bf16 v31, v79, v55, 0
    v_dot2_f32_bf16 v32, v80, v56, 0
    v_dot2_f32_bf16 v33, v81, v57, 0
    v_dot2_f32_bf16 v34, v82, v58, 0
    v_dot2_f32_bf16 v35, v83, v59, 0
    v_add_u32 v6, s19, v5
    v_pk_add_f32 v[14:15], v[24:25], v[26:27]
    v_pk_add_f32 v[14:15], v[14:15], v[28:29]
    v_pk_add_f32 v[14:15], v[14:15], v[30:31]
    v_pk_add_f32 v[14:15], v[14:15], v[32:33]
    v_pk_add_f32 v[14:15], v[14:15], v[34:35]
    s_cmp_ge_i32 s18, s17
    s_nop 0
    s_cbranch_scc1 L_kw0g
L_kw0:
    ds_read_b32 v4, v3 offset:16
    s_waitcnt lgkmcnt(0)
    v_readfirstlane_b32 s18, v4
    s_nop 0
    s_cmp_ge_i32 s18, s17
    s_nop 2
    s_cbranch_scc1 L_kw0g
    s_sleep 1
    s_branch L_kw0
L_kw0g:
    ds_read_b128 v[36:39], v6 offset:0
    ds_read_b128 v[40:43], v6 offset:256
    ds_read_b128 v[44:47], v6 offset:512
    v_add_u32 v10, 1, v10
    s_add_u32 s19, s19, 12288
    s_cmp_eq_u32 s19, 110592
    s_cselect_b32 s19, 0, s19
    s_add_u32 s17, s17, 12
    s_waitcnt lgkmcnt(2)
    v_cvt_f32_i32 v36, v36
    v_cvt_f32_i32 v37, v37
    v_cvt_f32_i32 v38, v38
    v_cvt_f32_i32 v39, v39
    v_pk_mul_f32 v[12:13], v[36:37], v[24:25]
    v_pk_fma_f32 v[12:13], v[38:39], v[26:27], v[12:13]
    s_waitcnt lgkmcnt(1)
    v_cvt_f32_i32 v40, v40
    v_cvt_f32_i32 v41, v41
    v_cvt_f32_i32 v42, v42
    v_cvt_f32_i32 v43, v43
    v_pk_fma_f32 v[12:13], v[40:41], v[28:29], v[12:13]
    v_pk_fma_f32 v[12:13], v[42:43], v[30:31], v[12:13]
    s_waitcnt lgkmcnt(0)
    v_cvt_f32_i32 v44, v44
    v_cvt_f32_i32 v45, v45
    v_cvt_f32_i32 v46, v46
    v_cvt_f32_i32 v47, v47
    v_pk_fma_f32 v[12:13], v[44:45], v[32:33], v[12:13]
    v_pk_fma_f32 v[12:13], v[46:47], v[34:35], v[12:13]
    v_add_f32 v12, v12, v13
    v_add_f32 v13, v14, v15
    s_nop 0
    v_add_f32_dpp v12, v12, v12 quad_perm:[1,0,3,2] row_mask:0xf bank_mask:0xf
    v_add_f32_dpp v13, v13, v13 quad_perm:[1,0,3,2] row_mask:0xf bank_mask:0xf
    s_nop 0
    v_add_f32_dpp v12, v12, v12 quad_perm:[2,3,0,1] row_mask:0xf bank_mask:0xf
    v_add_f32_dpp v13, v13, v13 quad_perm:[2,3,0,1] row_mask:0xf bank_mask:0xf
    s_nop 0
    v_add_f32_dpp v12, v12, v12 row_half_mirror row_mask:0xf bank_mask:0xf
    v_add_f32_dpp v13, v13, v13 row_half_mirror row_mask:0xf bank_mask:0xf
    s_nop 0
    v_add_f32_dpp v12, v12, v12 row_mirror row_mask:0xf bank_mask:0xf
    v_add_f32_dpp v13, v13, v13 row_mirror row_mask:0xf bank_mask:0xf
    ds_write_b64 v8, v[12:13] offset:0
    ds_write_b32 v11, v10
    v_dot2_f32_bf16 v24, v84, v48, 0
    v_dot2_f32_bf16 v25, v85, v49, 0
    v_dot2_f32_bf16 v26, v86, v50, 0
    v_dot2_f32_bf16 v27, v87, v51, 0
    v_dot2_f32_bf16 v28, v88, v52, 0
    v_dot2_f32_bf16 v29, v89, v53, 0
    v_dot2_f32_bf16 v30, v90, v54, 0
    v_dot2_f32_bf16 v31, v91, v55, 0
    v_dot2_f32_bf16 v32, v92, v56, 0
    v_dot2_f32_bf16 v33, v93, v57, 0
    v_dot2_f32_bf16 v34, v94, v58, 0
    v_dot2_f32_bf16 v35, v95, v59, 0
    v_add_u32 v6, s19, v5
    v_pk_add_f32 v[14:15], v[24:25], v[26:27]
    v_pk_add_f32 v[14:15], v[14:15], v[28:29]
    v_pk_add_f32 v[14:15], v[14:15], v[30:31]
    v_pk_add_f32 v[14:15], v[14:15], v[32:33]
    v_pk_add_f32 v[14:15], v[14:15], v[34:35]
    s_cmp_ge_i32 s18, s17
    s_nop 0
    s_cbranch_scc1 L_kw1g
L_kw1:
    ds_read_b32 v4, v3 offset:16
    s_waitcnt lgkmcnt(0)
    v_readfirstlane_b32 s18, v4
    s_nop 0
    s_cmp_ge_i32 s18, s17
    s_nop 2
    s_cbranch_scc1 L_kw1g
    s_sleep 1
    s_branch L_kw1
L_kw1g:
    ds_read_b128 v[36:39], v6 offset:0
    ds_read_b128 v[40:43], v6 offset:256
    ds_read_b128 v[44:47], v6 offset:512
    v_add_u32 v10, 1, v10
    s_add_u32 s19, s19, 12288
    s_cmp_eq_u32 s19, 110592
    s_cselect_b32 s19, 0, s19
    s_add_u32 s17, s17, 12
    s_waitcnt lgkmcnt(2)
    v_cvt_f32_i32 v36, v36
    v_cvt_f32_i32 v37, v37
    v_cvt_f32_i32 v38, v38
    v_cvt_f32_i32 v39, v39
    v_pk_mul_f32 v[12:13], v[36:37], v[24:25]
    v_pk_fma_f32 v[12:13], v[38:39], v[26:27], v[12:13]
    s_waitcnt lgkmcnt(1)
    v_cvt_f32_i32 v40, v40
    v_cvt_f32_i32 v41, v41
    v_cvt_f32_i32 v42, v42
    v_cvt_f32_i32 v43, v43
    v_pk_fma_f32 v[12:13], v[40:41], v[28:29], v[12:13]
    v_pk_fma_f32 v[12:13], v[42:43], v[30:31], v[12:13]
    s_waitcnt lgkmcnt(0)
    v_cvt_f32_i32 v44, v44
    v_cvt_f32_i32 v45, v45
    v_cvt_f32_i32 v46, v46
    v_cvt_f32_i32 v47, v47
    v_pk_fma_f32 v[12:13], v[44:45], v[32:33], v[12:13]
    v_pk_fma_f32 v[12:13], v[46:47], v[34:35], v[12:13]
    v_add_f32 v12, v12, v13
    v_add_f32 v13, v14, v15
    s_nop 0
    v_add_f32_dpp v12, v12, v12 quad_perm:[1,0,3,2] row_mask:0xf bank_mask:0xf
    v_add_f32_dpp v13, v13, v13 quad_perm:[1,0,3,2] row_mask:0xf bank_mask:0xf
    s_nop 0
    v_add_f32_dpp v12, v12, v12 quad_perm:[2,3,0,1] row_mask:0xf bank_mask:0xf
    v_add_f32_dpp v13, v13, v13 quad_perm:[2,3,0,1] row_mask:0xf bank_mask:0xf
    s_nop 0
    v_add_f32_dpp v12, v12, v12 row_half_mirror row_mask:0xf bank_mask:0xf
    v_add_f32_dpp v13, v13, v13 row_half_mirror row_mask:0xf bank_mask:0xf
    s_nop 0
    v_add_f32_dpp v12, v12, v12 row_mirror row_mask:0xf bank_mask:0xf
    v_add_f32_dpp v13, v13, v13 row_mirror row_mask:0xf bank_mask:0xf
    ds_write_b64 v8, v[12:13] offset:128
    ds_write_b32 v11, v10
    v_dot2_f32_bf16 v24, v96, v48, 0
    v_dot2_f32_bf16 v25, v97, v49, 0
    v_dot2_f32_bf16 v26, v98, v50, 0
    v_dot2_f32_bf16 v27, v99, v51, 0
    v_dot2_f32_bf16 v28, v100, v52, 0
    v_dot2_f32_bf16 v29, v101, v53, 0
    v_dot2_f32_bf16 v30, v102, v54, 0
    v_dot2_f32_bf16 v31, v103, v55, 0
    v_dot2_f32_bf16 v32, v104, v56, 0
    v_dot2_f32_bf16 v33, v105, v57, 0
    v_dot2_f32_bf16 v34, v106, v58, 0
    v_dot2_f32_bf16 v35, v107, v59, 0
    v_add_u32 v6, s19, v5
    v_pk_add_f32 v[14:15], v[24:25], v[26:27]
    v_pk_add_f32 v[14:15], v[14:15], v[28:29]
    v_pk_add_f32 v[14:15], v[14:15], v[30:31]
    v_pk_add_f32 v[14:15], v[14:15], v[32:33]
    v_pk_add_f32 v[14:15], v[14:15], v[34:35]
    s_cmp_ge_i32 s18, s17
    s_nop 0
    s_cbranch_scc1 L_kw2g
L_kw2:
    ds_read_b32 v4, v3 offset:16
    s_waitcnt lgkmcnt(0)
    v_readfirstlane_b32 s18, v4
    s_nop 0
    s_cmp_ge_i32 s18, s17
    s_nop 2
    s_cbranch_scc1 L_kw2g
    s_sleep 1
    s_branch L_kw2
L_kw2g:
    ds_read_b128 v[36:39], v6 offset:0
    ds_read_b128 v[40:43], v6 offset:256
    ds_read_b128 v[44:47], v6 offset:512
    v_add_u32 v10, 1, v10
    s_add_u32 s19, s19, 12288
    s_cmp_eq_u32 s19, 110592
    s_cselect_b32 s19, 0, s19
    s_add_u32 s17, s17, 12
    s_waitcnt lgkmcnt(2)
    v_cvt_f32_i32 v36, v36
    v_cvt_f32_i32 v37, v37
    v_cvt_f32_i32 v38, v38
    v_cvt_f32_i32 v39, v39
    v_pk_mul_f32 v[12:13], v[36:37], v[24:25]
    v_pk_fma_f32 v[12:13], v[38:39], v[26:27], v[12:13]
    s_waitcnt lgkmcnt(1)
    v_cvt_f32_i32 v40, v40
    v_cvt_f32_i32 v41, v41
    v_cvt_f32_i32 v42, v42
    v_cvt_f32_i32 v43, v43
    v_pk_fma_f32 v[12:13], v[40:41], v[28:29], v[12:13]
    v_pk_fma_f32 v[12:13], v[42:43], v[30:31], v[12:13]
    s_waitcnt lgkmcnt(0)
    v_cvt_f32_i32 v44, v44
    v_cvt_f32_i32 v45, v45
    v_cvt_f32_i32 v46, v46
    v_cvt_f32_i32 v47, v47
    v_pk_fma_f32 v[12:13], v[44:45], v[32:33], v[12:13]
    v_pk_fma_f32 v[12:13], v[46:47], v[34:35], v[12:13]
    v_add_f32 v12, v12, v13
    v_add_f32 v13, v14, v15
    s_nop 0
    v_add_f32_dpp v12, v12, v12 quad_perm:[1,0,3,2] row_mask:0xf bank_mask:0xf
    v_add_f32_dpp v13, v13, v13 quad_perm:[1,0,3,2] row_mask:0xf bank_mask:0xf
    s_nop 0
    v_add_f32_dpp v12, v12, v12 quad_perm:[2,3,0,1] row_mask:0xf bank_mask:0xf
    v_add_f32_dpp v13, v13, v13 quad_perm:[2,3,0,1] row_mask:0xf bank_mask:0xf
    s_nop 0
    v_add_f32_dpp v12, v12, v12 row_half_mirror row_mask:0xf bank_mask:0xf
    v_add_f32_dpp v13, v13, v13 row_half_mirror row_mask:0xf bank_mask:0xf
    s_nop 0
    v_add_f32_dpp v12, v12, v12 row_mirror row_mask:0xf bank_mask:0xf
    v_add_f32_dpp v13, v13, v13 row_mirror row_mask:0xf bank_mask:0xf
    ds_write_b64 v8, v[12:13] offset:256
    ds_write_b32 v11, v10
    v_dot2_f32_bf16 v24, v108, v48, 0
    v_dot2_f32_bf16 v25, v109, v49, 0
    v_dot2_f32_bf16 v26, v110, v50, 0
    v_dot2_f32_bf16 v27, v111, v51, 0
    v_dot2_f32_bf16 v28, v112, v52, 0
    v_dot2_f32_bf16 v29, v113, v53, 0
    v_dot2_f32_bf16 v30, v114, v54, 0
    v_dot2_f32_bf16 v31, v115, v55, 0
    v_dot2_f32_bf16 v32, v116, v56, 0
    v_dot2_f32_bf16 v33, v117, v57, 0
    v_dot2_f32_bf16 v34, v118, v58, 0
    v_dot2_f32_bf16 v35, v119, v59, 0
    v_add_u32 v6, s19, v5
    v_pk_add_f32 v[14:15], v[24:25], v[26:27]
    v_pk_add_f32 v[14:15], v[14:15], v[28:29]
    v_pk_add_f32 v[14:15], v[14:15], v[30:31]
    v_pk_add_f32 v[14:15], v[14:15], v[32:33]
    v_pk_add_f32 v[14:15], v[14:15], v[34:35]
    s_cmp_ge_i32 s18, s17
    s_nop 0
    s_cbranch_scc1 L_kw3g
L_kw3:
    ds_read_b32 v4, v3 offset:16
    s_waitcnt lgkmcnt(0)
    v_readfirstlane_b32 s18, v4
    s_nop 0
    s_cmp_ge_i32 s18, s17
    s_nop 2
    s_cbranch_scc1 L_kw3g
    s_sleep 1
    s_branch L_kw3
L_kw3g:
    ds_read_b128 v[36:39], v6 offset:0
    ds_read_b128 v[40:43], v6 offset:256
    ds_read_b128 v[44:47], v6 offset:512
    v_add_u32 v10, 1, v10
    s_add_u32 s19, s19, 12288
    s_cmp_eq_u32 s19, 110592
    s_cselect_b32 s19, 0, s19
    s_add_u32 s17, s17, 12
    s_waitcnt lgkmcnt(2)
    v_cvt_f32_i32 v36, v36
    v_cvt_f32_i32 v37, v37
    v_cvt_f32_i32 v38, v38
    v_cvt_f32_i32 v39, v39
    v_pk_mul_f32 v[12:13], v[36:37], v[24:25]
    v_pk_fma_f32 v[12:13], v[38:39], v[26:27], v[12:13]
    s_waitcnt lgkmcnt(1)
    v_cvt_f32_i32 v40, v40
    v_cvt_f32_i32 v41, v41
    v_cvt_f32_i32 v42, v42
    v_cvt_f32_i32 v43, v43
    v_pk_fma_f32 v[12:13], v[40:41], v[28:29], v[12:13]
    v_pk_fma_f32 v[12:13], v[42:43], v[30:31], v[12:13]
    s_waitcnt lgkmcnt(0)
    v_cvt_f32_i32 v44, v44
    v_cvt_f32_i32 v45, v45
    v_cvt_f32_i32 v46, v46
    v_cvt_f32_i32 v47, v47
    v_pk_fma_f32 v[12:13], v[44:45], v[32:33], v[12:13]
    v_pk_fma_f32 v[12:13], v[46:47], v[34:35], v[12:13]
    v_add_f32 v12, v12, v13
    v_add_f32 v13, v14, v15
    s_nop 0
    v_add_f32_dpp v12, v12, v12 quad_perm:[1,0,3,2] row_mask:0xf bank_mask:0xf
    v_add_f32_dpp v13, v13, v13 quad_perm:[1,0,3,2] row_mask:0xf bank_mask:0xf
    s_nop 0
    v_add_f32_dpp v12, v12, v12 quad_perm:[2,3,0,1] row_mask:0xf bank_mask:0xf
    v_add_f32_dpp v13, v13, v13 quad_perm:[2,3,0,1] row_mask:0xf bank_mask:0xf
    s_nop 0
    v_add_f32_dpp v12, v12, v12 row_half_mirror row_mask:0xf bank_mask:0xf
    v_add_f32_dpp v13, v13, v13 row_half_mirror row_mask:0xf bank_mask:0xf
    s_nop 0
    v_add_f32_dpp v12, v12, v12 row_mirror row_mask:0xf bank_mask:0xf
    v_add_f32_dpp v13, v13, v13 row_mirror row_mask:0xf bank_mask:0xf
    ds_write_b64 v8, v[12:13] offset:384
    ds_write_b32 v11, v10
    s_add_u32 s20, s20, 1
    s_and_b32 s80, s20, 1
    s_cbranch_scc1 L_kvisit
    v_mov_b64 v[120:121], v[132:133]
    v_mov_b64 v[122:123], v[134:135]
    v_mov_b64 v[124:125], v[136:137]
    v_mov_b64 v[126:127], v[138:139]
    v_mov_b64 v[128:129], v[140:141]
    v_mov_b64 v[130:131], v[142:143]
    v_mov_b64 v[132:133], v[144:145]
    v_mov_b64 v[134:135], v[146:147]
    v_mov_b64 v[136:137], v[148:149]
    v_mov_b64 v[138:139], v[150:151]
    v_mov_b64 v[140:141], v[152:153]
    v_mov_b64 v[142:143], v[154:155]
    v_mov_b64 v[144:145], v[156:157]
    v_mov_b64 v[146:147], v[158:159]
    v_mov_b64 v[148:149], v[160:161]
    v_mov_b64 v[150:151], v[162:163]
    v_mov_b64 v[152:153], v[164:165]
    v_mov_b64 v[154:155], v[166:167]
    s_waitcnt vmcnt(0)
    v_cndmask_b32 v24, v70, v68, vcc
    v_cndmask_b32 v25, v71, v69, vcc
    v_cndmask_b32 v26, v66, v70, vcc
    v_cndmask_b32 v27, v67, v71, vcc
    v_cndmask_b32 v28, v68, v66, vcc
    v_cndmask_b32 v29, v69, v67, vcc
    v_perm_b32 v156, v24, v60, s22
    v_perm_b32 v157, v24, v60, s23
    v_perm_b32 v158, v25, v61, s22
    v_perm_b32 v159, v25, v61, s23
    v_perm_b32 v160, v26, v62, s22
    v_perm_b32 v161, v26, v62, s23
    v_perm_b32 v162, v27, v63, s22
    v_perm_b32 v163, v27, v63, s23
    v_perm_b32 v164, v28, v64, s22
    v_perm_b32 v165, v28, v64, s23
    v_perm_b32 v166, v29, v65, s22
    v_perm_b32 v167, v29, v65, s23
    s_cmp_lt_u32 s20, 8
    s_nop 0
    s_cbranch_scc1 L_kvisit
    v_mov_b64 v[72:73], v[120:121]
    v_mov_b64 v[74:75], v[122:123]
    v_mov_b64 v[76:77], v[124:125]
    v_mov_b64 v[78:79], v[126:127]
    v_mov_b64 v[80:81], v[128:129]
    v_mov_b64 v[82:83], v[130:131]
    v_mov_b64 v[84:85], v[132:133]
    v_mov_b64 v[86:87], v[134:135]
    v_mov_b64 v[88:89], v[136:137]
    v_mov_b64 v[90:91], v[138:139]
    v_mov_b64 v[92:93], v[140:141]
    v_mov_b64 v[94:95], v[142:143]
    v_mov_b64 v[96:97], v[144:145]
    v_mov_b64 v[98:99], v[146:147]
    v_mov_b64 v[100:101], v[148:149]
    v_mov_b64 v[102:103], v[150:151]
    v_mov_b64 v[104:105], v[152:153]
    v_mov_b64 v[106:107], v[154:155]
    v_mov_b64 v[108:109], v[156:157]
    v_mov_b64 v[110:111], v[158:159]
    v_mov_b64 v[112:113], v[160:161]
    v_mov_b64 v[114:115], v[162:163]
    v_mov_b64 v[116:117], v[164:165]
    v_mov_b64 v[118:119], v[166:167]
    s_mov_b32 s20, 0
    s_add_u32 s24, s24, 4
    s_and_b32 s24, s24, 15
    s_add_u32 s21, s21, 1
    s_cmp_lt_u32 s21, 4
    s_cbranch_scc1 L_kvisit
    v_lshrrev_b32 v21, 2, v1
    v_and_b32 v22, 3, v1
    v_mul_u32_u24 v5, 768, v21
    v_lshl_add_u32 v5, v22, 4, v5
    s_mul_i32 s80, s76, 192
    v_add_u32 v5, s80, v5
    v_lshlrev_b32 v19, 3, v21
    v_add_u32 v19, 126976, v19
    v_lshrrev_b32 v21, 4, v1
    v_lshl_add_u32 v7, v22, 2, v21
    v_lshlrev_b32 v7, 4, v7
    s_lshl_b32 s80, s76, 8
    v_add_u32 v7, s80, v7
    v_and_b32 v21, 1, v21
    v_lshlrev_b32 v18, 3, v21
    v_add_u32 v18, 157696, v18
    v_add_u32 v16, 143360, v7
    s_mov_b32 s32, 0x000f000f
    s_mov_b32 s33, 0x000f000f
    s_mov_b32 s17, 1548
    s_mul_i32 s24, s77, 4
    s_and_b32 s24, s24, 15
    s_mov_b32 s20, 0
    s_add_u32 s25, s77, 0
    s_mul_i32 s25, s25, 64
    s_add_u32 s25, s25, s78
    s_lshl_b32 s25, s25, 10
L_vhead:
    v_mov_b64 v[24:25], 0
    v_mov_b64 v[26:27], 0
    v_mov_b64 v[28:29], 0
    v_mov_b64 v[30:31], 0
    v_mov_b64 v[32:33], 0
    v_mov_b64 v[34:35], 0
    s_mov_b32 s21, 0
    s_nop 0
L_pw:
    ds_read_b64 v[36:37], v3 offset:32
    ds_read_b32 v4, v3 offset:40
    ds_read_b64 v[14:15], v18
    s_waitcnt lgkmcnt(0)
    v_readfirstlane_b32 s80, v37
    v_readfirstlane_b32 s28, v4
    s_cmp_gt_u32 s80, s20
    s_nop 3
    s_cbranch_scc1 L_pwg
    s_sleep 2
    s_branch L_pw
L_pwg:
    s_lshr_b32 s29, s28, 8
    s_lshr_b32 s30, s28, 16
L_vstep:
    s_xor_b32 s80, s20, 7
    s_lshl_b32 s80, s80, 4
    s_add_u32 s80, s80, s24
    s_lshl_b32 s80, s80, 7
    v_add_u32 v8, s80, v19
    v_add_u32 v6, s19, v5
    ds_read_b32 v12, v8
    s_cmp_ge_i32 s18, s17
    s_cbranch_scc1 L_vwg
L_vw:
    ds_read_b32 v4, v3 offset:16
    s_waitcnt lgkmcnt(0)
    v_readfirstlane_b32 s18, v4
    s_nop 0
    s_cmp_ge_i32 s18, s17
    s_nop 2
    s_cbranch_scc1 L_vwg
    s_sleep 1
    s_branch L_vw
L_vwg:
    ds_read_b128 v[36:39], v6 offset:0
    ds_read_b128 v[40:43], v6 offset:64
    ds_read_b128 v[44:47], v6 offset:128
    v_add_u32 v10, 1, v10
    s_add_u32 s19, s19, 12288
    s_cmp_eq_u32 s19, 110592
    s_cselect_b32 s19, 0, s19
    s_add_u32 s17, s17, 12
    s_add_u32 s24, s24, 1
    s_and_b32 s24, s24, 15
    s_add_u32 s21, s21, 1
    s_cmp_lt_u32 s21, 16
    s_waitcnt lgkmcnt(2)
    v_cvt_f32_i32 v36, v36
    v_cvt_f32_i32 v37, v37
    v_cvt_f32_i32 v38, v38
    v_cvt_f32_i32 v39, v39
    v_pk_fma_f32 v[24:25], v[36:37], v[12:13], v[24:25] op_sel_hi:[1,0,1]
    v_pk_fma_f32 v[26:27], v[38:39], v[12:13], v[26:27] op_sel_hi:[1,0,1]
    s_waitcnt lgkmcnt(1)
    v_cvt_f32_i32 v40, v40
    v_cvt_f32_i32 v41, v41
    v_cvt_f32_i32 v42, v42
    v_cvt_f32_i32 v43, v43
    v_pk_fma_f32 v[28:29], v[40:41], v[12:13], v[28:29] op_sel_hi:[1,0,1]
    v_pk_fma_f32 v[30:31], v[42:43], v[12:13], v[30:31] op_sel_hi:[1,0,1]
    s_waitcnt lgkmcnt(0)
    v_cvt_f32_i32 v44, v44
    v_cvt_f32_i32 v45, v45
    v_cvt_f32_i32 v46, v46
    v_cvt_f32_i32 v47, v47
    v_pk_fma_f32 v[32:33], v[44:45], v[12:13], v[32:33] op_sel_hi:[1,0,1]
    v_pk_fma_f32 v[34:35], v[46:47], v[12:13], v[34:35] op_sel_hi:[1,0,1]
    s_nop 1
    s_cbranch_scc0 L_vend
    ds_write_b32 v11, v10
    s_branch L_vstep
L_vend:
    v_permlane32_swap_b32 v24, v26
    v_permlane32_swap_b32 v25, v27
    v_permlane32_swap_b32 v28, v30
    v_permlane32_swap_b32 v29, v31
    v_permlane32_swap_b32 v32, v34
    v_permlane32_swap_b32 v33, v35
    v_pk_add_f32 v[24:25], v[24:25], v[26:27]
    v_pk_add_f32 v[28:29], v[28:29], v[30:31]
    v_pk_add_f32 v[32:33], v[32:33], v[34:35]
    v_permlane16_swap_b32 v24, v25
    v_permlane16_swap_b32 v28, v29
    v_permlane16_swap_b32 v32, v33
    v_add_f32 v36, v24, v25
    v_add_f32 v37, v28, v29
    v_add_f32 v38, v32, v33
    v_mov_b32 v39, v14
    v_add_f32_dpp v36, v36, v36 row_ror:4 row_mask:0xf bank_mask:0xf
    v_add_f32_dpp v37, v37, v37 row_ror:4 row_mask:0xf bank_mask:0xf
    v_add_f32_dpp v38, v38, v38 row_ror:4 row_mask:0xf bank_mask:0xf
    v_add_f32_dpp v36, v36, v36 row_ror:8 row_mask:0xf bank_mask:0xf
    v_add_f32_dpp v37, v37, v37 row_ror:8 row_mask:0xf bank_mask:0xf
    v_add_f32_dpp v38, v38, v38 row_ror:8 row_mask:0xf bank_mask:0xf
    v_sub_f32 v36, v36, v15
    v_sub_f32 v37, v37, v15
    v_sub_f32 v38, v38, v15
    v_bfi_b32 v36, v23, s28, v36
    v_bfi_b32 v37, v23, s29, v37
    v_bfi_b32 v38, v23, s30, v38
    s_add_u32 s20, s20, 1
    s_cmp_eq_u32 s20, 8
    s_mov_b64 exec, s[32:33]
    s_cbranch_scc1 L_vlast
    ds_write_b128 v16, v[36:39]
    s_mov_b64 exec, -1
    ds_write_b32 v11, v10
    v_add_u32 v16, 1024, v16
    v_add_u32 v18, 16, v18
    s_nop 1
    s_branch L_vhead
L_vlast:
    buffer_store_dwordx4 v[36:39], v7, s[12:15], s25 offen sc0 sc1
    s_endpgm
    s_nop 0
L_aux:
    s_cmp_eq_u32 s76, 5
    s_cbranch_scc0 L_pacer
    v_lshlrev_b32 v5, 3, v1
    v_cmp_gt_u32 vcc, 24, v1
    v_mov_b32 v13, 0xffffff40
    v_mov_b32 v10, 192
    v_cndmask_b32 v13, v13, v10, vcc
    v_add_u32 v6, v5, v13
    v_mov_b32 v10, 0x80008000
    v_cndmask_b32 v7, 0, v10, vcc
    v_lshrrev_b32 v10, 1, v1
    v_and_b32 v11, 15, v10
    v_lshrrev_b32 v10, 4, v10
    v_mul_u32_u24 v10, 131072, v10
    v_mul_u32_u24 v11, 2048, v11
    v_add_u32 v10, v10, v11
    v_and_b32 v11, 1, v1
    v_lshl_add_u32 v17, v11, 4, v10
    v_add_u32 v10, 0, v1
    v_mul_u32_u24 v12, 2731, v10
    v_lshrrev_b32 v12, 16, v12
    v_mul_u32_u24 v12, 1152, v12
    v_lshl_add_u32 v56, v10, 4, v12
    v_add_u32 v10, 64, v1
    v_mul_u32_u24 v12, 2731, v10
    v_lshrrev_b32 v12, 16, v12
    v_mul_u32_u24 v12, 1152, v12
    v_lshl_add_u32 v57, v10, 4, v12
    v_add_u32 v10, 128, v1
    v_mul_u32_u24 v12, 2731, v10
    v_lshrrev_b32 v12, 16, v12
    v_mul_u32_u24 v12, 1152, v12
    v_lshl_add_u32 v58, v10, 4, v12
    v_cmp_eq_u32 s[32:33], 0, v11
    s_lshl_b32 s27, s77, 15
    s_lshl_b32 s80, s78, 5
    s_add_u32 s27, s27, s80
    s_mov_b32 m0, 143360
    s_waitcnt lgkmcnt(0)
    s_mov_b32 s4, s62
    s_mov_b32 s5, s63
    s_mov_b32 s6, 384
    s_mov_b32 s7, 0x20000
    s_mov_b32 s20, s64
    s_mov_b32 s21, s65
    s_mov_b32 s22, 384
    s_mov_b32 s23, 0x20000
    buffer_load_dwordx2 v[28:29], v5, s[4:7], 0 offen
    buffer_load_dwordx2 v[30:31], v5, s[20:23], 0 offen
    s_mov_b32 s4, s48
    s_mov_b32 s5, s49
    s_mov_b32 s6, 12288
    s_mov_b32 s7, 0x20000
    s_mul_i32 s80, s77, 384
    buffer_load_dwordx4 v56, s[4:7], s80 offen lds
    s_add_u32 m0, m0, 1024
    s_nop 0
    buffer_load_dwordx4 v57, s[4:7], s80 offen lds
    s_add_u32 m0, m0, 1024
    s_nop 0
    buffer_load_dwordx4 v58, s[4:7], s80 offen lds
    s_add_u32 m0, m0, 1024
    s_mov_b32 s12, s74
    s_mov_b32 s13, s75
    s_mov_b32 s14, 1610612736
    s_mov_b32 s15, 0x20000
    s_mov_b32 s8, s72
    s_mov_b32 s9, s73
    s_mov_b32 s10, 256
    s_mov_b32 s11, 0x20000
    s_mov_b32 s16, s70
    s_mov_b32 s17, s71
    s_mov_b32 s18, 12288
    s_mov_b32 s19, 0x20000
    v_mov_b32 v14, 0xff
    s_barrier
    v_add_u32 v15, 143360, v5
    v_add_u32 v16, 143360, v6
    v_lshlrev_b32 v8, 1, v5
    v_lshlrev_b32 v9, 1, v6
    v_add_u32 v8, 151552, v8
    v_add_u32 v9, 151552, v9
    v_mov_b32 v12, 0
    s_mov_b32 s24, 0
    s_waitcnt vmcnt(3)
    v_xor_b32 v30, v30, v7
    v_xor_b32 v31, v31, v7
    v_lshlrev_b32 v32, 16, v28
    v_and_b32 v33, 0xffff0000, v28
    v_lshlrev_b32 v34, 16, v29
    v_and_b32 v35, 0xffff0000, v29
    v_lshlrev_b32 v36, 16, v30
    v_and_b32 v37, 0xffff0000, v30
    v_lshlrev_b32 v38, 16, v31
    v_and_b32 v39, 0xffff0000, v31
    v_and_b32 v7, 0x80000000, v7
    s_waitcnt vmcnt(0)
    s_mov_b32 exec_hi, 0xffff
L_hq:
    ds_read_b64 v[20:21], v15
    ds_read_b64 v[22:23], v16
    v_add_u32 v15, 384, v15
    v_add_u32 v16, 384, v16
    v_add_u32 v12, 1, v12
    s_waitcnt lgkmcnt(0)
    v_lshlrev_b32 v40, 16, v20
    v_and_b32 v41, 0xffff0000, v20
    v_lshlrev_b32 v42, 16, v21
    v_and_b32 v43, 0xffff0000, v21
    v_lshlrev_b32 v44, 16, v22
    v_and_b32 v45, 0xffff0000, v22
    v_lshlrev_b32 v46, 16, v23
    v_and_b32 v47, 0xffff0000, v23
    v_pk_mul_f32 v[40:41], v[40:41], v[32:33]
    v_pk_mul_f32 v[44:45], v[44:45], v[36:37]
    v_pk_mul_f32 v[42:43], v[42:43], v[34:35]
    v_pk_mul_f32 v[46:47], v[46:47], v[38:39]
    v_cvt_pk_bf16_f32 v40, v40, v44
    v_cvt_pk_bf16_f32 v41, v41, v45
    v_cvt_pk_bf16_f32 v42, v42, v46
    v_cvt_pk_bf16_f32 v43, v43, v47
    v_and_b32 v44, 0xffff0000, v40
    v_lshlrev_b32 v40, 16, v40
    v_and_b32 v45, 0xffff0000, v41
    v_lshlrev_b32 v41, 16, v41
    v_and_b32 v46, 0xffff0000, v42
    v_lshlrev_b32 v42, 16, v42
    v_and_b32 v47, 0xffff0000, v43
    v_lshlrev_b32 v43, 16, v43
    v_pk_add_f32 v[40:41], v[40:41], v[44:45]
    v_pk_add_f32 v[42:43], v[42:43], v[46:47]
    v_cvt_pk_bf16_f32 v48, v40, v40
    v_cvt_pk_bf16_f32 v49, v41, v41
    v_cvt_pk_bf16_f32 v50, v42, v42
    v_cvt_pk_bf16_f32 v51, v43, v43
    v_xor_b32 v48, v48, v7
    v_xor_b32 v49, v49, v7
    v_xor_b32 v50, v50, v7
    v_xor_b32 v51, v51, v7
    ds_write_b16 v8, v48 offset:0
    ds_write_b16_d16_hi v9, v48 offset:2
    ds_write_b16 v8, v49 offset:4
    ds_write_b16_d16_hi v9, v49 offset:6
    ds_write_b16 v8, v50 offset:8
    ds_write_b16_d16_hi v9, v50 offset:10
    ds_write_b16 v8, v51 offset:12
    ds_write_b16_d16_hi v9, v51 offset:14
    ds_write_b32 v3, v12 offset:32
    v_add_u32 v8, 768, v8
    v_add_u32 v9, 768, v9
    s_add_u32 s24, s24, 1
    s_cmp_lt_u32 s24, 8
    s_cbranch_scc1 L_hq
    s_mov_b32 exec_hi, -1
    v_mov_b32 v15, 0
    s_mov_b32 s25, 0
    s_cmp_eq_u32 s2, 0
    s_cbranch_scc1 L_epc
L_epw:
    s_sleep 16
    ds_read_b32 v4, v3 offset:20
    s_waitcnt lgkmcnt(0)
    v_readfirstlane_b32 s80, v4
    s_nop 0
    s_cmp_lt_i32 s80, 16
    s_nop 2
    s_cbranch_scc1 L_epw
L_ep:
    s_mov_b64 exec, 1
    buffer_load_dword v11, v15, s[8:11], 0 offen sc0 sc1
    s_waitcnt vmcnt(0)
    v_readfirstlane_b32 s28, v11
    s_mov_b64 exec, -1
    s_cmp_lg_u32 s28, 0
    s_nop 2
    s_cbranch_scc1 L_epd
    s_sleep 32
    s_add_u32 s25, s25, 1
    s_cmp_lt_u32 s25, 8
    s_cbranch_scc1 L_ep
L_epc:
    s_mul_i32 s28, s84, 0x9e3779b1
    s_lshr_b32 s81, s28, 15
    s_xor_b32 s28, s28, s81
    s_mul_i32 s28, s28, 0x85ebca6b
    s_lshr_b32 s81, s28, 13
    s_xor_b32 s28, s28, s81
    s_max_u32 s28, s28, 1
    v_mov_b32 v20, s28
    v_mov_b32 v21, 0
    s_mov_b64 exec, 1
    buffer_atomic_cmpswap v[20:21], v15, s[8:11], 0 offen sc0 sc1
    s_waitcnt vmcnt(0)
    v_readfirstlane_b32 s80, v20
    s_mov_b64 exec, -1
    s_cmp_eq_u32 s80, 0
    s_cselect_b32 s28, s28, s80
    s_nop 1
L_epd:
    v_mov_b32 v12, s28
    ds_write_b32 v3, v12 offset:40
    s_lshr_b32 s29, s28, 8
    s_lshr_b32 s30, s28, 16
    s_lshr_b32 s31, s28, 24
    s_and_b32 s80, s78, 3
    s_lshl_b32 s80, s80, 3
    v_lshrrev_b32 v10, 3, v1
    v_add_u32 v10, s80, v10
    v_and_b32 v11, 15, v10
    v_lshrrev_b32 v10, 4, v10
    v_mul_u32_u24 v10, 131072, v10
    v_mul_u32_u24 v11, 2048, v11
    v_add_u32 v10, v10, v11
    v_and_b32 v11, 7, v1
    v_lshl_add_u32 v56, v11, 4, v10
    s_mov_b32 s24, 8
    s_mov_b32 s25, 0
    s_mov_b32 m0, 110592
    s_mov_b32 s4, s52
    s_mov_b32 s5, s53
    s_mov_b32 s6, 1048576
    s_mov_b32 s7, 0x20000
    s_mov_b32 s20, s52
    s_mov_b32 s21, s53
    s_mov_b32 s22, 0
    s_mov_b32 s23, 0x20000
L_sc:
    s_sleep 16
    ds_read_b32 v4, v3 offset:20
    s_waitcnt lgkmcnt(0)
    v_readfirstlane_b32 s80, v4
    s_nop 0
    s_cmp_lt_i32 s80, s24
    s_nop 2
    s_cbranch_scc1 L_sc
    s_and_b32 s80, s25, 3
    s_mul_i32 s80, s80, 262144
    s_add_u32 s80, s80, s27
    s_andn2_b32 s81, s80, 127
    s_cmp_eq_u32 s25, 0
    s_cbranch_scc1 L_sc1
    buffer_load_dwordx4 v17, s[20:23], s83 offen  lds
    s_add_u32 m0, m0, 1024
L_sc1:
    s_mov_b32 s83, s80
    s_mov_b32 s20, s4
    s_mov_b32 s21, s5
    s_mov_b32 s22, 1048576
    s_add_u32 s25, s25, 1
    s_cmp_eq_u32 s25, 4
    s_cselect_b32 s4, s54, s4
    s_cselect_b32 s5, s55, s5
    s_cmp_eq_u32 s25, 8
    s_cselect_b32 s4, s58, s4
    s_cselect_b32 s5, s59, s5
    s_cmp_eq_u32 s25, 12
    s_cselect_b32 s4, s60, s4
    s_cselect_b32 s5, s61, s5
    s_cmp_eq_u32 s25, 16
    s_cselect_b32 s6, 0, s6
    s_add_u32 s24, s24, 4
    s_cmp_le_u32 s25, 16
    s_cbranch_scc1 L_sc
    s_waitcnt vmcnt(0)
    v_mov_b32 v28, 0
    v_mov_b32 v29, 0
    v_mov_b32 v30, 0
    v_mov_b32 v31, 0
    v_mov_b32 v32, 0
    v_mov_b32 v33, 0
    v_mov_b32 v34, 0
    v_mov_b32 v35, 0
    v_mov_b32 v36, 0
    v_mov_b32 v37, 0
    v_mov_b32 v38, 0
    v_mov_b32 v39, 0
    v_mov_b32 v40, 0
    v_mov_b32 v41, 0
    v_mov_b32 v42, 0
    v_mov_b32 v43, 0
    v_mov_b32 v44, 0
    v_mov_b32 v45, 0
    v_mov_b32 v46, 0
    v_mov_b32 v47, 0
    v_mov_b32 v48, 0
    v_mov_b32 v49, 0
    v_mov_b32 v50, 0
    v_mov_b32 v51, 0
    v_mov_b32 v64, 0
    v_mov_b32 v65, 0
    v_mov_b32 v66, 0
    v_mov_b32 v67, 0
    v_mov_b32 v68, 0
    v_mov_b32 v69, 0
    v_mov_b32 v70, 0
    v_mov_b32 v71, 0
    v_lshlrev_b32 v15, 3, v1
    v_add_u32 v15, 141312, v15
    v_lshlrev_b32 v16, 1, v1
    v_add_u32 v16, 114176, v16
    v_mov_b32 v8, 157696
    v_mov_b32 v9, 0
    s_mov_b32 s24, 100
    s_nop 0
L_hp:
    s_sleep 8
    ds_read_b128 v[56:59], v3
    s_waitcnt lgkmcnt(0)
    v_min3_i32 v56, v56, v57, v58
    v_min_i32 v56, v56, v59
    s_nop 0
    v_readfirstlane_b32 s80, v56
    s_nop 0
    s_cmp_lt_i32 s80, s24
    s_nop 2
    s_cbranch_scc1 L_hp
    ds_read_b64 v[72:73], v15 offset:0
    ds_read_u16_d16_hi v28, v16 offset:0
    ds_read_u16_d16_hi v64, v16 offset:4096
    ds_read_b64 v[74:75], v15 offset:512
    ds_read_u16_d16_hi v29, v16 offset:128
    ds_read_u16_d16_hi v65, v16 offset:4224
    ds_read_b64 v[76:77], v15 offset:1024
    ds_read_u16_d16_hi v30, v16 offset:256
    ds_read_u16_d16_hi v66, v16 offset:4352
    ds_read_b64 v[78:79], v15 offset:1536
    ds_read_u16_d16_hi v31, v16 offset:384
    ds_read_u16_d16_hi v67, v16 offset:4480
    s_waitcnt lgkmcnt(0)
    ds_read_u16_d16_hi v36, v16 offset:8192
    ds_read_u16_d16_hi v44, v16 offset:12288
    ds_read_u16_d16_hi v37, v16 offset:8320
    ds_read_u16_d16_hi v45, v16 offset:12416
    ds_read_u16_d16_hi v38, v16 offset:8448
    ds_read_u16_d16_hi v46, v16 offset:12544
    ds_read_u16_d16_hi v39, v16 offset:8576
    ds_read_u16_d16_hi v47, v16 offset:12672
    v_fma_f32 v20, -v64, v73, v72
    v_fma_f32 v21, -v65, v75, v74
    v_fma_f32 v22, -v66, v77, v76
    v_fma_f32 v23, -v67, v79, v78
    v_mul_f32 v20, v20, v28
    v_mul_f32 v21, v21, v29
    v_mul_f32 v22, v22, v30
    v_mul_f32 v23, v23, v31
    v_mul_f32 v20, 0x3dd53b95, v20
    v_mul_f32 v21, 0x3dd53b95, v21
    v_mul_f32 v22, 0x3dd53b95, v22
    v_mul_f32 v23, 0x3dd53b95, v23
    v_mov_b32 v52, v20
    v_max_f32 v52, v52, v21
    v_max_f32 v52, v52, v22
    v_max_f32 v52, v52, v23
    s_nop 1
    v_max_f32_dpp v52, v52, v52 quad_perm:[1,0,3,2] row_mask:0xf bank_mask:0xf
    s_nop 1
    v_max_f32_dpp v52, v52, v52 quad_perm:[2,3,0,1] row_mask:0xf bank_mask:0xf
    s_nop 1
    v_max_f32_dpp v52, v52, v52 row_half_mirror row_mask:0xf bank_mask:0xf
    s_nop 1
    v_max_f32_dpp v52, v52, v52 row_mirror row_mask:0xf bank_mask:0xf
    v_mov_b32 v13, v52
    s_nop 1
    v_permlane32_swap_b32 v52, v13
    v_max_f32 v52, v52, v13
    v_mov_b32 v13, v52
    s_nop 1
    v_permlane16_swap_b32 v52, v13
    v_max_f32 v52, v52, v13
    v_sub_f32 v20, v20, v52
    v_sub_f32 v21, v21, v52
    v_sub_f32 v22, v22, v52
    v_sub_f32 v23, v23, v52
    v_exp_f32 v20, v20
    v_exp_f32 v21, v21
    v_exp_f32 v22, v22
    v_exp_f32 v23, v23
    v_mov_b32 v54, v20
    v_add_f32 v54, v54, v21
    v_add_f32 v54, v54, v22
    v_add_f32 v54, v54, v23
    s_waitcnt lgkmcnt(0)
    v_mul_f32 v20, v20, v36
    v_mul_f32 v21, v21, v37
    v_mul_f32 v22, v22, v38
    v_mul_f32 v23, v23, v39
    v_mul_f32 v53, v20, v44
    v_fmac_f32 v53, v21, v45
    v_fmac_f32 v53, v22, v46
    v_fmac_f32 v53, v23, v47
    ds_write_b32 v15, v20 offset:0
    ds_write_b32 v15, v21 offset:512
    ds_write_b32 v15, v22 offset:1024
    ds_write_b32 v15, v23 offset:1536
    v_add_f32_dpp v54, v54, v54 quad_perm:[1,0,3,2] row_mask:0xf bank_mask:0xf
    s_nop 1
    v_add_f32_dpp v54, v54, v54 quad_perm:[2,3,0,1] row_mask:0xf bank_mask:0xf
    s_nop 1
    v_add_f32_dpp v54, v54, v54 row_half_mirror row_mask:0xf bank_mask:0xf
    s_nop 1
    v_add_f32_dpp v54, v54, v54 row_mirror row_mask:0xf bank_mask:0xf
    v_mov_b32 v13, v54
    s_nop 1
    v_permlane32_swap_b32 v54, v13
    v_add_f32 v54, v54, v13
    v_mov_b32 v13, v54
    s_nop 1
    v_permlane16_swap_b32 v54, v13
    v_add_f32 v54, v54, v13
    v_add_f32_dpp v53, v53, v53 quad_perm:[1,0,3,2] row_mask:0xf bank_mask:0xf
    s_nop 1
    v_add_f32_dpp v53, v53, v53 quad_perm:[2,3,0,1] row_mask:0xf bank_mask:0xf
    s_nop 1
    v_add_f32_dpp v53, v53, v53 row_half_mirror row_mask:0xf bank_mask:0xf
    s_nop 1
    v_add_f32_dpp v53, v53, v53 row_mirror row_mask:0xf bank_mask:0xf
    v_mov_b32 v13, v53
    s_nop 1
    v_permlane32_swap_b32 v53, v13
    v_add_f32 v53, v53, v13
    v_mov_b32 v13, v53
    s_nop 1
    v_permlane16_swap_b32 v53, v13
    v_add_f32 v53, v53, v13
    v_bfi_b32 v54, v14, s31, v54
    v_mov_b32 v55, v53
    v_add_u32 v9, 1, v9
    s_mov_b64 exec, 1
    ds_write_b128 v8, v[52:55]
    ds_write_b32 v3, v9 offset:36
    s_mov_b64 exec, -1
    v_add_u32 v15, -2048, v15
    v_add_u32 v16, -512, v16
    v_add_u32 v8, 16, v8
    s_add_u32 s24, s24, 4
    s_cmp_le_u32 s24, 128
    s_cbranch_scc1 L_hp
    s_add_u32 s26, s77, 28
    s_mul_i32 s26, s26, 64
    s_add_u32 s26, s26, s78
    s_lshl_b32 s26, s26, 10
    s_lshr_b32 s34, s2, 3
    s_and_b32 s35, s2, 7
    v_lshrrev_b32 v10, 3, v1
    v_and_b32 v16, 7, v1
    v_lshlrev_b32 v10, 10, v10
    v_lshl_add_u32 v15, v16, 4, v10
    v_lshlrev_b32 v16, 1, v16
    v_add_u32 v13, 143360, v2
    s_mov_b32 s25, 0
    s_nop 0
L_hf:
    s_sleep 32
    ds_read_b128 v[56:59], v3
    s_waitcnt lgkmcnt(0)
    v_min3_i32 v56, v56, v57, v58
    v_min_i32 v56, v56, v59
    s_nop 0
    v_readfirstlane_b32 s80, v56
    s_nop 0
    s_cmp_lt_i32 s80, 240
    s_nop 2
    s_cbranch_scc1 L_hf
    ds_read_b128 v[64:67], v13 offset:0
    ds_read_b128 v[68:71], v13 offset:1024
    ds_read_b128 v[72:75], v13 offset:2048
    ds_read_b128 v[76:79], v13 offset:3072
    ds_read_b128 v[80:83], v13 offset:4096
    ds_read_b128 v[84:87], v13 offset:5120
    ds_read_b128 v[88:91], v13 offset:6144
L_hn:
    s_sleep 4
    ds_read_b32 v4, v3 offset:20
    s_waitcnt lgkmcnt(0)
    v_readfirstlane_b32 s80, v4
    s_nop 0
    s_cmp_lt_i32 s80, 252
    s_nop 2
    s_cbranch_scc1 L_hn
    buffer_store_dwordx4 v[64:67], v2, s[12:15], s26 offen sc0 sc1
    s_sub_u32 s26, s26, 262144
    buffer_store_dwordx4 v[68:71], v2, s[12:15], s26 offen sc0 sc1
    s_sub_u32 s26, s26, 262144
    buffer_store_dwordx4 v[72:75], v2, s[12:15], s26 offen sc0 sc1
    s_sub_u32 s26, s26, 262144
    buffer_store_dwordx4 v[76:79], v2, s[12:15], s26 offen sc0 sc1
    s_sub_u32 s26, s26, 262144
    buffer_store_dwordx4 v[80:83], v2, s[12:15], s26 offen sc0 sc1
    s_sub_u32 s26, s26, 262144
    buffer_store_dwordx4 v[84:87], v2, s[12:15], s26 offen sc0 sc1
    s_sub_u32 s26, s26, 262144
    buffer_store_dwordx4 v[88:91], v2, s[12:15], s26 offen sc0 sc1
    s_sub_u32 s26, s26, 262144
    s_nop 0
L_hl:
    s_sleep 2
    ds_read_b32 v4, v3 offset:16
    s_waitcnt lgkmcnt(0)
    v_readfirstlane_b32 s80, v4
    s_nop 0
    s_cmp_lt_i32 s80, 3072
    s_nop 2
    s_cbranch_scc1 L_hl
    s_mul_i32 s82, s34, 65536
    s_lshl_b32 s83, s35, 7
    s_add_u32 s82, s82, s83
    s_mul_i32 s81, s34, 384
    s_lshr_b32 s83, s35, 1
    s_mul_i32 s83, s83, 96
    s_add_u32 s81, s81, s83
    s_and_b32 s83, s35, 1
    s_lshl_b32 s83, s83, 4
    s_add_u32 s81, s81, s83
    s_waitcnt vmcnt(0)
L_try:
    s_mov_b32 s80, s82
    buffer_load_dwordx4 v[64:67], v15, s[12:15], s80 offen sc0 sc1
    s_add_u32 s80, s80, 8192
    buffer_load_dwordx4 v[68:71], v15, s[12:15], s80 offen sc0 sc1
    s_add_u32 s80, s80, 8192
    buffer_load_dwordx4 v[72:75], v15, s[12:15], s80 offen sc0 sc1
    s_add_u32 s80, s80, 8192
    buffer_load_dwordx4 v[76:79], v15, s[12:15], s80 offen sc0 sc1
    s_add_u32 s80, s80, 8192
    buffer_load_dwordx4 v[80:83], v15, s[12:15], s80 offen sc0 sc1
    s_add_u32 s80, s80, 8192
    buffer_load_dwordx4 v[84:87], v15, s[12:15], s80 offen sc0 sc1
    s_add_u32 s80, s80, 8192
    buffer_load_dwordx4 v[88:91], v15, s[12:15], s80 offen sc0 sc1
    s_add_u32 s80, s80, 8192
    buffer_load_dwordx4 v[92:95], v15, s[12:15], s80 offen sc0 sc1
    s_waitcnt vmcnt(7)
    v_xor_b32 v12, s28, v64
    v_bitop3_b32 v12, v12, v65, s29 bitop3:0xf6
    v_bitop3_b32 v12, v12, v66, s30 bitop3:0xf6
    v_xor_b32 v13, s31, v67
    s_waitcnt vmcnt(6)
    v_bitop3_b32 v12, v12, v68, s28 bitop3:0xf6
    v_bitop3_b32 v12, v12, v69, s29 bitop3:0xf6
    v_bitop3_b32 v12, v12, v70, s30 bitop3:0xf6
    v_bitop3_b32 v13, v13, v71, s31 bitop3:0xf6
    s_waitcnt vmcnt(5)
    v_bitop3_b32 v12, v12, v72, s28 bitop3:0xf6
    v_bitop3_b32 v12, v12, v73, s29 bitop3:0xf6
    v_bitop3_b32 v12, v12, v74, s30 bitop3:0xf6
    v_bitop3_b32 v13, v13, v75, s31 bitop3:0xf6
    s_waitcnt vmcnt(4)
    v_bitop3_b32 v12, v12, v76, s28 bitop3:0xf6
    v_bitop3_b32 v12, v12, v77, s29 bitop3:0xf6
    v_bitop3_b32 v12, v12, v78, s30 bitop3:0xf6
    v_bitop3_b32 v13, v13, v79, s31 bitop3:0xf6
    s_waitcnt vmcnt(3)
    v_bitop3_b32 v12, v12, v80, s28 bitop3:0xf6
    v_bitop3_b32 v12, v12, v81, s29 bitop3:0xf6
    v_bitop3_b32 v12, v12, v82, s30 bitop3:0xf6
    v_bitop3_b32 v13, v13, v83, s31 bitop3:0xf6
    s_waitcnt vmcnt(2)
    v_bitop3_b32 v12, v12, v84, s28 bitop3:0xf6
    v_bitop3_b32 v12, v12, v85, s29 bitop3:0xf6
    v_bitop3_b32 v12, v12, v86, s30 bitop3:0xf6
    v_bitop3_b32 v13, v13, v87, s31 bitop3:0xf6
    s_waitcnt vmcnt(1)
    v_bitop3_b32 v12, v12, v88, s28 bitop3:0xf6
    v_bitop3_b32 v12, v12, v89, s29 bitop3:0xf6
    v_bitop3_b32 v12, v12, v90, s30 bitop3:0xf6
    v_bitop3_b32 v13, v13, v91, s31 bitop3:0xf6
    s_waitcnt vmcnt(0)
    v_bitop3_b32 v12, v12, v92, s28 bitop3:0xf6
    v_bitop3_b32 v12, v12, v93, s29 bitop3:0xf6
    v_bitop3_b32 v12, v12, v94, s30 bitop3:0xf6
    v_bitop3_b32 v13, v13, v95, s31 bitop3:0xf6
    v_cndmask_b32 v13, v13, 0, s[32:33]
    v_or_b32 v12, v12, v13
    v_and_b32 v12, 0xff, v12
    v_cmp_ne_u32 vcc, 0, v12
    s_nop 4
    s_cbranch_vccz L_cok
    s_sleep 1
    s_add_u32 s25, s25, 1
    s_cmp_lt_u32 s25, 2000000
    s_cbranch_scc1 L_try
L_cok:
    v_max_f32 v11, v67, v71
    v_max3_f32 v11, v11, v75, v79
    v_max3_f32 v11, v11, v83, v87
    v_max3_f32 v11, v11, v91, v95
    s_nop 1
    v_max_f32_dpp v11, v11, v11 row_ror:8 row_mask:0xf bank_mask:0xf
    v_mov_b32 v13, v11
    s_nop 1
    v_permlane32_swap_b32 v11, v13
    v_max_f32 v11, v11, v13
    v_mov_b32 v13, v11
    s_nop 1
    v_permlane16_swap_b32 v11, v13
    v_max_f32 v11, v11, v13
    s_nop 1
    v_mov_b32_dpp v11, v11 quad_perm:[0,0,2,2] row_mask:0xf bank_mask:0xf
    s_nop 1
    v_sub_f32_dpp v20, v67, v11 quad_perm:[0,0,2,2] row_mask:0xf bank_mask:0xf
    v_sub_f32_dpp v21, v71, v11 quad_perm:[0,0,2,2] row_mask:0xf bank_mask:0xf
    v_sub_f32_dpp v22, v75, v11 quad_perm:[0,0,2,2] row_mask:0xf bank_mask:0xf
    v_sub_f32_dpp v23, v79, v11 quad_perm:[0,0,2,2] row_mask:0xf bank_mask:0xf
    v_sub_f32_dpp v24, v83, v11 quad_perm:[0,0,2,2] row_mask:0xf bank_mask:0xf
    v_sub_f32_dpp v25, v87, v11 quad_perm:[0,0,2,2] row_mask:0xf bank_mask:0xf
    v_sub_f32_dpp v26, v91, v11 quad_perm:[0,0,2,2] row_mask:0xf bank_mask:0xf
    v_sub_f32_dpp v27, v95, v11 quad_perm:[0,0,2,2] row_mask:0xf bank_mask:0xf
    v_exp_f32 v20, v20
    v_exp_f32 v21, v21
    v_exp_f32 v22, v22
    v_exp_f32 v23, v23
    v_exp_f32 v24, v24
    v_exp_f32 v25, v25
    v_exp_f32 v26, v26
    v_exp_f32 v27, v27
    v_mul_f32 v40, v64, v20
    v_mul_f32 v41, v65, v20
    v_mul_f32 v42, v66, v20
    v_mul_f32_dpp v43, v67, v20 quad_perm:[1,1,3,3] row_mask:0xf bank_mask:0xf
    v_fmac_f32 v40, v68, v21
    v_fmac_f32 v41, v69, v21
    v_fmac_f32 v42, v70, v21
    v_fmac_f32_dpp v43, v71, v21 quad_perm:[1,1,3,3] row_mask:0xf bank_mask:0xf
    v_fmac_f32 v40, v72, v22
    v_fmac_f32 v41, v73, v22
    v_fmac_f32 v42, v74, v22
    v_fmac_f32_dpp v43, v75, v22 quad_perm:[1,1,3,3] row_mask:0xf bank_mask:0xf
    v_fmac_f32 v40, v76, v23
    v_fmac_f32 v41, v77, v23
    v_fmac_f32 v42, v78, v23
    v_fmac_f32_dpp v43, v79, v23 quad_perm:[1,1,3,3] row_mask:0xf bank_mask:0xf
    v_fmac_f32 v40, v80, v24
    v_fmac_f32 v41, v81, v24
    v_fmac_f32 v42, v82, v24
    v_fmac_f32_dpp v43, v83, v24 quad_perm:[1,1,3,3] row_mask:0xf bank_mask:0xf
    v_fmac_f32 v40, v84, v25
    v_fmac_f32 v41, v85, v25
    v_fmac_f32 v42, v86, v25
    v_fmac_f32_dpp v43, v87, v25 quad_perm:[1,1,3,3] row_mask:0xf bank_mask:0xf
    v_fmac_f32 v40, v88, v26
    v_fmac_f32 v41, v89, v26
    v_fmac_f32 v42, v90, v26
    v_fmac_f32_dpp v43, v91, v26 quad_perm:[1,1,3,3] row_mask:0xf bank_mask:0xf
    v_fmac_f32 v40, v92, v27
    v_fmac_f32 v41, v93, v27
    v_fmac_f32 v42, v94, v27
    v_fmac_f32_dpp v43, v95, v27 quad_perm:[1,1,3,3] row_mask:0xf bank_mask:0xf
    v_add_f32_dpp v40, v40, v40 row_ror:8 row_mask:0xf bank_mask:0xf
    v_add_f32_dpp v41, v41, v41 row_ror:8 row_mask:0xf bank_mask:0xf
    v_add_f32_dpp v42, v42, v42 row_ror:8 row_mask:0xf bank_mask:0xf
    v_add_f32_dpp v43, v43, v43 row_ror:8 row_mask:0xf bank_mask:0xf
    v_mov_b32 v44, v40
    s_nop 1
    v_permlane32_swap_b32 v40, v44
    v_add_f32 v40, v40, v44
    v_mov_b32 v44, v40
    s_nop 1
    v_permlane16_swap_b32 v40, v44
    v_add_f32 v40, v40, v44
    v_mov_b32 v45, v41
    s_nop 1
    v_permlane32_swap_b32 v41, v45
    v_add_f32 v41, v41, v45
    v_mov_b32 v45, v41
    s_nop 1
    v_permlane16_swap_b32 v41, v45
    v_add_f32 v41, v41, v45
    v_mov_b32 v46, v42
    s_nop 1
    v_permlane32_swap_b32 v42, v46
    v_add_f32 v42, v42, v46
    v_mov_b32 v46, v42
    s_nop 1
    v_permlane16_swap_b32 v42, v46
    v_add_f32 v42, v42, v46
    v_mov_b32 v47, v43
    s_nop 1
    v_permlane32_swap_b32 v43, v47
    v_add_f32 v43, v43, v47
    v_mov_b32 v47, v43
    s_nop 1
    v_permlane16_swap_b32 v43, v47
    v_add_f32 v43, v43, v47
    v_rcp_f32 v10, v43
    s_nop 0
    v_mul_f32 v40, v40, v10
    v_mul_f32 v41, v41, v10
    v_mul_f32 v42, v42, v10
    v_cvt_pk_bf16_f32 v40, v40, v40
    v_cvt_pk_bf16_f32 v41, v41, v41
    v_cvt_pk_bf16_f32 v42, v42, v42
    s_mov_b64 exec, 0xff
    buffer_store_short v40, v16, s[16:19], s81 offen offset:0
    buffer_store_short v41, v16, s[16:19], s81 offen offset:32
    buffer_store_short v42, v16, s[16:19], s81 offen offset:64
    s_endpgm
L_pacer:
    s_cmp_eq_u32 s76, 6
    s_cbranch_scc0 L_exch
    v_lshl_add_u32 v15, v1, 2, v3
    v_mov_b32 v8, 0
    ds_write_b32 v15, v8
    v_mov_b32 v15, 2325
    ds_write_b32 v3, v15 offset:44
    s_mov_b32 s4, 0
    s_mov_b32 s5, 12
    s_mov_b32 s6, 0
    s_mov_b32 s7, 128
    s_mov_b32 s8, 21
    v_mov_b32 v14, 157824
    s_waitcnt lgkmcnt(0)
    s_lshl_b32 s80, s84, 12
    s_add_u32 s80, s80, 1351680
    v_mov_b32 v12, s80
    v_mov_b32 v13, 5104
    ds_write_b64 v3, v[12:13] offset:24
    v_mov_b32 v15, s84
    ds_write_b32 v14, v15
    s_waitcnt lgkmcnt(0)
    s_barrier
L_g:
    s_sleep 1
    ds_read_b32 v4, v3 offset:16
    s_memrealtime s[10:11]
    ds_read_b128 v[8:11], v3
    ds_read_b64 v[12:13], v3 offset:24
    s_waitcnt lgkmcnt(0)
    v_readfirstlane_b32 s83, v4
    v_min3_i32 v15, v8, v9, v10
    v_min_i32 v8, v15, v11
    s_cmp_ge_i32 s83, s5
    s_nop 1
    s_cbranch_scc0 L_gw
    v_readfirstlane_b32 s80, v12
    v_readfirstlane_b32 s81, v13
    s_add_u32 s4, s4, 1
    s_add_u32 s5, s5, 12
    s_cmp_le_u32 s4, 96
    s_add_u32 s6, s6, 32
    v_add_u32 v14, 4, v14
    v_mov_b32 v15, s10
    ds_write_b32 v14, v15
    v_mov_b32 v15, s4
    ds_write_b32 v3, v15 offset:20
    s_mul_i32 s81, s81, s6
    s_add_u32 s80, s80, s81
    s_lshl_b32 s81, s10, 12
    s_sub_u32 s80, s81, s80
    s_ashr_i32 s80, s80, 6
    s_min_i32 s80, s80, 0x40000
    s_max_i32 s80, s80, 0xfffc0000
    s_mul_i32 s80, s80, 655
    s_ashr_i32 s80, s80, 12
    s_and_b32 s7, s7, 255
    s_add_u32 s7, s7, s80
    s_add_u32 s7, s7, 5248
    s_ashr_i32 s8, s7, 8
    s_min_i32 s8, s8, 36
    s_max_i32 s8, s8, 16
    s_cmp_lt_u32 s4, 3
    s_cselect_b32 s8, 21, s8
L_gw:
    s_add_u32 s80, s8, 2304
    v_lshl_add_u32 v15, v8, 8, s80
    ds_write_b32 v3, v15 offset:44
    s_cmp_lt_u32 s4, 256
    s_cbranch_scc1 L_g
    s_endpgm
L_exch:
    s_getpc_b64 s[26:27]
L_pc:
    s_sub_u32 s26, s26, L_pc-standalone__kv_cache_quant_pre_rope_vs_post_rope__decode_kernel
    s_subb_u32 s27, s27, 0
    s_lshr_b32 s80, s2, 3
    s_lshl_b32 s80, s80, 9
    v_lshl_add_u32 v10, v1, 3, s80
    v_min_u32 v10, L_end-standalone__kv_cache_quant_pre_rope_vs_post_rope__decode_kernel, v10
    global_load_dword v7, v10, s[26:27]
    s_waitcnt lgkmcnt(0)
    s_barrier
    s_mov_b32 s12, s74
    s_mov_b32 s13, s75
    s_mov_b32 s14, 1610612736
    s_mov_b32 s15, 0x20000
    s_mov_b32 s80, 4352
    v_mul_lo_u32 v5, v1, s80
    s_lshr_b32 s80, s2, 3
    s_mul_i32 s21, s79, 5
    s_add_u32 s21, s21, s80
    s_and_b32 s21, s21, 31
    s_lshr_b32 s80, s80, 5
    s_lshl_b32 s80, s80, 3
    s_add_u32 s80, s80, s79
    s_mul_i32 s80, s80, 4352
    s_waitcnt vmcnt(0)
    v_mov_b32 v7, s80
    s_mov_b32 s16, 0
    s_mov_b32 s17, 33554432
    s_mov_b32 s18, 8
    s_mov_b32 s20, 0
    s_mov_b32 s19, 0
    s_mov_b32 s24, 0
L_pc0:
L_pw1:
    s_sleep 8
    ds_read_b32 v4, v3 offset:20
    s_waitcnt lgkmcnt(0)
    v_readfirstlane_b32 s80, v4
    s_nop 0
    s_cmp_lt_i32 s80, s18
    s_nop 2
    s_cbranch_scc1 L_pw1
    s_lshl_b32 s80, s18, 2
    s_add_u32 s80, s80, 157824
    v_mov_b32 v8, s80
    ds_read_b32 v6, v8
    s_waitcnt lgkmcnt(0)
    s_and_b32 s80, s16, 31
    s_cmp_eq_u32 s80, s21
    s_cbranch_scc0 L_np
    s_mov_b64 exec, 1
    buffer_store_dword v6, v7, s[12:15], s17 offen sc0 sc1
    s_mov_b64 exec, -1
L_np:
    s_add_u32 s81, s18, 4
L_pw2:
    s_sleep 8
    ds_read_b32 v4, v3 offset:20
    s_waitcnt lgkmcnt(0)
    v_readfirstlane_b32 s80, v4
    s_nop 0
    s_cmp_lt_i32 s80, s81
    s_nop 2
    s_cbranch_scc1 L_pw2
    s_add_u32 s30, s74, s17
    s_addc_u32 s31, s75, 0
    s_load_dword s32, s[30:31], 0
    s_load_dword s33, s[30:31], 4352
    s_load_dword s34, s[30:31], 8704
    s_load_dword s35, s[30:31], 13056
    s_load_dword s36, s[30:31], 17408
    s_load_dword s37, s[30:31], 21760
    s_load_dword s38, s[30:31], 26112
    s_load_dword s39, s[30:31], 30464
    s_memrealtime s[22:23]
    v_readfirstlane_b32 s26, v6
    s_mov_b32 s27, 0
    s_mov_b32 s28, 0
    s_mov_b32 s29, -4096
    s_waitcnt lgkmcnt(0)
    s_sub_u32 s83, s22, s26
    s_sub_u32 s80, s32, s26
    s_add_u32 s81, s80, 4096
    s_cmp_lt_u32 s81, 0x2000
    s_cselect_b32 s80, s80, s83
    s_addc_u32 s28, s28, 0
    s_add_u32 s27, s27, s80
    s_sub_u32 s80, s33, s26
    s_add_u32 s81, s80, 4096
    s_cmp_lt_u32 s81, 0x2000
    s_cselect_b32 s80, s80, s83
    s_addc_u32 s28, s28, 0
    s_add_u32 s27, s27, s80
    s_sub_u32 s80, s34, s26
    s_add_u32 s81, s80, 4096
    s_cmp_lt_u32 s81, 0x2000
    s_cselect_b32 s80, s80, s83
    s_addc_u32 s28, s28, 0
    s_add_u32 s27, s27, s80
    s_sub_u32 s80, s35, s26
    s_add_u32 s81, s80, 4096
    s_cmp_lt_u32 s81, 0x2000
    s_cselect_b32 s80, s80, s83
    s_addc_u32 s28, s28, 0
    s_add_u32 s27, s27, s80
    s_sub_u32 s80, s36, s26
    s_add_u32 s81, s80, 4096
    s_cmp_lt_u32 s81, 0x2000
    s_cselect_b32 s80, s80, s83
    s_addc_u32 s28, s28, 0
    s_add_u32 s27, s27, s80
    s_sub_u32 s80, s37, s26
    s_add_u32 s81, s80, 4096
    s_cmp_lt_u32 s81, 0x2000
    s_cselect_b32 s80, s80, s83
    s_addc_u32 s28, s28, 0
    s_add_u32 s27, s27, s80
    s_sub_u32 s80, s38, s26
    s_add_u32 s81, s80, 4096
    s_cmp_lt_u32 s81, 0x2000
    s_cselect_b32 s80, s80, s83
    s_addc_u32 s28, s28, 0
    s_add_u32 s27, s27, s80
    s_sub_u32 s80, s39, s26
    s_add_u32 s81, s80, 4096
    s_cmp_lt_u32 s81, 0x2000
    s_cselect_b32 s80, s80, s83
    s_addc_u32 s28, s28, 0
    s_add_u32 s27, s27, s80
    s_cmp_lt_u32 s28, 4
    s_cbranch_scc1 L_pskip
    s_mul_i32 s27, s27, 512
    s_lshl_b32 s80, s26, 12
    s_add_u32 s80, s80, s27
    s_min_u32 s82, s18, 0
    s_lshl_b32 s83, s18, 5
    s_add_u32 s82, s82, s83
    s_sub_u32 s81, s80, s19
    s_sub_u32 s83, s82, s24
    v_cvt_f32_u32 v8, s81
    v_cvt_f32_u32 v9, s83
    v_rcp_f32 v9, v9
    v_mul_f32 v8, 0x3f800000, v8
    v_mul_f32 v8, v8, v9
    v_mul_f32 v9, 0x3f7851ec, v8
    v_mov_b32 v10, 0x459f8000
    v_mul_f32 v8, 0x3f828f5c, v8
    v_med3_f32 v8, v8, v9, v10
    v_cvt_u32_f32 v8, v8
    s_nop 0
    v_readfirstlane_b32 s81, v8
    s_mov_b32 s19, s80
    s_mov_b32 s24, s82
    s_cmp_eq_u32 s20, 0
    s_cselect_b32 s81, 5104, s81
    s_mov_b32 s20, 1
    s_mul_i32 s82, s82, s81
    s_sub_u32 s80, s80, s82
    v_mov_b32 v8, s80
    v_mov_b32 v9, s81
    ds_write_b64 v3, v[8:9] offset:24
    s_nop 0
L_pskip:
    s_add_u32 s16, s16, 1
    s_add_u32 s17, s17, 34816
    s_add_u32 s18, s18, 16
    s_cmp_lt_u32 s18, 250
    s_cbranch_scc1 L_pc0
L_end:
    s_endpgm
.section .rodata,"a"
.p2align 6
.amdhsa_kernel standalone__kv_cache_quant_pre_rope_vs_post_rope__decode_kernel
  .amdhsa_next_free_vgpr 168
  .amdhsa_next_free_sgpr 96
  .amdhsa_accum_offset 168
  .amdhsa_group_segment_fixed_size 0
  .amdhsa_kernarg_size 112
  .amdhsa_user_sgpr_count 2
  .amdhsa_user_sgpr_kernarg_segment_ptr 1
  .amdhsa_system_sgpr_workgroup_id_x 1
.end_amdhsa_kernel
```

```asm
; @launch grid=(256,1,1) block=(512,1,1) lds=159168
.amdgcn_target "amdgcn-amd-amdhsa--gfx950"
.text
.globl standalone__kv_cache_quant_pre_rope_vs_post_rope__decode_kernel
.p2align 8
.type standalone__kv_cache_quant_pre_rope_vs_post_rope__decode_kernel,@function
standalone__kv_cache_quant_pre_rope_vs_post_rope__decode_kernel:
    s_cmp_ge_u32 s2, 256
    s_cbranch_scc1 L_end
    s_load_dwordx16 s[48:63], s[0:1], 0
    s_load_dwordx8 s[64:71], s[0:1], 64
    s_load_dwordx4 s[72:75], s[0:1], 96
    s_memrealtime s[84:85]
    v_lshrrev_b32 v4, 6, v0
    v_and_b32 v1, 63, v0
    v_readfirstlane_b32 s76, v4
    v_lshlrev_b32 v2, 4, v1
    v_mov_b32 v3, 158912
    s_lshl_b32 s76, s76, 2
    s_lshr_b32 s76, 0x65372104, s76
    s_and_b32 s76, s76, 7
    s_and_b32 s79, s2, 7
    s_lshr_b32 s80, s2, 3
    s_and_b32 s77, s80, 3
    s_lshr_b32 s80, s80, 2
    s_lshr_b32 s78, s80, 2
    s_lshl_b32 s78, s78, 3
    s_add_u32 s78, s78, s79
    s_lshl_b32 s78, s78, 2
    s_and_b32 s80, s80, 3
    s_add_u32 s78, s78, s80
    s_cmp_eq_u32 s76, 4
    s_cbranch_scc1 L_ld
    s_cmp_eq_u32 s76, 7
    s_cbranch_scc0 L_nopf
    s_getpc_b64 s[26:27]
L_pc:
    s_sub_u32 s26, s26, L_pc-standalone__kv_cache_quant_pre_rope_vs_post_rope__decode_kernel
    s_subb_u32 s27, s27, 0
    s_lshr_b32 s80, s2, 3
    s_lshl_b32 s80, s80, 9
    v_lshl_add_u32 v5, v1, 3, s80
    v_min_u32 v5, L_end-standalone__kv_cache_quant_pre_rope_vs_post_rope__decode_kernel, v5
    global_load_dword v7, v5, s[26:27]
    s_nop 0
L_nopf:
    v_cmp_eq_u32 vcc, 11, v1
    v_mov_b32 v5, 2328
    v_lshl_add_u32 v6, v1, 2, v3
    v_cndmask_b32 v5, 0, v5, vcc
    ds_write_b32 v6, v5
    s_waitcnt lgkmcnt(0)
    s_barrier
    s_branch L_notld
L_ld:
    s_setprio 3
    s_mul_i32 s8, s77, 12582912
    s_mul_i32 s80, s78, 12288
    s_add_u32 s8, s8, s80
    s_mul_i32 s16, s77, 4
    s_mul_i32 s17, s77, 4
    s_and_b32 s80, s16, 15
    s_mul_i32 s9, s80, 786432
    s_add_u32 s9, s9, s8
    s_mov_b32 m0, 0
    s_mov_b32 s6, 402653184
    s_mov_b32 s7, 0x20000
    s_waitcnt lgkmcnt(0)
    s_mov_b32 s4, s50
    s_mov_b32 s5, s51
    buffer_load_dwordx4 v2, s[4:7], s9 offen offset:0 nt lds
    buffer_load_dwordx4 v2, s[4:7], s9 offen offset:1024 nt lds
    buffer_load_dwordx4 v2, s[4:7], s9 offen offset:2048 nt lds
    buffer_load_dwordx4 v2, s[4:7], s9 offen offset:3072 nt lds
    s_add_u32 s9, s9, 4096
    s_add_u32 m0, m0, 4096
    s_nop 0
    buffer_load_dwordx4 v2, s[4:7], s9 offen offset:0 nt lds
    buffer_load_dwordx4 v2, s[4:7], s9 offen offset:1024 nt lds
    buffer_load_dwordx4 v2, s[4:7], s9 offen offset:2048 nt lds
    buffer_load_dwordx4 v2, s[4:7], s9 offen offset:3072 nt lds
    s_add_u32 s9, s9, 4096
    s_add_u32 m0, m0, 4096
    s_nop 0
    buffer_load_dwordx4 v2, s[4:7], s9 offen offset:0 nt lds
    buffer_load_dwordx4 v2, s[4:7], s9 offen offset:1024 nt lds
    buffer_load_dwordx4 v2, s[4:7], s9 offen offset:2048 nt lds
    buffer_load_dwordx4 v2, s[4:7], s9 offen offset:3072 nt lds
    s_add_u32 s9, s9, 4096
    s_add_u32 m0, m0, 4096
    s_barrier
    s_add_u32 s9, s9, 774144
    buffer_load_dwordx4 v2, s[4:7], s9 offen offset:0 nt lds
    buffer_load_dwordx4 v2, s[4:7], s9 offen offset:1024 nt lds
    buffer_load_dwordx4 v2, s[4:7], s9 offen offset:2048 nt lds
    buffer_load_dwordx4 v2, s[4:7], s9 offen offset:3072 nt lds
    s_add_u32 s9, s9, 4096
    s_add_u32 m0, m0, 4096
    s_nop 0
    buffer_load_dwordx4 v2, s[4:7], s9 offen offset:0 nt lds
    buffer_load_dwordx4 v2, s[4:7], s9 offen offset:1024 nt lds
    buffer_load_dwordx4 v2, s[4:7], s9 offen offset:2048 nt lds
    buffer_load_dwordx4 v2, s[4:7], s9 offen offset:3072 nt lds
    s_add_u32 s9, s9, 4096
    s_add_u32 m0, m0, 4096
    s_nop 0
    buffer_load_dwordx4 v2, s[4:7], s9 offen offset:0 nt lds
    buffer_load_dwordx4 v2, s[4:7], s9 offen offset:1024 nt lds
    buffer_load_dwordx4 v2, s[4:7], s9 offen offset:2048 nt lds
    buffer_load_dwordx4 v2, s[4:7], s9 offen offset:3072 nt lds
    s_add_u32 s9, s9, 4096
    s_add_u32 m0, m0, 4096
    s_mov_b32 s10, 1
    v_mov_b32 v5, 24
    v_mov_b32 v7, 2328
    s_nop 1
L_next:
    s_add_u32 s10, s10, 1
    s_cmp_eq_u32 m0, 110592
    s_cselect_b32 m0, 0, m0
    s_waitcnt lgkmcnt(4)
    v_readfirstlane_b32 s11, v7
    s_add_u32 s12, m0, 12288
    s_add_u32 s9, s9, 774144
    s_and_b32 s80, s10, 3
    s_cbranch_scc0 L_addr
L_aj:
    s_lshr_b32 s80, s11, 8
    ds_read_b32 v7, v3 offset:44
    s_cmp_gt_u32 s80, s10
    s_cbranch_scc0 L_full
    s_and_b32 s15, s11, 255
    s_cmp_ge_i32 s15, 26
    s_cbranch_scc1 L_t_26_36
    s_cmp_ge_i32 s15, 21
    s_cbranch_scc1 L_t_21_25
    s_cmp_ge_i32 s15, 18
    s_cbranch_scc1 L_t_18_20
    s_cmp_ge_i32 s15, 17
    s_cbranch_scc1 L_v17
    s_branch L_v16
L_t_18_20:
    s_cmp_ge_i32 s15, 19
    s_cbranch_scc1 L_t_19_20
    s_branch L_v18
L_t_19_20:
    s_cmp_ge_i32 s15, 20
    s_cbranch_scc1 L_v20
    s_branch L_v19
L_t_21_25:
    s_cmp_ge_i32 s15, 23
    s_cbranch_scc1 L_t_23_25
    s_cmp_ge_i32 s15, 22
    s_cbranch_scc1 L_v22
    s_branch L_v21
L_t_23_25:
    s_cmp_ge_i32 s15, 24
    s_cbranch_scc1 L_t_24_25
    s_branch L_v23
L_t_24_25:
    s_cmp_ge_i32 s15, 25
    s_cbranch_scc1 L_v25
    s_branch L_v24
L_t_26_36:
    s_cmp_ge_i32 s15, 31
    s_cbranch_scc1 L_t_31_36
    s_cmp_ge_i32 s15, 28
    s_cbranch_scc1 L_t_28_30
    s_cmp_ge_i32 s15, 27
    s_cbranch_scc1 L_v27
    s_branch L_v26
L_t_28_30:
    s_cmp_ge_i32 s15, 29
    s_cbranch_scc1 L_t_29_30
    s_branch L_v28
L_t_29_30:
    s_cmp_ge_i32 s15, 30
    s_cbranch_scc1 L_v30
    s_branch L_v29
L_t_31_36:
    s_cmp_ge_i32 s15, 34
    s_cbranch_scc1 L_t_34_36
    s_cmp_ge_i32 s15, 32
    s_cbranch_scc1 L_t_32_33
    s_branch L_v31
L_t_32_33:
    s_cmp_ge_i32 s15, 33
    s_cbranch_scc1 L_v33
    s_branch L_v32
L_t_34_36:
    s_cmp_ge_i32 s15, 35
    s_cbranch_scc1 L_t_35_36
    s_branch L_v34
L_t_35_36:
    s_cmp_ge_i32 s15, 36
    s_cbranch_scc1 L_v36
    s_branch L_v35
L_v16:
    s_waitcnt vmcnt(15)
    buffer_load_dwordx4 v2, s[4:7], s9 offen offset:0 nt lds
    s_waitcnt vmcnt(15)
    buffer_load_dwordx4 v2, s[4:7], s9 offen offset:1024 nt lds
    s_waitcnt vmcnt(15)
    buffer_load_dwordx4 v2, s[4:7], s9 offen offset:2048 nt lds
    v_subrev_u32 v6, 13, v5
    s_add_u32 m0, m0, 3072
    ds_write_b32 v3, v6 offset:16
    v_add_u32 v5, 3, v5
    s_add_u32 s9, s9, 3072
    s_cmp_lg_u32 m0, s12
    s_cbranch_scc1 L_v16
    s_branch L_next
L_v17:
    s_waitcnt vmcnt(16)
    buffer_load_dwordx4 v2, s[4:7], s9 offen offset:0 nt lds
    s_waitcnt vmcnt(16)
    buffer_load_dwordx4 v2, s[4:7], s9 offen offset:1024 nt lds
    s_waitcnt vmcnt(16)
    buffer_load_dwordx4 v2, s[4:7], s9 offen offset:2048 nt lds
    v_subrev_u32 v6, 14, v5
    s_add_u32 m0, m0, 3072
    ds_write_b32 v3, v6 offset:16
    v_add_u32 v5, 3, v5
    s_add_u32 s9, s9, 3072
    s_cmp_lg_u32 m0, s12
    s_cbranch_scc1 L_v17
    s_branch L_next
L_v18:
    s_waitcnt vmcnt(17)
    buffer_load_dwordx4 v2, s[4:7], s9 offen offset:0 nt lds
    s_waitcnt vmcnt(17)
    buffer_load_dwordx4 v2, s[4:7], s9 offen offset:1024 nt lds
    s_waitcnt vmcnt(17)
    buffer_load_dwordx4 v2, s[4:7], s9 offen offset:2048 nt lds
    v_subrev_u32 v6, 15, v5
    s_add_u32 m0, m0, 3072
    ds_write_b32 v3, v6 offset:16
    v_add_u32 v5, 3, v5
    s_add_u32 s9, s9, 3072
    s_cmp_lg_u32 m0, s12
    s_cbranch_scc1 L_v18
    s_branch L_next
L_v19:
    s_waitcnt vmcnt(18)
    buffer_load_dwordx4 v2, s[4:7], s9 offen offset:0 nt lds
    s_waitcnt vmcnt(18)
    buffer_load_dwordx4 v2, s[4:7], s9 offen offset:1024 nt lds
    s_waitcnt vmcnt(18)
    buffer_load_dwordx4 v2, s[4:7], s9 offen offset:2048 nt lds
    v_subrev_u32 v6, 16, v5
    s_add_u32 m0, m0, 3072
    ds_write_b32 v3, v6 offset:16
    v_add_u32 v5, 3, v5
    s_add_u32 s9, s9, 3072
    s_cmp_lg_u32 m0, s12
    s_cbranch_scc1 L_v19
    s_branch L_next
L_v20:
    s_waitcnt vmcnt(19)
    buffer_load_dwordx4 v2, s[4:7], s9 offen offset:0 nt lds
    s_waitcnt vmcnt(19)
    buffer_load_dwordx4 v2, s[4:7], s9 offen offset:1024 nt lds
    s_waitcnt vmcnt(19)
    buffer_load_dwordx4 v2, s[4:7], s9 offen offset:2048 nt lds
    v_subrev_u32 v6, 17, v5
    s_add_u32 m0, m0, 3072
    ds_write_b32 v3, v6 offset:16
    v_add_u32 v5, 3, v5
    s_add_u32 s9, s9, 3072
    s_cmp_lg_u32 m0, s12
    s_cbranch_scc1 L_v20
    s_branch L_next
L_v21:
    s_waitcnt vmcnt(20)
    buffer_load_dwordx4 v2, s[4:7], s9 offen offset:0 nt lds
    s_waitcnt vmcnt(20)
    buffer_load_dwordx4 v2, s[4:7], s9 offen offset:1024 nt lds
    s_waitcnt vmcnt(20)
    buffer_load_dwordx4 v2, s[4:7], s9 offen offset:2048 nt lds
    v_subrev_u32 v6, 18, v5
    s_add_u32 m0, m0, 3072
    ds_write_b32 v3, v6 offset:16
    v_add_u32 v5, 3, v5
    s_add_u32 s9, s9, 3072
    s_cmp_lg_u32 m0, s12
    s_cbranch_scc1 L_v21
    s_branch L_next
L_v22:
    s_waitcnt vmcnt(21)
    buffer_load_dwordx4 v2, s[4:7], s9 offen offset:0 nt lds
    s_waitcnt vmcnt(21)
    buffer_load_dwordx4 v2, s[4:7], s9 offen offset:1024 nt lds
    s_waitcnt vmcnt(21)
    buffer_load_dwordx4 v2, s[4:7], s9 offen offset:2048 nt lds
    v_subrev_u32 v6, 19, v5
    s_add_u32 m0, m0, 3072
    ds_write_b32 v3, v6 offset:16
    v_add_u32 v5, 3, v5
    s_add_u32 s9, s9, 3072
    s_cmp_lg_u32 m0, s12
    s_cbranch_scc1 L_v22
    s_branch L_next
L_v23:
    s_waitcnt vmcnt(22)
    buffer_load_dwordx4 v2, s[4:7], s9 offen offset:0 nt lds
    s_waitcnt vmcnt(22)
    buffer_load_dwordx4 v2, s[4:7], s9 offen offset:1024 nt lds
    s_waitcnt vmcnt(22)
    buffer_load_dwordx4 v2, s[4:7], s9 offen offset:2048 nt lds
    v_subrev_u32 v6, 20, v5
    s_add_u32 m0, m0, 3072
    ds_write_b32 v3, v6 offset:16
    v_add_u32 v5, 3, v5
    s_add_u32 s9, s9, 3072
    s_cmp_lg_u32 m0, s12
    s_cbranch_scc1 L_v23
    s_branch L_next
L_v24:
    s_waitcnt vmcnt(23)
    buffer_load_dwordx4 v2, s[4:7], s9 offen offset:0 nt lds
    s_waitcnt vmcnt(23)
    buffer_load_dwordx4 v2, s[4:7], s9 offen offset:1024 nt lds
    s_waitcnt vmcnt(23)
    buffer_load_dwordx4 v2, s[4:7], s9 offen offset:2048 nt lds
    v_subrev_u32 v6, 21, v5
    s_add_u32 m0, m0, 3072
    ds_write_b32 v3, v6 offset:16
    v_add_u32 v5, 3, v5
    s_add_u32 s9, s9, 3072
    s_cmp_lg_u32 m0, s12
    s_cbranch_scc1 L_v24
    s_branch L_next
L_v25:
    s_waitcnt vmcnt(24)
    buffer_load_dwordx4 v2, s[4:7], s9 offen offset:0 nt lds
    s_waitcnt vmcnt(24)
    buffer_load_dwordx4 v2, s[4:7], s9 offen offset:1024 nt lds
    s_waitcnt vmcnt(24)
    buffer_load_dwordx4 v2, s[4:7], s9 offen offset:2048 nt lds
    v_subrev_u32 v6, 22, v5
    s_add_u32 m0, m0, 3072
    ds_write_b32 v3, v6 offset:16
    v_add_u32 v5, 3, v5
    s_add_u32 s9, s9, 3072
    s_cmp_lg_u32 m0, s12
    s_cbranch_scc1 L_v25
    s_branch L_next
L_v26:
    s_waitcnt vmcnt(25)
    buffer_load_dwordx4 v2, s[4:7], s9 offen offset:0 nt lds
    s_waitcnt vmcnt(25)
    buffer_load_dwordx4 v2, s[4:7], s9 offen offset:1024 nt lds
    s_waitcnt vmcnt(25)
    buffer_load_dwordx4 v2, s[4:7], s9 offen offset:2048 nt lds
    v_subrev_u32 v6, 23, v5
    s_add_u32 m0, m0, 3072
    ds_write_b32 v3, v6 offset:16
    v_add_u32 v5, 3, v5
    s_add_u32 s9, s9, 3072
    s_cmp_lg_u32 m0, s12
    s_cbranch_scc1 L_v26
    s_branch L_next
L_v27:
    s_waitcnt vmcnt(26)
    buffer_load_dwordx4 v2, s[4:7], s9 offen offset:0 nt lds
    s_waitcnt vmcnt(26)
    buffer_load_dwordx4 v2, s[4:7], s9 offen offset:1024 nt lds
    s_waitcnt vmcnt(26)
    buffer_load_dwordx4 v2, s[4:7], s9 offen offset:2048 nt lds
    v_subrev_u32 v6, 24, v5
    s_add_u32 m0, m0, 3072
    ds_write_b32 v3, v6 offset:16
    v_add_u32 v5, 3, v5
    s_add_u32 s9, s9, 3072
    s_cmp_lg_u32 m0, s12
    s_cbranch_scc1 L_v27
    s_branch L_next
L_v28:
    s_waitcnt vmcnt(27)
    buffer_load_dwordx4 v2, s[4:7], s9 offen offset:0 nt lds
    s_waitcnt vmcnt(27)
    buffer_load_dwordx4 v2, s[4:7], s9 offen offset:1024 nt lds
    s_waitcnt vmcnt(27)
    buffer_load_dwordx4 v2, s[4:7], s9 offen offset:2048 nt lds
    v_subrev_u32 v6, 25, v5
    s_add_u32 m0, m0, 3072
    ds_write_b32 v3, v6 offset:16
    v_add_u32 v5, 3, v5
    s_add_u32 s9, s9, 3072
    s_cmp_lg_u32 m0, s12
    s_cbranch_scc1 L_v28
    s_branch L_next
L_v29:
    s_waitcnt vmcnt(28)
    buffer_load_dwordx4 v2, s[4:7], s9 offen offset:0 nt lds
    s_waitcnt vmcnt(28)
    buffer_load_dwordx4 v2, s[4:7], s9 offen offset:1024 nt lds
    s_waitcnt vmcnt(28)
    buffer_load_dwordx4 v2, s[4:7], s9 offen offset:2048 nt lds
    v_subrev_u32 v6, 26, v5
    s_add_u32 m0, m0, 3072
    ds_write_b32 v3, v6 offset:16
    v_add_u32 v5, 3, v5
    s_add_u32 s9, s9, 3072
    s_cmp_lg_u32 m0, s12
    s_cbranch_scc1 L_v29
    s_branch L_next
L_v30:
    s_waitcnt vmcnt(29)
    buffer_load_dwordx4 v2, s[4:7], s9 offen offset:0 nt lds
    s_waitcnt vmcnt(29)
    buffer_load_dwordx4 v2, s[4:7], s9 offen offset:1024 nt lds
    s_waitcnt vmcnt(29)
    buffer_load_dwordx4 v2, s[4:7], s9 offen offset:2048 nt lds
    v_subrev_u32 v6, 27, v5
    s_add_u32 m0, m0, 3072
    ds_write_b32 v3, v6 offset:16
    v_add_u32 v5, 3, v5
    s_add_u32 s9, s9, 3072
    s_cmp_lg_u32 m0, s12
    s_cbranch_scc1 L_v30
    s_branch L_next
L_v31:
    s_waitcnt vmcnt(30)
    buffer_load_dwordx4 v2, s[4:7], s9 offen offset:0 nt lds
    s_waitcnt vmcnt(30)
    buffer_load_dwordx4 v2, s[4:7], s9 offen offset:1024 nt lds
    s_waitcnt vmcnt(30)
    buffer_load_dwordx4 v2, s[4:7], s9 offen offset:2048 nt lds
    v_subrev_u32 v6, 28, v5
    s_add_u32 m0, m0, 3072
    ds_write_b32 v3, v6 offset:16
    v_add_u32 v5, 3, v5
    s_add_u32 s9, s9, 3072
    s_cmp_lg_u32 m0, s12
    s_cbranch_scc1 L_v31
    s_branch L_next
L_v32:
    s_waitcnt vmcnt(31)
    buffer_load_dwordx4 v2, s[4:7], s9 offen offset:0 nt lds
    s_waitcnt vmcnt(31)
    buffer_load_dwordx4 v2, s[4:7], s9 offen offset:1024 nt lds
    s_waitcnt vmcnt(31)
    buffer_load_dwordx4 v2, s[4:7], s9 offen offset:2048 nt lds
    v_subrev_u32 v6, 29, v5
    s_add_u32 m0, m0, 3072
    ds_write_b32 v3, v6 offset:16
    v_add_u32 v5, 3, v5
    s_add_u32 s9, s9, 3072
    s_cmp_lg_u32 m0, s12
    s_cbranch_scc1 L_v32
    s_branch L_next
L_v33:
    s_waitcnt vmcnt(32)
    buffer_load_dwordx4 v2, s[4:7], s9 offen offset:0 nt lds
    s_waitcnt vmcnt(32)
    buffer_load_dwordx4 v2, s[4:7], s9 offen offset:1024 nt lds
    s_waitcnt vmcnt(32)
    buffer_load_dwordx4 v2, s[4:7], s9 offen offset:2048 nt lds
    v_subrev_u32 v6, 30, v5
    s_add_u32 m0, m0, 3072
    ds_write_b32 v3, v6 offset:16
    v_add_u32 v5, 3, v5
    s_add_u32 s9, s9, 3072
    s_cmp_lg_u32 m0, s12
    s_cbranch_scc1 L_v33
    s_branch L_next
L_v34:
    s_waitcnt vmcnt(33)
    buffer_load_dwordx4 v2, s[4:7], s9 offen offset:0 nt lds
    s_waitcnt vmcnt(33)
    buffer_load_dwordx4 v2, s[4:7], s9 offen offset:1024 nt lds
    s_waitcnt vmcnt(33)
    buffer_load_dwordx4 v2, s[4:7], s9 offen offset:2048 nt lds
    v_subrev_u32 v6, 31, v5
    s_add_u32 m0, m0, 3072
    ds_write_b32 v3, v6 offset:16
    v_add_u32 v5, 3, v5
    s_add_u32 s9, s9, 3072
    s_cmp_lg_u32 m0, s12
    s_cbranch_scc1 L_v34
    s_branch L_next
L_v35:
    s_waitcnt vmcnt(34)
    buffer_load_dwordx4 v2, s[4:7], s9 offen offset:0 nt lds
    s_waitcnt vmcnt(34)
    buffer_load_dwordx4 v2, s[4:7], s9 offen offset:1024 nt lds
    s_waitcnt vmcnt(34)
    buffer_load_dwordx4 v2, s[4:7], s9 offen offset:2048 nt lds
    v_subrev_u32 v6, 32, v5
    s_add_u32 m0, m0, 3072
    ds_write_b32 v3, v6 offset:16
    v_add_u32 v5, 3, v5
    s_add_u32 s9, s9, 3072
    s_cmp_lg_u32 m0, s12
    s_cbranch_scc1 L_v35
    s_branch L_next
L_v36:
    s_waitcnt vmcnt(35)
    buffer_load_dwordx4 v2, s[4:7], s9 offen offset:0 nt lds
    s_waitcnt vmcnt(35)
    buffer_load_dwordx4 v2, s[4:7], s9 offen offset:1024 nt lds
    s_waitcnt vmcnt(35)
    buffer_load_dwordx4 v2, s[4:7], s9 offen offset:2048 nt lds
    v_subrev_u32 v6, 33, v5
    s_add_u32 m0, m0, 3072
    ds_write_b32 v3, v6 offset:16
    v_add_u32 v5, 3, v5
    s_add_u32 s9, s9, 3072
    s_cmp_lg_u32 m0, s12
    s_cbranch_scc1 L_v36
    s_branch L_next
L_full:
    s_waitcnt lgkmcnt(0)
    v_readfirstlane_b32 s11, v7
    s_nop 4
    s_branch L_aj
L_addr:
    s_cmp_lt_u32 s10, 128
    s_cbranch_scc0 L_av
    s_lshr_b32 s80, s10, 5
    s_lshl_b32 s80, s80, 2
    s_add_u32 s80, s80, s16
    s_bfe_u32 s81, s10, 0x30002
    s_bitcmp1_b32 s10, 5
    s_cselect_b32 s82, 7, 0
    s_xor_b32 s81, s81, s82
    s_branch L_ak
L_av:
    s_cmp_eq_u32 s10, 256
    s_cbranch_scc1 L_drain
    s_mov_b32 s4, s56
    s_mov_b32 s5, s57
    s_add_u32 s80, s10, s17
    s_bfe_u32 s81, s10, 0x30004
    s_xor_b32 s81, s81, 7
L_ak:
    s_and_b32 s80, s80, 15
    s_mul_i32 s80, s80, 786432
    s_mul_i32 s81, s81, 50331648
    s_add_u32 s9, s80, s81
    s_add_u32 s9, s9, s8
    s_branch L_aj
L_drain:
    v_mov_b32 v6, 3048
    s_waitcnt vmcnt(24)
    ds_write_b32 v3, v6 offset:16
    v_mov_b32 v6, 3060
    s_waitcnt vmcnt(12)
    ds_write_b32 v3, v6 offset:16
    v_mov_b32 v6, 3072
    s_waitcnt vmcnt(0)
    ds_write_b32 v3, v6 offset:16
    s_endpgm
L_notld:
    s_cmp_gt_u32 s76, 4
    s_cbranch_scc1 L_aux
    v_lshrrev_b32 v21, 4, v1
    v_and_b32 v22, 15, v1
    v_mul_u32_u24 v16, 384, v21
    v_lshl_add_u32 v16, v22, 3, v16
    v_cmp_gt_u32 vcc, 8, v22
    v_xor_b32 v17, 64, v16
    s_mul_i32 s24, s77, 4
    s_and_b32 s24, s24, 15
    s_lshl_b32 s80, s78, 2
    s_add_u32 s80, s80, s76
    s_mul_i32 s83, s80, 1536
    s_mul_i32 s16, s24, 393216
    s_add_u32 s16, s16, s83
    s_waitcnt lgkmcnt(0)
    s_mov_b32 s4, s66
    s_mov_b32 s5, s67
    s_mov_b32 s6, 6291456
    s_mov_b32 s7, 0x20000
    s_mov_b32 s8, s68
    s_mov_b32 s9, s69
    s_mov_b32 s10, 6291456
    s_mov_b32 s11, 0x20000
    buffer_load_dwordx2 v[120:121], v16, s[4:7], s16 offen offset:0
    buffer_load_dwordx2 v[126:127], v17, s[8:11], s16 offen offset:0
    buffer_load_dwordx2 v[122:123], v16, s[4:7], s16 offen offset:128
    buffer_load_dwordx2 v[128:129], v17, s[8:11], s16 offen offset:128
    buffer_load_dwordx2 v[124:125], v16, s[4:7], s16 offen offset:256
    buffer_load_dwordx2 v[130:131], v17, s[8:11], s16 offen offset:256
    s_add_u32 s16, s16, 393216
    buffer_load_dwordx2 v[132:133], v16, s[4:7], s16 offen offset:0
    buffer_load_dwordx2 v[138:139], v17, s[8:11], s16 offen offset:0
    buffer_load_dwordx2 v[134:135], v16, s[4:7], s16 offen offset:128
    buffer_load_dwordx2 v[140:141], v17, s[8:11], s16 offen offset:128
    buffer_load_dwordx2 v[136:137], v16, s[4:7], s16 offen offset:256
    buffer_load_dwordx2 v[142:143], v17, s[8:11], s16 offen offset:256
    s_add_u32 s16, s16, 393216
    buffer_load_dwordx2 v[144:145], v16, s[4:7], s16 offen offset:0
    buffer_load_dwordx2 v[150:151], v17, s[8:11], s16 offen offset:0
    buffer_load_dwordx2 v[146:147], v16, s[4:7], s16 offen offset:128
    buffer_load_dwordx2 v[152:153], v17, s[8:11], s16 offen offset:128
    buffer_load_dwordx2 v[148:149], v16, s[4:7], s16 offen offset:256
    buffer_load_dwordx2 v[154:155], v17, s[8:11], s16 offen offset:256
    s_add_u32 s16, s16, 393216
    buffer_load_dwordx2 v[156:157], v16, s[4:7], s16 offen offset:0
    buffer_load_dwordx2 v[162:163], v17, s[8:11], s16 offen offset:0
    buffer_load_dwordx2 v[158:159], v16, s[4:7], s16 offen offset:128
    buffer_load_dwordx2 v[164:165], v17, s[8:11], s16 offen offset:128
    buffer_load_dwordx2 v[160:161], v16, s[4:7], s16 offen offset:256
    buffer_load_dwordx2 v[166:167], v17, s[8:11], s16 offen offset:256
    s_add_u32 s16, s16, 393216
    s_mov_b32 s12, s74
    s_mov_b32 s13, s75
    s_mov_b32 s14, 1610612736
    s_mov_b32 s15, 0x20000
    s_mov_b32 s22, 0x05040100
    s_mov_b32 s23, 0x07060302
    s_lshl_b32 s80, s76, 2
    v_add_u32 v21, s80, v21
    v_mul_u32_u24 v5, 768, v21
    v_lshl_add_u32 v5, v22, 4, v5
    v_lshlrev_b32 v19, 3, v21
    v_add_u32 v19, 126976, v19
    v_lshlrev_b32 v18, 4, v22
    v_add_u32 v18, 151552, v18
    v_add_u32 v11, s80, v3
    v_mov_b32 v10, 0
    v_mov_b32 v23, 0xff
    s_mul_i32 s17, s76, 3
    s_add_u32 s17, s17, 3
    s_mov_b32 s18, 0
    s_mov_b32 s19, 0
    s_mov_b32 s20, 0
    s_mov_b32 s21, 0
    s_waitcnt vmcnt(18)
    v_cndmask_b32 v24, v130, v128, vcc
    v_cndmask_b32 v25, v131, v129, vcc
    v_cndmask_b32 v26, v126, v130, vcc
    v_cndmask_b32 v27, v127, v131, vcc
    v_cndmask_b32 v28, v128, v126, vcc
    v_cndmask_b32 v29, v129, v127, vcc
    v_perm_b32 v72, v24, v120, s22
    v_perm_b32 v73, v24, v120, s23
    v_perm_b32 v74, v25, v121, s22
    v_perm_b32 v75, v25, v121, s23
    v_perm_b32 v76, v26, v122, s22
    v_perm_b32 v77, v26, v122, s23
    v_perm_b32 v78, v27, v123, s22
    v_perm_b32 v79, v27, v123, s23
    v_perm_b32 v80, v28, v124, s22
    v_perm_b32 v81, v28, v124, s23
    v_perm_b32 v82, v29, v125, s22
    v_perm_b32 v83, v29, v125, s23
    s_waitcnt vmcnt(12)
    v_cndmask_b32 v24, v142, v140, vcc
    v_cndmask_b32 v25, v143, v141, vcc
    v_cndmask_b32 v26, v138, v142, vcc
    v_cndmask_b32 v27, v139, v143, vcc
    v_cndmask_b32 v28, v140, v138, vcc
    v_cndmask_b32 v29, v141, v139, vcc
    v_perm_b32 v84, v24, v132, s22
    v_perm_b32 v85, v24, v132, s23
    v_perm_b32 v86, v25, v133, s22
    v_perm_b32 v87, v25, v133, s23
    v_perm_b32 v88, v26, v134, s22
    v_perm_b32 v89, v26, v134, s23
    v_perm_b32 v90, v27, v135, s22
    v_perm_b32 v91, v27, v135, s23
    v_perm_b32 v92, v28, v136, s22
    v_perm_b32 v93, v28, v136, s23
    v_perm_b32 v94, v29, v137, s22
    v_perm_b32 v95, v29, v137, s23
    s_waitcnt vmcnt(6)
    v_cndmask_b32 v24, v154, v152, vcc
    v_cndmask_b32 v25, v155, v153, vcc
    v_cndmask_b32 v26, v150, v154, vcc
    v_cndmask_b32 v27, v151, v155, vcc
    v_cndmask_b32 v28, v152, v150, vcc
    v_cndmask_b32 v29, v153, v151, vcc
    v_perm_b32 v96, v24, v144, s22
    v_perm_b32 v97, v24, v144, s23
    v_perm_b32 v98, v25, v145, s22
    v_perm_b32 v99, v25, v145, s23
    v_perm_b32 v100, v26, v146, s22
    v_perm_b32 v101, v26, v146, s23
    v_perm_b32 v102, v27, v147, s22
    v_perm_b32 v103, v27, v147, s23
    v_perm_b32 v104, v28, v148, s22
    v_perm_b32 v105, v28, v148, s23
    v_perm_b32 v106, v29, v149, s22
    v_perm_b32 v107, v29, v149, s23
    s_waitcnt vmcnt(0)
    v_cndmask_b32 v24, v166, v164, vcc
    v_cndmask_b32 v25, v167, v165, vcc
    v_cndmask_b32 v26, v162, v166, vcc
    v_cndmask_b32 v27, v163, v167, vcc
    v_cndmask_b32 v28, v164, v162, vcc
    v_cndmask_b32 v29, v165, v163, vcc
    v_perm_b32 v108, v24, v156, s22
    v_perm_b32 v109, v24, v156, s23
    v_perm_b32 v110, v25, v157, s22
    v_perm_b32 v111, v25, v157, s23
    v_perm_b32 v112, v26, v158, s22
    v_perm_b32 v113, v26, v158, s23
    v_perm_b32 v114, v27, v159, s22
    v_perm_b32 v115, v27, v159, s23
    v_perm_b32 v116, v28, v160, s22
    v_perm_b32 v117, v28, v160, s23
    v_perm_b32 v118, v29, v161, s22
    v_perm_b32 v119, v29, v161, s23
    s_nop 1
L_kvisit:
    s_and_b32 s80, s20, 1
    s_cselect_b32 s80, 4, s21
    s_cmp_lt_u32 s80, 3
    s_cbranch_scc0 L_nocs
    s_cmp_ge_u32 s16, 6291456
    s_cselect_b32 s80, 6291456, 0
    s_sub_u32 s16, s16, s80
    buffer_load_dwordx2 v[60:61], v16, s[4:7], s16 offen offset:0
    buffer_load_dwordx2 v[66:67], v17, s[8:11], s16 offen offset:0
    buffer_load_dwordx2 v[62:63], v16, s[4:7], s16 offen offset:128
    buffer_load_dwordx2 v[68:69], v17, s[8:11], s16 offen offset:128
    buffer_load_dwordx2 v[64:65], v16, s[4:7], s16 offen offset:256
    buffer_load_dwordx2 v[70:71], v17, s[8:11], s16 offen offset:256
    s_add_u32 s16, s16, 393216
L_nocs:
    s_bitcmp1_b32 s21, 0
    s_cselect_b32 s82, 7, 0
    s_xor_b32 s82, s82, s20
    s_mul_i32 s80, s82, 768
    v_add_u32 v6, s80, v18
    s_lshl_b32 s80, s82, 4
    s_add_u32 s80, s80, s24
    s_lshl_b32 s81, s80, 7
    v_add_u32 v8, s81, v19
    s_nop 1
L_qw:
    ds_read_b32 v4, v3 offset:32
    ds_read_b128 v[48:51], v6 offset:0
    ds_read_b128 v[52:55], v6 offset:256
    ds_read_b128 v[56:59], v6 offset:512
    s_waitcnt lgkmcnt(0)
    v_readfirstlane_b32 s80, v4
    s_nop 0
    s_cmp_gt_u32 s80, s82
    s_nop 2
    s_cbranch_scc1 L_qwg
    s_sleep 2
    s_branch L_qw
L_qwg:
    v_dot2_f32_bf16 v24, v72, v48, 0
    v_dot2_f32_bf16 v25, v73, v49, 0
    v_dot2_f32_bf16 v26, v74, v50, 0
    v_dot2_f32_bf16 v27, v75, v51, 0
    v_dot2_f32_bf16 v28, v76, v52, 0
    v_dot2_f32_bf16 v29, v77, v53, 0
    v_dot2_f32_bf16 v30, v78, v54, 0
    v_dot2_f32_bf16 v31, v79, v55, 0
    v_dot2_f32_bf16 v32, v80, v56, 0
    v_dot2_f32_bf16 v33, v81, v57, 0
    v_dot2_f32_bf16 v34, v82, v58, 0
    v_dot2_f32_bf16 v35, v83, v59, 0
    v_add_u32 v6, s19, v5
    v_pk_add_f32 v[14:15], v[24:25], v[26:27]
    v_pk_add_f32 v[14:15], v[14:15], v[28:29]
    v_pk_add_f32 v[14:15], v[14:15], v[30:31]
    v_pk_add_f32 v[14:15], v[14:15], v[32:33]
    v_pk_add_f32 v[14:15], v[14:15], v[34:35]
    s_cmp_ge_i32 s18, s17
    s_nop 0
    s_cbranch_scc1 L_kw0g
L_kw0:
    ds_read_b32 v4, v3 offset:16
    s_waitcnt lgkmcnt(0)
    v_readfirstlane_b32 s18, v4
    s_nop 0
    s_cmp_ge_i32 s18, s17
    s_nop 2
    s_cbranch_scc1 L_kw0g
    s_sleep 1
    s_branch L_kw0
L_kw0g:
    ds_read_b128 v[36:39], v6 offset:0
    ds_read_b128 v[40:43], v6 offset:256
    ds_read_b128 v[44:47], v6 offset:512
    v_add_u32 v10, 1, v10
    s_add_u32 s19, s19, 12288
    s_cmp_eq_u32 s19, 110592
    s_cselect_b32 s19, 0, s19
    s_add_u32 s17, s17, 12
    s_waitcnt lgkmcnt(2)
    v_cvt_f32_i32 v36, v36
    v_cvt_f32_i32 v37, v37
    v_cvt_f32_i32 v38, v38
    v_cvt_f32_i32 v39, v39
    v_pk_mul_f32 v[12:13], v[36:37], v[24:25]
    v_pk_fma_f32 v[12:13], v[38:39], v[26:27], v[12:13]
    s_waitcnt lgkmcnt(1)
    v_cvt_f32_i32 v40, v40
    v_cvt_f32_i32 v41, v41
    v_cvt_f32_i32 v42, v42
    v_cvt_f32_i32 v43, v43
    v_pk_fma_f32 v[12:13], v[40:41], v[28:29], v[12:13]
    v_pk_fma_f32 v[12:13], v[42:43], v[30:31], v[12:13]
    s_waitcnt lgkmcnt(0)
    v_cvt_f32_i32 v44, v44
    v_cvt_f32_i32 v45, v45
    v_cvt_f32_i32 v46, v46
    v_cvt_f32_i32 v47, v47
    v_pk_fma_f32 v[12:13], v[44:45], v[32:33], v[12:13]
    v_pk_fma_f32 v[12:13], v[46:47], v[34:35], v[12:13]
    v_add_f32 v12, v12, v13
    v_add_f32 v13, v14, v15
    s_nop 0
    v_add_f32_dpp v12, v12, v12 quad_perm:[1,0,3,2] row_mask:0xf bank_mask:0xf
    v_add_f32_dpp v13, v13, v13 quad_perm:[1,0,3,2] row_mask:0xf bank_mask:0xf
    s_nop 0
    v_add_f32_dpp v12, v12, v12 quad_perm:[2,3,0,1] row_mask:0xf bank_mask:0xf
    v_add_f32_dpp v13, v13, v13 quad_perm:[2,3,0,1] row_mask:0xf bank_mask:0xf
    s_nop 0
    v_add_f32_dpp v12, v12, v12 row_half_mirror row_mask:0xf bank_mask:0xf
    v_add_f32_dpp v13, v13, v13 row_half_mirror row_mask:0xf bank_mask:0xf
    s_nop 0
    v_add_f32_dpp v12, v12, v12 row_mirror row_mask:0xf bank_mask:0xf
    v_add_f32_dpp v13, v13, v13 row_mirror row_mask:0xf bank_mask:0xf
    ds_write_b64 v8, v[12:13] offset:0
    ds_write_b32 v11, v10
    v_dot2_f32_bf16 v24, v84, v48, 0
    v_dot2_f32_bf16 v25, v85, v49, 0
    v_dot2_f32_bf16 v26, v86, v50, 0
    v_dot2_f32_bf16 v27, v87, v51, 0
    v_dot2_f32_bf16 v28, v88, v52, 0
    v_dot2_f32_bf16 v29, v89, v53, 0
    v_dot2_f32_bf16 v30, v90, v54, 0
    v_dot2_f32_bf16 v31, v91, v55, 0
    v_dot2_f32_bf16 v32, v92, v56, 0
    v_dot2_f32_bf16 v33, v93, v57, 0
    v_dot2_f32_bf16 v34, v94, v58, 0
    v_dot2_f32_bf16 v35, v95, v59, 0
    v_add_u32 v6, s19, v5
    v_pk_add_f32 v[14:15], v[24:25], v[26:27]
    v_pk_add_f32 v[14:15], v[14:15], v[28:29]
    v_pk_add_f32 v[14:15], v[14:15], v[30:31]
    v_pk_add_f32 v[14:15], v[14:15], v[32:33]
    v_pk_add_f32 v[14:15], v[14:15], v[34:35]
    s_cmp_ge_i32 s18, s17
    s_nop 0
    s_cbranch_scc1 L_kw1g
L_kw1:
    ds_read_b32 v4, v3 offset:16
    s_waitcnt lgkmcnt(0)
    v_readfirstlane_b32 s18, v4
    s_nop 0
    s_cmp_ge_i32 s18, s17
    s_nop 2
    s_cbranch_scc1 L_kw1g
    s_sleep 1
    s_branch L_kw1
L_kw1g:
    ds_read_b128 v[36:39], v6 offset:0
    ds_read_b128 v[40:43], v6 offset:256
    ds_read_b128 v[44:47], v6 offset:512
    v_add_u32 v10, 1, v10
    s_add_u32 s19, s19, 12288
    s_cmp_eq_u32 s19, 110592
    s_cselect_b32 s19, 0, s19
    s_add_u32 s17, s17, 12
    s_waitcnt lgkmcnt(2)
    v_cvt_f32_i32 v36, v36
    v_cvt_f32_i32 v37, v37
    v_cvt_f32_i32 v38, v38
    v_cvt_f32_i32 v39, v39
    v_pk_mul_f32 v[12:13], v[36:37], v[24:25]
    v_pk_fma_f32 v[12:13], v[38:39], v[26:27], v[12:13]
    s_waitcnt lgkmcnt(1)
    v_cvt_f32_i32 v40, v40
    v_cvt_f32_i32 v41, v41
    v_cvt_f32_i32 v42, v42
    v_cvt_f32_i32 v43, v43
    v_pk_fma_f32 v[12:13], v[40:41], v[28:29], v[12:13]
    v_pk_fma_f32 v[12:13], v[42:43], v[30:31], v[12:13]
    s_waitcnt lgkmcnt(0)
    v_cvt_f32_i32 v44, v44
    v_cvt_f32_i32 v45, v45
    v_cvt_f32_i32 v46, v46
    v_cvt_f32_i32 v47, v47
    v_pk_fma_f32 v[12:13], v[44:45], v[32:33], v[12:13]
    v_pk_fma_f32 v[12:13], v[46:47], v[34:35], v[12:13]
    v_add_f32 v12, v12, v13
    v_add_f32 v13, v14, v15
    s_nop 0
    v_add_f32_dpp v12, v12, v12 quad_perm:[1,0,3,2] row_mask:0xf bank_mask:0xf
    v_add_f32_dpp v13, v13, v13 quad_perm:[1,0,3,2] row_mask:0xf bank_mask:0xf
    s_nop 0
    v_add_f32_dpp v12, v12, v12 quad_perm:[2,3,0,1] row_mask:0xf bank_mask:0xf
    v_add_f32_dpp v13, v13, v13 quad_perm:[2,3,0,1] row_mask:0xf bank_mask:0xf
    s_nop 0
    v_add_f32_dpp v12, v12, v12 row_half_mirror row_mask:0xf bank_mask:0xf
    v_add_f32_dpp v13, v13, v13 row_half_mirror row_mask:0xf bank_mask:0xf
    s_nop 0
    v_add_f32_dpp v12, v12, v12 row_mirror row_mask:0xf bank_mask:0xf
    v_add_f32_dpp v13, v13, v13 row_mirror row_mask:0xf bank_mask:0xf
    ds_write_b64 v8, v[12:13] offset:128
    ds_write_b32 v11, v10
    v_dot2_f32_bf16 v24, v96, v48, 0
    v_dot2_f32_bf16 v25, v97, v49, 0
    v_dot2_f32_bf16 v26, v98, v50, 0
    v_dot2_f32_bf16 v27, v99, v51, 0
    v_dot2_f32_bf16 v28, v100, v52, 0
    v_dot2_f32_bf16 v29, v101, v53, 0
    v_dot2_f32_bf16 v30, v102, v54, 0
    v_dot2_f32_bf16 v31, v103, v55, 0
    v_dot2_f32_bf16 v32, v104, v56, 0
    v_dot2_f32_bf16 v33, v105, v57, 0
    v_dot2_f32_bf16 v34, v106, v58, 0
    v_dot2_f32_bf16 v35, v107, v59, 0
    v_add_u32 v6, s19, v5
    v_pk_add_f32 v[14:15], v[24:25], v[26:27]
    v_pk_add_f32 v[14:15], v[14:15], v[28:29]
    v_pk_add_f32 v[14:15], v[14:15], v[30:31]
    v_pk_add_f32 v[14:15], v[14:15], v[32:33]
    v_pk_add_f32 v[14:15], v[14:15], v[34:35]
    s_cmp_ge_i32 s18, s17
    s_nop 0
    s_cbranch_scc1 L_kw2g
L_kw2:
    ds_read_b32 v4, v3 offset:16
    s_waitcnt lgkmcnt(0)
    v_readfirstlane_b32 s18, v4
    s_nop 0
    s_cmp_ge_i32 s18, s17
    s_nop 2
    s_cbranch_scc1 L_kw2g
    s_sleep 1
    s_branch L_kw2
L_kw2g:
    ds_read_b128 v[36:39], v6 offset:0
    ds_read_b128 v[40:43], v6 offset:256
    ds_read_b128 v[44:47], v6 offset:512
    v_add_u32 v10, 1, v10
    s_add_u32 s19, s19, 12288
    s_cmp_eq_u32 s19, 110592
    s_cselect_b32 s19, 0, s19
    s_add_u32 s17, s17, 12
    s_waitcnt lgkmcnt(2)
    v_cvt_f32_i32 v36, v36
    v_cvt_f32_i32 v37, v37
    v_cvt_f32_i32 v38, v38
    v_cvt_f32_i32 v39, v39
    v_pk_mul_f32 v[12:13], v[36:37], v[24:25]
    v_pk_fma_f32 v[12:13], v[38:39], v[26:27], v[12:13]
    s_waitcnt lgkmcnt(1)
    v_cvt_f32_i32 v40, v40
    v_cvt_f32_i32 v41, v41
    v_cvt_f32_i32 v42, v42
    v_cvt_f32_i32 v43, v43
    v_pk_fma_f32 v[12:13], v[40:41], v[28:29], v[12:13]
    v_pk_fma_f32 v[12:13], v[42:43], v[30:31], v[12:13]
    s_waitcnt lgkmcnt(0)
    v_cvt_f32_i32 v44, v44
    v_cvt_f32_i32 v45, v45
    v_cvt_f32_i32 v46, v46
    v_cvt_f32_i32 v47, v47
    v_pk_fma_f32 v[12:13], v[44:45], v[32:33], v[12:13]
    v_pk_fma_f32 v[12:13], v[46:47], v[34:35], v[12:13]
    v_add_f32 v12, v12, v13
    v_add_f32 v13, v14, v15
    s_nop 0
    v_add_f32_dpp v12, v12, v12 quad_perm:[1,0,3,2] row_mask:0xf bank_mask:0xf
    v_add_f32_dpp v13, v13, v13 quad_perm:[1,0,3,2] row_mask:0xf bank_mask:0xf
    s_nop 0
    v_add_f32_dpp v12, v12, v12 quad_perm:[2,3,0,1] row_mask:0xf bank_mask:0xf
    v_add_f32_dpp v13, v13, v13 quad_perm:[2,3,0,1] row_mask:0xf bank_mask:0xf
    s_nop 0
    v_add_f32_dpp v12, v12, v12 row_half_mirror row_mask:0xf bank_mask:0xf
    v_add_f32_dpp v13, v13, v13 row_half_mirror row_mask:0xf bank_mask:0xf
    s_nop 0
    v_add_f32_dpp v12, v12, v12 row_mirror row_mask:0xf bank_mask:0xf
    v_add_f32_dpp v13, v13, v13 row_mirror row_mask:0xf bank_mask:0xf
    ds_write_b64 v8, v[12:13] offset:256
    ds_write_b32 v11, v10
    v_dot2_f32_bf16 v24, v108, v48, 0
    v_dot2_f32_bf16 v25, v109, v49, 0
    v_dot2_f32_bf16 v26, v110, v50, 0
    v_dot2_f32_bf16 v27, v111, v51, 0
    v_dot2_f32_bf16 v28, v112, v52, 0
    v_dot2_f32_bf16 v29, v113, v53, 0
    v_dot2_f32_bf16 v30, v114, v54, 0
    v_dot2_f32_bf16 v31, v115, v55, 0
    v_dot2_f32_bf16 v32, v116, v56, 0
    v_dot2_f32_bf16 v33, v117, v57, 0
    v_dot2_f32_bf16 v34, v118, v58, 0
    v_dot2_f32_bf16 v35, v119, v59, 0
    v_add_u32 v6, s19, v5
    v_pk_add_f32 v[14:15], v[24:25], v[26:27]
    v_pk_add_f32 v[14:15], v[14:15], v[28:29]
    v_pk_add_f32 v[14:15], v[14:15], v[30:31]
    v_pk_add_f32 v[14:15], v[14:15], v[32:33]
    v_pk_add_f32 v[14:15], v[14:15], v[34:35]
    s_cmp_ge_i32 s18, s17
    s_nop 0
    s_cbranch_scc1 L_kw3g
L_kw3:
    ds_read_b32 v4, v3 offset:16
    s_waitcnt lgkmcnt(0)
    v_readfirstlane_b32 s18, v4
    s_nop 0
    s_cmp_ge_i32 s18, s17
    s_nop 2
    s_cbranch_scc1 L_kw3g
    s_sleep 1
    s_branch L_kw3
L_kw3g:
    ds_read_b128 v[36:39], v6 offset:0
    ds_read_b128 v[40:43], v6 offset:256
    ds_read_b128 v[44:47], v6 offset:512
    v_add_u32 v10, 1, v10
    s_add_u32 s19, s19, 12288
    s_cmp_eq_u32 s19, 110592
    s_cselect_b32 s19, 0, s19
    s_add_u32 s17, s17, 12
    s_waitcnt lgkmcnt(2)
    v_cvt_f32_i32 v36, v36
    v_cvt_f32_i32 v37, v37
    v_cvt_f32_i32 v38, v38
    v_cvt_f32_i32 v39, v39
    v_pk_mul_f32 v[12:13], v[36:37], v[24:25]
    v_pk_fma_f32 v[12:13], v[38:39], v[26:27], v[12:13]
    s_waitcnt lgkmcnt(1)
    v_cvt_f32_i32 v40, v40
    v_cvt_f32_i32 v41, v41
    v_cvt_f32_i32 v42, v42
    v_cvt_f32_i32 v43, v43
    v_pk_fma_f32 v[12:13], v[40:41], v[28:29], v[12:13]
    v_pk_fma_f32 v[12:13], v[42:43], v[30:31], v[12:13]
    s_waitcnt lgkmcnt(0)
    v_cvt_f32_i32 v44, v44
    v_cvt_f32_i32 v45, v45
    v_cvt_f32_i32 v46, v46
    v_cvt_f32_i32 v47, v47
    v_pk_fma_f32 v[12:13], v[44:45], v[32:33], v[12:13]
    v_pk_fma_f32 v[12:13], v[46:47], v[34:35], v[12:13]
    v_add_f32 v12, v12, v13
    v_add_f32 v13, v14, v15
    s_nop 0
    v_add_f32_dpp v12, v12, v12 quad_perm:[1,0,3,2] row_mask:0xf bank_mask:0xf
    v_add_f32_dpp v13, v13, v13 quad_perm:[1,0,3,2] row_mask:0xf bank_mask:0xf
    s_nop 0
    v_add_f32_dpp v12, v12, v12 quad_perm:[2,3,0,1] row_mask:0xf bank_mask:0xf
    v_add_f32_dpp v13, v13, v13 quad_perm:[2,3,0,1] row_mask:0xf bank_mask:0xf
    s_nop 0
    v_add_f32_dpp v12, v12, v12 row_half_mirror row_mask:0xf bank_mask:0xf
    v_add_f32_dpp v13, v13, v13 row_half_mirror row_mask:0xf bank_mask:0xf
    s_nop 0
    v_add_f32_dpp v12, v12, v12 row_mirror row_mask:0xf bank_mask:0xf
    v_add_f32_dpp v13, v13, v13 row_mirror row_mask:0xf bank_mask:0xf
    ds_write_b64 v8, v[12:13] offset:384
    ds_write_b32 v11, v10
    s_add_u32 s20, s20, 1
    s_and_b32 s80, s20, 1
    s_cbranch_scc1 L_kvisit
    v_mov_b64 v[120:121], v[132:133]
    v_mov_b64 v[122:123], v[134:135]
    v_mov_b64 v[124:125], v[136:137]
    v_mov_b64 v[126:127], v[138:139]
    v_mov_b64 v[128:129], v[140:141]
    v_mov_b64 v[130:131], v[142:143]
    v_mov_b64 v[132:133], v[144:145]
    v_mov_b64 v[134:135], v[146:147]
    v_mov_b64 v[136:137], v[148:149]
    v_mov_b64 v[138:139], v[150:151]
    v_mov_b64 v[140:141], v[152:153]
    v_mov_b64 v[142:143], v[154:155]
    v_mov_b64 v[144:145], v[156:157]
    v_mov_b64 v[146:147], v[158:159]
    v_mov_b64 v[148:149], v[160:161]
    v_mov_b64 v[150:151], v[162:163]
    v_mov_b64 v[152:153], v[164:165]
    v_mov_b64 v[154:155], v[166:167]
    s_waitcnt vmcnt(0)
    v_cndmask_b32 v24, v70, v68, vcc
    v_cndmask_b32 v25, v71, v69, vcc
    v_cndmask_b32 v26, v66, v70, vcc
    v_cndmask_b32 v27, v67, v71, vcc
    v_cndmask_b32 v28, v68, v66, vcc
    v_cndmask_b32 v29, v69, v67, vcc
    v_perm_b32 v156, v24, v60, s22
    v_perm_b32 v157, v24, v60, s23
    v_perm_b32 v158, v25, v61, s22
    v_perm_b32 v159, v25, v61, s23
    v_perm_b32 v160, v26, v62, s22
    v_perm_b32 v161, v26, v62, s23
    v_perm_b32 v162, v27, v63, s22
    v_perm_b32 v163, v27, v63, s23
    v_perm_b32 v164, v28, v64, s22
    v_perm_b32 v165, v28, v64, s23
    v_perm_b32 v166, v29, v65, s22
    v_perm_b32 v167, v29, v65, s23
    s_cmp_lt_u32 s20, 8
    s_nop 0
    s_cbranch_scc1 L_kvisit
    v_mov_b64 v[72:73], v[120:121]
    v_mov_b64 v[74:75], v[122:123]
    v_mov_b64 v[76:77], v[124:125]
    v_mov_b64 v[78:79], v[126:127]
    v_mov_b64 v[80:81], v[128:129]
    v_mov_b64 v[82:83], v[130:131]
    v_mov_b64 v[84:85], v[132:133]
    v_mov_b64 v[86:87], v[134:135]
    v_mov_b64 v[88:89], v[136:137]
    v_mov_b64 v[90:91], v[138:139]
    v_mov_b64 v[92:93], v[140:141]
    v_mov_b64 v[94:95], v[142:143]
    v_mov_b64 v[96:97], v[144:145]
    v_mov_b64 v[98:99], v[146:147]
    v_mov_b64 v[100:101], v[148:149]
    v_mov_b64 v[102:103], v[150:151]
    v_mov_b64 v[104:105], v[152:153]
    v_mov_b64 v[106:107], v[154:155]
    v_mov_b64 v[108:109], v[156:157]
    v_mov_b64 v[110:111], v[158:159]
    v_mov_b64 v[112:113], v[160:161]
    v_mov_b64 v[114:115], v[162:163]
    v_mov_b64 v[116:117], v[164:165]
    v_mov_b64 v[118:119], v[166:167]
    s_mov_b32 s20, 0
    s_add_u32 s24, s24, 4
    s_and_b32 s24, s24, 15
    s_add_u32 s21, s21, 1
    s_cmp_lt_u32 s21, 4
    s_cbranch_scc1 L_kvisit
    v_lshrrev_b32 v21, 2, v1
    v_and_b32 v22, 3, v1
    v_mul_u32_u24 v5, 768, v21
    v_lshl_add_u32 v5, v22, 4, v5
    s_mul_i32 s80, s76, 192
    v_add_u32 v5, s80, v5
    v_lshlrev_b32 v19, 3, v21
    v_add_u32 v19, 126976, v19
    v_lshrrev_b32 v21, 4, v1
    v_lshl_add_u32 v7, v21, 2, v22
    v_and_b32 v21, 1, v7
    v_lshlrev_b32 v7, 4, v7
    s_lshl_b32 s80, s76, 8
    v_add_u32 v7, s80, v7
    v_lshlrev_b32 v18, 3, v21
    v_add_u32 v18, 157696, v18
    v_add_u32 v16, 143360, v7
    s_mov_b32 s32, 0x000f000f
    s_mov_b32 s33, 0x000f000f
    s_mov_b32 s17, 1548
    s_mul_i32 s24, s77, 4
    s_and_b32 s24, s24, 15
    s_mov_b32 s20, 0
    s_add_u32 s25, s77, 0
    s_mul_i32 s25, s25, 64
    s_add_u32 s25, s25, s78
    s_lshl_b32 s25, s25, 10
L_vhead:
    v_mov_b64 v[24:25], 0
    v_mov_b64 v[26:27], 0
    v_mov_b64 v[28:29], 0
    v_mov_b64 v[30:31], 0
    v_mov_b64 v[32:33], 0
    v_mov_b64 v[34:35], 0
    s_mov_b32 s21, 0
    s_nop 0
L_pw:
    ds_read_b64 v[36:37], v3 offset:32
    ds_read_b32 v4, v3 offset:40
    ds_read_b64 v[14:15], v18
    s_waitcnt lgkmcnt(0)
    v_readfirstlane_b32 s80, v37
    v_readfirstlane_b32 s28, v4
    s_cmp_gt_u32 s80, s20
    s_nop 3
    s_cbranch_scc1 L_pwg
    s_sleep 2
    s_branch L_pw
L_pwg:
    s_lshr_b32 s29, s28, 8
    s_lshr_b32 s30, s28, 16
L_vstep:
    s_xor_b32 s80, s20, 7
    s_lshl_b32 s80, s80, 4
    s_add_u32 s80, s80, s24
    s_lshl_b32 s80, s80, 7
    v_add_u32 v8, s80, v19
    v_add_u32 v6, s19, v5
    ds_read_b32 v12, v8
    s_cmp_ge_i32 s18, s17
    s_cbranch_scc1 L_vwg
L_vw:
    ds_read_b32 v4, v3 offset:16
    s_waitcnt lgkmcnt(0)
    v_readfirstlane_b32 s18, v4
    s_nop 0
    s_cmp_ge_i32 s18, s17
    s_nop 2
    s_cbranch_scc1 L_vwg
    s_sleep 1
    s_branch L_vw
L_vwg:
    ds_read_b128 v[36:39], v6 offset:0
    ds_read_b128 v[40:43], v6 offset:64
    ds_read_b128 v[44:47], v6 offset:128
    v_add_u32 v10, 1, v10
    s_add_u32 s19, s19, 12288
    s_cmp_eq_u32 s19, 110592
    s_cselect_b32 s19, 0, s19
    s_add_u32 s17, s17, 12
    s_add_u32 s24, s24, 1
    s_and_b32 s24, s24, 15
    s_add_u32 s21, s21, 1
    s_cmp_lt_u32 s21, 16
    s_waitcnt lgkmcnt(2)
    v_cvt_f32_i32 v36, v36
    v_cvt_f32_i32 v37, v37
    v_cvt_f32_i32 v38, v38
    v_cvt_f32_i32 v39, v39
    v_pk_fma_f32 v[24:25], v[36:37], v[12:13], v[24:25] op_sel_hi:[1,0,1]
    v_pk_fma_f32 v[26:27], v[38:39], v[12:13], v[26:27] op_sel_hi:[1,0,1]
    s_waitcnt lgkmcnt(1)
    v_cvt_f32_i32 v40, v40
    v_cvt_f32_i32 v41, v41
    v_cvt_f32_i32 v42, v42
    v_cvt_f32_i32 v43, v43
    v_pk_fma_f32 v[28:29], v[40:41], v[12:13], v[28:29] op_sel_hi:[1,0,1]
    v_pk_fma_f32 v[30:31], v[42:43], v[12:13], v[30:31] op_sel_hi:[1,0,1]
    s_waitcnt lgkmcnt(0)
    v_cvt_f32_i32 v44, v44
    v_cvt_f32_i32 v45, v45
    v_cvt_f32_i32 v46, v46
    v_cvt_f32_i32 v47, v47
    v_pk_fma_f32 v[32:33], v[44:45], v[12:13], v[32:33] op_sel_hi:[1,0,1]
    v_pk_fma_f32 v[34:35], v[46:47], v[12:13], v[34:35] op_sel_hi:[1,0,1]
    s_nop 1
    s_cbranch_scc0 L_vend
    ds_write_b32 v11, v10
    s_branch L_vstep
L_vend:
    v_permlane32_swap_b32 v24, v26
    v_permlane32_swap_b32 v25, v27
    v_permlane32_swap_b32 v28, v30
    v_permlane32_swap_b32 v29, v31
    v_permlane32_swap_b32 v32, v34
    v_permlane32_swap_b32 v33, v35
    v_pk_add_f32 v[24:25], v[24:25], v[26:27]
    v_pk_add_f32 v[28:29], v[28:29], v[30:31]
    v_pk_add_f32 v[32:33], v[32:33], v[34:35]
    v_permlane16_swap_b32 v24, v25
    v_permlane16_swap_b32 v28, v29
    v_permlane16_swap_b32 v32, v33
    v_add_f32 v36, v24, v25
    v_add_f32 v37, v28, v29
    v_add_f32 v38, v32, v33
    v_mov_b32 v39, v14
    v_add_f32_dpp v36, v36, v36 row_ror:4 row_mask:0xf bank_mask:0xf
    v_add_f32_dpp v37, v37, v37 row_ror:4 row_mask:0xf bank_mask:0xf
    v_add_f32_dpp v38, v38, v38 row_ror:4 row_mask:0xf bank_mask:0xf
    v_add_f32_dpp v36, v36, v36 row_ror:8 row_mask:0xf bank_mask:0xf
    v_add_f32_dpp v37, v37, v37 row_ror:8 row_mask:0xf bank_mask:0xf
    v_add_f32_dpp v38, v38, v38 row_ror:8 row_mask:0xf bank_mask:0xf
    v_sub_f32 v36, v36, v15
    v_sub_f32 v37, v37, v15
    v_sub_f32 v38, v38, v15
    v_bfi_b32 v36, v23, s28, v36
    v_bfi_b32 v37, v23, s29, v37
    v_bfi_b32 v38, v23, s30, v38
    s_add_u32 s20, s20, 1
    s_cmp_eq_u32 s20, 8
    s_mov_b64 exec, s[32:33]
    s_cbranch_scc1 L_vlast
    ds_write_b128 v16, v[36:39]
    s_mov_b64 exec, -1
    ds_write_b32 v11, v10
    v_add_u32 v16, 1024, v16
    v_add_u32 v18, 16, v18
    s_nop 1
    s_branch L_vhead
L_vlast:
    buffer_store_dwordx4 v[36:39], v7, s[12:15], s25 offen sc0 sc1
    s_endpgm
    s_nop 0
L_aux:
    s_cmp_eq_u32 s76, 5
    s_cbranch_scc0 L_pacer
    v_lshlrev_b32 v5, 3, v1
    v_cmp_gt_u32 vcc, 24, v1
    v_mov_b32 v13, 0xffffff40
    v_mov_b32 v10, 192
    v_cndmask_b32 v13, v13, v10, vcc
    v_add_u32 v6, v5, v13
    v_mov_b32 v10, 0x80008000
    v_cndmask_b32 v7, 0, v10, vcc
    v_lshrrev_b32 v10, 1, v1
    v_and_b32 v11, 15, v10
    v_lshrrev_b32 v10, 4, v10
    v_mul_u32_u24 v10, 131072, v10
    v_mul_u32_u24 v11, 2048, v11
    v_add_u32 v10, v10, v11
    v_and_b32 v11, 1, v1
    v_lshl_add_u32 v17, v11, 4, v10
    v_add_u32 v10, 0, v1
    v_mul_u32_u24 v12, 2731, v10
    v_lshrrev_b32 v12, 16, v12
    v_mul_u32_u24 v12, 1152, v12
    v_lshl_add_u32 v56, v10, 4, v12
    v_add_u32 v10, 64, v1
    v_mul_u32_u24 v12, 2731, v10
    v_lshrrev_b32 v12, 16, v12
    v_mul_u32_u24 v12, 1152, v12
    v_lshl_add_u32 v57, v10, 4, v12
    v_add_u32 v10, 128, v1
    v_mul_u32_u24 v12, 2731, v10
    v_lshrrev_b32 v12, 16, v12
    v_mul_u32_u24 v12, 1152, v12
    v_lshl_add_u32 v58, v10, 4, v12
    v_cmp_eq_u32 s[32:33], 0, v11
    s_lshl_b32 s27, s77, 15
    s_lshl_b32 s80, s78, 5
    s_add_u32 s27, s27, s80
    s_mov_b32 m0, 143360
    s_waitcnt lgkmcnt(0)
    s_mov_b32 s4, s62
    s_mov_b32 s5, s63
    s_mov_b32 s6, 384
    s_mov_b32 s7, 0x20000
    s_mov_b32 s20, s64
    s_mov_b32 s21, s65
    s_mov_b32 s22, 384
    s_mov_b32 s23, 0x20000
    buffer_load_dwordx2 v[28:29], v5, s[4:7], 0 offen
    buffer_load_dwordx2 v[30:31], v5, s[20:23], 0 offen
    s_mov_b32 s4, s48
    s_mov_b32 s5, s49
    s_mov_b32 s6, 12288
    s_mov_b32 s7, 0x20000
    s_mul_i32 s80, s77, 384
    buffer_load_dwordx4 v56, s[4:7], s80 offen lds
    s_add_u32 m0, m0, 1024
    s_nop 0
    buffer_load_dwordx4 v57, s[4:7], s80 offen lds
    s_add_u32 m0, m0, 1024
    s_nop 0
    buffer_load_dwordx4 v58, s[4:7], s80 offen lds
    s_add_u32 m0, m0, 1024
    s_mov_b32 s12, s74
    s_mov_b32 s13, s75
    s_mov_b32 s14, 1610612736
    s_mov_b32 s15, 0x20000
    s_mov_b32 s8, s72
    s_mov_b32 s9, s73
    s_mov_b32 s10, 256
    s_mov_b32 s11, 0x20000
    s_mov_b32 s16, s70
    s_mov_b32 s17, s71
    s_mov_b32 s18, 12288
    s_mov_b32 s19, 0x20000
    v_mov_b32 v14, 0xff
    v_add_u32 v15, 143360, v5
    v_add_u32 v16, 143360, v6
    v_lshlrev_b32 v8, 1, v5
    v_lshlrev_b32 v9, 1, v6
    v_add_u32 v8, 151552, v8
    v_add_u32 v9, 151552, v9
    v_mov_b32 v12, 0
    s_mov_b32 s24, 0
    s_waitcnt vmcnt(3)
    v_xor_b32 v30, v30, v7
    v_xor_b32 v31, v31, v7
    v_lshlrev_b32 v32, 16, v28
    v_and_b32 v33, 0xffff0000, v28
    v_lshlrev_b32 v34, 16, v29
    v_and_b32 v35, 0xffff0000, v29
    v_lshlrev_b32 v36, 16, v30
    v_and_b32 v37, 0xffff0000, v30
    v_lshlrev_b32 v38, 16, v31
    v_and_b32 v39, 0xffff0000, v31
    v_and_b32 v7, 0x80000000, v7
    s_waitcnt vmcnt(0)
    s_mov_b32 exec_hi, 0xffff
L_hq:
    ds_read_b64 v[20:21], v15
    ds_read_b64 v[22:23], v16
    v_add_u32 v15, 384, v15
    v_add_u32 v16, 384, v16
    v_add_u32 v12, 1, v12
    s_waitcnt lgkmcnt(0)
    v_lshlrev_b32 v40, 16, v20
    v_and_b32 v41, 0xffff0000, v20
    v_lshlrev_b32 v42, 16, v21
    v_and_b32 v43, 0xffff0000, v21
    v_lshlrev_b32 v44, 16, v22
    v_and_b32 v45, 0xffff0000, v22
    v_lshlrev_b32 v46, 16, v23
    v_and_b32 v47, 0xffff0000, v23
    v_pk_mul_f32 v[40:41], v[40:41], v[32:33]
    v_pk_mul_f32 v[44:45], v[44:45], v[36:37]
    v_pk_mul_f32 v[42:43], v[42:43], v[34:35]
    v_pk_mul_f32 v[46:47], v[46:47], v[38:39]
    v_cvt_pk_bf16_f32 v40, v40, v44
    v_cvt_pk_bf16_f32 v41, v41, v45
    v_cvt_pk_bf16_f32 v42, v42, v46
    v_cvt_pk_bf16_f32 v43, v43, v47
    v_and_b32 v44, 0xffff0000, v40
    v_lshlrev_b32 v40, 16, v40
    v_and_b32 v45, 0xffff0000, v41
    v_lshlrev_b32 v41, 16, v41
    v_and_b32 v46, 0xffff0000, v42
    v_lshlrev_b32 v42, 16, v42
    v_and_b32 v47, 0xffff0000, v43
    v_lshlrev_b32 v43, 16, v43
    v_pk_add_f32 v[40:41], v[40:41], v[44:45]
    v_pk_add_f32 v[42:43], v[42:43], v[46:47]
    v_cvt_pk_bf16_f32 v48, v40, v40
    v_cvt_pk_bf16_f32 v49, v41, v41
    v_cvt_pk_bf16_f32 v50, v42, v42
    v_cvt_pk_bf16_f32 v51, v43, v43
    v_xor_b32 v48, v48, v7
    v_xor_b32 v49, v49, v7
    v_xor_b32 v50, v50, v7
    v_xor_b32 v51, v51, v7
    ds_write_b16 v8, v48 offset:0
    ds_write_b16_d16_hi v9, v48 offset:2
    ds_write_b16 v8, v49 offset:4
    ds_write_b16_d16_hi v9, v49 offset:6
    ds_write_b16 v8, v50 offset:8
    ds_write_b16_d16_hi v9, v50 offset:10
    ds_write_b16 v8, v51 offset:12
    ds_write_b16_d16_hi v9, v51 offset:14
    ds_write_b32 v3, v12 offset:32
    v_add_u32 v8, 768, v8
    v_add_u32 v9, 768, v9
    s_add_u32 s24, s24, 1
    s_cmp_lt_u32 s24, 8
    s_cbranch_scc1 L_hq
    s_mov_b32 exec_hi, -1
    v_mov_b32 v15, 0
    s_mov_b32 s25, 0
    s_cmp_eq_u32 s2, 0
    s_cbranch_scc1 L_epc
L_epw:
    s_sleep 16
    ds_read_b32 v4, v3 offset:20
    s_waitcnt lgkmcnt(0)
    v_readfirstlane_b32 s80, v4
    s_nop 0
    s_cmp_lt_i32 s80, 16
    s_nop 2
    s_cbranch_scc1 L_epw
L_ep:
    s_mov_b64 exec, 1
    buffer_load_dword v11, v15, s[8:11], 0 offen sc0 sc1
    s_waitcnt vmcnt(0)
    v_readfirstlane_b32 s28, v11
    s_mov_b64 exec, -1
    s_cmp_lg_u32 s28, 0
    s_nop 2
    s_cbranch_scc1 L_epd
    s_sleep 32
    s_add_u32 s25, s25, 1
    s_cmp_lt_u32 s25, 8
    s_cbranch_scc1 L_ep
L_epc:
    s_mul_i32 s28, s84, 0x9e3779b1
    s_lshr_b32 s81, s28, 15
    s_xor_b32 s28, s28, s81
    s_mul_i32 s28, s28, 0x85ebca6b
    s_lshr_b32 s81, s28, 13
    s_xor_b32 s28, s28, s81
    s_max_u32 s28, s28, 1
    v_mov_b32 v20, s28
    v_mov_b32 v21, 0
    s_mov_b64 exec, 1
    buffer_atomic_cmpswap v[20:21], v15, s[8:11], 0 offen sc0 sc1
    s_waitcnt vmcnt(0)
    v_readfirstlane_b32 s80, v20
    s_mov_b64 exec, -1
    s_cmp_eq_u32 s80, 0
    s_cselect_b32 s28, s28, s80
    s_nop 1
L_epd:
    v_mov_b32 v12, s28
    ds_write_b32 v3, v12 offset:40
    s_lshr_b32 s29, s28, 8
    s_lshr_b32 s30, s28, 16
    s_lshr_b32 s31, s28, 24
    s_and_b32 s80, s78, 3
    s_lshl_b32 s80, s80, 3
    v_lshrrev_b32 v10, 3, v1
    v_add_u32 v10, s80, v10
    v_and_b32 v11, 15, v10
    v_lshrrev_b32 v10, 4, v10
    v_mul_u32_u24 v10, 131072, v10
    v_mul_u32_u24 v11, 2048, v11
    v_add_u32 v10, v10, v11
    v_and_b32 v11, 7, v1
    v_lshl_add_u32 v56, v11, 4, v10
    s_mov_b32 s24, 8
    s_mov_b32 s25, 0
    s_mov_b32 m0, 110592
    s_mov_b32 s4, s52
    s_mov_b32 s5, s53
    s_mov_b32 s6, 1048576
    s_mov_b32 s7, 0x20000
    s_mov_b32 s20, s52
    s_mov_b32 s21, s53
    s_mov_b32 s22, 0
    s_mov_b32 s23, 0x20000
L_sc:
    s_sleep 16
    ds_read_b32 v4, v3 offset:20
    s_waitcnt lgkmcnt(0)
    v_readfirstlane_b32 s80, v4
    s_nop 0
    s_cmp_lt_i32 s80, s24
    s_nop 2
    s_cbranch_scc1 L_sc
    s_and_b32 s80, s25, 3
    s_mul_i32 s80, s80, 262144
    s_add_u32 s80, s80, s27
    s_andn2_b32 s81, s80, 127
    s_cmp_eq_u32 s25, 0
    s_cbranch_scc1 L_sc1
    buffer_load_dwordx4 v17, s[20:23], s83 offen  lds
    s_add_u32 m0, m0, 1024
L_sc1:
    s_mov_b32 s83, s80
    s_mov_b32 s20, s4
    s_mov_b32 s21, s5
    s_mov_b32 s22, 1048576
    s_add_u32 s25, s25, 1
    s_cmp_eq_u32 s25, 4
    s_cselect_b32 s4, s54, s4
    s_cselect_b32 s5, s55, s5
    s_cmp_eq_u32 s25, 8
    s_cselect_b32 s4, s58, s4
    s_cselect_b32 s5, s59, s5
    s_cmp_eq_u32 s25, 12
    s_cselect_b32 s4, s60, s4
    s_cselect_b32 s5, s61, s5
    s_cmp_eq_u32 s25, 16
    s_cselect_b32 s6, 0, s6
    s_add_u32 s24, s24, 4
    s_cmp_le_u32 s25, 16
    s_cbranch_scc1 L_sc
    s_waitcnt vmcnt(0)
    v_mov_b32 v28, 0
    v_mov_b32 v29, 0
    v_mov_b32 v30, 0
    v_mov_b32 v31, 0
    v_mov_b32 v32, 0
    v_mov_b32 v33, 0
    v_mov_b32 v34, 0
    v_mov_b32 v35, 0
    v_mov_b32 v36, 0
    v_mov_b32 v37, 0
    v_mov_b32 v38, 0
    v_mov_b32 v39, 0
    v_mov_b32 v40, 0
    v_mov_b32 v41, 0
    v_mov_b32 v42, 0
    v_mov_b32 v43, 0
    v_mov_b32 v44, 0
    v_mov_b32 v45, 0
    v_mov_b32 v46, 0
    v_mov_b32 v47, 0
    v_mov_b32 v48, 0
    v_mov_b32 v49, 0
    v_mov_b32 v50, 0
    v_mov_b32 v51, 0
    v_mov_b32 v64, 0
    v_mov_b32 v65, 0
    v_mov_b32 v66, 0
    v_mov_b32 v67, 0
    v_mov_b32 v68, 0
    v_mov_b32 v69, 0
    v_mov_b32 v70, 0
    v_mov_b32 v71, 0
    v_lshlrev_b32 v15, 3, v1
    v_add_u32 v15, 141312, v15
    v_lshlrev_b32 v16, 1, v1
    v_add_u32 v16, 114176, v16
    v_mov_b32 v8, 157696
    v_mov_b32 v9, 0
    s_mov_b32 s24, 100
    s_nop 0
L_hp:
    s_sleep 8
    ds_read_b128 v[56:59], v3
    s_waitcnt lgkmcnt(0)
    v_min3_i32 v56, v56, v57, v58
    v_min_i32 v56, v56, v59
    s_nop 0
    v_readfirstlane_b32 s80, v56
    s_nop 0
    s_cmp_lt_i32 s80, s24
    s_nop 2
    s_cbranch_scc1 L_hp
    ds_read_b64 v[72:73], v15 offset:0
    ds_read_u16_d16_hi v28, v16 offset:0
    ds_read_u16_d16_hi v64, v16 offset:4096
    ds_read_b64 v[74:75], v15 offset:512
    ds_read_u16_d16_hi v29, v16 offset:128
    ds_read_u16_d16_hi v65, v16 offset:4224
    ds_read_b64 v[76:77], v15 offset:1024
    ds_read_u16_d16_hi v30, v16 offset:256
    ds_read_u16_d16_hi v66, v16 offset:4352
    ds_read_b64 v[78:79], v15 offset:1536
    ds_read_u16_d16_hi v31, v16 offset:384
    ds_read_u16_d16_hi v67, v16 offset:4480
    s_waitcnt lgkmcnt(0)
    ds_read_u16_d16_hi v36, v16 offset:8192
    ds_read_u16_d16_hi v44, v16 offset:12288
    ds_read_u16_d16_hi v37, v16 offset:8320
    ds_read_u16_d16_hi v45, v16 offset:12416
    ds_read_u16_d16_hi v38, v16 offset:8448
    ds_read_u16_d16_hi v46, v16 offset:12544
    ds_read_u16_d16_hi v39, v16 offset:8576
    ds_read_u16_d16_hi v47, v16 offset:12672
    v_fma_f32 v20, -v64, v73, v72
    v_fma_f32 v21, -v65, v75, v74
    v_fma_f32 v22, -v66, v77, v76
    v_fma_f32 v23, -v67, v79, v78
    v_mul_f32 v20, v20, v28
    v_mul_f32 v21, v21, v29
    v_mul_f32 v22, v22, v30
    v_mul_f32 v23, v23, v31
    v_mul_f32 v20, 0x3dd53b95, v20
    v_mul_f32 v21, 0x3dd53b95, v21
    v_mul_f32 v22, 0x3dd53b95, v22
    v_mul_f32 v23, 0x3dd53b95, v23
    v_mov_b32 v52, v20
    v_max_f32 v52, v52, v21
    v_max_f32 v52, v52, v22
    v_max_f32 v52, v52, v23
    s_nop 1
    v_max_f32_dpp v52, v52, v52 quad_perm:[1,0,3,2] row_mask:0xf bank_mask:0xf
    s_nop 1
    v_max_f32_dpp v52, v52, v52 quad_perm:[2,3,0,1] row_mask:0xf bank_mask:0xf
    s_nop 1
    v_max_f32_dpp v52, v52, v52 row_half_mirror row_mask:0xf bank_mask:0xf
    s_nop 1
    v_max_f32_dpp v52, v52, v52 row_mirror row_mask:0xf bank_mask:0xf
    v_mov_b32 v13, v52
    s_nop 1
    v_permlane32_swap_b32 v52, v13
    v_max_f32 v52, v52, v13
    v_mov_b32 v13, v52
    s_nop 1
    v_permlane16_swap_b32 v52, v13
    v_max_f32 v52, v52, v13
    v_sub_f32 v20, v20, v52
    v_sub_f32 v21, v21, v52
    v_sub_f32 v22, v22, v52
    v_sub_f32 v23, v23, v52
    v_exp_f32 v20, v20
    v_exp_f32 v21, v21
    v_exp_f32 v22, v22
    v_exp_f32 v23, v23
    v_mov_b32 v54, v20
    v_add_f32 v54, v54, v21
    v_add_f32 v54, v54, v22
    v_add_f32 v54, v54, v23
    s_waitcnt lgkmcnt(0)
    v_mul_f32 v20, v20, v36
    v_mul_f32 v21, v21, v37
    v_mul_f32 v22, v22, v38
    v_mul_f32 v23, v23, v39
    v_mul_f32 v53, v20, v44
    v_fmac_f32 v53, v21, v45
    v_fmac_f32 v53, v22, v46
    v_fmac_f32 v53, v23, v47
    ds_write_b32 v15, v20 offset:0
    ds_write_b32 v15, v21 offset:512
    ds_write_b32 v15, v22 offset:1024
    ds_write_b32 v15, v23 offset:1536
    v_add_f32_dpp v54, v54, v54 quad_perm:[1,0,3,2] row_mask:0xf bank_mask:0xf
    s_nop 1
    v_add_f32_dpp v54, v54, v54 quad_perm:[2,3,0,1] row_mask:0xf bank_mask:0xf
    s_nop 1
    v_add_f32_dpp v54, v54, v54 row_half_mirror row_mask:0xf bank_mask:0xf
    s_nop 1
    v_add_f32_dpp v54, v54, v54 row_mirror row_mask:0xf bank_mask:0xf
    v_mov_b32 v13, v54
    s_nop 1
    v_permlane32_swap_b32 v54, v13
    v_add_f32 v54, v54, v13
    v_mov_b32 v13, v54
    s_nop 1
    v_permlane16_swap_b32 v54, v13
    v_add_f32 v54, v54, v13
    v_add_f32_dpp v53, v53, v53 quad_perm:[1,0,3,2] row_mask:0xf bank_mask:0xf
    s_nop 1
    v_add_f32_dpp v53, v53, v53 quad_perm:[2,3,0,1] row_mask:0xf bank_mask:0xf
    s_nop 1
    v_add_f32_dpp v53, v53, v53 row_half_mirror row_mask:0xf bank_mask:0xf
    s_nop 1
    v_add_f32_dpp v53, v53, v53 row_mirror row_mask:0xf bank_mask:0xf
    v_mov_b32 v13, v53
    s_nop 1
    v_permlane32_swap_b32 v53, v13
    v_add_f32 v53, v53, v13
    v_mov_b32 v13, v53
    s_nop 1
    v_permlane16_swap_b32 v53, v13
    v_add_f32 v53, v53, v13
    v_bfi_b32 v54, v14, s31, v54
    v_mov_b32 v55, v53
    v_add_u32 v9, 1, v9
    s_mov_b64 exec, 1
    ds_write_b128 v8, v[52:55]
    ds_write_b32 v3, v9 offset:36
    s_mov_b64 exec, -1
    v_add_u32 v15, -2048, v15
    v_add_u32 v16, -512, v16
    v_add_u32 v8, 16, v8
    s_add_u32 s24, s24, 4
    s_cmp_le_u32 s24, 128
    s_cbranch_scc1 L_hp
    s_add_u32 s26, s77, 28
    s_mul_i32 s26, s26, 64
    s_add_u32 s26, s26, s78
    s_lshl_b32 s26, s26, 10
    s_lshr_b32 s34, s2, 3
    s_and_b32 s35, s2, 7
    v_lshrrev_b32 v10, 3, v1
    v_and_b32 v16, 7, v1
    v_lshlrev_b32 v10, 10, v10
    v_lshl_add_u32 v15, v16, 4, v10
    v_lshrrev_b32 v10, 2, v16
    v_and_b32 v16, 3, v16
    v_lshl_add_u32 v16, v16, 2, v10
    v_lshlrev_b32 v16, 1, v16
    v_bfe_u32 v10, v1, 4, 1
    v_lshl_add_u32 v16, v10, 6, v16
    v_lshrrev_b32 v10, 5, v1
    v_lshl_add_u32 v16, v10, 5, v16
    s_mov_b32 s25, 0
    s_mov_b32 s38, 0
    s_mul_i32 s36, s34, 65536
    s_lshl_b32 s83, s35, 7
    s_add_u32 s36, s36, s83
    s_mul_i32 s37, s34, 384
    s_lshr_b32 s83, s35, 1
    s_mul_i32 s83, s83, 96
    s_add_u32 s37, s37, s83
    s_and_b32 s83, s35, 1
    s_lshl_b32 s83, s83, 2
    s_add_u32 s37, s37, s83
    s_mov_b32 s40, s74
    s_mov_b32 s41, s75
    s_mov_b32 s42, 1610612736
    s_mov_b32 s43, 0x20000
    s_mov_b32 s16, s70
    s_mov_b32 s17, s71
    s_mov_b32 s18, 12288
    s_mov_b32 s19, 0x20000
    v_add_u32 v13, 143360, v2
    s_nop 1
L_hf:
    s_sleep 32
    ds_read_b128 v[56:59], v3
    s_waitcnt lgkmcnt(0)
    v_min3_i32 v56, v56, v57, v58
    v_min_i32 v56, v56, v59
    s_nop 0
    v_readfirstlane_b32 s80, v56
    s_nop 0
    s_cmp_lt_i32 s80, 240
    s_nop 2
    s_cbranch_scc1 L_hf
    ds_read_b128 v[100:103], v13 offset:0
    ds_read_b128 v[104:107], v13 offset:1024
    ds_read_b128 v[108:111], v13 offset:2048
    ds_read_b128 v[112:115], v13 offset:3072
    ds_read_b128 v[116:119], v13 offset:4096
    ds_read_b128 v[120:123], v13 offset:5120
    ds_read_b128 v[124:127], v13 offset:6144
L_hn:
    s_sleep 2
    ds_read_b32 v4, v3 offset:20
    s_waitcnt lgkmcnt(0)
    v_readfirstlane_b32 s80, v4
    s_nop 0
    s_cmp_lt_i32 s80, 254
    s_nop 2
    s_cbranch_scc1 L_hn
    buffer_store_dwordx4 v[100:103], v2, s[12:15], s26 offen sc0 sc1
    s_sub_u32 s26, s26, 262144
    buffer_store_dwordx4 v[104:107], v2, s[12:15], s26 offen sc0 sc1
    s_sub_u32 s26, s26, 262144
    buffer_store_dwordx4 v[108:111], v2, s[12:15], s26 offen sc0 sc1
    s_sub_u32 s26, s26, 262144
    buffer_store_dwordx4 v[112:115], v2, s[12:15], s26 offen sc0 sc1
    s_sub_u32 s26, s26, 262144
    buffer_store_dwordx4 v[116:119], v2, s[12:15], s26 offen sc0 sc1
    s_sub_u32 s26, s26, 262144
    buffer_store_dwordx4 v[120:123], v2, s[12:15], s26 offen sc0 sc1
    s_sub_u32 s26, s26, 262144
    buffer_store_dwordx4 v[124:127], v2, s[12:15], s26 offen sc0 sc1
    s_sub_u32 s26, s26, 262144
    s_nop 0
L_hl:
    s_sleep 1
    ds_read_b32 v4, v3 offset:16
    s_waitcnt lgkmcnt(0)
    v_readfirstlane_b32 s80, v4
    s_nop 0
    s_cmp_lt_i32 s80, 3072
    s_nop 2
    s_cbranch_scc1 L_hl
L_try:
    s_mov_b32 s80, s36
    buffer_load_dwordx4 v[64:67], v15, s[40:43], s80 offen sc0 sc1
    s_add_u32 s80, s80, 8192
    buffer_load_dwordx4 v[68:71], v15, s[40:43], s80 offen sc0 sc1
    s_add_u32 s80, s80, 8192
    buffer_load_dwordx4 v[72:75], v15, s[40:43], s80 offen sc0 sc1
    s_add_u32 s80, s80, 8192
    buffer_load_dwordx4 v[76:79], v15, s[40:43], s80 offen sc0 sc1
    s_add_u32 s80, s80, 8192
    buffer_load_dwordx4 v[80:83], v15, s[40:43], s80 offen sc0 sc1
    s_add_u32 s80, s80, 8192
    buffer_load_dwordx4 v[84:87], v15, s[40:43], s80 offen sc0 sc1
    s_add_u32 s80, s80, 8192
    buffer_load_dwordx4 v[88:91], v15, s[40:43], s80 offen sc0 sc1
    s_add_u32 s80, s80, 8192
    buffer_load_dwordx4 v[92:95], v15, s[40:43], s80 offen sc0 sc1
    s_waitcnt vmcnt(7)
    v_xor_b32 v12, s28, v64
    v_bitop3_b32 v12, v12, v65, s29 bitop3:0xf6
    v_bitop3_b32 v12, v12, v66, s30 bitop3:0xf6
    v_xor_b32 v13, s31, v67
    s_waitcnt vmcnt(6)
    v_bitop3_b32 v12, v12, v68, s28 bitop3:0xf6
    v_bitop3_b32 v12, v12, v69, s29 bitop3:0xf6
    v_bitop3_b32 v12, v12, v70, s30 bitop3:0xf6
    v_bitop3_b32 v13, v13, v71, s31 bitop3:0xf6
    s_waitcnt vmcnt(5)
    v_bitop3_b32 v12, v12, v72, s28 bitop3:0xf6
    v_bitop3_b32 v12, v12, v73, s29 bitop3:0xf6
    v_bitop3_b32 v12, v12, v74, s30 bitop3:0xf6
    v_bitop3_b32 v13, v13, v75, s31 bitop3:0xf6
    s_waitcnt vmcnt(4)
    v_bitop3_b32 v12, v12, v76, s28 bitop3:0xf6
    v_bitop3_b32 v12, v12, v77, s29 bitop3:0xf6
    v_bitop3_b32 v12, v12, v78, s30 bitop3:0xf6
    v_bitop3_b32 v13, v13, v79, s31 bitop3:0xf6
    s_waitcnt vmcnt(3)
    v_bitop3_b32 v12, v12, v80, s28 bitop3:0xf6
    v_bitop3_b32 v12, v12, v81, s29 bitop3:0xf6
    v_bitop3_b32 v12, v12, v82, s30 bitop3:0xf6
    v_bitop3_b32 v13, v13, v83, s31 bitop3:0xf6
    s_waitcnt vmcnt(2)
    v_bitop3_b32 v12, v12, v84, s28 bitop3:0xf6
    v_bitop3_b32 v12, v12, v85, s29 bitop3:0xf6
    v_bitop3_b32 v12, v12, v86, s30 bitop3:0xf6
    v_bitop3_b32 v13, v13, v87, s31 bitop3:0xf6
    s_waitcnt vmcnt(1)
    v_bitop3_b32 v12, v12, v88, s28 bitop3:0xf6
    v_bitop3_b32 v12, v12, v89, s29 bitop3:0xf6
    v_bitop3_b32 v12, v12, v90, s30 bitop3:0xf6
    v_bitop3_b32 v13, v13, v91, s31 bitop3:0xf6
    s_waitcnt vmcnt(0)
    v_bitop3_b32 v12, v12, v92, s28 bitop3:0xf6
    v_bitop3_b32 v12, v12, v93, s29 bitop3:0xf6
    v_bitop3_b32 v12, v12, v94, s30 bitop3:0xf6
    v_bitop3_b32 v13, v13, v95, s31 bitop3:0xf6
    v_cndmask_b32 v13, v13, 0, s[32:33]
    v_or_b32 v12, v12, v13
    v_and_b32 v12, 0xff, v12
    v_cmp_ne_u32 vcc, 0, v12
    s_nop 4
    s_cbranch_vccz L_cok
    s_sleep 1
    s_add_u32 s25, s25, 1
    s_cmp_lt_u32 s25, 2000000
    s_cbranch_scc1 L_try
L_cok:
    v_max_f32 v11, v67, v71
    v_max3_f32 v11, v11, v75, v79
    v_max3_f32 v11, v11, v83, v87
    v_max3_f32 v11, v11, v91, v95
    s_nop 1
    v_max_f32_dpp v11, v11, v11 row_ror:8 row_mask:0xf bank_mask:0xf
    v_mov_b32 v13, v11
    s_nop 1
    v_permlane32_swap_b32 v11, v13
    v_max_f32 v11, v11, v13
    v_mov_b32 v13, v11
    s_nop 1
    v_permlane16_swap_b32 v11, v13
    v_max_f32 v11, v11, v13
    s_nop 1
    v_mov_b32_dpp v11, v11 quad_perm:[0,0,2,2] row_mask:0xf bank_mask:0xf
    s_nop 1
    v_sub_f32_dpp v20, v67, v11 quad_perm:[0,0,2,2] row_mask:0xf bank_mask:0xf
    v_sub_f32_dpp v21, v71, v11 quad_perm:[0,0,2,2] row_mask:0xf bank_mask:0xf
    v_sub_f32_dpp v22, v75, v11 quad_perm:[0,0,2,2] row_mask:0xf bank_mask:0xf
    v_sub_f32_dpp v23, v79, v11 quad_perm:[0,0,2,2] row_mask:0xf bank_mask:0xf
    v_sub_f32_dpp v24, v83, v11 quad_perm:[0,0,2,2] row_mask:0xf bank_mask:0xf
    v_sub_f32_dpp v25, v87, v11 quad_perm:[0,0,2,2] row_mask:0xf bank_mask:0xf
    v_sub_f32_dpp v26, v91, v11 quad_perm:[0,0,2,2] row_mask:0xf bank_mask:0xf
    v_sub_f32_dpp v27, v95, v11 quad_perm:[0,0,2,2] row_mask:0xf bank_mask:0xf
    v_exp_f32 v20, v20
    v_exp_f32 v21, v21
    v_exp_f32 v22, v22
    v_exp_f32 v23, v23
    v_exp_f32 v24, v24
    v_exp_f32 v25, v25
    v_exp_f32 v26, v26
    v_exp_f32 v27, v27
    v_pk_mul_f32 v[40:41], v[64:65], v[20:21] op_sel:[0,0] op_sel_hi:[1,0]
    v_pk_mul_f32 v[42:43], v[66:67], v[20:21] op_sel:[0,0] op_sel_hi:[1,0]
    v_pk_fma_f32 v[40:41], v[68:69], v[20:21], v[40:41] op_sel:[0,1,0] op_sel_hi:[1,1,1]
    v_pk_fma_f32 v[42:43], v[70:71], v[20:21], v[42:43] op_sel:[0,1,0] op_sel_hi:[1,1,1]
    v_pk_fma_f32 v[40:41], v[72:73], v[22:23], v[40:41] op_sel:[0,0,0] op_sel_hi:[1,0,1]
    v_pk_fma_f32 v[42:43], v[74:75], v[22:23], v[42:43] op_sel:[0,0,0] op_sel_hi:[1,0,1]
    v_pk_fma_f32 v[40:41], v[76:77], v[22:23], v[40:41] op_sel:[0,1,0] op_sel_hi:[1,1,1]
    v_pk_fma_f32 v[42:43], v[78:79], v[22:23], v[42:43] op_sel:[0,1,0] op_sel_hi:[1,1,1]
    v_pk_fma_f32 v[40:41], v[80:81], v[24:25], v[40:41] op_sel:[0,0,0] op_sel_hi:[1,0,1]
    v_pk_fma_f32 v[42:43], v[82:83], v[24:25], v[42:43] op_sel:[0,0,0] op_sel_hi:[1,0,1]
    v_pk_fma_f32 v[40:41], v[84:85], v[24:25], v[40:41] op_sel:[0,1,0] op_sel_hi:[1,1,1]
    v_pk_fma_f32 v[42:43], v[86:87], v[24:25], v[42:43] op_sel:[0,1,0] op_sel_hi:[1,1,1]
    v_pk_fma_f32 v[40:41], v[88:89], v[26:27], v[40:41] op_sel:[0,0,0] op_sel_hi:[1,0,1]
    v_pk_fma_f32 v[42:43], v[90:91], v[26:27], v[42:43] op_sel:[0,0,0] op_sel_hi:[1,0,1]
    v_pk_fma_f32 v[40:41], v[92:93], v[26:27], v[40:41] op_sel:[0,1,0] op_sel_hi:[1,1,1]
    v_pk_fma_f32 v[42:43], v[94:95], v[26:27], v[42:43] op_sel:[0,1,0] op_sel_hi:[1,1,1]
    s_nop 0
    v_permlane32_swap_b32 v40, v41
    v_permlane32_swap_b32 v42, v43
    v_add_f32 v40, v40, v41
    v_add_f32 v42, v42, v43
    s_nop 1
    v_permlane16_swap_b32 v40, v42
    v_add_f32 v40, v40, v42
    s_nop 1
    v_add_f32_dpp v40, v40, v40 row_ror:8 row_mask:0xf bank_mask:0xf
    v_rcp_f32 v10, v40
    s_nop 0
    v_readlane_b32 s81, v10, 49
    s_nop 1
    v_mul_f32 v40, s81, v40
    v_cvt_pk_bf16_f32 v40, v40, v40
    s_mov_b32 exec_lo, 0x00ff00ff
    s_mov_b32 exec_hi, 0xff
    buffer_store_short v40, v16, s[16:19], s37 offen
    s_endpgm
L_pacer:
    s_cmp_eq_u32 s76, 6
    s_cbranch_scc0 L_exch
    s_mov_b32 s4, 0
    s_mov_b32 s5, 12
    s_mov_b32 s6, 0
    s_mov_b32 s7, 128
    s_mov_b32 s8, 24
    v_mov_b32 v14, 157824
    s_waitcnt lgkmcnt(0)
    s_lshl_b32 s80, s84, 12
    s_add_u32 s80, s80, 1351680
    v_mov_b32 v12, s80
    v_mov_b32 v13, 5104
    ds_write_b64 v3, v[12:13] offset:24
    v_mov_b32 v15, s84
    ds_write_b32 v14, v15
    s_nop 0
L_g:
    s_sleep 1
    ds_read_b32 v4, v3 offset:16
    s_memrealtime s[10:11]
    ds_read_b128 v[8:11], v3
    ds_read_b64 v[12:13], v3 offset:24
    s_waitcnt lgkmcnt(0)
    v_readfirstlane_b32 s83, v4
    v_min3_i32 v15, v8, v9, v10
    v_min_i32 v8, v15, v11
    s_cmp_ge_i32 s83, s5
    s_nop 1
    s_cbranch_scc0 L_gw
    v_readfirstlane_b32 s80, v12
    v_readfirstlane_b32 s81, v13
    s_add_u32 s4, s4, 1
    s_add_u32 s5, s5, 12
    s_cmp_le_u32 s4, 96
    s_add_u32 s6, s6, 32
    v_add_u32 v14, 4, v14
    v_mov_b32 v15, s10
    ds_write_b32 v14, v15
    v_mov_b32 v15, s4
    ds_write_b32 v3, v15 offset:20
    s_mul_i32 s81, s81, s6
    s_add_u32 s80, s80, s81
    s_lshl_b32 s81, s10, 12
    s_sub_u32 s80, s81, s80
    s_ashr_i32 s80, s80, 6
    s_min_i32 s80, s80, 0x40000
    s_max_i32 s80, s80, 0xfffc0000
    s_mul_i32 s80, s80, 655
    s_ashr_i32 s80, s80, 12
    s_and_b32 s7, s7, 255
    s_add_u32 s7, s7, s80
    s_add_u32 s7, s7, 5632
    s_ashr_i32 s8, s7, 8
    s_min_i32 s8, s8, 36
    s_max_i32 s8, s8, 16
    s_cmp_lt_u32 s4, 3
    s_cselect_b32 s8, 24, s8
L_gw:
    s_add_u32 s80, s8, 2304
    v_lshl_add_u32 v15, v8, 8, s80
    ds_write_b32 v3, v15 offset:44
    s_cmp_lt_u32 s4, 256
    s_cbranch_scc1 L_g
    s_endpgm
L_exch:
    s_mov_b32 s12, s74
    s_mov_b32 s13, s75
    s_mov_b32 s14, 1610612736
    s_mov_b32 s15, 0x20000
    s_mov_b32 s80, 4352
    v_mul_lo_u32 v5, v1, s80
    s_lshr_b32 s80, s2, 3
    s_mul_i32 s21, s79, 5
    s_add_u32 s21, s21, s80
    s_and_b32 s21, s21, 31
    s_lshr_b32 s80, s80, 5
    s_lshl_b32 s80, s80, 3
    s_add_u32 s80, s80, s79
    s_mul_i32 s80, s80, 4352
    s_waitcnt vmcnt(0)
    v_mov_b32 v7, s80
    s_mov_b32 s16, 0
    s_mov_b32 s17, 33554432
    s_mov_b32 s18, 8
    s_mov_b32 s20, 0
    s_mov_b32 s19, 0
    s_mov_b32 s24, 0
L_pc0:
L_pw1:
    s_sleep 8
    ds_read_b32 v4, v3 offset:20
    s_waitcnt lgkmcnt(0)
    v_readfirstlane_b32 s80, v4
    s_nop 0
    s_cmp_lt_i32 s80, s18
    s_nop 2
    s_cbranch_scc1 L_pw1
    s_lshl_b32 s80, s18, 2
    s_add_u32 s80, s80, 157824
    v_mov_b32 v8, s80
    ds_read_b32 v6, v8
    s_waitcnt lgkmcnt(0)
    s_and_b32 s80, s16, 31
    s_cmp_eq_u32 s80, s21
    s_cbranch_scc0 L_np
    s_mov_b64 exec, 1
    buffer_store_dword v6, v7, s[12:15], s17 offen sc0 sc1
    s_mov_b64 exec, -1
L_np:
    s_add_u32 s81, s18, 4
L_pw2:
    s_sleep 8
    ds_read_b32 v4, v3 offset:20
    s_waitcnt lgkmcnt(0)
    v_readfirstlane_b32 s80, v4
    s_nop 0
    s_cmp_lt_i32 s80, s81
    s_nop 2
    s_cbranch_scc1 L_pw2
    s_add_u32 s30, s74, s17
    s_addc_u32 s31, s75, 0
    s_load_dword s32, s[30:31], 0
    s_load_dword s33, s[30:31], 4352
    s_load_dword s34, s[30:31], 8704
    s_load_dword s35, s[30:31], 13056
    s_load_dword s36, s[30:31], 17408
    s_load_dword s37, s[30:31], 21760
    s_load_dword s38, s[30:31], 26112
    s_load_dword s39, s[30:31], 30464
    s_memrealtime s[22:23]
    v_readfirstlane_b32 s26, v6
    s_mov_b32 s27, 0
    s_mov_b32 s28, 0
    s_mov_b32 s29, -4096
    s_waitcnt lgkmcnt(0)
    s_sub_u32 s83, s22, s26
    s_sub_u32 s80, s32, s26
    s_add_u32 s81, s80, 4096
    s_cmp_lt_u32 s81, 0x2000
    s_cselect_b32 s80, s80, s83
    s_addc_u32 s28, s28, 0
    s_add_u32 s27, s27, s80
    s_max_i32 s29, s29, s80
    s_sub_u32 s80, s33, s26
    s_add_u32 s81, s80, 4096
    s_cmp_lt_u32 s81, 0x2000
    s_cselect_b32 s80, s80, s83
    s_addc_u32 s28, s28, 0
    s_add_u32 s27, s27, s80
    s_max_i32 s29, s29, s80
    s_sub_u32 s80, s34, s26
    s_add_u32 s81, s80, 4096
    s_cmp_lt_u32 s81, 0x2000
    s_cselect_b32 s80, s80, s83
    s_addc_u32 s28, s28, 0
    s_add_u32 s27, s27, s80
    s_max_i32 s29, s29, s80
    s_sub_u32 s80, s35, s26
    s_add_u32 s81, s80, 4096
    s_cmp_lt_u32 s81, 0x2000
    s_cselect_b32 s80, s80, s83
    s_addc_u32 s28, s28, 0
    s_add_u32 s27, s27, s80
    s_max_i32 s29, s29, s80
    s_sub_u32 s80, s36, s26
    s_add_u32 s81, s80, 4096
    s_cmp_lt_u32 s81, 0x2000
    s_cselect_b32 s80, s80, s83
    s_addc_u32 s28, s28, 0
    s_add_u32 s27, s27, s80
    s_max_i32 s29, s29, s80
    s_sub_u32 s80, s37, s26
    s_add_u32 s81, s80, 4096
    s_cmp_lt_u32 s81, 0x2000
    s_cselect_b32 s80, s80, s83
    s_addc_u32 s28, s28, 0
    s_add_u32 s27, s27, s80
    s_max_i32 s29, s29, s80
    s_sub_u32 s80, s38, s26
    s_add_u32 s81, s80, 4096
    s_cmp_lt_u32 s81, 0x2000
    s_cselect_b32 s80, s80, s83
    s_addc_u32 s28, s28, 0
    s_add_u32 s27, s27, s80
    s_max_i32 s29, s29, s80
    s_sub_u32 s80, s39, s26
    s_add_u32 s81, s80, 4096
    s_cmp_lt_u32 s81, 0x2000
    s_cselect_b32 s80, s80, s83
    s_addc_u32 s28, s28, 0
    s_add_u32 s27, s27, s80
    s_max_i32 s29, s29, s80
    s_cmp_lt_u32 s28, 4
    s_cbranch_scc1 L_pskip
    s_mul_i32 s27, s27, 358
    s_lshl_b32 s80, s26, 12
    s_add_u32 s80, s80, s27
    s_mul_i32 s29, s29, 1229
    s_add_u32 s80, s80, s29
    s_min_u32 s82, s18, 0
    s_lshl_b32 s83, s18, 5
    s_add_u32 s82, s82, s83
    s_sub_u32 s81, s80, s19
    s_sub_u32 s83, s82, s24
    v_cvt_f32_u32 v8, s81
    v_cvt_f32_u32 v9, s83
    v_rcp_f32 v9, v9
    v_mul_f32 v8, 0x3f800000, v8
    v_mul_f32 v8, v8, v9
    v_mul_f32 v9, 0x3f7851ec, v8
    v_mov_b32 v10, 0x459f8000
    v_mul_f32 v8, 0x3f828f5c, v8
    v_med3_f32 v8, v8, v9, v10
    v_cvt_u32_f32 v8, v8
    s_nop 0
    v_readfirstlane_b32 s81, v8
    s_mov_b32 s19, s80
    s_mov_b32 s24, s82
    s_cmp_eq_u32 s20, 0
    s_cselect_b32 s81, 5104, s81
    s_mov_b32 s20, 1
    s_mul_i32 s82, s82, s81
    s_sub_u32 s80, s80, s82
    v_mov_b32 v8, s80
    v_mov_b32 v9, s81
    ds_write_b64 v3, v[8:9] offset:24
    s_nop 0
L_pskip:
    s_add_u32 s16, s16, 1
    s_add_u32 s17, s17, 34816
    s_add_u32 s18, s18, 16
    s_cmp_lt_u32 s18, 250
    s_cbranch_scc1 L_pc0
L_end:
    s_endpgm
.section .rodata,"a"
.p2align 6
.amdhsa_kernel standalone__kv_cache_quant_pre_rope_vs_post_rope__decode_kernel
  .amdhsa_next_free_vgpr 168
  .amdhsa_next_free_sgpr 96
  .amdhsa_accum_offset 168
  .amdhsa_group_segment_fixed_size 0
  .amdhsa_kernarg_size 112
  .amdhsa_user_sgpr_count 2
  .amdhsa_user_sgpr_kernarg_segment_ptr 1
  .amdhsa_system_sgpr_workgroup_id_x 1
.end_amdhsa_kernel
```

```asm
; @launch grid=(256,1,1) block=(512,1,1) lds=159168
.amdgcn_target "amdgcn-amd-amdhsa--gfx950"
.text
.globl standalone__kv_cache_quant_pre_rope_vs_post_rope__decode_kernel
.p2align 8
.type standalone__kv_cache_quant_pre_rope_vs_post_rope__decode_kernel,@function
standalone__kv_cache_quant_pre_rope_vs_post_rope__decode_kernel:
    s_cmp_ge_u32 s2, 256
    s_cbranch_scc1 L_end
    s_load_dwordx16 s[48:63], s[0:1], 0
    s_load_dwordx8 s[64:71], s[0:1], 64
    s_load_dwordx4 s[72:75], s[0:1], 96
    s_memrealtime s[84:85]
    v_lshrrev_b32 v4, 6, v0
    v_and_b32 v1, 63, v0
    v_readfirstlane_b32 s76, v4
    v_lshlrev_b32 v2, 4, v1
    v_mov_b32 v3, 158912
    s_lshl_b32 s76, s76, 2
    s_lshr_b32 s76, 0x65372104, s76
    s_and_b32 s76, s76, 7
    s_and_b32 s79, s2, 7
    s_lshr_b32 s80, s2, 3
    s_and_b32 s77, s80, 3
    s_lshr_b32 s80, s80, 2
    s_lshr_b32 s78, s80, 2
    s_lshl_b32 s78, s78, 3
    s_add_u32 s78, s78, s79
    s_lshl_b32 s78, s78, 2
    s_and_b32 s80, s80, 3
    s_add_u32 s78, s78, s80
    s_cmp_eq_u32 s76, 4
    s_cbranch_scc1 L_ld
    s_cmp_eq_u32 s76, 7
    s_cbranch_scc0 L_nopf
    s_getpc_b64 s[26:27]
L_pc:
    s_sub_u32 s26, s26, L_pc-standalone__kv_cache_quant_pre_rope_vs_post_rope__decode_kernel
    s_subb_u32 s27, s27, 0
    s_lshr_b32 s80, s2, 3
    s_lshl_b32 s80, s80, 9
    v_lshl_add_u32 v5, v1, 3, s80
    v_min_u32 v5, L_end-standalone__kv_cache_quant_pre_rope_vs_post_rope__decode_kernel, v5
    global_load_dword v7, v5, s[26:27]
    s_nop 0
L_nopf:
    v_cmp_eq_u32 vcc, 11, v1
    v_mov_b32 v5, 2328
    v_lshl_add_u32 v6, v1, 2, v3
    v_cndmask_b32 v5, 0, v5, vcc
    ds_write_b32 v6, v5
    s_waitcnt lgkmcnt(0)
    s_barrier
    s_branch L_notld
L_ld:
    s_setprio 3
    s_mul_i32 s8, s77, 12582912
    s_mul_i32 s80, s78, 12288
    s_add_u32 s8, s8, s80
    s_mul_i32 s16, s77, 4
    s_mul_i32 s17, s77, 4
    s_and_b32 s80, s16, 15
    s_mul_i32 s9, s80, 786432
    s_add_u32 s9, s9, s8
    s_mov_b32 m0, 0
    s_mov_b32 s6, 402653184
    s_mov_b32 s7, 0x20000
    s_waitcnt lgkmcnt(0)
    s_mov_b32 s4, s50
    s_mov_b32 s5, s51
    buffer_load_dwordx4 v2, s[4:7], s9 offen offset:0 nt lds
    buffer_load_dwordx4 v2, s[4:7], s9 offen offset:1024 nt lds
    buffer_load_dwordx4 v2, s[4:7], s9 offen offset:2048 nt lds
    buffer_load_dwordx4 v2, s[4:7], s9 offen offset:3072 nt lds
    s_add_u32 s9, s9, 4096
    s_add_u32 m0, m0, 4096
    s_nop 0
    buffer_load_dwordx4 v2, s[4:7], s9 offen offset:0 nt lds
    buffer_load_dwordx4 v2, s[4:7], s9 offen offset:1024 nt lds
    buffer_load_dwordx4 v2, s[4:7], s9 offen offset:2048 nt lds
    buffer_load_dwordx4 v2, s[4:7], s9 offen offset:3072 nt lds
    s_add_u32 s9, s9, 4096
    s_add_u32 m0, m0, 4096
    s_nop 0
    buffer_load_dwordx4 v2, s[4:7], s9 offen offset:0 nt lds
    buffer_load_dwordx4 v2, s[4:7], s9 offen offset:1024 nt lds
    buffer_load_dwordx4 v2, s[4:7], s9 offen offset:2048 nt lds
    buffer_load_dwordx4 v2, s[4:7], s9 offen offset:3072 nt lds
    s_add_u32 s9, s9, 4096
    s_add_u32 m0, m0, 4096
    s_barrier
    s_add_u32 s9, s9, 774144
    buffer_load_dwordx4 v2, s[4:7], s9 offen offset:0 nt lds
    buffer_load_dwordx4 v2, s[4:7], s9 offen offset:1024 nt lds
    buffer_load_dwordx4 v2, s[4:7], s9 offen offset:2048 nt lds
    buffer_load_dwordx4 v2, s[4:7], s9 offen offset:3072 nt lds
    s_add_u32 s9, s9, 4096
    s_add_u32 m0, m0, 4096
    s_nop 0
    buffer_load_dwordx4 v2, s[4:7], s9 offen offset:0 nt lds
    buffer_load_dwordx4 v2, s[4:7], s9 offen offset:1024 nt lds
    buffer_load_dwordx4 v2, s[4:7], s9 offen offset:2048 nt lds
    buffer_load_dwordx4 v2, s[4:7], s9 offen offset:3072 nt lds
    s_add_u32 s9, s9, 4096
    s_add_u32 m0, m0, 4096
    s_nop 0
    buffer_load_dwordx4 v2, s[4:7], s9 offen offset:0 nt lds
    buffer_load_dwordx4 v2, s[4:7], s9 offen offset:1024 nt lds
    buffer_load_dwordx4 v2, s[4:7], s9 offen offset:2048 nt lds
    buffer_load_dwordx4 v2, s[4:7], s9 offen offset:3072 nt lds
    s_add_u32 s9, s9, 4096
    s_add_u32 m0, m0, 4096
    s_mov_b32 s10, 1
    v_mov_b32 v5, 24
    v_mov_b32 v7, 2328
    s_nop 1
L_next:
    s_add_u32 s10, s10, 1
    s_cmp_eq_u32 m0, 110592
    s_cselect_b32 m0, 0, m0
    s_waitcnt lgkmcnt(1)
    v_readfirstlane_b32 s11, v7
    s_add_u32 s12, m0, 12288
    s_add_u32 s9, s9, 774144
    s_and_b32 s80, s10, 3
    s_cbranch_scc0 L_addr
L_aj:
    s_lshr_b32 s80, s11, 8
    s_cmp_gt_u32 s80, s10
    s_cbranch_scc0 L_full
    s_and_b32 s15, s11, 255
    s_cmp_ge_i32 s15, 26
    s_cbranch_scc1 L_t_26_36
    s_cmp_ge_i32 s15, 21
    s_cbranch_scc1 L_t_21_25
    s_cmp_ge_i32 s15, 18
    s_cbranch_scc1 L_t_18_20
    s_cmp_ge_i32 s15, 17
    s_cbranch_scc1 L_v17
    s_branch L_v16
L_t_18_20:
    s_cmp_ge_i32 s15, 19
    s_cbranch_scc1 L_t_19_20
    s_branch L_v18
L_t_19_20:
    s_cmp_ge_i32 s15, 20
    s_cbranch_scc1 L_v20
    s_branch L_v19
L_t_21_25:
    s_cmp_ge_i32 s15, 23
    s_cbranch_scc1 L_t_23_25
    s_cmp_ge_i32 s15, 22
    s_cbranch_scc1 L_v22
    s_branch L_v21
L_t_23_25:
    s_cmp_ge_i32 s15, 24
    s_cbranch_scc1 L_t_24_25
    s_branch L_v23
L_t_24_25:
    s_cmp_ge_i32 s15, 25
    s_cbranch_scc1 L_v25
    s_branch L_v24
L_t_26_36:
    s_cmp_ge_i32 s15, 31
    s_cbranch_scc1 L_t_31_36
    s_cmp_ge_i32 s15, 28
    s_cbranch_scc1 L_t_28_30
    s_cmp_ge_i32 s15, 27
    s_cbranch_scc1 L_v27
    s_branch L_v26
L_t_28_30:
    s_cmp_ge_i32 s15, 29
    s_cbranch_scc1 L_t_29_30
    s_branch L_v28
L_t_29_30:
    s_cmp_ge_i32 s15, 30
    s_cbranch_scc1 L_v30
    s_branch L_v29
L_t_31_36:
    s_cmp_ge_i32 s15, 34
    s_cbranch_scc1 L_t_34_36
    s_cmp_ge_i32 s15, 32
    s_cbranch_scc1 L_t_32_33
    s_branch L_v31
L_t_32_33:
    s_cmp_ge_i32 s15, 33
    s_cbranch_scc1 L_v33
    s_branch L_v32
L_t_34_36:
    s_cmp_ge_i32 s15, 35
    s_cbranch_scc1 L_t_35_36
    s_branch L_v34
L_t_35_36:
    s_cmp_ge_i32 s15, 36
    s_cbranch_scc1 L_v36
    s_branch L_v35
L_v16:
    s_waitcnt vmcnt(15)
    buffer_load_dwordx4 v2, s[4:7], s9 offen offset:0 nt lds
    s_waitcnt vmcnt(15)
    buffer_load_dwordx4 v2, s[4:7], s9 offen offset:1024 nt lds
    ds_read_b32 v7, v3 offset:44
    s_waitcnt vmcnt(15)
    buffer_load_dwordx4 v2, s[4:7], s9 offen offset:2048 nt lds
    v_subrev_u32 v6, 13, v5
    s_add_u32 m0, m0, 3072
    ds_write_b32 v3, v6 offset:16
    v_add_u32 v5, 3, v5
    s_add_u32 s9, s9, 3072
    s_cmp_lg_u32 m0, s12
    s_cbranch_scc1 L_v16
    s_branch L_next
L_v17:
    s_waitcnt vmcnt(16)
    buffer_load_dwordx4 v2, s[4:7], s9 offen offset:0 nt lds
    s_waitcnt vmcnt(16)
    buffer_load_dwordx4 v2, s[4:7], s9 offen offset:1024 nt lds
    ds_read_b32 v7, v3 offset:44
    s_waitcnt vmcnt(16)
    buffer_load_dwordx4 v2, s[4:7], s9 offen offset:2048 nt lds
    v_subrev_u32 v6, 14, v5
    s_add_u32 m0, m0, 3072
    ds_write_b32 v3, v6 offset:16
    v_add_u32 v5, 3, v5
    s_add_u32 s9, s9, 3072
    s_cmp_lg_u32 m0, s12
    s_cbranch_scc1 L_v17
    s_branch L_next
L_v18:
    s_waitcnt vmcnt(17)
    buffer_load_dwordx4 v2, s[4:7], s9 offen offset:0 nt lds
    s_waitcnt vmcnt(17)
    buffer_load_dwordx4 v2, s[4:7], s9 offen offset:1024 nt lds
    ds_read_b32 v7, v3 offset:44
    s_waitcnt vmcnt(17)
    buffer_load_dwordx4 v2, s[4:7], s9 offen offset:2048 nt lds
    v_subrev_u32 v6, 15, v5
    s_add_u32 m0, m0, 3072
    ds_write_b32 v3, v6 offset:16
    v_add_u32 v5, 3, v5
    s_add_u32 s9, s9, 3072
    s_cmp_lg_u32 m0, s12
    s_cbranch_scc1 L_v18
    s_branch L_next
L_v19:
    s_waitcnt vmcnt(18)
    buffer_load_dwordx4 v2, s[4:7], s9 offen offset:0 nt lds
    s_waitcnt vmcnt(18)
    buffer_load_dwordx4 v2, s[4:7], s9 offen offset:1024 nt lds
    ds_read_b32 v7, v3 offset:44
    s_waitcnt vmcnt(18)
    buffer_load_dwordx4 v2, s[4:7], s9 offen offset:2048 nt lds
    v_subrev_u32 v6, 16, v5
    s_add_u32 m0, m0, 3072
    ds_write_b32 v3, v6 offset:16
    v_add_u32 v5, 3, v5
    s_add_u32 s9, s9, 3072
    s_cmp_lg_u32 m0, s12
    s_cbranch_scc1 L_v19
    s_branch L_next
L_v20:
    s_waitcnt vmcnt(19)
    buffer_load_dwordx4 v2, s[4:7], s9 offen offset:0 nt lds
    s_waitcnt vmcnt(19)
    buffer_load_dwordx4 v2, s[4:7], s9 offen offset:1024 nt lds
    ds_read_b32 v7, v3 offset:44
    s_waitcnt vmcnt(19)
    buffer_load_dwordx4 v2, s[4:7], s9 offen offset:2048 nt lds
    v_subrev_u32 v6, 17, v5
    s_add_u32 m0, m0, 3072
    ds_write_b32 v3, v6 offset:16
    v_add_u32 v5, 3, v5
    s_add_u32 s9, s9, 3072
    s_cmp_lg_u32 m0, s12
    s_cbranch_scc1 L_v20
    s_branch L_next
L_v21:
    s_waitcnt vmcnt(20)
    buffer_load_dwordx4 v2, s[4:7], s9 offen offset:0 nt lds
    s_waitcnt vmcnt(20)
    buffer_load_dwordx4 v2, s[4:7], s9 offen offset:1024 nt lds
    ds_read_b32 v7, v3 offset:44
    s_waitcnt vmcnt(20)
    buffer_load_dwordx4 v2, s[4:7], s9 offen offset:2048 nt lds
    v_subrev_u32 v6, 18, v5
    s_add_u32 m0, m0, 3072
    ds_write_b32 v3, v6 offset:16
    v_add_u32 v5, 3, v5
    s_add_u32 s9, s9, 3072
    s_cmp_lg_u32 m0, s12
    s_cbranch_scc1 L_v21
    s_branch L_next
L_v22:
    s_waitcnt vmcnt(21)
    buffer_load_dwordx4 v2, s[4:7], s9 offen offset:0 nt lds
    s_waitcnt vmcnt(21)
    buffer_load_dwordx4 v2, s[4:7], s9 offen offset:1024 nt lds
    ds_read_b32 v7, v3 offset:44
    s_waitcnt vmcnt(21)
    buffer_load_dwordx4 v2, s[4:7], s9 offen offset:2048 nt lds
    v_subrev_u32 v6, 19, v5
    s_add_u32 m0, m0, 3072
    ds_write_b32 v3, v6 offset:16
    v_add_u32 v5, 3, v5
    s_add_u32 s9, s9, 3072
    s_cmp_lg_u32 m0, s12
    s_cbranch_scc1 L_v22
    s_branch L_next
L_v23:
    s_waitcnt vmcnt(22)
    buffer_load_dwordx4 v2, s[4:7], s9 offen offset:0 nt lds
    s_waitcnt vmcnt(22)
    buffer_load_dwordx4 v2, s[4:7], s9 offen offset:1024 nt lds
    ds_read_b32 v7, v3 offset:44
    s_waitcnt vmcnt(22)
    buffer_load_dwordx4 v2, s[4:7], s9 offen offset:2048 nt lds
    v_subrev_u32 v6, 20, v5
    s_add_u32 m0, m0, 3072
    ds_write_b32 v3, v6 offset:16
    v_add_u32 v5, 3, v5
    s_add_u32 s9, s9, 3072
    s_cmp_lg_u32 m0, s12
    s_cbranch_scc1 L_v23
    s_branch L_next
L_v24:
    s_waitcnt vmcnt(23)
    buffer_load_dwordx4 v2, s[4:7], s9 offen offset:0 nt lds
    s_waitcnt vmcnt(23)
    buffer_load_dwordx4 v2, s[4:7], s9 offen offset:1024 nt lds
    ds_read_b32 v7, v3 offset:44
    s_waitcnt vmcnt(23)
    buffer_load_dwordx4 v2, s[4:7], s9 offen offset:2048 nt lds
    v_subrev_u32 v6, 21, v5
    s_add_u32 m0, m0, 3072
    ds_write_b32 v3, v6 offset:16
    v_add_u32 v5, 3, v5
    s_add_u32 s9, s9, 3072
    s_cmp_lg_u32 m0, s12
    s_cbranch_scc1 L_v24
    s_branch L_next
L_v25:
    s_waitcnt vmcnt(24)
    buffer_load_dwordx4 v2, s[4:7], s9 offen offset:0 nt lds
    s_waitcnt vmcnt(24)
    buffer_load_dwordx4 v2, s[4:7], s9 offen offset:1024 nt lds
    ds_read_b32 v7, v3 offset:44
    s_waitcnt vmcnt(24)
    buffer_load_dwordx4 v2, s[4:7], s9 offen offset:2048 nt lds
    v_subrev_u32 v6, 22, v5
    s_add_u32 m0, m0, 3072
    ds_write_b32 v3, v6 offset:16
    v_add_u32 v5, 3, v5
    s_add_u32 s9, s9, 3072
    s_cmp_lg_u32 m0, s12
    s_cbranch_scc1 L_v25
    s_branch L_next
L_v26:
    s_waitcnt vmcnt(25)
    buffer_load_dwordx4 v2, s[4:7], s9 offen offset:0 nt lds
    s_waitcnt vmcnt(25)
    buffer_load_dwordx4 v2, s[4:7], s9 offen offset:1024 nt lds
    ds_read_b32 v7, v3 offset:44
    s_waitcnt vmcnt(25)
    buffer_load_dwordx4 v2, s[4:7], s9 offen offset:2048 nt lds
    v_subrev_u32 v6, 23, v5
    s_add_u32 m0, m0, 3072
    ds_write_b32 v3, v6 offset:16
    v_add_u32 v5, 3, v5
    s_add_u32 s9, s9, 3072
    s_cmp_lg_u32 m0, s12
    s_cbranch_scc1 L_v26
    s_branch L_next
L_v27:
    s_waitcnt vmcnt(26)
    buffer_load_dwordx4 v2, s[4:7], s9 offen offset:0 nt lds
    s_waitcnt vmcnt(26)
    buffer_load_dwordx4 v2, s[4:7], s9 offen offset:1024 nt lds
    ds_read_b32 v7, v3 offset:44
    s_waitcnt vmcnt(26)
    buffer_load_dwordx4 v2, s[4:7], s9 offen offset:2048 nt lds
    v_subrev_u32 v6, 24, v5
    s_add_u32 m0, m0, 3072
    ds_write_b32 v3, v6 offset:16
    v_add_u32 v5, 3, v5
    s_add_u32 s9, s9, 3072
    s_cmp_lg_u32 m0, s12
    s_cbranch_scc1 L_v27
    s_branch L_next
L_v28:
    s_waitcnt vmcnt(27)
    buffer_load_dwordx4 v2, s[4:7], s9 offen offset:0 nt lds
    s_waitcnt vmcnt(27)
    buffer_load_dwordx4 v2, s[4:7], s9 offen offset:1024 nt lds
    ds_read_b32 v7, v3 offset:44
    s_waitcnt vmcnt(27)
    buffer_load_dwordx4 v2, s[4:7], s9 offen offset:2048 nt lds
    v_subrev_u32 v6, 25, v5
    s_add_u32 m0, m0, 3072
    ds_write_b32 v3, v6 offset:16
    v_add_u32 v5, 3, v5
    s_add_u32 s9, s9, 3072
    s_cmp_lg_u32 m0, s12
    s_cbranch_scc1 L_v28
    s_branch L_next
L_v29:
    s_waitcnt vmcnt(28)
    buffer_load_dwordx4 v2, s[4:7], s9 offen offset:0 nt lds
    s_waitcnt vmcnt(28)
    buffer_load_dwordx4 v2, s[4:7], s9 offen offset:1024 nt lds
    ds_read_b32 v7, v3 offset:44
    s_waitcnt vmcnt(28)
    buffer_load_dwordx4 v2, s[4:7], s9 offen offset:2048 nt lds
    v_subrev_u32 v6, 26, v5
    s_add_u32 m0, m0, 3072
    ds_write_b32 v3, v6 offset:16
    v_add_u32 v5, 3, v5
    s_add_u32 s9, s9, 3072
    s_cmp_lg_u32 m0, s12
    s_cbranch_scc1 L_v29
    s_branch L_next
L_v30:
    s_waitcnt vmcnt(29)
    buffer_load_dwordx4 v2, s[4:7], s9 offen offset:0 nt lds
    s_waitcnt vmcnt(29)
    buffer_load_dwordx4 v2, s[4:7], s9 offen offset:1024 nt lds
    ds_read_b32 v7, v3 offset:44
    s_waitcnt vmcnt(29)
    buffer_load_dwordx4 v2, s[4:7], s9 offen offset:2048 nt lds
    v_subrev_u32 v6, 27, v5
    s_add_u32 m0, m0, 3072
    ds_write_b32 v3, v6 offset:16
    v_add_u32 v5, 3, v5
    s_add_u32 s9, s9, 3072
    s_cmp_lg_u32 m0, s12
    s_cbranch_scc1 L_v30
    s_branch L_next
L_v31:
    s_waitcnt vmcnt(30)
    buffer_load_dwordx4 v2, s[4:7], s9 offen offset:0 nt lds
    s_waitcnt vmcnt(30)
    buffer_load_dwordx4 v2, s[4:7], s9 offen offset:1024 nt lds
    ds_read_b32 v7, v3 offset:44
    s_waitcnt vmcnt(30)
    buffer_load_dwordx4 v2, s[4:7], s9 offen offset:2048 nt lds
    v_subrev_u32 v6, 28, v5
    s_add_u32 m0, m0, 3072
    ds_write_b32 v3, v6 offset:16
    v_add_u32 v5, 3, v5
    s_add_u32 s9, s9, 3072
    s_cmp_lg_u32 m0, s12
    s_cbranch_scc1 L_v31
    s_branch L_next
L_v32:
    s_waitcnt vmcnt(31)
    buffer_load_dwordx4 v2, s[4:7], s9 offen offset:0 nt lds
    s_waitcnt vmcnt(31)
    buffer_load_dwordx4 v2, s[4:7], s9 offen offset:1024 nt lds
    ds_read_b32 v7, v3 offset:44
    s_waitcnt vmcnt(31)
    buffer_load_dwordx4 v2, s[4:7], s9 offen offset:2048 nt lds
    v_subrev_u32 v6, 29, v5
    s_add_u32 m0, m0, 3072
    ds_write_b32 v3, v6 offset:16
    v_add_u32 v5, 3, v5
    s_add_u32 s9, s9, 3072
    s_cmp_lg_u32 m0, s12
    s_cbranch_scc1 L_v32
    s_branch L_next
L_v33:
    s_waitcnt vmcnt(32)
    buffer_load_dwordx4 v2, s[4:7], s9 offen offset:0 nt lds
    s_waitcnt vmcnt(32)
    buffer_load_dwordx4 v2, s[4:7], s9 offen offset:1024 nt lds
    ds_read_b32 v7, v3 offset:44
    s_waitcnt vmcnt(32)
    buffer_load_dwordx4 v2, s[4:7], s9 offen offset:2048 nt lds
    v_subrev_u32 v6, 30, v5
    s_add_u32 m0, m0, 3072
    ds_write_b32 v3, v6 offset:16
    v_add_u32 v5, 3, v5
    s_add_u32 s9, s9, 3072
    s_cmp_lg_u32 m0, s12
    s_cbranch_scc1 L_v33
    s_branch L_next
L_v34:
    s_waitcnt vmcnt(33)
    buffer_load_dwordx4 v2, s[4:7], s9 offen offset:0 nt lds
    s_waitcnt vmcnt(33)
    buffer_load_dwordx4 v2, s[4:7], s9 offen offset:1024 nt lds
    ds_read_b32 v7, v3 offset:44
    s_waitcnt vmcnt(33)
    buffer_load_dwordx4 v2, s[4:7], s9 offen offset:2048 nt lds
    v_subrev_u32 v6, 31, v5
    s_add_u32 m0, m0, 3072
    ds_write_b32 v3, v6 offset:16
    v_add_u32 v5, 3, v5
    s_add_u32 s9, s9, 3072
    s_cmp_lg_u32 m0, s12
    s_cbranch_scc1 L_v34
    s_branch L_next
L_v35:
    s_waitcnt vmcnt(34)
    buffer_load_dwordx4 v2, s[4:7], s9 offen offset:0 nt lds
    s_waitcnt vmcnt(34)
    buffer_load_dwordx4 v2, s[4:7], s9 offen offset:1024 nt lds
    ds_read_b32 v7, v3 offset:44
    s_waitcnt vmcnt(34)
    buffer_load_dwordx4 v2, s[4:7], s9 offen offset:2048 nt lds
    v_subrev_u32 v6, 32, v5
    s_add_u32 m0, m0, 3072
    ds_write_b32 v3, v6 offset:16
    v_add_u32 v5, 3, v5
    s_add_u32 s9, s9, 3072
    s_cmp_lg_u32 m0, s12
    s_cbranch_scc1 L_v35
    s_branch L_next
L_v36:
    s_waitcnt vmcnt(35)
    buffer_load_dwordx4 v2, s[4:7], s9 offen offset:0 nt lds
    s_waitcnt vmcnt(35)
    buffer_load_dwordx4 v2, s[4:7], s9 offen offset:1024 nt lds
    ds_read_b32 v7, v3 offset:44
    s_waitcnt vmcnt(35)
    buffer_load_dwordx4 v2, s[4:7], s9 offen offset:2048 nt lds
    v_subrev_u32 v6, 33, v5
    s_add_u32 m0, m0, 3072
    ds_write_b32 v3, v6 offset:16
    v_add_u32 v5, 3, v5
    s_add_u32 s9, s9, 3072
    s_cmp_lg_u32 m0, s12
    s_cbranch_scc1 L_v36
    s_branch L_next
L_full:
    ds_read_b32 v7, v3 offset:44
    s_waitcnt lgkmcnt(0)
    v_readfirstlane_b32 s11, v7
    s_nop 4
    s_branch L_aj
L_addr:
    s_cmp_lt_u32 s10, 128
    s_cbranch_scc0 L_av
    s_lshr_b32 s80, s10, 5
    s_lshl_b32 s80, s80, 2
    s_add_u32 s80, s80, s16
    s_bfe_u32 s81, s10, 0x30002
    s_bitcmp1_b32 s10, 5
    s_cselect_b32 s82, 7, 0
    s_xor_b32 s81, s81, s82
    s_branch L_ak
L_av:
    s_cmp_eq_u32 s10, 256
    s_cbranch_scc1 L_drain
    s_mov_b32 s4, s56
    s_mov_b32 s5, s57
    s_add_u32 s80, s10, s17
    s_bfe_u32 s81, s10, 0x30004
    s_xor_b32 s81, s81, 7
L_ak:
    s_and_b32 s80, s80, 15
    s_mul_i32 s80, s80, 786432
    s_mul_i32 s81, s81, 50331648
    s_add_u32 s9, s80, s81
    s_add_u32 s9, s9, s8
    s_branch L_aj
L_drain:
    v_mov_b32 v6, 3048
    s_waitcnt vmcnt(24)
    ds_write_b32 v3, v6 offset:16
    v_mov_b32 v6, 3060
    s_waitcnt vmcnt(12)
    ds_write_b32 v3, v6 offset:16
    v_mov_b32 v6, 3072
    s_waitcnt vmcnt(0)
    ds_write_b32 v3, v6 offset:16
    s_endpgm
L_notld:
    s_cmp_gt_u32 s76, 4
    s_cbranch_scc1 L_aux
    v_lshrrev_b32 v21, 4, v1
    v_and_b32 v22, 15, v1
    v_mul_u32_u24 v16, 384, v21
    v_lshl_add_u32 v16, v22, 3, v16
    v_cmp_gt_u32 vcc, 8, v22
    v_xor_b32 v17, 64, v16
    s_mul_i32 s24, s77, 4
    s_and_b32 s24, s24, 15
    s_lshl_b32 s80, s78, 2
    s_add_u32 s80, s80, s76
    s_mul_i32 s83, s80, 1536
    s_mul_i32 s16, s24, 393216
    s_add_u32 s16, s16, s83
    s_waitcnt lgkmcnt(0)
    s_mov_b32 s4, s66
    s_mov_b32 s5, s67
    s_mov_b32 s6, 6291456
    s_mov_b32 s7, 0x20000
    s_mov_b32 s8, s68
    s_mov_b32 s9, s69
    s_mov_b32 s10, 6291456
    s_mov_b32 s11, 0x20000
    buffer_load_dwordx2 v[120:121], v16, s[4:7], s16 offen offset:0
    buffer_load_dwordx2 v[126:127], v17, s[8:11], s16 offen offset:0
    buffer_load_dwordx2 v[122:123], v16, s[4:7], s16 offen offset:128
    buffer_load_dwordx2 v[128:129], v17, s[8:11], s16 offen offset:128
    buffer_load_dwordx2 v[124:125], v16, s[4:7], s16 offen offset:256
    buffer_load_dwordx2 v[130:131], v17, s[8:11], s16 offen offset:256
    s_add_u32 s16, s16, 393216
    buffer_load_dwordx2 v[132:133], v16, s[4:7], s16 offen offset:0
    buffer_load_dwordx2 v[138:139], v17, s[8:11], s16 offen offset:0
    buffer_load_dwordx2 v[134:135], v16, s[4:7], s16 offen offset:128
    buffer_load_dwordx2 v[140:141], v17, s[8:11], s16 offen offset:128
    buffer_load_dwordx2 v[136:137], v16, s[4:7], s16 offen offset:256
    buffer_load_dwordx2 v[142:143], v17, s[8:11], s16 offen offset:256
    s_add_u32 s16, s16, 393216
    buffer_load_dwordx2 v[144:145], v16, s[4:7], s16 offen offset:0
    buffer_load_dwordx2 v[150:151], v17, s[8:11], s16 offen offset:0
    buffer_load_dwordx2 v[146:147], v16, s[4:7], s16 offen offset:128
    buffer_load_dwordx2 v[152:153], v17, s[8:11], s16 offen offset:128
    buffer_load_dwordx2 v[148:149], v16, s[4:7], s16 offen offset:256
    buffer_load_dwordx2 v[154:155], v17, s[8:11], s16 offen offset:256
    s_add_u32 s16, s16, 393216
    buffer_load_dwordx2 v[156:157], v16, s[4:7], s16 offen offset:0
    buffer_load_dwordx2 v[162:163], v17, s[8:11], s16 offen offset:0
    buffer_load_dwordx2 v[158:159], v16, s[4:7], s16 offen offset:128
    buffer_load_dwordx2 v[164:165], v17, s[8:11], s16 offen offset:128
    buffer_load_dwordx2 v[160:161], v16, s[4:7], s16 offen offset:256
    buffer_load_dwordx2 v[166:167], v17, s[8:11], s16 offen offset:256
    s_add_u32 s16, s16, 393216
    s_mov_b32 s12, s74
    s_mov_b32 s13, s75
    s_mov_b32 s14, 1610612736
    s_mov_b32 s15, 0x20000
    s_mov_b32 s22, 0x05040100
    s_mov_b32 s23, 0x07060302
    s_lshl_b32 s80, s76, 2
    v_add_u32 v21, s80, v21
    v_mul_u32_u24 v5, 768, v21
    v_lshl_add_u32 v5, v22, 4, v5
    v_lshlrev_b32 v19, 3, v21
    v_add_u32 v19, 126976, v19
    v_lshlrev_b32 v18, 4, v22
    v_add_u32 v18, 151552, v18
    v_add_u32 v11, s80, v3
    v_mov_b32 v10, 0
    v_mov_b32 v23, 0xff
    s_mul_i32 s17, s76, 3
    s_add_u32 s17, s17, 3
    s_mov_b32 s18, 0
    s_mov_b32 s19, 0
    s_mov_b32 s20, 0
    s_mov_b32 s21, 0
    s_waitcnt vmcnt(18)
    v_cndmask_b32 v24, v130, v128, vcc
    v_cndmask_b32 v25, v131, v129, vcc
    v_cndmask_b32 v26, v126, v130, vcc
    v_cndmask_b32 v27, v127, v131, vcc
    v_cndmask_b32 v28, v128, v126, vcc
    v_cndmask_b32 v29, v129, v127, vcc
    v_perm_b32 v72, v24, v120, s22
    v_perm_b32 v73, v24, v120, s23
    v_perm_b32 v74, v25, v121, s22
    v_perm_b32 v75, v25, v121, s23
    v_perm_b32 v76, v26, v122, s22
    v_perm_b32 v77, v26, v122, s23
    v_perm_b32 v78, v27, v123, s22
    v_perm_b32 v79, v27, v123, s23
    v_perm_b32 v80, v28, v124, s22
    v_perm_b32 v81, v28, v124, s23
    v_perm_b32 v82, v29, v125, s22
    v_perm_b32 v83, v29, v125, s23
    s_waitcnt vmcnt(12)
    v_cndmask_b32 v24, v142, v140, vcc
    v_cndmask_b32 v25, v143, v141, vcc
    v_cndmask_b32 v26, v138, v142, vcc
    v_cndmask_b32 v27, v139, v143, vcc
    v_cndmask_b32 v28, v140, v138, vcc
    v_cndmask_b32 v29, v141, v139, vcc
    v_perm_b32 v84, v24, v132, s22
    v_perm_b32 v85, v24, v132, s23
    v_perm_b32 v86, v25, v133, s22
    v_perm_b32 v87, v25, v133, s23
    v_perm_b32 v88, v26, v134, s22
    v_perm_b32 v89, v26, v134, s23
    v_perm_b32 v90, v27, v135, s22
    v_perm_b32 v91, v27, v135, s23
    v_perm_b32 v92, v28, v136, s22
    v_perm_b32 v93, v28, v136, s23
    v_perm_b32 v94, v29, v137, s22
    v_perm_b32 v95, v29, v137, s23
    s_waitcnt vmcnt(6)
    v_cndmask_b32 v24, v154, v152, vcc
    v_cndmask_b32 v25, v155, v153, vcc
    v_cndmask_b32 v26, v150, v154, vcc
    v_cndmask_b32 v27, v151, v155, vcc
    v_cndmask_b32 v28, v152, v150, vcc
    v_cndmask_b32 v29, v153, v151, vcc
    v_perm_b32 v96, v24, v144, s22
    v_perm_b32 v97, v24, v144, s23
    v_perm_b32 v98, v25, v145, s22
    v_perm_b32 v99, v25, v145, s23
    v_perm_b32 v100, v26, v146, s22
    v_perm_b32 v101, v26, v146, s23
    v_perm_b32 v102, v27, v147, s22
    v_perm_b32 v103, v27, v147, s23
    v_perm_b32 v104, v28, v148, s22
    v_perm_b32 v105, v28, v148, s23
    v_perm_b32 v106, v29, v149, s22
    v_perm_b32 v107, v29, v149, s23
    s_waitcnt vmcnt(0)
    v_cndmask_b32 v24, v166, v164, vcc
    v_cndmask_b32 v25, v167, v165, vcc
    v_cndmask_b32 v26, v162, v166, vcc
    v_cndmask_b32 v27, v163, v167, vcc
    v_cndmask_b32 v28, v164, v162, vcc
    v_cndmask_b32 v29, v165, v163, vcc
    v_perm_b32 v108, v24, v156, s22
    v_perm_b32 v109, v24, v156, s23
    v_perm_b32 v110, v25, v157, s22
    v_perm_b32 v111, v25, v157, s23
    v_perm_b32 v112, v26, v158, s22
    v_perm_b32 v113, v26, v158, s23
    v_perm_b32 v114, v27, v159, s22
    v_perm_b32 v115, v27, v159, s23
    v_perm_b32 v116, v28, v160, s22
    v_perm_b32 v117, v28, v160, s23
    v_perm_b32 v118, v29, v161, s22
    v_perm_b32 v119, v29, v161, s23
    s_nop 1
L_kvisit:
    s_cmp_ge_u32 s16, 6291456
    s_cselect_b32 s80, 6291456, 0
    s_sub_u32 s16, s16, s80
    s_and_b32 s26, s20, 1
    s_cmp_lt_u32 s21, 3
    s_cselect_b32 s26, s26, 9
    s_bitcmp1_b32 s21, 0
    s_cselect_b32 s82, 7, 0
    s_xor_b32 s82, s82, s20
    s_mul_i32 s80, s82, 768
    v_add_u32 v6, s80, v18
    s_lshl_b32 s80, s82, 4
    s_add_u32 s80, s80, s24
    s_lshl_b32 s81, s80, 7
    v_add_u32 v8, s81, v19
    s_nop 1
L_qw:
    ds_read_b32 v4, v3 offset:32
    ds_read_b128 v[48:51], v6 offset:0
    ds_read_b128 v[52:55], v6 offset:256
    ds_read_b128 v[56:59], v6 offset:512
    s_waitcnt lgkmcnt(0)
    v_readfirstlane_b32 s80, v4
    s_nop 0
    s_cmp_gt_u32 s80, s82
    s_nop 2
    s_cbranch_scc1 L_qwg
    s_sleep 2
    s_branch L_qw
L_qwg:
    s_cmp_eq_u32 s26, 0
    s_cbranch_scc0 L_nc0
    buffer_load_dwordx2 v[60:61], v16, s[4:7], s16 offen offset:0
L_nc0:
    s_cmp_eq_u32 s26, 1
    s_cbranch_scc0 L_nd0
    buffer_load_dwordx2 v[64:65], v16, s[4:7], s16 offen offset:256
L_nd0:
    v_dot2_f32_bf16 v24, v72, v48, 0
    v_dot2_f32_bf16 v25, v73, v49, 0
    v_dot2_f32_bf16 v26, v74, v50, 0
    v_dot2_f32_bf16 v27, v75, v51, 0
    v_dot2_f32_bf16 v28, v76, v52, 0
    v_dot2_f32_bf16 v29, v77, v53, 0
    v_dot2_f32_bf16 v30, v78, v54, 0
    v_dot2_f32_bf16 v31, v79, v55, 0
    v_dot2_f32_bf16 v32, v80, v56, 0
    v_dot2_f32_bf16 v33, v81, v57, 0
    v_dot2_f32_bf16 v34, v82, v58, 0
    v_dot2_f32_bf16 v35, v83, v59, 0
    v_add_u32 v6, s19, v5
    v_pk_add_f32 v[14:15], v[24:25], v[26:27]
    v_pk_add_f32 v[14:15], v[14:15], v[28:29]
    v_pk_add_f32 v[14:15], v[14:15], v[30:31]
    v_pk_add_f32 v[14:15], v[14:15], v[32:33]
    v_pk_add_f32 v[14:15], v[14:15], v[34:35]
    s_cmp_ge_i32 s18, s17
    s_nop 0
    s_cbranch_scc1 L_kw0g
L_kw0:
    ds_read_b32 v4, v3 offset:16
    s_waitcnt lgkmcnt(0)
    v_readfirstlane_b32 s18, v4
    s_nop 0
    s_cmp_ge_i32 s18, s17
    s_nop 2
    s_cbranch_scc1 L_kw0g
    s_sleep 1
    s_branch L_kw0
L_kw0g:
    ds_read_b128 v[36:39], v6 offset:0
    ds_read_b128 v[40:43], v6 offset:256
    ds_read_b128 v[44:47], v6 offset:512
    v_add_u32 v10, 1, v10
    s_add_u32 s19, s19, 12288
    s_cmp_eq_u32 s19, 110592
    s_cselect_b32 s19, 0, s19
    s_add_u32 s17, s17, 12
    s_waitcnt lgkmcnt(2)
    v_cvt_f32_i32 v36, v36
    v_cvt_f32_i32 v37, v37
    v_cvt_f32_i32 v38, v38
    v_cvt_f32_i32 v39, v39
    v_pk_mul_f32 v[12:13], v[36:37], v[24:25]
    v_pk_fma_f32 v[12:13], v[38:39], v[26:27], v[12:13]
    s_waitcnt lgkmcnt(1)
    v_cvt_f32_i32 v40, v40
    v_cvt_f32_i32 v41, v41
    v_cvt_f32_i32 v42, v42
    v_cvt_f32_i32 v43, v43
    v_pk_fma_f32 v[12:13], v[40:41], v[28:29], v[12:13]
    v_pk_fma_f32 v[12:13], v[42:43], v[30:31], v[12:13]
    s_waitcnt lgkmcnt(0)
    v_cvt_f32_i32 v44, v44
    v_cvt_f32_i32 v45, v45
    v_cvt_f32_i32 v46, v46
    v_cvt_f32_i32 v47, v47
    v_pk_fma_f32 v[12:13], v[44:45], v[32:33], v[12:13]
    v_pk_fma_f32 v[12:13], v[46:47], v[34:35], v[12:13]
    v_add_f32 v12, v12, v13
    v_add_f32 v13, v14, v15
    s_nop 0
    v_add_f32_dpp v12, v12, v12 quad_perm:[1,0,3,2] row_mask:0xf bank_mask:0xf
    v_add_f32_dpp v13, v13, v13 quad_perm:[1,0,3,2] row_mask:0xf bank_mask:0xf
    s_nop 0
    v_add_f32_dpp v12, v12, v12 quad_perm:[2,3,0,1] row_mask:0xf bank_mask:0xf
    v_add_f32_dpp v13, v13, v13 quad_perm:[2,3,0,1] row_mask:0xf bank_mask:0xf
    s_nop 0
    v_add_f32_dpp v12, v12, v12 row_half_mirror row_mask:0xf bank_mask:0xf
    v_add_f32_dpp v13, v13, v13 row_half_mirror row_mask:0xf bank_mask:0xf
    s_nop 0
    v_add_f32_dpp v12, v12, v12 row_mirror row_mask:0xf bank_mask:0xf
    v_add_f32_dpp v13, v13, v13 row_mirror row_mask:0xf bank_mask:0xf
    ds_write_b64 v8, v[12:13] offset:0
    ds_write_b32 v11, v10
    s_cmp_eq_u32 s26, 0
    s_cbranch_scc0 L_nc1
    buffer_load_dwordx2 v[66:67], v17, s[8:11], s16 offen offset:0
L_nc1:
    s_cmp_eq_u32 s26, 1
    s_cbranch_scc0 L_nd1
    buffer_load_dwordx2 v[70:71], v17, s[8:11], s16 offen offset:256
    s_add_u32 s16, s16, 393216
L_nd1:
    v_dot2_f32_bf16 v24, v84, v48, 0
    v_dot2_f32_bf16 v25, v85, v49, 0
    v_dot2_f32_bf16 v26, v86, v50, 0
    v_dot2_f32_bf16 v27, v87, v51, 0
    v_dot2_f32_bf16 v28, v88, v52, 0
    v_dot2_f32_bf16 v29, v89, v53, 0
    v_dot2_f32_bf16 v30, v90, v54, 0
    v_dot2_f32_bf16 v31, v91, v55, 0
    v_dot2_f32_bf16 v32, v92, v56, 0
    v_dot2_f32_bf16 v33, v93, v57, 0
    v_dot2_f32_bf16 v34, v94, v58, 0
    v_dot2_f32_bf16 v35, v95, v59, 0
    v_add_u32 v6, s19, v5
    v_pk_add_f32 v[14:15], v[24:25], v[26:27]
    v_pk_add_f32 v[14:15], v[14:15], v[28:29]
    v_pk_add_f32 v[14:15], v[14:15], v[30:31]
    v_pk_add_f32 v[14:15], v[14:15], v[32:33]
    v_pk_add_f32 v[14:15], v[14:15], v[34:35]
    s_cmp_ge_i32 s18, s17
    s_nop 0
    s_cbranch_scc1 L_kw1g
L_kw1:
    ds_read_b32 v4, v3 offset:16
    s_waitcnt lgkmcnt(0)
    v_readfirstlane_b32 s18, v4
    s_nop 0
    s_cmp_ge_i32 s18, s17
    s_nop 2
    s_cbranch_scc1 L_kw1g
    s_sleep 1
    s_branch L_kw1
L_kw1g:
    ds_read_b128 v[36:39], v6 offset:0
    ds_read_b128 v[40:43], v6 offset:256
    ds_read_b128 v[44:47], v6 offset:512
    v_add_u32 v10, 1, v10
    s_add_u32 s19, s19, 12288
    s_cmp_eq_u32 s19, 110592
    s_cselect_b32 s19, 0, s19
    s_add_u32 s17, s17, 12
    s_waitcnt lgkmcnt(2)
    v_cvt_f32_i32 v36, v36
    v_cvt_f32_i32 v37, v37
    v_cvt_f32_i32 v38, v38
    v_cvt_f32_i32 v39, v39
    v_pk_mul_f32 v[12:13], v[36:37], v[24:25]
    v_pk_fma_f32 v[12:13], v[38:39], v[26:27], v[12:13]
    s_waitcnt lgkmcnt(1)
    v_cvt_f32_i32 v40, v40
    v_cvt_f32_i32 v41, v41
    v_cvt_f32_i32 v42, v42
    v_cvt_f32_i32 v43, v43
    v_pk_fma_f32 v[12:13], v[40:41], v[28:29], v[12:13]
    v_pk_fma_f32 v[12:13], v[42:43], v[30:31], v[12:13]
    s_waitcnt lgkmcnt(0)
    v_cvt_f32_i32 v44, v44
    v_cvt_f32_i32 v45, v45
    v_cvt_f32_i32 v46, v46
    v_cvt_f32_i32 v47, v47
    v_pk_fma_f32 v[12:13], v[44:45], v[32:33], v[12:13]
    v_pk_fma_f32 v[12:13], v[46:47], v[34:35], v[12:13]
    v_add_f32 v12, v12, v13
    v_add_f32 v13, v14, v15
    s_nop 0
    v_add_f32_dpp v12, v12, v12 quad_perm:[1,0,3,2] row_mask:0xf bank_mask:0xf
    v_add_f32_dpp v13, v13, v13 quad_perm:[1,0,3,2] row_mask:0xf bank_mask:0xf
    s_nop 0
    v_add_f32_dpp v12, v12, v12 quad_perm:[2,3,0,1] row_mask:0xf bank_mask:0xf
    v_add_f32_dpp v13, v13, v13 quad_perm:[2,3,0,1] row_mask:0xf bank_mask:0xf
    s_nop 0
    v_add_f32_dpp v12, v12, v12 row_half_mirror row_mask:0xf bank_mask:0xf
    v_add_f32_dpp v13, v13, v13 row_half_mirror row_mask:0xf bank_mask:0xf
    s_nop 0
    v_add_f32_dpp v12, v12, v12 row_mirror row_mask:0xf bank_mask:0xf
    v_add_f32_dpp v13, v13, v13 row_mirror row_mask:0xf bank_mask:0xf
    ds_write_b64 v8, v[12:13] offset:128
    ds_write_b32 v11, v10
    s_cmp_eq_u32 s26, 0
    s_cbranch_scc0 L_nc2
    buffer_load_dwordx2 v[62:63], v16, s[4:7], s16 offen offset:128
L_nc2:
    v_dot2_f32_bf16 v24, v96, v48, 0
    v_dot2_f32_bf16 v25, v97, v49, 0
    v_dot2_f32_bf16 v26, v98, v50, 0
    v_dot2_f32_bf16 v27, v99, v51, 0
    v_dot2_f32_bf16 v28, v100, v52, 0
    v_dot2_f32_bf16 v29, v101, v53, 0
    v_dot2_f32_bf16 v30, v102, v54, 0
    v_dot2_f32_bf16 v31, v103, v55, 0
    v_dot2_f32_bf16 v32, v104, v56, 0
    v_dot2_f32_bf16 v33, v105, v57, 0
    v_dot2_f32_bf16 v34, v106, v58, 0
    v_dot2_f32_bf16 v35, v107, v59, 0
    v_add_u32 v6, s19, v5
    v_pk_add_f32 v[14:15], v[24:25], v[26:27]
    v_pk_add_f32 v[14:15], v[14:15], v[28:29]
    v_pk_add_f32 v[14:15], v[14:15], v[30:31]
    v_pk_add_f32 v[14:15], v[14:15], v[32:33]
    v_pk_add_f32 v[14:15], v[14:15], v[34:35]
    s_cmp_ge_i32 s18, s17
    s_nop 0
    s_cbranch_scc1 L_kw2g
L_kw2:
    ds_read_b32 v4, v3 offset:16
    s_waitcnt lgkmcnt(0)
    v_readfirstlane_b32 s18, v4
    s_nop 0
    s_cmp_ge_i32 s18, s17
    s_nop 2
    s_cbranch_scc1 L_kw2g
    s_sleep 1
    s_branch L_kw2
L_kw2g:
    ds_read_b128 v[36:39], v6 offset:0
    ds_read_b128 v[40:43], v6 offset:256
    ds_read_b128 v[44:47], v6 offset:512
    v_add_u32 v10, 1, v10
    s_add_u32 s19, s19, 12288
    s_cmp_eq_u32 s19, 110592
    s_cselect_b32 s19, 0, s19
    s_add_u32 s17, s17, 12
    s_waitcnt lgkmcnt(2)
    v_cvt_f32_i32 v36, v36
    v_cvt_f32_i32 v37, v37
    v_cvt_f32_i32 v38, v38
    v_cvt_f32_i32 v39, v39
    v_pk_mul_f32 v[12:13], v[36:37], v[24:25]
    v_pk_fma_f32 v[12:13], v[38:39], v[26:27], v[12:13]
    s_waitcnt lgkmcnt(1)
    v_cvt_f32_i32 v40, v40
    v_cvt_f32_i32 v41, v41
    v_cvt_f32_i32 v42, v42
    v_cvt_f32_i32 v43, v43
    v_pk_fma_f32 v[12:13], v[40:41], v[28:29], v[12:13]
    v_pk_fma_f32 v[12:13], v[42:43], v[30:31], v[12:13]
    s_waitcnt lgkmcnt(0)
    v_cvt_f32_i32 v44, v44
    v_cvt_f32_i32 v45, v45
    v_cvt_f32_i32 v46, v46
    v_cvt_f32_i32 v47, v47
    v_pk_fma_f32 v[12:13], v[44:45], v[32:33], v[12:13]
    v_pk_fma_f32 v[12:13], v[46:47], v[34:35], v[12:13]
    v_add_f32 v12, v12, v13
    v_add_f32 v13, v14, v15
    s_nop 0
    v_add_f32_dpp v12, v12, v12 quad_perm:[1,0,3,2] row_mask:0xf bank_mask:0xf
    v_add_f32_dpp v13, v13, v13 quad_perm:[1,0,3,2] row_mask:0xf bank_mask:0xf
    s_nop 0
    v_add_f32_dpp v12, v12, v12 quad_perm:[2,3,0,1] row_mask:0xf bank_mask:0xf
    v_add_f32_dpp v13, v13, v13 quad_perm:[2,3,0,1] row_mask:0xf bank_mask:0xf
    s_nop 0
    v_add_f32_dpp v12, v12, v12 row_half_mirror row_mask:0xf bank_mask:0xf
    v_add_f32_dpp v13, v13, v13 row_half_mirror row_mask:0xf bank_mask:0xf
    s_nop 0
    v_add_f32_dpp v12, v12, v12 row_mirror row_mask:0xf bank_mask:0xf
    v_add_f32_dpp v13, v13, v13 row_mirror row_mask:0xf bank_mask:0xf
    ds_write_b64 v8, v[12:13] offset:256
    ds_write_b32 v11, v10
    s_cmp_eq_u32 s26, 0
    s_cbranch_scc0 L_nc3
    buffer_load_dwordx2 v[68:69], v17, s[8:11], s16 offen offset:128
L_nc3:
    v_dot2_f32_bf16 v24, v108, v48, 0
    v_dot2_f32_bf16 v25, v109, v49, 0
    v_dot2_f32_bf16 v26, v110, v50, 0
    v_dot2_f32_bf16 v27, v111, v51, 0
    v_dot2_f32_bf16 v28, v112, v52, 0
    v_dot2_f32_bf16 v29, v113, v53, 0
    v_dot2_f32_bf16 v30, v114, v54, 0
    v_dot2_f32_bf16 v31, v115, v55, 0
    v_dot2_f32_bf16 v32, v116, v56, 0
    v_dot2_f32_bf16 v33, v117, v57, 0
    v_dot2_f32_bf16 v34, v118, v58, 0
    v_dot2_f32_bf16 v35, v119, v59, 0
    v_add_u32 v6, s19, v5
    v_pk_add_f32 v[14:15], v[24:25], v[26:27]
    v_pk_add_f32 v[14:15], v[14:15], v[28:29]
    v_pk_add_f32 v[14:15], v[14:15], v[30:31]
    v_pk_add_f32 v[14:15], v[14:15], v[32:33]
    v_pk_add_f32 v[14:15], v[14:15], v[34:35]
    s_cmp_ge_i32 s18, s17
    s_nop 0
    s_cbranch_scc1 L_kw3g
L_kw3:
    ds_read_b32 v4, v3 offset:16
    s_waitcnt lgkmcnt(0)
    v_readfirstlane_b32 s18, v4
    s_nop 0
    s_cmp_ge_i32 s18, s17
    s_nop 2
    s_cbranch_scc1 L_kw3g
    s_sleep 1
    s_branch L_kw3
L_kw3g:
    ds_read_b128 v[36:39], v6 offset:0
    ds_read_b128 v[40:43], v6 offset:256
    ds_read_b128 v[44:47], v6 offset:512
    v_add_u32 v10, 1, v10
    s_add_u32 s19, s19, 12288
    s_cmp_eq_u32 s19, 110592
    s_cselect_b32 s19, 0, s19
    s_add_u32 s17, s17, 12
    s_waitcnt lgkmcnt(2)
    v_cvt_f32_i32 v36, v36
    v_cvt_f32_i32 v37, v37
    v_cvt_f32_i32 v38, v38
    v_cvt_f32_i32 v39, v39
    v_pk_mul_f32 v[12:13], v[36:37], v[24:25]
    v_pk_fma_f32 v[12:13], v[38:39], v[26:27], v[12:13]
    s_waitcnt lgkmcnt(1)
    v_cvt_f32_i32 v40, v40
    v_cvt_f32_i32 v41, v41
    v_cvt_f32_i32 v42, v42
    v_cvt_f32_i32 v43, v43
    v_pk_fma_f32 v[12:13], v[40:41], v[28:29], v[12:13]
    v_pk_fma_f32 v[12:13], v[42:43], v[30:31], v[12:13]
    s_waitcnt lgkmcnt(0)
    v_cvt_f32_i32 v44, v44
    v_cvt_f32_i32 v45, v45
    v_cvt_f32_i32 v46, v46
    v_cvt_f32_i32 v47, v47
    v_pk_fma_f32 v[12:13], v[44:45], v[32:33], v[12:13]
    v_pk_fma_f32 v[12:13], v[46:47], v[34:35], v[12:13]
    v_add_f32 v12, v12, v13
    v_add_f32 v13, v14, v15
    s_nop 0
    v_add_f32_dpp v12, v12, v12 quad_perm:[1,0,3,2] row_mask:0xf bank_mask:0xf
    v_add_f32_dpp v13, v13, v13 quad_perm:[1,0,3,2] row_mask:0xf bank_mask:0xf
    s_nop 0
    v_add_f32_dpp v12, v12, v12 quad_perm:[2,3,0,1] row_mask:0xf bank_mask:0xf
    v_add_f32_dpp v13, v13, v13 quad_perm:[2,3,0,1] row_mask:0xf bank_mask:0xf
    s_nop 0
    v_add_f32_dpp v12, v12, v12 row_half_mirror row_mask:0xf bank_mask:0xf
    v_add_f32_dpp v13, v13, v13 row_half_mirror row_mask:0xf bank_mask:0xf
    s_nop 0
    v_add_f32_dpp v12, v12, v12 row_mirror row_mask:0xf bank_mask:0xf
    v_add_f32_dpp v13, v13, v13 row_mirror row_mask:0xf bank_mask:0xf
    ds_write_b64 v8, v[12:13] offset:384
    ds_write_b32 v11, v10
    s_add_u32 s20, s20, 1
    s_and_b32 s80, s20, 1
    s_cbranch_scc1 L_kvisit
    v_mov_b64 v[120:121], v[132:133]
    v_mov_b64 v[122:123], v[134:135]
    v_mov_b64 v[124:125], v[136:137]
    v_mov_b64 v[126:127], v[138:139]
    v_mov_b64 v[128:129], v[140:141]
    v_mov_b64 v[130:131], v[142:143]
    v_mov_b64 v[132:133], v[144:145]
    v_mov_b64 v[134:135], v[146:147]
    v_mov_b64 v[136:137], v[148:149]
    v_mov_b64 v[138:139], v[150:151]
    v_mov_b64 v[140:141], v[152:153]
    v_mov_b64 v[142:143], v[154:155]
    v_mov_b64 v[144:145], v[156:157]
    v_mov_b64 v[146:147], v[158:159]
    v_mov_b64 v[148:149], v[160:161]
    v_mov_b64 v[150:151], v[162:163]
    v_mov_b64 v[152:153], v[164:165]
    v_mov_b64 v[154:155], v[166:167]
    s_waitcnt vmcnt(0)
    v_cndmask_b32 v24, v70, v68, vcc
    v_cndmask_b32 v25, v71, v69, vcc
    v_cndmask_b32 v26, v66, v70, vcc
    v_cndmask_b32 v27, v67, v71, vcc
    v_cndmask_b32 v28, v68, v66, vcc
    v_cndmask_b32 v29, v69, v67, vcc
    v_perm_b32 v156, v24, v60, s22
    v_perm_b32 v157, v24, v60, s23
    v_perm_b32 v158, v25, v61, s22
    v_perm_b32 v159, v25, v61, s23
    v_perm_b32 v160, v26, v62, s22
    v_perm_b32 v161, v26, v62, s23
    v_perm_b32 v162, v27, v63, s22
    v_perm_b32 v163, v27, v63, s23
    v_perm_b32 v164, v28, v64, s22
    v_perm_b32 v165, v28, v64, s23
    v_perm_b32 v166, v29, v65, s22
    v_perm_b32 v167, v29, v65, s23
    s_cmp_lt_u32 s20, 8
    s_nop 0
    s_cbranch_scc1 L_kvisit
    v_mov_b64 v[72:73], v[120:121]
    v_mov_b64 v[74:75], v[122:123]
    v_mov_b64 v[76:77], v[124:125]
    v_mov_b64 v[78:79], v[126:127]
    v_mov_b64 v[80:81], v[128:129]
    v_mov_b64 v[82:83], v[130:131]
    v_mov_b64 v[84:85], v[132:133]
    v_mov_b64 v[86:87], v[134:135]
    v_mov_b64 v[88:89], v[136:137]
    v_mov_b64 v[90:91], v[138:139]
    v_mov_b64 v[92:93], v[140:141]
    v_mov_b64 v[94:95], v[142:143]
    v_mov_b64 v[96:97], v[144:145]
    v_mov_b64 v[98:99], v[146:147]
    v_mov_b64 v[100:101], v[148:149]
    v_mov_b64 v[102:103], v[150:151]
    v_mov_b64 v[104:105], v[152:153]
    v_mov_b64 v[106:107], v[154:155]
    v_mov_b64 v[108:109], v[156:157]
    v_mov_b64 v[110:111], v[158:159]
    v_mov_b64 v[112:113], v[160:161]
    v_mov_b64 v[114:115], v[162:163]
    v_mov_b64 v[116:117], v[164:165]
    v_mov_b64 v[118:119], v[166:167]
    s_mov_b32 s20, 0
    s_add_u32 s24, s24, 4
    s_and_b32 s24, s24, 15
    s_add_u32 s21, s21, 1
    s_cmp_lt_u32 s21, 4
    s_cbranch_scc1 L_kvisit
    v_lshrrev_b32 v21, 2, v1
    v_and_b32 v22, 3, v1
    v_mul_u32_u24 v5, 768, v21
    v_lshl_add_u32 v5, v22, 4, v5
    s_mul_i32 s80, s76, 192
    v_add_u32 v5, s80, v5
    v_lshlrev_b32 v19, 3, v21
    v_add_u32 v19, 126976, v19
    v_lshrrev_b32 v21, 4, v1
    v_lshl_add_u32 v7, v21, 2, v22
    v_and_b32 v21, 1, v7
    v_lshlrev_b32 v7, 4, v7
    s_lshl_b32 s80, s76, 8
    v_add_u32 v7, s80, v7
    v_lshlrev_b32 v18, 3, v21
    v_add_u32 v18, 157696, v18
    v_add_u32 v16, 143360, v7
    s_mov_b32 s32, 0x000f000f
    s_mov_b32 s33, 0x000f000f
    s_mov_b32 s17, 1548
    s_mul_i32 s24, s77, 4
    s_and_b32 s24, s24, 15
    s_mov_b32 s20, 0
    s_add_u32 s25, s77, 0
    s_mul_i32 s25, s25, 64
    s_add_u32 s25, s25, s78
    s_lshl_b32 s25, s25, 10
L_vhead:
    v_mov_b64 v[24:25], 0
    v_mov_b64 v[26:27], 0
    v_mov_b64 v[28:29], 0
    v_mov_b64 v[30:31], 0
    v_mov_b64 v[32:33], 0
    v_mov_b64 v[34:35], 0
    s_mov_b32 s21, 0
    s_nop 0
L_pw:
    ds_read_b64 v[36:37], v3 offset:32
    ds_read_b32 v4, v3 offset:40
    ds_read_b64 v[14:15], v18
    s_waitcnt lgkmcnt(0)
    v_readfirstlane_b32 s80, v37
    v_readfirstlane_b32 s28, v4
    s_cmp_gt_u32 s80, s20
    s_nop 3
    s_cbranch_scc1 L_pwg
    s_sleep 2
    s_branch L_pw
L_pwg:
    s_lshr_b32 s29, s28, 8
    s_lshr_b32 s30, s28, 16
L_vstep:
    s_xor_b32 s80, s20, 7
    s_lshl_b32 s80, s80, 4
    s_add_u32 s80, s80, s24
    s_lshl_b32 s80, s80, 7
    v_add_u32 v8, s80, v19
    v_add_u32 v6, s19, v5
    ds_read_b32 v12, v8
    s_cmp_ge_i32 s18, s17
    s_cbranch_scc1 L_vwg
L_vw:
    ds_read_b32 v4, v3 offset:16
    s_waitcnt lgkmcnt(0)
    v_readfirstlane_b32 s18, v4
    s_nop 0
    s_cmp_ge_i32 s18, s17
    s_nop 2
    s_cbranch_scc1 L_vwg
    s_sleep 1
    s_branch L_vw
L_vwg:
    ds_read_b128 v[36:39], v6 offset:0
    ds_read_b128 v[40:43], v6 offset:64
    ds_read_b128 v[44:47], v6 offset:128
    v_add_u32 v10, 1, v10
    s_add_u32 s19, s19, 12288
    s_cmp_eq_u32 s19, 110592
    s_cselect_b32 s19, 0, s19
    s_add_u32 s17, s17, 12
    s_add_u32 s24, s24, 1
    s_and_b32 s24, s24, 15
    s_add_u32 s21, s21, 1
    s_cmp_lt_u32 s21, 16
    s_waitcnt lgkmcnt(2)
    v_cvt_f32_i32 v36, v36
    v_cvt_f32_i32 v37, v37
    v_cvt_f32_i32 v38, v38
    v_cvt_f32_i32 v39, v39
    v_pk_fma_f32 v[24:25], v[36:37], v[12:13], v[24:25] op_sel_hi:[1,0,1]
    v_pk_fma_f32 v[26:27], v[38:39], v[12:13], v[26:27] op_sel_hi:[1,0,1]
    s_waitcnt lgkmcnt(1)
    v_cvt_f32_i32 v40, v40
    v_cvt_f32_i32 v41, v41
    v_cvt_f32_i32 v42, v42
    v_cvt_f32_i32 v43, v43
    v_pk_fma_f32 v[28:29], v[40:41], v[12:13], v[28:29] op_sel_hi:[1,0,1]
    v_pk_fma_f32 v[30:31], v[42:43], v[12:13], v[30:31] op_sel_hi:[1,0,1]
    s_waitcnt lgkmcnt(0)
    v_cvt_f32_i32 v44, v44
    v_cvt_f32_i32 v45, v45
    v_cvt_f32_i32 v46, v46
    v_cvt_f32_i32 v47, v47
    v_pk_fma_f32 v[32:33], v[44:45], v[12:13], v[32:33] op_sel_hi:[1,0,1]
    v_pk_fma_f32 v[34:35], v[46:47], v[12:13], v[34:35] op_sel_hi:[1,0,1]
    s_nop 1
    s_cbranch_scc0 L_vend
    ds_write_b32 v11, v10
    s_branch L_vstep
L_vend:
    v_permlane32_swap_b32 v24, v26
    v_permlane32_swap_b32 v25, v27
    v_permlane32_swap_b32 v28, v30
    v_permlane32_swap_b32 v29, v31
    v_permlane32_swap_b32 v32, v34
    v_permlane32_swap_b32 v33, v35
    v_pk_add_f32 v[24:25], v[24:25], v[26:27]
    v_pk_add_f32 v[28:29], v[28:29], v[30:31]
    v_pk_add_f32 v[32:33], v[32:33], v[34:35]
    v_permlane16_swap_b32 v24, v25
    v_permlane16_swap_b32 v28, v29
    v_permlane16_swap_b32 v32, v33
    v_add_f32 v36, v24, v25
    v_add_f32 v37, v28, v29
    v_add_f32 v38, v32, v33
    v_mov_b32 v39, v14
    v_add_f32_dpp v36, v36, v36 row_ror:4 row_mask:0xf bank_mask:0xf
    v_add_f32_dpp v37, v37, v37 row_ror:4 row_mask:0xf bank_mask:0xf
    v_add_f32_dpp v38, v38, v38 row_ror:4 row_mask:0xf bank_mask:0xf
    v_add_f32_dpp v36, v36, v36 row_ror:8 row_mask:0xf bank_mask:0xf
    v_add_f32_dpp v37, v37, v37 row_ror:8 row_mask:0xf bank_mask:0xf
    v_add_f32_dpp v38, v38, v38 row_ror:8 row_mask:0xf bank_mask:0xf
    v_sub_f32 v36, v36, v15
    v_sub_f32 v37, v37, v15
    v_sub_f32 v38, v38, v15
    v_bfi_b32 v36, v23, s28, v36
    v_bfi_b32 v37, v23, s29, v37
    v_bfi_b32 v38, v23, s30, v38
    s_add_u32 s20, s20, 1
    s_cmp_eq_u32 s20, 8
    s_mov_b64 exec, s[32:33]
    s_cbranch_scc1 L_vlast
    ds_write_b128 v16, v[36:39]
    s_mov_b64 exec, -1
    ds_write_b32 v11, v10
    v_add_u32 v16, 1024, v16
    v_add_u32 v18, 16, v18
    s_nop 1
    s_branch L_vhead
L_vlast:
    buffer_store_dwordx4 v[36:39], v7, s[12:15], s25 offen sc0 sc1
    s_endpgm
    s_nop 0
L_aux:
    s_cmp_eq_u32 s76, 5
    s_cbranch_scc0 L_pacer
    v_lshlrev_b32 v5, 3, v1
    v_cmp_gt_u32 vcc, 24, v1
    v_mov_b32 v13, 0xffffff40
    v_mov_b32 v10, 192
    v_cndmask_b32 v13, v13, v10, vcc
    v_add_u32 v6, v5, v13
    v_mov_b32 v10, 0x80008000
    v_cndmask_b32 v7, 0, v10, vcc
    v_lshrrev_b32 v10, 1, v1
    v_and_b32 v11, 15, v10
    v_lshrrev_b32 v10, 4, v10
    v_mul_u32_u24 v10, 131072, v10
    v_mul_u32_u24 v11, 2048, v11
    v_add_u32 v10, v10, v11
    v_and_b32 v11, 1, v1
    v_lshl_add_u32 v17, v11, 4, v10
    v_add_u32 v10, 0, v1
    v_mul_u32_u24 v12, 2731, v10
    v_lshrrev_b32 v12, 16, v12
    v_mul_u32_u24 v12, 1152, v12
    v_lshl_add_u32 v56, v10, 4, v12
    v_add_u32 v10, 64, v1
    v_mul_u32_u24 v12, 2731, v10
    v_lshrrev_b32 v12, 16, v12
    v_mul_u32_u24 v12, 1152, v12
    v_lshl_add_u32 v57, v10, 4, v12
    v_add_u32 v10, 128, v1
    v_mul_u32_u24 v12, 2731, v10
    v_lshrrev_b32 v12, 16, v12
    v_mul_u32_u24 v12, 1152, v12
    v_lshl_add_u32 v58, v10, 4, v12
    v_cmp_eq_u32 s[32:33], 0, v11
    s_lshl_b32 s27, s77, 15
    s_lshl_b32 s80, s78, 5
    s_add_u32 s27, s27, s80
    s_mov_b32 m0, 143360
    s_waitcnt lgkmcnt(0)
    s_mov_b32 s4, s62
    s_mov_b32 s5, s63
    s_mov_b32 s6, 384
    s_mov_b32 s7, 0x20000
    s_mov_b32 s20, s64
    s_mov_b32 s21, s65
    s_mov_b32 s22, 384
    s_mov_b32 s23, 0x20000
    buffer_load_dwordx2 v[28:29], v5, s[4:7], 0 offen
    buffer_load_dwordx2 v[30:31], v5, s[20:23], 0 offen
    s_mov_b32 s4, s48
    s_mov_b32 s5, s49
    s_mov_b32 s6, 12288
    s_mov_b32 s7, 0x20000
    s_mul_i32 s80, s77, 384
    buffer_load_dwordx4 v56, s[4:7], s80 offen lds
    s_add_u32 m0, m0, 1024
    s_nop 0
    buffer_load_dwordx4 v57, s[4:7], s80 offen lds
    s_add_u32 m0, m0, 1024
    s_nop 0
    buffer_load_dwordx4 v58, s[4:7], s80 offen lds
    s_add_u32 m0, m0, 1024
    s_and_b32 s80, s78, 3
    s_lshl_b32 s80, s80, 3
    v_lshrrev_b32 v10, 3, v1
    v_add_u32 v10, s80, v10
    v_and_b32 v11, 15, v10
    v_lshrrev_b32 v10, 4, v10
    v_mul_u32_u24 v10, 131072, v10
    v_mul_u32_u24 v11, 2048, v11
    v_add_u32 v10, v10, v11
    v_and_b32 v11, 7, v1
    v_lshl_add_u32 v62, v11, 4, v10
    s_mov_b32 s20, s52
    s_mov_b32 s21, s53
    s_mov_b32 s22, 1048576
    s_mov_b32 s23, 0x20000
    s_andn2_b32 s80, s27, 127
    buffer_load_dwordx4 v[64:67], v62, s[20:23], s80 offen
    s_add_u32 s80, s80, 262144
    buffer_load_dwordx4 v[64:67], v62, s[20:23], s80 offen
    s_add_u32 s80, s80, 262144
    buffer_load_dwordx4 v[64:67], v62, s[20:23], s80 offen
    s_add_u32 s80, s80, 262144
    buffer_load_dwordx4 v[64:67], v62, s[20:23], s80 offen
    s_add_u32 s80, s80, 262144
    s_mov_b32 s20, s54
    s_mov_b32 s21, s55
    s_mov_b32 s22, 1048576
    s_mov_b32 s23, 0x20000
    s_andn2_b32 s80, s27, 127
    buffer_load_dwordx4 v[64:67], v62, s[20:23], s80 offen
    s_add_u32 s80, s80, 262144
    buffer_load_dwordx4 v[64:67], v62, s[20:23], s80 offen
    s_add_u32 s80, s80, 262144
    buffer_load_dwordx4 v[64:67], v62, s[20:23], s80 offen
    s_add_u32 s80, s80, 262144
    buffer_load_dwordx4 v[64:67], v62, s[20:23], s80 offen
    s_add_u32 s80, s80, 262144
    s_mov_b32 s20, s58
    s_mov_b32 s21, s59
    s_mov_b32 s22, 1048576
    s_mov_b32 s23, 0x20000
    s_andn2_b32 s80, s27, 127
    buffer_load_dwordx4 v[64:67], v62, s[20:23], s80 offen
    s_add_u32 s80, s80, 262144
    buffer_load_dwordx4 v[64:67], v62, s[20:23], s80 offen
    s_add_u32 s80, s80, 262144
    buffer_load_dwordx4 v[64:67], v62, s[20:23], s80 offen
    s_add_u32 s80, s80, 262144
    buffer_load_dwordx4 v[64:67], v62, s[20:23], s80 offen
    s_add_u32 s80, s80, 262144
    s_mov_b32 s20, s60
    s_mov_b32 s21, s61
    s_mov_b32 s22, 1048576
    s_mov_b32 s23, 0x20000
    s_andn2_b32 s80, s27, 127
    buffer_load_dwordx4 v[64:67], v62, s[20:23], s80 offen
    s_add_u32 s80, s80, 262144
    buffer_load_dwordx4 v[64:67], v62, s[20:23], s80 offen
    s_add_u32 s80, s80, 262144
    buffer_load_dwordx4 v[64:67], v62, s[20:23], s80 offen
    s_add_u32 s80, s80, 262144
    buffer_load_dwordx4 v[64:67], v62, s[20:23], s80 offen
    s_add_u32 s80, s80, 262144
    s_mov_b32 s12, s74
    s_mov_b32 s13, s75
    s_mov_b32 s14, 1610612736
    s_mov_b32 s15, 0x20000
    s_mov_b32 s8, s72
    s_mov_b32 s9, s73
    s_mov_b32 s10, 256
    s_mov_b32 s11, 0x20000
    s_mov_b32 s16, s70
    s_mov_b32 s17, s71
    s_mov_b32 s18, 12288
    s_mov_b32 s19, 0x20000
    v_mov_b32 v14, 0xff
    v_add_u32 v15, 143360, v5
    v_add_u32 v16, 143360, v6
    v_lshlrev_b32 v8, 1, v5
    v_lshlrev_b32 v9, 1, v6
    v_add_u32 v8, 151552, v8
    v_add_u32 v9, 151552, v9
    v_mov_b32 v12, 0
    s_mov_b32 s24, 0
    s_waitcnt vmcnt(19)
    v_xor_b32 v30, v30, v7
    v_xor_b32 v31, v31, v7
    v_lshlrev_b32 v32, 16, v28
    v_and_b32 v33, 0xffff0000, v28
    v_lshlrev_b32 v34, 16, v29
    v_and_b32 v35, 0xffff0000, v29
    v_lshlrev_b32 v36, 16, v30
    v_and_b32 v37, 0xffff0000, v30
    v_lshlrev_b32 v38, 16, v31
    v_and_b32 v39, 0xffff0000, v31
    v_and_b32 v7, 0x80000000, v7
    s_waitcnt vmcnt(16)
    s_mov_b32 exec_hi, 0xffff
L_hq:
    ds_read_b64 v[20:21], v15
    ds_read_b64 v[22:23], v16
    v_add_u32 v15, 384, v15
    v_add_u32 v16, 384, v16
    v_add_u32 v12, 1, v12
    s_waitcnt lgkmcnt(0)
    v_lshlrev_b32 v40, 16, v20
    v_and_b32 v41, 0xffff0000, v20
    v_lshlrev_b32 v42, 16, v21
    v_and_b32 v43, 0xffff0000, v21
    v_lshlrev_b32 v44, 16, v22
    v_and_b32 v45, 0xffff0000, v22
    v_lshlrev_b32 v46, 16, v23
    v_and_b32 v47, 0xffff0000, v23
    v_pk_mul_f32 v[40:41], v[40:41], v[32:33]
    v_pk_mul_f32 v[44:45], v[44:45], v[36:37]
    v_pk_mul_f32 v[42:43], v[42:43], v[34:35]
    v_pk_mul_f32 v[46:47], v[46:47], v[38:39]
    v_cvt_pk_bf16_f32 v40, v40, v44
    v_cvt_pk_bf16_f32 v41, v41, v45
    v_cvt_pk_bf16_f32 v42, v42, v46
    v_cvt_pk_bf16_f32 v43, v43, v47
    v_and_b32 v44, 0xffff0000, v40
    v_lshlrev_b32 v40, 16, v40
    v_and_b32 v45, 0xffff0000, v41
    v_lshlrev_b32 v41, 16, v41
    v_and_b32 v46, 0xffff0000, v42
    v_lshlrev_b32 v42, 16, v42
    v_and_b32 v47, 0xffff0000, v43
    v_lshlrev_b32 v43, 16, v43
    v_pk_add_f32 v[40:41], v[40:41], v[44:45]
    v_pk_add_f32 v[42:43], v[42:43], v[46:47]
    v_cvt_pk_bf16_f32 v48, v40, v40
    v_cvt_pk_bf16_f32 v49, v41, v41
    v_cvt_pk_bf16_f32 v50, v42, v42
    v_cvt_pk_bf16_f32 v51, v43, v43
    v_xor_b32 v48, v48, v7
    v_xor_b32 v49, v49, v7
    v_xor_b32 v50, v50, v7
    v_xor_b32 v51, v51, v7
    ds_write_b16 v8, v48 offset:0
    ds_write_b16_d16_hi v9, v48 offset:2
    ds_write_b16 v8, v49 offset:4
    ds_write_b16_d16_hi v9, v49 offset:6
    ds_write_b16 v8, v50 offset:8
    ds_write_b16_d16_hi v9, v50 offset:10
    ds_write_b16 v8, v51 offset:12
    ds_write_b16_d16_hi v9, v51 offset:14
    ds_write_b32 v3, v12 offset:32
    v_add_u32 v8, 768, v8
    v_add_u32 v9, 768, v9
    s_add_u32 s24, s24, 1
    s_cmp_lt_u32 s24, 8
    s_cbranch_scc1 L_hq
    s_mov_b32 exec_hi, -1
    s_add_u32 s80, s77, 0
    s_mul_i32 s80, s80, 64
    s_add_u32 s80, s80, s78
    s_lshl_b32 s80, s80, 10
    buffer_load_dwordx4 v[64:67], v2, s[12:15], s80 offen
    s_add_u32 s80, s80, 262144
    v_mov_b32 v15, 0
    s_mov_b32 s25, 0
    s_cmp_eq_u32 s2, 0
    s_cbranch_scc1 L_epc
L_epw:
    s_sleep 16
    ds_read_b32 v4, v3 offset:20
    s_waitcnt lgkmcnt(0)
    v_readfirstlane_b32 s80, v4
    s_nop 0
    s_cmp_lt_i32 s80, 16
    s_nop 2
    s_cbranch_scc1 L_epw
    s_load_dword s28, s[72:73], 0
    s_waitcnt lgkmcnt(0)
    s_cmp_lg_u32 s28, 0
    s_cbranch_scc1 L_epd
L_ep:
    s_mov_b64 exec, 1
    buffer_load_dword v11, v15, s[8:11], 0 offen sc0 sc1
    s_waitcnt vmcnt(0)
    v_readfirstlane_b32 s28, v11
    s_mov_b64 exec, -1
    s_cmp_lg_u32 s28, 0
    s_nop 2
    s_cbranch_scc1 L_epd
    s_sleep 32
    s_add_u32 s25, s25, 1
    s_cmp_lt_u32 s25, 8
    s_cbranch_scc1 L_ep
L_epc:
    s_mul_i32 s28, s84, 0x9e3779b1
    s_lshr_b32 s81, s28, 15
    s_xor_b32 s28, s28, s81
    s_mul_i32 s28, s28, 0x85ebca6b
    s_lshr_b32 s81, s28, 13
    s_xor_b32 s28, s28, s81
    s_max_u32 s28, s28, 1
    v_mov_b32 v20, s28
    v_mov_b32 v21, 0
    s_mov_b64 exec, 1
    buffer_atomic_cmpswap v[20:21], v15, s[8:11], 0 offen sc0 sc1
    s_waitcnt vmcnt(0)
    v_readfirstlane_b32 s80, v20
    s_mov_b64 exec, -1
    s_cmp_eq_u32 s80, 0
    s_cselect_b32 s28, s28, s80
    s_nop 1
L_epd:
    v_mov_b32 v12, s28
    ds_write_b32 v3, v12 offset:40
    s_lshr_b32 s29, s28, 8
    s_lshr_b32 s30, s28, 16
    s_lshr_b32 s31, s28, 24
    s_add_u32 s24, s77, 16
    s_mov_b32 s25, 0
    s_mov_b32 s20, s52
    s_mov_b32 s21, s53
    s_mov_b32 s22, 1048576
    s_mov_b32 s23, 0x20000
L_sc:
    s_sleep 16
    ds_read_b32 v4, v3 offset:20
    s_waitcnt lgkmcnt(0)
    v_readfirstlane_b32 s80, v4
    s_nop 0
    s_cmp_lt_i32 s80, s24
    s_nop 2
    s_cbranch_scc1 L_sc
    s_lshr_b32 s80, s78, 2
    s_add_u32 s80, s80, s25
    s_and_b32 s80, s80, 15
    s_lshl_b32 s81, s80, 10
    s_add_u32 m0, s81, 110592
    s_mov_b64 s[20:21], s[52:53]
    s_cmp_ge_u32 s80, 4
    s_cselect_b64 s[20:21], s[54:55], s[20:21]
    s_cmp_ge_u32 s80, 8
    s_cselect_b64 s[20:21], s[58:59], s[20:21]
    s_cmp_ge_u32 s80, 12
    s_cselect_b64 s[20:21], s[60:61], s[20:21]
    s_and_b32 s80, s80, 3
    s_mul_i32 s80, s80, 262144
    s_add_u32 s80, s80, s27
    buffer_load_dwordx4 v17, s[20:23], s80 offen  lds
    s_add_u32 s25, s25, 1
    s_add_u32 s24, s24, 4
    s_cmp_lt_u32 s25, 16
    s_cbranch_scc1 L_sc
    s_waitcnt vmcnt(0)
    v_mov_b32 v28, 0
    v_mov_b32 v29, 0
    v_mov_b32 v30, 0
    v_mov_b32 v31, 0
    v_mov_b32 v32, 0
    v_mov_b32 v33, 0
    v_mov_b32 v34, 0
    v_mov_b32 v35, 0
    v_mov_b32 v36, 0
    v_mov_b32 v37, 0
    v_mov_b32 v38, 0
    v_mov_b32 v39, 0
    v_mov_b32 v40, 0
    v_mov_b32 v41, 0
    v_mov_b32 v42, 0
    v_mov_b32 v43, 0
    v_mov_b32 v44, 0
    v_mov_b32 v45, 0
    v_mov_b32 v46, 0
    v_mov_b32 v47, 0
    v_mov_b32 v48, 0
    v_mov_b32 v49, 0
    v_mov_b32 v50, 0
    v_mov_b32 v51, 0
    v_mov_b32 v64, 0
    v_mov_b32 v65, 0
    v_mov_b32 v66, 0
    v_mov_b32 v67, 0
    v_mov_b32 v68, 0
    v_mov_b32 v69, 0
    v_mov_b32 v70, 0
    v_mov_b32 v71, 0
    v_lshlrev_b32 v15, 3, v1
    v_add_u32 v15, 141312, v15
    v_lshlrev_b32 v16, 1, v1
    v_add_u32 v16, 114176, v16
    v_mov_b32 v8, 157696
    v_mov_b32 v9, 0
    s_mov_b32 s24, 100
    s_nop 0
L_hp:
    s_sleep 8
    ds_read_b128 v[56:59], v3
    s_waitcnt lgkmcnt(0)
    v_min3_i32 v56, v56, v57, v58
    v_min_i32 v56, v56, v59
    s_nop 0
    v_readfirstlane_b32 s80, v56
    s_nop 0
    s_cmp_lt_i32 s80, s24
    s_nop 2
    s_cbranch_scc1 L_hp
    ds_read_b64 v[72:73], v15 offset:0
    ds_read_u16_d16_hi v28, v16 offset:0
    ds_read_u16_d16_hi v64, v16 offset:4096
    ds_read_b64 v[74:75], v15 offset:512
    ds_read_u16_d16_hi v29, v16 offset:128
    ds_read_u16_d16_hi v65, v16 offset:4224
    ds_read_b64 v[76:77], v15 offset:1024
    ds_read_u16_d16_hi v30, v16 offset:256
    ds_read_u16_d16_hi v66, v16 offset:4352
    ds_read_b64 v[78:79], v15 offset:1536
    ds_read_u16_d16_hi v31, v16 offset:384
    ds_read_u16_d16_hi v67, v16 offset:4480
    s_waitcnt lgkmcnt(0)
    ds_read_u16_d16_hi v36, v16 offset:8192
    ds_read_u16_d16_hi v44, v16 offset:12288
    ds_read_u16_d16_hi v37, v16 offset:8320
    ds_read_u16_d16_hi v45, v16 offset:12416
    ds_read_u16_d16_hi v38, v16 offset:8448
    ds_read_u16_d16_hi v46, v16 offset:12544
    ds_read_u16_d16_hi v39, v16 offset:8576
    ds_read_u16_d16_hi v47, v16 offset:12672
    v_fma_f32 v20, -v64, v73, v72
    v_fma_f32 v21, -v65, v75, v74
    v_fma_f32 v22, -v66, v77, v76
    v_fma_f32 v23, -v67, v79, v78
    v_mul_f32 v20, v20, v28
    v_mul_f32 v21, v21, v29
    v_mul_f32 v22, v22, v30
    v_mul_f32 v23, v23, v31
    v_mul_f32 v20, 0x3dd53b95, v20
    v_mul_f32 v21, 0x3dd53b95, v21
    v_mul_f32 v22, 0x3dd53b95, v22
    v_mul_f32 v23, 0x3dd53b95, v23
    v_mov_b32 v52, v20
    v_max_f32 v52, v52, v21
    v_max_f32 v52, v52, v22
    v_max_f32 v52, v52, v23
    s_nop 1
    v_max_f32_dpp v52, v52, v52 quad_perm:[1,0,3,2] row_mask:0xf bank_mask:0xf
    s_nop 1
    v_max_f32_dpp v52, v52, v52 quad_perm:[2,3,0,1] row_mask:0xf bank_mask:0xf
    s_nop 1
    v_max_f32_dpp v52, v52, v52 row_half_mirror row_mask:0xf bank_mask:0xf
    s_nop 1
    v_max_f32_dpp v52, v52, v52 row_mirror row_mask:0xf bank_mask:0xf
    v_mov_b32 v13, v52
    s_nop 1
    v_permlane32_swap_b32 v52, v13
    v_max_f32 v52, v52, v13
    v_mov_b32 v13, v52
    s_nop 1
    v_permlane16_swap_b32 v52, v13
    v_max_f32 v52, v52, v13
    v_sub_f32 v20, v20, v52
    v_sub_f32 v21, v21, v52
    v_sub_f32 v22, v22, v52
    v_sub_f32 v23, v23, v52
    v_exp_f32 v20, v20
    v_exp_f32 v21, v21
    v_exp_f32 v22, v22
    v_exp_f32 v23, v23
    v_mov_b32 v54, v20
    v_add_f32 v54, v54, v21
    v_add_f32 v54, v54, v22
    v_add_f32 v54, v54, v23
    s_waitcnt lgkmcnt(0)
    v_mul_f32 v20, v20, v36
    v_mul_f32 v21, v21, v37
    v_mul_f32 v22, v22, v38
    v_mul_f32 v23, v23, v39
    v_mul_f32 v53, v20, v44
    v_fmac_f32 v53, v21, v45
    v_fmac_f32 v53, v22, v46
    v_fmac_f32 v53, v23, v47
    ds_write_b32 v15, v20 offset:0
    ds_write_b32 v15, v21 offset:512
    ds_write_b32 v15, v22 offset:1024
    ds_write_b32 v15, v23 offset:1536
    v_add_f32_dpp v54, v54, v54 quad_perm:[1,0,3,2] row_mask:0xf bank_mask:0xf
    s_nop 1
    v_add_f32_dpp v54, v54, v54 quad_perm:[2,3,0,1] row_mask:0xf bank_mask:0xf
    s_nop 1
    v_add_f32_dpp v54, v54, v54 row_half_mirror row_mask:0xf bank_mask:0xf
    s_nop 1
    v_add_f32_dpp v54, v54, v54 row_mirror row_mask:0xf bank_mask:0xf
    v_mov_b32 v13, v54
    s_nop 1
    v_permlane32_swap_b32 v54, v13
    v_add_f32 v54, v54, v13
    v_mov_b32 v13, v54
    s_nop 1
    v_permlane16_swap_b32 v54, v13
    v_add_f32 v54, v54, v13
    v_add_f32_dpp v53, v53, v53 quad_perm:[1,0,3,2] row_mask:0xf bank_mask:0xf
    s_nop 1
    v_add_f32_dpp v53, v53, v53 quad_perm:[2,3,0,1] row_mask:0xf bank_mask:0xf
    s_nop 1
    v_add_f32_dpp v53, v53, v53 row_half_mirror row_mask:0xf bank_mask:0xf
    s_nop 1
    v_add_f32_dpp v53, v53, v53 row_mirror row_mask:0xf bank_mask:0xf
    v_mov_b32 v13, v53
    s_nop 1
    v_permlane32_swap_b32 v53, v13
    v_add_f32 v53, v53, v13
    v_mov_b32 v13, v53
    s_nop 1
    v_permlane16_swap_b32 v53, v13
    v_add_f32 v53, v53, v13
    v_bfi_b32 v54, v14, s31, v54
    v_mov_b32 v55, v53
    v_add_u32 v9, 1, v9
    s_mov_b64 exec, 1
    ds_write_b128 v8, v[52:55]
    ds_write_b32 v3, v9 offset:36
    s_mov_b64 exec, -1
    v_add_u32 v15, -2048, v15
    v_add_u32 v16, -512, v16
    v_add_u32 v8, 16, v8
    s_add_u32 s24, s24, 4
    s_cmp_le_u32 s24, 128
    s_cbranch_scc1 L_hp
    s_add_u32 s26, s77, 28
    s_mul_i32 s26, s26, 64
    s_add_u32 s26, s26, s78
    s_lshl_b32 s26, s26, 10
    s_lshr_b32 s34, s2, 3
    s_and_b32 s35, s2, 7
    v_lshrrev_b32 v10, 3, v1
    v_and_b32 v16, 7, v1
    v_lshlrev_b32 v10, 10, v10
    v_lshl_add_u32 v15, v16, 4, v10
    v_lshrrev_b32 v10, 2, v16
    v_and_b32 v16, 3, v16
    v_lshl_add_u32 v16, v16, 2, v10
    v_lshlrev_b32 v16, 1, v16
    v_bfe_u32 v10, v1, 4, 1
    v_lshl_add_u32 v16, v10, 6, v16
    v_lshrrev_b32 v10, 5, v1
    v_lshl_add_u32 v16, v10, 5, v16
    s_mov_b32 s25, 0
    s_mov_b32 s38, 0
    s_mul_i32 s36, s34, 65536
    s_lshl_b32 s83, s35, 7
    s_add_u32 s36, s36, s83
    s_mul_i32 s37, s34, 384
    s_lshr_b32 s83, s35, 1
    s_mul_i32 s83, s83, 96
    s_add_u32 s37, s37, s83
    s_and_b32 s83, s35, 1
    s_lshl_b32 s83, s83, 2
    s_add_u32 s37, s37, s83
    s_mov_b32 s40, s74
    s_mov_b32 s41, s75
    s_mov_b32 s42, 1610612736
    s_mov_b32 s43, 0x20000
    s_mov_b32 s16, s70
    s_mov_b32 s17, s71
    s_mov_b32 s18, 12288
    s_mov_b32 s19, 0x20000
    v_add_u32 v13, 143360, v2
    s_nop 1
L_hf:
    s_sleep 32
    ds_read_b128 v[56:59], v3
    s_waitcnt lgkmcnt(0)
    v_min3_i32 v56, v56, v57, v58
    v_min_i32 v56, v56, v59
    s_nop 0
    v_readfirstlane_b32 s80, v56
    s_nop 0
    s_cmp_lt_i32 s80, 240
    s_nop 2
    s_cbranch_scc1 L_hf
    ds_read_b128 v[140:143], v13 offset:0
    ds_read_b128 v[144:147], v13 offset:1024
    ds_read_b128 v[148:151], v13 offset:2048
    ds_read_b128 v[152:155], v13 offset:3072
    ds_read_b128 v[156:159], v13 offset:4096
    ds_read_b128 v[160:163], v13 offset:5120
    ds_read_b128 v[164:167], v13 offset:6144
L_hn:
    s_sleep 2
    ds_read_b32 v4, v3 offset:20
    s_waitcnt lgkmcnt(0)
    v_readfirstlane_b32 s80, v4
    s_nop 0
    s_cmp_lt_i32 s80, 253
    s_nop 2
    s_cbranch_scc1 L_hn
    buffer_store_dwordx4 v[140:143], v2, s[12:15], s26 offen sc0 sc1
    s_sub_u32 s26, s26, 262144
    buffer_store_dwordx4 v[144:147], v2, s[12:15], s26 offen sc0 sc1
    s_sub_u32 s26, s26, 262144
    buffer_store_dwordx4 v[148:151], v2, s[12:15], s26 offen sc0 sc1
    s_sub_u32 s26, s26, 262144
    buffer_store_dwordx4 v[152:155], v2, s[12:15], s26 offen sc0 sc1
    s_sub_u32 s26, s26, 262144
    buffer_store_dwordx4 v[156:159], v2, s[12:15], s26 offen sc0 sc1
    s_sub_u32 s26, s26, 262144
    buffer_store_dwordx4 v[160:163], v2, s[12:15], s26 offen sc0 sc1
    s_sub_u32 s26, s26, 262144
    buffer_store_dwordx4 v[164:167], v2, s[12:15], s26 offen sc0 sc1
    s_sub_u32 s26, s26, 262144
    s_nop 0
L_hl:
    s_sleep 1
    ds_read_b32 v4, v3 offset:16
    s_waitcnt lgkmcnt(0)
    v_readfirstlane_b32 s80, v4
    s_nop 0
    s_cmp_lt_i32 s80, 3072
    s_nop 2
    s_cbranch_scc1 L_hl
    s_mov_b32 s80, s36
    buffer_load_dwordx4 v[44:47], v15, s[40:43], s80 offen sc0 sc1
    s_add_u32 s80, s80, 8192
    buffer_load_dwordx4 v[48:51], v15, s[40:43], s80 offen sc0 sc1
    s_add_u32 s80, s80, 8192
    buffer_load_dwordx4 v[52:55], v15, s[40:43], s80 offen sc0 sc1
    s_add_u32 s80, s80, 8192
    buffer_load_dwordx4 v[56:59], v15, s[40:43], s80 offen sc0 sc1
    s_add_u32 s80, s80, 8192
    buffer_load_dwordx4 v[60:63], v15, s[40:43], s80 offen sc0 sc1
    s_add_u32 s80, s80, 8192
    buffer_load_dwordx4 v[64:67], v15, s[40:43], s80 offen sc0 sc1
    s_add_u32 s80, s80, 8192
    buffer_load_dwordx4 v[68:71], v15, s[40:43], s80 offen sc0 sc1
    s_add_u32 s80, s80, 8192
    buffer_load_dwordx4 v[72:75], v15, s[40:43], s80 offen sc0 sc1
    s_waitcnt vmcnt(7)
    v_xor_b32 v12, s28, v44
    v_bitop3_b32 v12, v12, v45, s29 bitop3:0xf6
    v_bitop3_b32 v12, v12, v46, s30 bitop3:0xf6
    v_xor_b32 v13, s31, v47
    s_waitcnt vmcnt(6)
    v_bitop3_b32 v12, v12, v48, s28 bitop3:0xf6
    v_bitop3_b32 v12, v12, v49, s29 bitop3:0xf6
    v_bitop3_b32 v12, v12, v50, s30 bitop3:0xf6
    v_bitop3_b32 v13, v13, v51, s31 bitop3:0xf6
    s_waitcnt vmcnt(5)
    v_bitop3_b32 v12, v12, v52, s28 bitop3:0xf6
    v_bitop3_b32 v12, v12, v53, s29 bitop3:0xf6
    v_bitop3_b32 v12, v12, v54, s30 bitop3:0xf6
    v_bitop3_b32 v13, v13, v55, s31 bitop3:0xf6
    s_waitcnt vmcnt(4)
    v_bitop3_b32 v12, v12, v56, s28 bitop3:0xf6
    v_bitop3_b32 v12, v12, v57, s29 bitop3:0xf6
    v_bitop3_b32 v12, v12, v58, s30 bitop3:0xf6
    v_bitop3_b32 v13, v13, v59, s31 bitop3:0xf6
    s_waitcnt vmcnt(3)
    v_bitop3_b32 v12, v12, v60, s28 bitop3:0xf6
    v_bitop3_b32 v12, v12, v61, s29 bitop3:0xf6
    v_bitop3_b32 v12, v12, v62, s30 bitop3:0xf6
    v_bitop3_b32 v13, v13, v63, s31 bitop3:0xf6
    s_waitcnt vmcnt(2)
    v_bitop3_b32 v12, v12, v64, s28 bitop3:0xf6
    v_bitop3_b32 v12, v12, v65, s29 bitop3:0xf6
    v_bitop3_b32 v12, v12, v66, s30 bitop3:0xf6
    v_bitop3_b32 v13, v13, v67, s31 bitop3:0xf6
    s_waitcnt vmcnt(1)
    v_bitop3_b32 v12, v12, v68, s28 bitop3:0xf6
    v_bitop3_b32 v12, v12, v69, s29 bitop3:0xf6
    v_bitop3_b32 v12, v12, v70, s30 bitop3:0xf6
    v_bitop3_b32 v13, v13, v71, s31 bitop3:0xf6
    s_waitcnt vmcnt(0)
    v_bitop3_b32 v12, v12, v72, s28 bitop3:0xf6
    v_bitop3_b32 v12, v12, v73, s29 bitop3:0xf6
    v_bitop3_b32 v12, v12, v74, s30 bitop3:0xf6
    v_bitop3_b32 v13, v13, v75, s31 bitop3:0xf6
    v_cndmask_b32 v13, v13, 0, s[32:33]
    v_bitop3_b32 v12, v12, v13, v14 bitop3:0xa8
    v_cmp_ne_u32 vcc, 0, v12
    s_nop 4
    s_cbranch_vccz L_ok0
    s_mov_b32 s80, s36
    buffer_load_dwordx4 v[44:47], v15, s[40:43], s80 offen sc0 sc1
    s_add_u32 s80, s80, 8192
    buffer_load_dwordx4 v[48:51], v15, s[40:43], s80 offen sc0 sc1
    s_add_u32 s80, s80, 8192
    buffer_load_dwordx4 v[52:55], v15, s[40:43], s80 offen sc0 sc1
    s_add_u32 s80, s80, 8192
    buffer_load_dwordx4 v[56:59], v15, s[40:43], s80 offen sc0 sc1
    s_add_u32 s80, s80, 8192
    buffer_load_dwordx4 v[60:63], v15, s[40:43], s80 offen sc0 sc1
    s_add_u32 s80, s80, 8192
    buffer_load_dwordx4 v[64:67], v15, s[40:43], s80 offen sc0 sc1
    s_add_u32 s80, s80, 8192
    buffer_load_dwordx4 v[68:71], v15, s[40:43], s80 offen sc0 sc1
    s_add_u32 s80, s80, 8192
    buffer_load_dwordx4 v[72:75], v15, s[40:43], s80 offen sc0 sc1
    s_sleep 6
L_try:
    s_mov_b32 s80, s36
    buffer_load_dwordx4 v[76:79], v15, s[40:43], s80 offen sc0 sc1
    s_add_u32 s80, s80, 8192
    buffer_load_dwordx4 v[80:83], v15, s[40:43], s80 offen sc0 sc1
    s_add_u32 s80, s80, 8192
    buffer_load_dwordx4 v[84:87], v15, s[40:43], s80 offen sc0 sc1
    s_add_u32 s80, s80, 8192
    buffer_load_dwordx4 v[88:91], v15, s[40:43], s80 offen sc0 sc1
    s_add_u32 s80, s80, 8192
    buffer_load_dwordx4 v[92:95], v15, s[40:43], s80 offen sc0 sc1
    s_add_u32 s80, s80, 8192
    buffer_load_dwordx4 v[96:99], v15, s[40:43], s80 offen sc0 sc1
    s_add_u32 s80, s80, 8192
    buffer_load_dwordx4 v[100:103], v15, s[40:43], s80 offen sc0 sc1
    s_add_u32 s80, s80, 8192
    buffer_load_dwordx4 v[104:107], v15, s[40:43], s80 offen sc0 sc1
    s_waitcnt vmcnt(15)
    v_xor_b32 v12, s28, v44
    v_bitop3_b32 v12, v12, v45, s29 bitop3:0xf6
    v_bitop3_b32 v12, v12, v46, s30 bitop3:0xf6
    v_xor_b32 v13, s31, v47
    s_waitcnt vmcnt(14)
    v_bitop3_b32 v12, v12, v48, s28 bitop3:0xf6
    v_bitop3_b32 v12, v12, v49, s29 bitop3:0xf6
    v_bitop3_b32 v12, v12, v50, s30 bitop3:0xf6
    v_bitop3_b32 v13, v13, v51, s31 bitop3:0xf6
    s_waitcnt vmcnt(13)
    v_bitop3_b32 v12, v12, v52, s28 bitop3:0xf6
    v_bitop3_b32 v12, v12, v53, s29 bitop3:0xf6
    v_bitop3_b32 v12, v12, v54, s30 bitop3:0xf6
    v_bitop3_b32 v13, v13, v55, s31 bitop3:0xf6
    s_waitcnt vmcnt(12)
    v_bitop3_b32 v12, v12, v56, s28 bitop3:0xf6
    v_bitop3_b32 v12, v12, v57, s29 bitop3:0xf6
    v_bitop3_b32 v12, v12, v58, s30 bitop3:0xf6
    v_bitop3_b32 v13, v13, v59, s31 bitop3:0xf6
    s_waitcnt vmcnt(11)
    v_bitop3_b32 v12, v12, v60, s28 bitop3:0xf6
    v_bitop3_b32 v12, v12, v61, s29 bitop3:0xf6
    v_bitop3_b32 v12, v12, v62, s30 bitop3:0xf6
    v_bitop3_b32 v13, v13, v63, s31 bitop3:0xf6
    s_waitcnt vmcnt(10)
    v_bitop3_b32 v12, v12, v64, s28 bitop3:0xf6
    v_bitop3_b32 v12, v12, v65, s29 bitop3:0xf6
    v_bitop3_b32 v12, v12, v66, s30 bitop3:0xf6
    v_bitop3_b32 v13, v13, v67, s31 bitop3:0xf6
    s_waitcnt vmcnt(9)
    v_bitop3_b32 v12, v12, v68, s28 bitop3:0xf6
    v_bitop3_b32 v12, v12, v69, s29 bitop3:0xf6
    v_bitop3_b32 v12, v12, v70, s30 bitop3:0xf6
    v_bitop3_b32 v13, v13, v71, s31 bitop3:0xf6
    s_waitcnt vmcnt(8)
    v_bitop3_b32 v12, v12, v72, s28 bitop3:0xf6
    v_bitop3_b32 v12, v12, v73, s29 bitop3:0xf6
    v_bitop3_b32 v12, v12, v74, s30 bitop3:0xf6
    v_bitop3_b32 v13, v13, v75, s31 bitop3:0xf6
    v_cndmask_b32 v13, v13, 0, s[32:33]
    v_bitop3_b32 v12, v12, v13, v14 bitop3:0xa8
    v_cmp_ne_u32 vcc, 0, v12
    s_nop 4
    s_cbranch_vccz L_ok0
    s_mov_b32 s80, s36
    buffer_load_dwordx4 v[44:47], v15, s[40:43], s80 offen sc0 sc1
    s_add_u32 s80, s80, 8192
    buffer_load_dwordx4 v[48:51], v15, s[40:43], s80 offen sc0 sc1
    s_add_u32 s80, s80, 8192
    buffer_load_dwordx4 v[52:55], v15, s[40:43], s80 offen sc0 sc1
    s_add_u32 s80, s80, 8192
    buffer_load_dwordx4 v[56:59], v15, s[40:43], s80 offen sc0 sc1
    s_add_u32 s80, s80, 8192
    buffer_load_dwordx4 v[60:63], v15, s[40:43], s80 offen sc0 sc1
    s_add_u32 s80, s80, 8192
    buffer_load_dwordx4 v[64:67], v15, s[40:43], s80 offen sc0 sc1
    s_add_u32 s80, s80, 8192
    buffer_load_dwordx4 v[68:71], v15, s[40:43], s80 offen sc0 sc1
    s_add_u32 s80, s80, 8192
    buffer_load_dwordx4 v[72:75], v15, s[40:43], s80 offen sc0 sc1
    s_waitcnt vmcnt(15)
    v_xor_b32 v12, s28, v76
    v_bitop3_b32 v12, v12, v77, s29 bitop3:0xf6
    v_bitop3_b32 v12, v12, v78, s30 bitop3:0xf6
    v_xor_b32 v13, s31, v79
    s_waitcnt vmcnt(14)
    v_bitop3_b32 v12, v12, v80, s28 bitop3:0xf6
    v_bitop3_b32 v12, v12, v81, s29 bitop3:0xf6
    v_bitop3_b32 v12, v12, v82, s30 bitop3:0xf6
    v_bitop3_b32 v13, v13, v83, s31 bitop3:0xf6
    s_waitcnt vmcnt(13)
    v_bitop3_b32 v12, v12, v84, s28 bitop3:0xf6
    v_bitop3_b32 v12, v12, v85, s29 bitop3:0xf6
    v_bitop3_b32 v12, v12, v86, s30 bitop3:0xf6
    v_bitop3_b32 v13, v13, v87, s31 bitop3:0xf6
    s_waitcnt vmcnt(12)
    v_bitop3_b32 v12, v12, v88, s28 bitop3:0xf6
    v_bitop3_b32 v12, v12, v89, s29 bitop3:0xf6
    v_bitop3_b32 v12, v12, v90, s30 bitop3:0xf6
    v_bitop3_b32 v13, v13, v91, s31 bitop3:0xf6
    s_waitcnt vmcnt(11)
    v_bitop3_b32 v12, v12, v92, s28 bitop3:0xf6
    v_bitop3_b32 v12, v12, v93, s29 bitop3:0xf6
    v_bitop3_b32 v12, v12, v94, s30 bitop3:0xf6
    v_bitop3_b32 v13, v13, v95, s31 bitop3:0xf6
    s_waitcnt vmcnt(10)
    v_bitop3_b32 v12, v12, v96, s28 bitop3:0xf6
    v_bitop3_b32 v12, v12, v97, s29 bitop3:0xf6
    v_bitop3_b32 v12, v12, v98, s30 bitop3:0xf6
    v_bitop3_b32 v13, v13, v99, s31 bitop3:0xf6
    s_waitcnt vmcnt(9)
    v_bitop3_b32 v12, v12, v100, s28 bitop3:0xf6
    v_bitop3_b32 v12, v12, v101, s29 bitop3:0xf6
    v_bitop3_b32 v12, v12, v102, s30 bitop3:0xf6
    v_bitop3_b32 v13, v13, v103, s31 bitop3:0xf6
    s_waitcnt vmcnt(8)
    v_bitop3_b32 v12, v12, v104, s28 bitop3:0xf6
    v_bitop3_b32 v12, v12, v105, s29 bitop3:0xf6
    v_bitop3_b32 v12, v12, v106, s30 bitop3:0xf6
    v_bitop3_b32 v13, v13, v107, s31 bitop3:0xf6
    v_cndmask_b32 v13, v13, 0, s[32:33]
    v_bitop3_b32 v12, v12, v13, v14 bitop3:0xa8
    v_cmp_ne_u32 vcc, 0, v12
    s_nop 4
    s_cbranch_vccz L_ok1
    s_add_u32 s25, s25, 1
    s_cmp_lt_u32 s25, 2000000
    s_cbranch_scc1 L_try
L_ok1:
    v_max_f32 v11, v79, v83
    v_max3_f32 v11, v11, v87, v91
    v_max3_f32 v11, v11, v95, v99
    v_max3_f32 v11, v11, v103, v107
    s_nop 1
    v_max_f32_dpp v11, v11, v11 row_ror:8 row_mask:0xf bank_mask:0xf
    v_mov_b32 v13, v11
    s_nop 1
    v_permlane32_swap_b32 v11, v13
    v_max_f32 v11, v11, v13
    v_mov_b32 v13, v11
    s_nop 1
    v_permlane16_swap_b32 v11, v13
    v_max_f32 v11, v11, v13
    s_nop 1
    v_mov_b32_dpp v11, v11 quad_perm:[0,0,2,2] row_mask:0xf bank_mask:0xf
    s_nop 1
    v_sub_f32_dpp v20, v79, v11 quad_perm:[0,0,2,2] row_mask:0xf bank_mask:0xf
    v_sub_f32_dpp v21, v83, v11 quad_perm:[0,0,2,2] row_mask:0xf bank_mask:0xf
    v_sub_f32_dpp v22, v87, v11 quad_perm:[0,0,2,2] row_mask:0xf bank_mask:0xf
    v_sub_f32_dpp v23, v91, v11 quad_perm:[0,0,2,2] row_mask:0xf bank_mask:0xf
    v_sub_f32_dpp v24, v95, v11 quad_perm:[0,0,2,2] row_mask:0xf bank_mask:0xf
    v_sub_f32_dpp v25, v99, v11 quad_perm:[0,0,2,2] row_mask:0xf bank_mask:0xf
    v_sub_f32_dpp v26, v103, v11 quad_perm:[0,0,2,2] row_mask:0xf bank_mask:0xf
    v_sub_f32_dpp v27, v107, v11 quad_perm:[0,0,2,2] row_mask:0xf bank_mask:0xf
    v_exp_f32 v20, v20
    v_exp_f32 v21, v21
    v_exp_f32 v22, v22
    v_exp_f32 v23, v23
    v_exp_f32 v24, v24
    v_exp_f32 v25, v25
    v_exp_f32 v26, v26
    v_exp_f32 v27, v27
    v_pk_mul_f32 v[40:41], v[76:77], v[20:21] op_sel:[0,0] op_sel_hi:[1,0]
    v_pk_mul_f32 v[42:43], v[78:79], v[20:21] op_sel:[0,0] op_sel_hi:[1,0]
    v_pk_fma_f32 v[40:41], v[80:81], v[20:21], v[40:41] op_sel:[0,1,0] op_sel_hi:[1,1,1]
    v_pk_fma_f32 v[42:43], v[82:83], v[20:21], v[42:43] op_sel:[0,1,0] op_sel_hi:[1,1,1]
    v_pk_fma_f32 v[40:41], v[84:85], v[22:23], v[40:41] op_sel:[0,0,0] op_sel_hi:[1,0,1]
    v_pk_fma_f32 v[42:43], v[86:87], v[22:23], v[42:43] op_sel:[0,0,0] op_sel_hi:[1,0,1]
    v_pk_fma_f32 v[40:41], v[88:89], v[22:23], v[40:41] op_sel:[0,1,0] op_sel_hi:[1,1,1]
    v_pk_fma_f32 v[42:43], v[90:91], v[22:23], v[42:43] op_sel:[0,1,0] op_sel_hi:[1,1,1]
    v_pk_fma_f32 v[40:41], v[92:93], v[24:25], v[40:41] op_sel:[0,0,0] op_sel_hi:[1,0,1]
    v_pk_fma_f32 v[42:43], v[94:95], v[24:25], v[42:43] op_sel:[0,0,0] op_sel_hi:[1,0,1]
    v_pk_fma_f32 v[40:41], v[96:97], v[24:25], v[40:41] op_sel:[0,1,0] op_sel_hi:[1,1,1]
    v_pk_fma_f32 v[42:43], v[98:99], v[24:25], v[42:43] op_sel:[0,1,0] op_sel_hi:[1,1,1]
    v_pk_fma_f32 v[40:41], v[100:101], v[26:27], v[40:41] op_sel:[0,0,0] op_sel_hi:[1,0,1]
    v_pk_fma_f32 v[42:43], v[102:103], v[26:27], v[42:43] op_sel:[0,0,0] op_sel_hi:[1,0,1]
    v_pk_fma_f32 v[40:41], v[104:105], v[26:27], v[40:41] op_sel:[0,1,0] op_sel_hi:[1,1,1]
    v_pk_fma_f32 v[42:43], v[106:107], v[26:27], v[42:43] op_sel:[0,1,0] op_sel_hi:[1,1,1]
    s_nop 1
    s_branch L_fin
L_ok0:
    v_max_f32 v11, v47, v51
    v_max3_f32 v11, v11, v55, v59
    v_max3_f32 v11, v11, v63, v67
    v_max3_f32 v11, v11, v71, v75
    s_nop 1
    v_max_f32_dpp v11, v11, v11 row_ror:8 row_mask:0xf bank_mask:0xf
    v_mov_b32 v13, v11
    s_nop 1
    v_permlane32_swap_b32 v11, v13
    v_max_f32 v11, v11, v13
    v_mov_b32 v13, v11
    s_nop 1
    v_permlane16_swap_b32 v11, v13
    v_max_f32 v11, v11, v13
    s_nop 1
    v_mov_b32_dpp v11, v11 quad_perm:[0,0,2,2] row_mask:0xf bank_mask:0xf
    s_nop 1
    v_sub_f32_dpp v20, v47, v11 quad_perm:[0,0,2,2] row_mask:0xf bank_mask:0xf
    v_sub_f32_dpp v21, v51, v11 quad_perm:[0,0,2,2] row_mask:0xf bank_mask:0xf
    v_sub_f32_dpp v22, v55, v11 quad_perm:[0,0,2,2] row_mask:0xf bank_mask:0xf
    v_sub_f32_dpp v23, v59, v11 quad_perm:[0,0,2,2] row_mask:0xf bank_mask:0xf
    v_sub_f32_dpp v24, v63, v11 quad_perm:[0,0,2,2] row_mask:0xf bank_mask:0xf
    v_sub_f32_dpp v25, v67, v11 quad_perm:[0,0,2,2] row_mask:0xf bank_mask:0xf
    v_sub_f32_dpp v26, v71, v11 quad_perm:[0,0,2,2] row_mask:0xf bank_mask:0xf
    v_sub_f32_dpp v27, v75, v11 quad_perm:[0,0,2,2] row_mask:0xf bank_mask:0xf
    v_exp_f32 v20, v20
    v_exp_f32 v21, v21
    v_exp_f32 v22, v22
    v_exp_f32 v23, v23
    v_exp_f32 v24, v24
    v_exp_f32 v25, v25
    v_exp_f32 v26, v26
    v_exp_f32 v27, v27
    v_pk_mul_f32 v[40:41], v[44:45], v[20:21] op_sel:[0,0] op_sel_hi:[1,0]
    v_pk_mul_f32 v[42:43], v[46:47], v[20:21] op_sel:[0,0] op_sel_hi:[1,0]
    v_pk_fma_f32 v[40:41], v[48:49], v[20:21], v[40:41] op_sel:[0,1,0] op_sel_hi:[1,1,1]
    v_pk_fma_f32 v[42:43], v[50:51], v[20:21], v[42:43] op_sel:[0,1,0] op_sel_hi:[1,1,1]
    v_pk_fma_f32 v[40:41], v[52:53], v[22:23], v[40:41] op_sel:[0,0,0] op_sel_hi:[1,0,1]
    v_pk_fma_f32 v[42:43], v[54:55], v[22:23], v[42:43] op_sel:[0,0,0] op_sel_hi:[1,0,1]
    v_pk_fma_f32 v[40:41], v[56:57], v[22:23], v[40:41] op_sel:[0,1,0] op_sel_hi:[1,1,1]
    v_pk_fma_f32 v[42:43], v[58:59], v[22:23], v[42:43] op_sel:[0,1,0] op_sel_hi:[1,1,1]
    v_pk_fma_f32 v[40:41], v[60:61], v[24:25], v[40:41] op_sel:[0,0,0] op_sel_hi:[1,0,1]
    v_pk_fma_f32 v[42:43], v[62:63], v[24:25], v[42:43] op_sel:[0,0,0] op_sel_hi:[1,0,1]
    v_pk_fma_f32 v[40:41], v[64:65], v[24:25], v[40:41] op_sel:[0,1,0] op_sel_hi:[1,1,1]
    v_pk_fma_f32 v[42:43], v[66:67], v[24:25], v[42:43] op_sel:[0,1,0] op_sel_hi:[1,1,1]
    v_pk_fma_f32 v[40:41], v[68:69], v[26:27], v[40:41] op_sel:[0,0,0] op_sel_hi:[1,0,1]
    v_pk_fma_f32 v[42:43], v[70:71], v[26:27], v[42:43] op_sel:[0,0,0] op_sel_hi:[1,0,1]
    v_pk_fma_f32 v[40:41], v[72:73], v[26:27], v[40:41] op_sel:[0,1,0] op_sel_hi:[1,1,1]
    v_pk_fma_f32 v[42:43], v[74:75], v[26:27], v[42:43] op_sel:[0,1,0] op_sel_hi:[1,1,1]
    s_nop 1
L_fin:
    v_permlane32_swap_b32 v40, v41
    v_permlane32_swap_b32 v42, v43
    v_add_f32 v40, v40, v41
    v_add_f32 v42, v42, v43
    s_nop 1
    v_permlane16_swap_b32 v40, v42
    v_add_f32 v40, v40, v42
    s_nop 1
    v_add_f32_dpp v40, v40, v40 row_ror:8 row_mask:0xf bank_mask:0xf
    v_rcp_f32 v10, v40
    s_nop 0
    v_readlane_b32 s81, v10, 49
    s_nop 1
    v_mul_f32 v40, s81, v40
    v_cvt_pk_bf16_f32 v40, v40, v40
    s_mov_b32 exec_lo, 0x00ff00ff
    s_mov_b32 exec_hi, 0xff
    buffer_store_short v40, v16, s[16:19], s37 offen
    s_endpgm
L_pacer:
    s_cmp_eq_u32 s76, 6
    s_cbranch_scc0 L_exch
    s_mov_b32 s4, 0
    s_mov_b32 s5, 12
    s_mov_b32 s6, 0
    s_mov_b32 s7, 128
    s_mov_b32 s8, 24
    s_mov_b32 s9, 0
    v_mov_b32 v14, 157824
    s_waitcnt lgkmcnt(0)
    s_lshl_b32 s80, s84, 12
    s_add_u32 s80, s80, 1515520
    v_mov_b32 v12, s80
    v_mov_b32 v13, 5104
    ds_write_b64 v3, v[12:13] offset:24
    v_mov_b32 v15, s84
    ds_write_b32 v14, v15
    s_nop 0
L_g:
    s_sleep 1
    ds_read_b32 v4, v3 offset:16
    s_memrealtime s[10:11]
    ds_read_b128 v[8:11], v3
    ds_read_b64 v[12:13], v3 offset:24
    s_waitcnt lgkmcnt(0)
    v_readfirstlane_b32 s83, v4
    v_min3_i32 v15, v8, v9, v10
    v_min_i32 v8, v15, v11
    v_readfirstlane_b32 s80, v12
    v_readfirstlane_b32 s81, v13
    s_max_i32 s9, s9, s83
    s_cmp_ge_i32 s9, s5
    s_nop 2
    s_cbranch_scc0 L_gn
    s_add_u32 s4, s4, 1
    s_add_u32 s5, s5, 12
    v_add_u32 v14, 4, v14
    v_mov_b32 v15, s10
    ds_write_b32 v14, v15
    v_mov_b32 v15, s4
    ds_write_b32 v3, v15 offset:20
    s_nop 0
L_gn:
    s_mul_i32 s6, s9, 43691
    s_lshr_b32 s6, s6, 14
    s_mul_i32 s81, s81, s6
    s_add_u32 s80, s80, s81
    s_lshl_b32 s81, s10, 12
    s_sub_u32 s80, s81, s80
    s_ashr_i32 s80, s80, 6
    s_min_i32 s80, s80, 0x40000
    s_max_i32 s80, s80, 0xfffc0000
    s_mul_i32 s80, s80, 983
    s_ashr_i32 s80, s80, 12
    s_and_b32 s7, s7, 255
    s_add_u32 s7, s7, s80
    s_add_u32 s7, s7, 5632
    s_ashr_i32 s8, s7, 8
    s_min_i32 s8, s8, 36
    s_max_i32 s8, s8, 16
    s_cmp_lt_u32 s4, 3
    s_cselect_b32 s8, 24, s8
L_gw:
    s_add_u32 s80, s8, 2304
    v_lshl_add_u32 v15, v8, 8, s80
    ds_write_b32 v3, v15 offset:44
    s_cmp_lt_u32 s4, 256
    s_cbranch_scc1 L_g
    s_endpgm
L_exch:
    s_mov_b32 s12, s74
    s_mov_b32 s13, s75
    s_mov_b32 s14, 1610612736
    s_mov_b32 s15, 0x20000
    s_mov_b32 s80, 4352
    v_mul_lo_u32 v5, v1, s80
    s_lshr_b32 s80, s2, 3
    s_mul_i32 s21, s79, 5
    s_add_u32 s21, s21, s80
    s_and_b32 s21, s21, 31
    s_lshr_b32 s80, s80, 5
    s_lshl_b32 s80, s80, 3
    s_add_u32 s80, s80, s79
    s_mul_i32 s80, s80, 4352
    s_waitcnt vmcnt(0)
    v_mov_b32 v7, s80
    s_mov_b32 s16, 0
    s_mov_b32 s17, 33554432
    s_mov_b32 s18, 8
    s_mov_b32 s20, 0
    s_mov_b32 s19, 0
    s_mov_b32 s24, 0
L_pc0:
L_pw1:
    s_sleep 8
    ds_read_b32 v4, v3 offset:20
    s_waitcnt lgkmcnt(0)
    v_readfirstlane_b32 s80, v4
    s_nop 0
    s_cmp_lt_i32 s80, s18
    s_nop 2
    s_cbranch_scc1 L_pw1
    s_lshl_b32 s80, s18, 2
    s_add_u32 s80, s80, 157824
    v_mov_b32 v8, s80
    ds_read_b32 v6, v8
    s_waitcnt lgkmcnt(0)
    s_and_b32 s80, s16, 31
    s_cmp_eq_u32 s80, s21
    s_cbranch_scc0 L_np
    s_mov_b64 exec, 1
    buffer_store_dword v6, v7, s[12:15], s17 offen sc0 sc1
    s_mov_b64 exec, -1
L_np:
    s_add_u32 s81, s18, 4
L_pw2:
    s_sleep 8
    ds_read_b32 v4, v3 offset:20
    s_waitcnt lgkmcnt(0)
    v_readfirstlane_b32 s80, v4
    s_nop 0
    s_cmp_lt_i32 s80, s81
    s_nop 2
    s_cbranch_scc1 L_pw2
    s_add_u32 s30, s74, s17
    s_addc_u32 s31, s75, 0
    s_load_dword s32, s[30:31], 0
    s_load_dword s33, s[30:31], 4352
    s_load_dword s34, s[30:31], 8704
    s_load_dword s35, s[30:31], 13056
    s_load_dword s36, s[30:31], 17408
    s_load_dword s37, s[30:31], 21760
    s_load_dword s38, s[30:31], 26112
    s_load_dword s39, s[30:31], 30464
    s_memrealtime s[22:23]
    v_readfirstlane_b32 s26, v6
    s_mov_b32 s27, 0
    s_mov_b32 s28, 0
    s_mov_b32 s29, -4096
    s_waitcnt lgkmcnt(0)
    s_sub_u32 s83, s22, s26
    s_sub_u32 s80, s32, s26
    s_add_u32 s81, s80, 4096
    s_cmp_lt_u32 s81, 0x2000
    s_cselect_b32 s80, s80, s83
    s_addc_u32 s28, s28, 0
    s_add_u32 s27, s27, s80
    s_max_i32 s29, s29, s80
    s_sub_u32 s80, s33, s26
    s_add_u32 s81, s80, 4096
    s_cmp_lt_u32 s81, 0x2000
    s_cselect_b32 s80, s80, s83
    s_addc_u32 s28, s28, 0
    s_add_u32 s27, s27, s80
    s_max_i32 s29, s29, s80
    s_sub_u32 s80, s34, s26
    s_add_u32 s81, s80, 4096
    s_cmp_lt_u32 s81, 0x2000
    s_cselect_b32 s80, s80, s83
    s_addc_u32 s28, s28, 0
    s_add_u32 s27, s27, s80
    s_max_i32 s29, s29, s80
    s_sub_u32 s80, s35, s26
    s_add_u32 s81, s80, 4096
    s_cmp_lt_u32 s81, 0x2000
    s_cselect_b32 s80, s80, s83
    s_addc_u32 s28, s28, 0
    s_add_u32 s27, s27, s80
    s_max_i32 s29, s29, s80
    s_sub_u32 s80, s36, s26
    s_add_u32 s81, s80, 4096
    s_cmp_lt_u32 s81, 0x2000
    s_cselect_b32 s80, s80, s83
    s_addc_u32 s28, s28, 0
    s_add_u32 s27, s27, s80
    s_max_i32 s29, s29, s80
    s_sub_u32 s80, s37, s26
    s_add_u32 s81, s80, 4096
    s_cmp_lt_u32 s81, 0x2000
    s_cselect_b32 s80, s80, s83
    s_addc_u32 s28, s28, 0
    s_add_u32 s27, s27, s80
    s_max_i32 s29, s29, s80
    s_sub_u32 s80, s38, s26
    s_add_u32 s81, s80, 4096
    s_cmp_lt_u32 s81, 0x2000
    s_cselect_b32 s80, s80, s83
    s_addc_u32 s28, s28, 0
    s_add_u32 s27, s27, s80
    s_max_i32 s29, s29, s80
    s_sub_u32 s80, s39, s26
    s_add_u32 s81, s80, 4096
    s_cmp_lt_u32 s81, 0x2000
    s_cselect_b32 s80, s80, s83
    s_addc_u32 s28, s28, 0
    s_add_u32 s27, s27, s80
    s_max_i32 s29, s29, s80
    s_cmp_lt_u32 s28, 4
    s_cbranch_scc1 L_pskip
    s_mul_i32 s27, s27, 410
    s_lshl_b32 s80, s26, 12
    s_add_u32 s80, s80, s27
    s_mul_i32 s29, s29, 819
    s_add_u32 s80, s80, s29
    s_min_u32 s82, s18, 0
    s_lshl_b32 s83, s18, 5
    s_add_u32 s82, s82, s83
    s_sub_u32 s81, s80, s19
    s_sub_u32 s83, s82, s24
    v_cvt_f32_u32 v8, s81
    v_cvt_f32_u32 v9, s83
    v_rcp_f32 v9, v9
    v_mul_f32 v8, 0x3f800000, v8
    v_mul_f32 v8, v8, v9
    v_mul_f32 v9, 0x3f7851ec, v8
    v_mov_b32 v10, 0x459f8000
    v_mul_f32 v8, 0x3f828f5c, v8
    v_med3_f32 v8, v8, v9, v10
    v_cvt_u32_f32 v8, v8
    s_nop 0
    v_readfirstlane_b32 s81, v8
    s_mov_b32 s19, s80
    s_mov_b32 s24, s82
    s_cmp_eq_u32 s20, 0
    s_cselect_b32 s81, 5104, s81
    s_mov_b32 s20, 1
    s_mul_i32 s82, s82, s81
    s_sub_u32 s80, s80, s82
    v_mov_b32 v8, s80
    v_mov_b32 v9, s81
    ds_write_b64 v3, v[8:9] offset:24
    s_nop 0
L_pskip:
    s_add_u32 s16, s16, 1
    s_add_u32 s17, s17, 34816
    s_add_u32 s18, s18, 16
    s_cmp_lt_u32 s18, 250
    s_cbranch_scc1 L_pc0
L_end:
    s_endpgm
.section .rodata,"a"
.p2align 6
.amdhsa_kernel standalone__kv_cache_quant_pre_rope_vs_post_rope__decode_kernel
  .amdhsa_next_free_vgpr 168
  .amdhsa_next_free_sgpr 96
  .amdhsa_accum_offset 168
  .amdhsa_group_segment_fixed_size 0
  .amdhsa_kernarg_size 112
  .amdhsa_user_sgpr_count 2
  .amdhsa_user_sgpr_kernarg_segment_ptr 1
  .amdhsa_system_sgpr_workgroup_id_x 1
.end_amdhsa_kernel
```

```asm
; @launch grid=(256,1,1) block=(512,1,1) lds=159168
.amdgcn_target "amdgcn-amd-amdhsa--gfx950"
.text
.globl standalone__kv_cache_quant_pre_rope_vs_post_rope__decode_kernel
.p2align 8
.type standalone__kv_cache_quant_pre_rope_vs_post_rope__decode_kernel,@function
standalone__kv_cache_quant_pre_rope_vs_post_rope__decode_kernel:
    s_cmp_ge_u32 s2, 256
    s_cbranch_scc1 L_end
    s_load_dwordx2 s[4:5], s[0:1], 8
    v_readfirstlane_b32 s76, v0
    s_and_b32 s79, s2, 7
    s_lshr_b32 s78, s2, 7
    s_lshl3_add_u32 s78, s78, s79
    s_lshr_b32 s77, s2, 3
    s_lshr_b32 s80, s77, 2
    s_and_b32 s77, s77, 3
    s_and_b32 s80, s80, 3
    s_lshl2_add_u32 s78, s78, s80
    s_cmp_lt_u32 s76, 64
    s_cbranch_scc0 L_init
    s_getpc_b64 s[26:27]
L_pc:
    s_lshl_b32 s81, s2, 6
    s_and_b32 s81, s81, 0x3e00
    v_lshl_add_u32 v5, v0, 3, s81
    v_min_u32 v5, L_end-L_pc, v5
    global_load_dword v7, v5, s[26:27]
    v_lshlrev_b32 v2, 4, v0
    s_mul_i32 s9, s77, 15728640
    s_mul_i32 s80, s78, 12288
    s_mov_b32 m0, 0
    s_add_u32 s9, s9, s80
    s_mov_b32 s6, 402653184
    s_mov_b32 s7, 0x20000
    s_movk_i32 s12, 12288
    s_waitcnt lgkmcnt(0)
L_first:
    s_waitcnt vmcnt(22)
    buffer_load_dwordx4 v2, s[4:7], s9 offen offset:0 nt lds
    buffer_load_dwordx4 v2, s[4:7], s9 offen offset:1024 nt lds
    s_waitcnt vmcnt(22)
    buffer_load_dwordx4 v2, s[4:7], s9 offen offset:2048 nt lds
    buffer_load_dwordx4 v2, s[4:7], s9 offen offset:3072 nt lds
    s_addk_i32 m0, 4096
    s_addk_i32 s9, 4096
    s_cmp_lg_u32 m0, s12
    s_cbranch_scc1 L_first
    s_addk_i32 s12, 12288
    s_add_u32 s9, s9, 774144
    s_cmp_lt_u32 m0, 36864
    s_cbranch_scc1 L_first
    s_sub_u32 s9, s9, 774144
    s_barrier
    s_load_dwordx2 s[56:57], s[0:1], 32
    s_setprio 3
    s_mul_i32 s8, s77, 12582912
    s_add_u32 s8, s8, s80
    s_mul_i32 s16, s77, 4
    s_mul_i32 s17, s77, 4
    v_mov_b32 v3, 158912
    s_waitcnt vmcnt(24)
    s_mov_b32 s10, 2
    v_mov_b32 v5, 36
    v_mov_b32 v7, 2328
    s_waitcnt lgkmcnt(0)
    s_nop 0
    s_branch L_next
L_init:
    s_load_dwordx16 s[48:63], s[0:1], 0
    s_load_dwordx8 s[64:71], s[0:1], 64
    s_load_dwordx4 s[72:75], s[0:1], 96
    s_memrealtime s[84:85]
    v_and_b32 v1, 63, v0
    s_lshr_b32 s76, s76, 4
    s_lshr_b32 s76, 0x65372104, s76
    s_and_b32 s76, s76, 7
    v_lshlrev_b32 v2, 4, v1
    v_mov_b32 v3, 158912
    v_cmp_eq_u32 vcc, 11, v1
    v_mov_b32 v5, 2328
    v_lshl_add_u32 v6, v1, 2, v3
    v_cndmask_b32 v5, 0, v5, vcc
    ds_write_b32 v6, v5
    s_waitcnt lgkmcnt(0)
    s_barrier
    s_branch L_notld
L_next:
    s_add_u32 s10, s10, 1
    s_cmp_eq_u32 m0, 110592
    s_cselect_b32 m0, 0, m0
    s_waitcnt lgkmcnt(1)
    v_readfirstlane_b32 s11, v7
    s_add_u32 s12, m0, 12288
    s_add_u32 s9, s9, 774144
    s_and_b32 s80, s10, 3
    s_cbranch_scc0 L_addr
L_aj:
    s_lshr_b32 s80, s11, 8
    s_cmp_gt_u32 s80, s10
    s_cbranch_scc0 L_full
    s_and_b32 s15, s11, 255
    s_cmp_ge_i32 s15, 26
    s_cbranch_scc1 L_t_26_36
    s_cmp_ge_i32 s15, 21
    s_cbranch_scc1 L_t_21_25
    s_cmp_ge_i32 s15, 18
    s_cbranch_scc1 L_t_18_20
    s_cmp_ge_i32 s15, 17
    s_cbranch_scc1 L_v17
    s_branch L_v16
L_t_18_20:
    s_cmp_ge_i32 s15, 19
    s_cbranch_scc1 L_t_19_20
    s_branch L_v18
L_t_19_20:
    s_cmp_ge_i32 s15, 20
    s_cbranch_scc1 L_v20
    s_branch L_v19
L_t_21_25:
    s_cmp_ge_i32 s15, 23
    s_cbranch_scc1 L_t_23_25
    s_cmp_ge_i32 s15, 22
    s_cbranch_scc1 L_v22
    s_branch L_v21
L_t_23_25:
    s_cmp_ge_i32 s15, 24
    s_cbranch_scc1 L_t_24_25
    s_branch L_v23
L_t_24_25:
    s_cmp_ge_i32 s15, 25
    s_cbranch_scc1 L_v25
    s_branch L_v24
L_t_26_36:
    s_cmp_ge_i32 s15, 31
    s_cbranch_scc1 L_t_31_36
    s_cmp_ge_i32 s15, 28
    s_cbranch_scc1 L_t_28_30
    s_cmp_ge_i32 s15, 27
    s_cbranch_scc1 L_v27
    s_branch L_v26
L_t_28_30:
    s_cmp_ge_i32 s15, 29
    s_cbranch_scc1 L_t_29_30
    s_branch L_v28
L_t_29_30:
    s_cmp_ge_i32 s15, 30
    s_cbranch_scc1 L_v30
    s_branch L_v29
L_t_31_36:
    s_cmp_ge_i32 s15, 34
    s_cbranch_scc1 L_t_34_36
    s_cmp_ge_i32 s15, 32
    s_cbranch_scc1 L_t_32_33
    s_branch L_v31
L_t_32_33:
    s_cmp_ge_i32 s15, 33
    s_cbranch_scc1 L_v33
    s_branch L_v32
L_t_34_36:
    s_cmp_ge_i32 s15, 35
    s_cbranch_scc1 L_t_35_36
    s_branch L_v34
L_t_35_36:
    s_cmp_ge_i32 s15, 36
    s_cbranch_scc1 L_v36
    s_branch L_v35
L_v16:
    s_waitcnt vmcnt(15)
    buffer_load_dwordx4 v2, s[4:7], s9 offen offset:0 nt lds
    s_waitcnt vmcnt(15)
    buffer_load_dwordx4 v2, s[4:7], s9 offen offset:1024 nt lds
    ds_read_b32 v7, v3 offset:44
    s_waitcnt vmcnt(15)
    buffer_load_dwordx4 v2, s[4:7], s9 offen offset:2048 nt lds
    v_subrev_u32 v6, 13, v5
    s_add_u32 m0, m0, 3072
    ds_write_b32 v3, v6 offset:16
    v_add_u32 v5, 3, v5
    s_add_u32 s9, s9, 3072
    s_cmp_lg_u32 m0, s12
    s_cbranch_scc1 L_v16
    s_branch L_next
L_v17:
    s_waitcnt vmcnt(16)
    buffer_load_dwordx4 v2, s[4:7], s9 offen offset:0 nt lds
    s_waitcnt vmcnt(16)
    buffer_load_dwordx4 v2, s[4:7], s9 offen offset:1024 nt lds
    ds_read_b32 v7, v3 offset:44
    s_waitcnt vmcnt(16)
    buffer_load_dwordx4 v2, s[4:7], s9 offen offset:2048 nt lds
    v_subrev_u32 v6, 14, v5
    s_add_u32 m0, m0, 3072
    ds_write_b32 v3, v6 offset:16
    v_add_u32 v5, 3, v5
    s_add_u32 s9, s9, 3072
    s_cmp_lg_u32 m0, s12
    s_cbranch_scc1 L_v17
    s_branch L_next
L_v18:
    s_waitcnt vmcnt(17)
    buffer_load_dwordx4 v2, s[4:7], s9 offen offset:0 nt lds
    s_waitcnt vmcnt(17)
    buffer_load_dwordx4 v2, s[4:7], s9 offen offset:1024 nt lds
    ds_read_b32 v7, v3 offset:44
    s_waitcnt vmcnt(17)
    buffer_load_dwordx4 v2, s[4:7], s9 offen offset:2048 nt lds
    v_subrev_u32 v6, 15, v5
    s_add_u32 m0, m0, 3072
    ds_write_b32 v3, v6 offset:16
    v_add_u32 v5, 3, v5
    s_add_u32 s9, s9, 3072
    s_cmp_lg_u32 m0, s12
    s_cbranch_scc1 L_v18
    s_branch L_next
L_v19:
    s_waitcnt vmcnt(18)
    buffer_load_dwordx4 v2, s[4:7], s9 offen offset:0 nt lds
    s_waitcnt vmcnt(18)
    buffer_load_dwordx4 v2, s[4:7], s9 offen offset:1024 nt lds
    ds_read_b32 v7, v3 offset:44
    s_waitcnt vmcnt(18)
    buffer_load_dwordx4 v2, s[4:7], s9 offen offset:2048 nt lds
    v_subrev_u32 v6, 16, v5
    s_add_u32 m0, m0, 3072
    ds_write_b32 v3, v6 offset:16
    v_add_u32 v5, 3, v5
    s_add_u32 s9, s9, 3072
    s_cmp_lg_u32 m0, s12
    s_cbranch_scc1 L_v19
    s_branch L_next
L_v20:
    s_waitcnt vmcnt(19)
    buffer_load_dwordx4 v2, s[4:7], s9 offen offset:0 nt lds
    s_waitcnt vmcnt(19)
    buffer_load_dwordx4 v2, s[4:7], s9 offen offset:1024 nt lds
    ds_read_b32 v7, v3 offset:44
    s_waitcnt vmcnt(19)
    buffer_load_dwordx4 v2, s[4:7], s9 offen offset:2048 nt lds
    v_subrev_u32 v6, 17, v5
    s_add_u32 m0, m0, 3072
    ds_write_b32 v3, v6 offset:16
    v_add_u32 v5, 3, v5
    s_add_u32 s9, s9, 3072
    s_cmp_lg_u32 m0, s12
    s_cbranch_scc1 L_v20
    s_branch L_next
L_v21:
    s_waitcnt vmcnt(20)
    buffer_load_dwordx4 v2, s[4:7], s9 offen offset:0 nt lds
    s_waitcnt vmcnt(20)
    buffer_load_dwordx4 v2, s[4:7], s9 offen offset:1024 nt lds
    ds_read_b32 v7, v3 offset:44
    s_waitcnt vmcnt(20)
    buffer_load_dwordx4 v2, s[4:7], s9 offen offset:2048 nt lds
    v_subrev_u32 v6, 18, v5
    s_add_u32 m0, m0, 3072
    ds_write_b32 v3, v6 offset:16
    v_add_u32 v5, 3, v5
    s_add_u32 s9, s9, 3072
    s_cmp_lg_u32 m0, s12
    s_cbranch_scc1 L_v21
    s_branch L_next
L_v22:
    s_waitcnt vmcnt(21)
    buffer_load_dwordx4 v2, s[4:7], s9 offen offset:0 nt lds
    s_waitcnt vmcnt(21)
    buffer_load_dwordx4 v2, s[4:7], s9 offen offset:1024 nt lds
    ds_read_b32 v7, v3 offset:44
    s_waitcnt vmcnt(21)
    buffer_load_dwordx4 v2, s[4:7], s9 offen offset:2048 nt lds
    v_subrev_u32 v6, 19, v5
    s_add_u32 m0, m0, 3072
    ds_write_b32 v3, v6 offset:16
    v_add_u32 v5, 3, v5
    s_add_u32 s9, s9, 3072
    s_cmp_lg_u32 m0, s12
    s_cbranch_scc1 L_v22
    s_branch L_next
L_v23:
    s_waitcnt vmcnt(22)
    buffer_load_dwordx4 v2, s[4:7], s9 offen offset:0 nt lds
    s_waitcnt vmcnt(22)
    buffer_load_dwordx4 v2, s[4:7], s9 offen offset:1024 nt lds
    ds_read_b32 v7, v3 offset:44
    s_waitcnt vmcnt(22)
    buffer_load_dwordx4 v2, s[4:7], s9 offen offset:2048 nt lds
    v_subrev_u32 v6, 20, v5
    s_add_u32 m0, m0, 3072
    ds_write_b32 v3, v6 offset:16
    v_add_u32 v5, 3, v5
    s_add_u32 s9, s9, 3072
    s_cmp_lg_u32 m0, s12
    s_cbranch_scc1 L_v23
    s_branch L_next
L_v24:
    s_waitcnt vmcnt(23)
    buffer_load_dwordx4 v2, s[4:7], s9 offen offset:0 nt lds
    s_waitcnt vmcnt(23)
    buffer_load_dwordx4 v2, s[4:7], s9 offen offset:1024 nt lds
    ds_read_b32 v7, v3 offset:44
    s_waitcnt vmcnt(23)
    buffer_load_dwordx4 v2, s[4:7], s9 offen offset:2048 nt lds
    v_subrev_u32 v6, 21, v5
    s_add_u32 m0, m0, 3072
    ds_write_b32 v3, v6 offset:16
    v_add_u32 v5, 3, v5
    s_add_u32 s9, s9, 3072
    s_cmp_lg_u32 m0, s12
    s_cbranch_scc1 L_v24
    s_branch L_next
L_v25:
    s_waitcnt vmcnt(24)
    buffer_load_dwordx4 v2, s[4:7], s9 offen offset:0 nt lds
    s_waitcnt vmcnt(24)
    buffer_load_dwordx4 v2, s[4:7], s9 offen offset:1024 nt lds
    ds_read_b32 v7, v3 offset:44
    s_waitcnt vmcnt(24)
    buffer_load_dwordx4 v2, s[4:7], s9 offen offset:2048 nt lds
    v_subrev_u32 v6, 22, v5
    s_add_u32 m0, m0, 3072
    ds_write_b32 v3, v6 offset:16
    v_add_u32 v5, 3, v5
    s_add_u32 s9, s9, 3072
    s_cmp_lg_u32 m0, s12
    s_cbranch_scc1 L_v25
    s_branch L_next
L_v26:
    s_waitcnt vmcnt(25)
    buffer_load_dwordx4 v2, s[4:7], s9 offen offset:0 nt lds
    s_waitcnt vmcnt(25)
    buffer_load_dwordx4 v2, s[4:7], s9 offen offset:1024 nt lds
    ds_read_b32 v7, v3 offset:44
    s_waitcnt vmcnt(25)
    buffer_load_dwordx4 v2, s[4:7], s9 offen offset:2048 nt lds
    v_subrev_u32 v6, 23, v5
    s_add_u32 m0, m0, 3072
    ds_write_b32 v3, v6 offset:16
    v_add_u32 v5, 3, v5
    s_add_u32 s9, s9, 3072
    s_cmp_lg_u32 m0, s12
    s_cbranch_scc1 L_v26
    s_branch L_next
L_v27:
    s_waitcnt vmcnt(26)
    buffer_load_dwordx4 v2, s[4:7], s9 offen offset:0 nt lds
    s_waitcnt vmcnt(26)
    buffer_load_dwordx4 v2, s[4:7], s9 offen offset:1024 nt lds
    ds_read_b32 v7, v3 offset:44
    s_waitcnt vmcnt(26)
    buffer_load_dwordx4 v2, s[4:7], s9 offen offset:2048 nt lds
    v_subrev_u32 v6, 24, v5
    s_add_u32 m0, m0, 3072
    ds_write_b32 v3, v6 offset:16
    v_add_u32 v5, 3, v5
    s_add_u32 s9, s9, 3072
    s_cmp_lg_u32 m0, s12
    s_cbranch_scc1 L_v27
    s_branch L_next
L_v28:
    s_waitcnt vmcnt(27)
    buffer_load_dwordx4 v2, s[4:7], s9 offen offset:0 nt lds
    s_waitcnt vmcnt(27)
    buffer_load_dwordx4 v2, s[4:7], s9 offen offset:1024 nt lds
    ds_read_b32 v7, v3 offset:44
    s_waitcnt vmcnt(27)
    buffer_load_dwordx4 v2, s[4:7], s9 offen offset:2048 nt lds
    v_subrev_u32 v6, 25, v5
    s_add_u32 m0, m0, 3072
    ds_write_b32 v3, v6 offset:16
    v_add_u32 v5, 3, v5
    s_add_u32 s9, s9, 3072
    s_cmp_lg_u32 m0, s12
    s_cbranch_scc1 L_v28
    s_branch L_next
L_v29:
    s_waitcnt vmcnt(28)
    buffer_load_dwordx4 v2, s[4:7], s9 offen offset:0 nt lds
    s_waitcnt vmcnt(28)
    buffer_load_dwordx4 v2, s[4:7], s9 offen offset:1024 nt lds
    ds_read_b32 v7, v3 offset:44
    s_waitcnt vmcnt(28)
    buffer_load_dwordx4 v2, s[4:7], s9 offen offset:2048 nt lds
    v_subrev_u32 v6, 26, v5
    s_add_u32 m0, m0, 3072
    ds_write_b32 v3, v6 offset:16
    v_add_u32 v5, 3, v5
    s_add_u32 s9, s9, 3072
    s_cmp_lg_u32 m0, s12
    s_cbranch_scc1 L_v29
    s_branch L_next
L_v30:
    s_waitcnt vmcnt(29)
    buffer_load_dwordx4 v2, s[4:7], s9 offen offset:0 nt lds
    s_waitcnt vmcnt(29)
    buffer_load_dwordx4 v2, s[4:7], s9 offen offset:1024 nt lds
    ds_read_b32 v7, v3 offset:44
    s_waitcnt vmcnt(29)
    buffer_load_dwordx4 v2, s[4:7], s9 offen offset:2048 nt lds
    v_subrev_u32 v6, 27, v5
    s_add_u32 m0, m0, 3072
    ds_write_b32 v3, v6 offset:16
    v_add_u32 v5, 3, v5
    s_add_u32 s9, s9, 3072
    s_cmp_lg_u32 m0, s12
    s_cbranch_scc1 L_v30
    s_branch L_next
L_v31:
    s_waitcnt vmcnt(30)
    buffer_load_dwordx4 v2, s[4:7], s9 offen offset:0 nt lds
    s_waitcnt vmcnt(30)
    buffer_load_dwordx4 v2, s[4:7], s9 offen offset:1024 nt lds
    ds_read_b32 v7, v3 offset:44
    s_waitcnt vmcnt(30)
    buffer_load_dwordx4 v2, s[4:7], s9 offen offset:2048 nt lds
    v_subrev_u32 v6, 28, v5
    s_add_u32 m0, m0, 3072
    ds_write_b32 v3, v6 offset:16
    v_add_u32 v5, 3, v5
    s_add_u32 s9, s9, 3072
    s_cmp_lg_u32 m0, s12
    s_cbranch_scc1 L_v31
    s_branch L_next
L_v32:
    s_waitcnt vmcnt(31)
    buffer_load_dwordx4 v2, s[4:7], s9 offen offset:0 nt lds
    s_waitcnt vmcnt(31)
    buffer_load_dwordx4 v2, s[4:7], s9 offen offset:1024 nt lds
    ds_read_b32 v7, v3 offset:44
    s_waitcnt vmcnt(31)
    buffer_load_dwordx4 v2, s[4:7], s9 offen offset:2048 nt lds
    v_subrev_u32 v6, 29, v5
    s_add_u32 m0, m0, 3072
    ds_write_b32 v3, v6 offset:16
    v_add_u32 v5, 3, v5
    s_add_u32 s9, s9, 3072
    s_cmp_lg_u32 m0, s12
    s_cbranch_scc1 L_v32
    s_branch L_next
L_v33:
    s_waitcnt vmcnt(32)
    buffer_load_dwordx4 v2, s[4:7], s9 offen offset:0 nt lds
    s_waitcnt vmcnt(32)
    buffer_load_dwordx4 v2, s[4:7], s9 offen offset:1024 nt lds
    ds_read_b32 v7, v3 offset:44
    s_waitcnt vmcnt(32)
    buffer_load_dwordx4 v2, s[4:7], s9 offen offset:2048 nt lds
    v_subrev_u32 v6, 30, v5
    s_add_u32 m0, m0, 3072
    ds_write_b32 v3, v6 offset:16
    v_add_u32 v5, 3, v5
    s_add_u32 s9, s9, 3072
    s_cmp_lg_u32 m0, s12
    s_cbranch_scc1 L_v33
    s_branch L_next
L_v34:
    s_waitcnt vmcnt(33)
    buffer_load_dwordx4 v2, s[4:7], s9 offen offset:0 nt lds
    s_waitcnt vmcnt(33)
    buffer_load_dwordx4 v2, s[4:7], s9 offen offset:1024 nt lds
    ds_read_b32 v7, v3 offset:44
    s_waitcnt vmcnt(33)
    buffer_load_dwordx4 v2, s[4:7], s9 offen offset:2048 nt lds
    v_subrev_u32 v6, 31, v5
    s_add_u32 m0, m0, 3072
    ds_write_b32 v3, v6 offset:16
    v_add_u32 v5, 3, v5
    s_add_u32 s9, s9, 3072
    s_cmp_lg_u32 m0, s12
    s_cbranch_scc1 L_v34
    s_branch L_next
L_v35:
    s_waitcnt vmcnt(34)
    buffer_load_dwordx4 v2, s[4:7], s9 offen offset:0 nt lds
    s_waitcnt vmcnt(34)
    buffer_load_dwordx4 v2, s[4:7], s9 offen offset:1024 nt lds
    ds_read_b32 v7, v3 offset:44
    s_waitcnt vmcnt(34)
    buffer_load_dwordx4 v2, s[4:7], s9 offen offset:2048 nt lds
    v_subrev_u32 v6, 32, v5
    s_add_u32 m0, m0, 3072
    ds_write_b32 v3, v6 offset:16
    v_add_u32 v5, 3, v5
    s_add_u32 s9, s9, 3072
    s_cmp_lg_u32 m0, s12
    s_cbranch_scc1 L_v35
    s_branch L_next
L_v36:
    s_waitcnt vmcnt(35)
    buffer_load_dwordx4 v2, s[4:7], s9 offen offset:0 nt lds
    s_waitcnt vmcnt(35)
    buffer_load_dwordx4 v2, s[4:7], s9 offen offset:1024 nt lds
    ds_read_b32 v7, v3 offset:44
    s_waitcnt vmcnt(35)
    buffer_load_dwordx4 v2, s[4:7], s9 offen offset:2048 nt lds
    v_subrev_u32 v6, 33, v5
    s_add_u32 m0, m0, 3072
    ds_write_b32 v3, v6 offset:16
    v_add_u32 v5, 3, v5
    s_add_u32 s9, s9, 3072
    s_cmp_lg_u32 m0, s12
    s_cbranch_scc1 L_v36
    s_branch L_next
L_full:
    ds_read_b32 v7, v3 offset:44
    s_waitcnt lgkmcnt(0)
    v_readfirstlane_b32 s11, v7
    s_nop 4
    s_branch L_aj
L_addr:
    s_cmp_lt_u32 s10, 128
    s_cbranch_scc0 L_av
    s_lshr_b32 s80, s10, 5
    s_lshl_b32 s80, s80, 2
    s_add_u32 s80, s80, s16
    s_bfe_u32 s81, s10, 0x30002
    s_bitcmp1_b32 s10, 5
    s_cselect_b32 s82, 7, 0
    s_xor_b32 s81, s81, s82
    s_branch L_ak
L_av:
    s_cmp_eq_u32 s10, 256
    s_cbranch_scc1 L_drain
    s_mov_b32 s4, s56
    s_mov_b32 s5, s57
    s_add_u32 s80, s10, s17
    s_bfe_u32 s81, s10, 0x30004
    s_xor_b32 s81, s81, 7
L_ak:
    s_and_b32 s80, s80, 15
    s_mul_i32 s80, s80, 786432
    s_mul_i32 s81, s81, 50331648
    s_add_u32 s9, s80, s81
    s_add_u32 s9, s9, s8
    s_branch L_aj
L_drain:
    v_mov_b32 v6, 3048
    s_waitcnt vmcnt(24)
    ds_write_b32 v3, v6 offset:16
    v_mov_b32 v6, 3060
    s_waitcnt vmcnt(12)
    ds_write_b32 v3, v6 offset:16
    v_mov_b32 v6, 3072
    s_waitcnt vmcnt(0)
    ds_write_b32 v3, v6 offset:16
    s_endpgm
L_notld:
    s_cmp_gt_u32 s76, 4
    s_cbranch_scc1 L_aux
    v_lshrrev_b32 v21, 4, v1
    v_and_b32 v22, 15, v1
    v_mul_u32_u24 v16, 384, v21
    v_lshl_add_u32 v16, v22, 3, v16
    v_cmp_gt_u32 vcc, 8, v22
    v_xor_b32 v17, 64, v16
    s_mul_i32 s24, s77, 4
    s_and_b32 s24, s24, 15
    s_lshl_b32 s80, s78, 2
    s_add_u32 s80, s80, s76
    s_mul_i32 s83, s80, 1536
    s_mul_i32 s16, s24, 393216
    s_add_u32 s16, s16, s83
    s_waitcnt lgkmcnt(0)
    s_mov_b32 s4, s66
    s_mov_b32 s5, s67
    s_mov_b32 s6, 6291456
    s_mov_b32 s7, 0x20000
    s_mov_b32 s8, s68
    s_mov_b32 s9, s69
    s_mov_b32 s10, 6291456
    s_mov_b32 s11, 0x20000
    buffer_load_dwordx2 v[120:121], v16, s[4:7], s16 offen offset:0
    buffer_load_dwordx2 v[126:127], v17, s[8:11], s16 offen offset:0
    buffer_load_dwordx2 v[122:123], v16, s[4:7], s16 offen offset:128
    buffer_load_dwordx2 v[128:129], v17, s[8:11], s16 offen offset:128
    buffer_load_dwordx2 v[124:125], v16, s[4:7], s16 offen offset:256
    buffer_load_dwordx2 v[130:131], v17, s[8:11], s16 offen offset:256
    s_add_u32 s16, s16, 393216
    buffer_load_dwordx2 v[132:133], v16, s[4:7], s16 offen offset:0
    buffer_load_dwordx2 v[138:139], v17, s[8:11], s16 offen offset:0
    buffer_load_dwordx2 v[134:135], v16, s[4:7], s16 offen offset:128
    buffer_load_dwordx2 v[140:141], v17, s[8:11], s16 offen offset:128
    buffer_load_dwordx2 v[136:137], v16, s[4:7], s16 offen offset:256
    buffer_load_dwordx2 v[142:143], v17, s[8:11], s16 offen offset:256
    s_add_u32 s16, s16, 393216
    buffer_load_dwordx2 v[144:145], v16, s[4:7], s16 offen offset:0
    buffer_load_dwordx2 v[150:151], v17, s[8:11], s16 offen offset:0
    buffer_load_dwordx2 v[146:147], v16, s[4:7], s16 offen offset:128
    buffer_load_dwordx2 v[152:153], v17, s[8:11], s16 offen offset:128
    buffer_load_dwordx2 v[148:149], v16, s[4:7], s16 offen offset:256
    buffer_load_dwordx2 v[154:155], v17, s[8:11], s16 offen offset:256
    s_add_u32 s16, s16, 393216
    buffer_load_dwordx2 v[156:157], v16, s[4:7], s16 offen offset:0
    buffer_load_dwordx2 v[162:163], v17, s[8:11], s16 offen offset:0
    buffer_load_dwordx2 v[158:159], v16, s[4:7], s16 offen offset:128
    buffer_load_dwordx2 v[164:165], v17, s[8:11], s16 offen offset:128
    buffer_load_dwordx2 v[160:161], v16, s[4:7], s16 offen offset:256
    buffer_load_dwordx2 v[166:167], v17, s[8:11], s16 offen offset:256
    s_add_u32 s16, s16, 393216
    s_mov_b32 s12, s74
    s_mov_b32 s13, s75
    s_mov_b32 s14, 1610612736
    s_mov_b32 s15, 0x20000
    s_mov_b32 s22, 0x05040100
    s_mov_b32 s23, 0x07060302
    s_lshl_b32 s80, s76, 2
    v_add_u32 v21, s80, v21
    v_mul_u32_u24 v5, 768, v21
    v_lshl_add_u32 v5, v22, 4, v5
    v_lshlrev_b32 v19, 3, v21
    v_add_u32 v19, 126976, v19
    v_lshlrev_b32 v18, 4, v22
    v_add_u32 v18, 151552, v18
    v_add_u32 v11, s80, v3
    v_mov_b32 v10, 0
    v_mov_b32 v23, 0xff
    s_mul_i32 s17, s76, 3
    s_add_u32 s17, s17, 3
    s_mov_b32 s18, 0
    s_mov_b32 s19, 0
    s_mov_b32 s20, 0
    s_mov_b32 s21, 0
    s_waitcnt vmcnt(18)
    v_cndmask_b32 v24, v130, v128, vcc
    v_cndmask_b32 v25, v131, v129, vcc
    v_cndmask_b32 v26, v126, v130, vcc
    v_cndmask_b32 v27, v127, v131, vcc
    v_cndmask_b32 v28, v128, v126, vcc
    v_cndmask_b32 v29, v129, v127, vcc
    v_perm_b32 v72, v24, v120, s22
    v_perm_b32 v73, v24, v120, s23
    v_perm_b32 v74, v25, v121, s22
    v_perm_b32 v75, v25, v121, s23
    v_perm_b32 v76, v26, v122, s22
    v_perm_b32 v77, v26, v122, s23
    v_perm_b32 v78, v27, v123, s22
    v_perm_b32 v79, v27, v123, s23
    v_perm_b32 v80, v28, v124, s22
    v_perm_b32 v81, v28, v124, s23
    v_perm_b32 v82, v29, v125, s22
    v_perm_b32 v83, v29, v125, s23
    s_waitcnt vmcnt(12)
    v_cndmask_b32 v24, v142, v140, vcc
    v_cndmask_b32 v25, v143, v141, vcc
    v_cndmask_b32 v26, v138, v142, vcc
    v_cndmask_b32 v27, v139, v143, vcc
    v_cndmask_b32 v28, v140, v138, vcc
    v_cndmask_b32 v29, v141, v139, vcc
    v_perm_b32 v84, v24, v132, s22
    v_perm_b32 v85, v24, v132, s23
    v_perm_b32 v86, v25, v133, s22
    v_perm_b32 v87, v25, v133, s23
    v_perm_b32 v88, v26, v134, s22
    v_perm_b32 v89, v26, v134, s23
    v_perm_b32 v90, v27, v135, s22
    v_perm_b32 v91, v27, v135, s23
    v_perm_b32 v92, v28, v136, s22
    v_perm_b32 v93, v28, v136, s23
    v_perm_b32 v94, v29, v137, s22
    v_perm_b32 v95, v29, v137, s23
    s_waitcnt vmcnt(6)
    v_cndmask_b32 v24, v154, v152, vcc
    v_cndmask_b32 v25, v155, v153, vcc
    v_cndmask_b32 v26, v150, v154, vcc
    v_cndmask_b32 v27, v151, v155, vcc
    v_cndmask_b32 v28, v152, v150, vcc
    v_cndmask_b32 v29, v153, v151, vcc
    v_perm_b32 v96, v24, v144, s22
    v_perm_b32 v97, v24, v144, s23
    v_perm_b32 v98, v25, v145, s22
    v_perm_b32 v99, v25, v145, s23
    v_perm_b32 v100, v26, v146, s22
    v_perm_b32 v101, v26, v146, s23
    v_perm_b32 v102, v27, v147, s22
    v_perm_b32 v103, v27, v147, s23
    v_perm_b32 v104, v28, v148, s22
    v_perm_b32 v105, v28, v148, s23
    v_perm_b32 v106, v29, v149, s22
    v_perm_b32 v107, v29, v149, s23
    s_waitcnt vmcnt(0)
    v_cndmask_b32 v24, v166, v164, vcc
    v_cndmask_b32 v25, v167, v165, vcc
    v_cndmask_b32 v26, v162, v166, vcc
    v_cndmask_b32 v27, v163, v167, vcc
    v_cndmask_b32 v28, v164, v162, vcc
    v_cndmask_b32 v29, v165, v163, vcc
    v_perm_b32 v108, v24, v156, s22
    v_perm_b32 v109, v24, v156, s23
    v_perm_b32 v110, v25, v157, s22
    v_perm_b32 v111, v25, v157, s23
    v_perm_b32 v112, v26, v158, s22
    v_perm_b32 v113, v26, v158, s23
    v_perm_b32 v114, v27, v159, s22
    v_perm_b32 v115, v27, v159, s23
    v_perm_b32 v116, v28, v160, s22
    v_perm_b32 v117, v28, v160, s23
    v_perm_b32 v118, v29, v161, s22
    v_perm_b32 v119, v29, v161, s23
    s_nop 1
L_kvisit:
    s_cmp_ge_u32 s16, 6291456
    s_cselect_b32 s80, 6291456, 0
    s_sub_u32 s16, s16, s80
    s_and_b32 s26, s20, 1
    s_cmp_lt_u32 s21, 3
    s_cselect_b32 s26, s26, 9
    s_bitcmp1_b32 s21, 0
    s_cselect_b32 s82, 7, 0
    s_xor_b32 s82, s82, s20
    s_mul_i32 s80, s82, 768
    v_add_u32 v6, s80, v18
    s_lshl_b32 s80, s82, 4
    s_add_u32 s80, s80, s24
    s_lshl_b32 s81, s80, 7
    v_add_u32 v8, s81, v19
    s_nop 1
L_qw:
    ds_read_b32 v4, v3 offset:32
    ds_read_b128 v[48:51], v6 offset:0
    ds_read_b128 v[52:55], v6 offset:256
    ds_read_b128 v[56:59], v6 offset:512
    s_waitcnt lgkmcnt(0)
    v_readfirstlane_b32 s80, v4
    s_nop 0
    s_cmp_gt_u32 s80, s82
    s_nop 2
    s_cbranch_scc1 L_qwg
    s_sleep 2
    s_branch L_qw
L_qwg:
    s_cmp_eq_u32 s26, 0
    s_cbranch_scc0 L_nc0
    buffer_load_dwordx2 v[60:61], v16, s[4:7], s16 offen offset:0
L_nc0:
    s_cmp_eq_u32 s26, 1
    s_cbranch_scc0 L_nd0
    buffer_load_dwordx2 v[64:65], v16, s[4:7], s16 offen offset:256
L_nd0:
    v_dot2_f32_bf16 v24, v72, v48, 0
    v_dot2_f32_bf16 v25, v73, v49, 0
    v_dot2_f32_bf16 v26, v74, v50, 0
    v_dot2_f32_bf16 v27, v75, v51, 0
    v_dot2_f32_bf16 v28, v76, v52, 0
    v_dot2_f32_bf16 v29, v77, v53, 0
    v_dot2_f32_bf16 v30, v78, v54, 0
    v_dot2_f32_bf16 v31, v79, v55, 0
    v_dot2_f32_bf16 v32, v80, v56, 0
    v_dot2_f32_bf16 v33, v81, v57, 0
    v_dot2_f32_bf16 v34, v82, v58, 0
    v_dot2_f32_bf16 v35, v83, v59, 0
    v_add_u32 v6, s19, v5
    v_pk_add_f32 v[14:15], v[24:25], v[26:27]
    v_pk_add_f32 v[14:15], v[14:15], v[28:29]
    v_pk_add_f32 v[14:15], v[14:15], v[30:31]
    v_pk_add_f32 v[14:15], v[14:15], v[32:33]
    v_pk_add_f32 v[14:15], v[14:15], v[34:35]
    s_cmp_ge_i32 s18, s17
    s_nop 0
    s_cbranch_scc1 L_kw0g
L_kw0:
    ds_read_b32 v4, v3 offset:16
    s_waitcnt lgkmcnt(0)
    v_readfirstlane_b32 s18, v4
    s_nop 0
    s_cmp_ge_i32 s18, s17
    s_nop 2
    s_cbranch_scc1 L_kw0g
    s_sleep 1
    s_branch L_kw0
L_kw0g:
    ds_read_b128 v[36:39], v6 offset:0
    ds_read_b128 v[40:43], v6 offset:256
    ds_read_b128 v[44:47], v6 offset:512
    v_add_u32 v10, 1, v10
    s_add_u32 s19, s19, 12288
    s_cmp_eq_u32 s19, 110592
    s_cselect_b32 s19, 0, s19
    s_add_u32 s17, s17, 12
    s_waitcnt lgkmcnt(2)
    v_cvt_f32_i32 v36, v36
    v_cvt_f32_i32 v37, v37
    v_cvt_f32_i32 v38, v38
    v_cvt_f32_i32 v39, v39
    v_pk_mul_f32 v[12:13], v[36:37], v[24:25]
    v_pk_fma_f32 v[12:13], v[38:39], v[26:27], v[12:13]
    s_waitcnt lgkmcnt(1)
    v_cvt_f32_i32 v40, v40
    v_cvt_f32_i32 v41, v41
    v_cvt_f32_i32 v42, v42
    v_cvt_f32_i32 v43, v43
    v_pk_fma_f32 v[12:13], v[40:41], v[28:29], v[12:13]
    v_pk_fma_f32 v[12:13], v[42:43], v[30:31], v[12:13]
    s_waitcnt lgkmcnt(0)
    v_cvt_f32_i32 v44, v44
    v_cvt_f32_i32 v45, v45
    v_cvt_f32_i32 v46, v46
    v_cvt_f32_i32 v47, v47
    v_pk_fma_f32 v[12:13], v[44:45], v[32:33], v[12:13]
    v_pk_fma_f32 v[12:13], v[46:47], v[34:35], v[12:13]
    v_add_f32 v12, v12, v13
    v_add_f32 v13, v14, v15
    s_nop 0
    v_add_f32_dpp v12, v12, v12 quad_perm:[1,0,3,2] row_mask:0xf bank_mask:0xf
    v_add_f32_dpp v13, v13, v13 quad_perm:[1,0,3,2] row_mask:0xf bank_mask:0xf
    s_nop 0
    v_add_f32_dpp v12, v12, v12 quad_perm:[2,3,0,1] row_mask:0xf bank_mask:0xf
    v_add_f32_dpp v13, v13, v13 quad_perm:[2,3,0,1] row_mask:0xf bank_mask:0xf
    s_nop 0
    v_add_f32_dpp v12, v12, v12 row_half_mirror row_mask:0xf bank_mask:0xf
    v_add_f32_dpp v13, v13, v13 row_half_mirror row_mask:0xf bank_mask:0xf
    s_nop 0
    v_add_f32_dpp v12, v12, v12 row_mirror row_mask:0xf bank_mask:0xf
    v_add_f32_dpp v13, v13, v13 row_mirror row_mask:0xf bank_mask:0xf
    ds_write_b64 v8, v[12:13] offset:0
    ds_write_b32 v11, v10
    s_cmp_eq_u32 s26, 0
    s_cbranch_scc0 L_nc1
    buffer_load_dwordx2 v[66:67], v17, s[8:11], s16 offen offset:0
L_nc1:
    s_cmp_eq_u32 s26, 1
    s_cbranch_scc0 L_nd1
    buffer_load_dwordx2 v[70:71], v17, s[8:11], s16 offen offset:256
    s_add_u32 s16, s16, 393216
L_nd1:
    v_dot2_f32_bf16 v24, v84, v48, 0
    v_dot2_f32_bf16 v25, v85, v49, 0
    v_dot2_f32_bf16 v26, v86, v50, 0
    v_dot2_f32_bf16 v27, v87, v51, 0
    v_dot2_f32_bf16 v28, v88, v52, 0
    v_dot2_f32_bf16 v29, v89, v53, 0
    v_dot2_f32_bf16 v30, v90, v54, 0
    v_dot2_f32_bf16 v31, v91, v55, 0
    v_dot2_f32_bf16 v32, v92, v56, 0
    v_dot2_f32_bf16 v33, v93, v57, 0
    v_dot2_f32_bf16 v34, v94, v58, 0
    v_dot2_f32_bf16 v35, v95, v59, 0
    v_add_u32 v6, s19, v5
    v_pk_add_f32 v[14:15], v[24:25], v[26:27]
    v_pk_add_f32 v[14:15], v[14:15], v[28:29]
    v_pk_add_f32 v[14:15], v[14:15], v[30:31]
    v_pk_add_f32 v[14:15], v[14:15], v[32:33]
    v_pk_add_f32 v[14:15], v[14:15], v[34:35]
    s_cmp_ge_i32 s18, s17
    s_nop 0
    s_cbranch_scc1 L_kw1g
L_kw1:
    ds_read_b32 v4, v3 offset:16
    s_waitcnt lgkmcnt(0)
    v_readfirstlane_b32 s18, v4
    s_nop 0
    s_cmp_ge_i32 s18, s17
    s_nop 2
    s_cbranch_scc1 L_kw1g
    s_sleep 1
    s_branch L_kw1
L_kw1g:
    ds_read_b128 v[36:39], v6 offset:0
    ds_read_b128 v[40:43], v6 offset:256
    ds_read_b128 v[44:47], v6 offset:512
    v_add_u32 v10, 1, v10
    s_add_u32 s19, s19, 12288
    s_cmp_eq_u32 s19, 110592
    s_cselect_b32 s19, 0, s19
    s_add_u32 s17, s17, 12
    s_waitcnt lgkmcnt(2)
    v_cvt_f32_i32 v36, v36
    v_cvt_f32_i32 v37, v37
    v_cvt_f32_i32 v38, v38
    v_cvt_f32_i32 v39, v39
    v_pk_mul_f32 v[12:13], v[36:37], v[24:25]
    v_pk_fma_f32 v[12:13], v[38:39], v[26:27], v[12:13]
    s_waitcnt lgkmcnt(1)
    v_cvt_f32_i32 v40, v40
    v_cvt_f32_i32 v41, v41
    v_cvt_f32_i32 v42, v42
    v_cvt_f32_i32 v43, v43
    v_pk_fma_f32 v[12:13], v[40:41], v[28:29], v[12:13]
    v_pk_fma_f32 v[12:13], v[42:43], v[30:31], v[12:13]
    s_waitcnt lgkmcnt(0)
    v_cvt_f32_i32 v44, v44
    v_cvt_f32_i32 v45, v45
    v_cvt_f32_i32 v46, v46
    v_cvt_f32_i32 v47, v47
    v_pk_fma_f32 v[12:13], v[44:45], v[32:33], v[12:13]
    v_pk_fma_f32 v[12:13], v[46:47], v[34:35], v[12:13]
    v_add_f32 v12, v12, v13
    v_add_f32 v13, v14, v15
    s_nop 0
    v_add_f32_dpp v12, v12, v12 quad_perm:[1,0,3,2] row_mask:0xf bank_mask:0xf
    v_add_f32_dpp v13, v13, v13 quad_perm:[1,0,3,2] row_mask:0xf bank_mask:0xf
    s_nop 0
    v_add_f32_dpp v12, v12, v12 quad_perm:[2,3,0,1] row_mask:0xf bank_mask:0xf
    v_add_f32_dpp v13, v13, v13 quad_perm:[2,3,0,1] row_mask:0xf bank_mask:0xf
    s_nop 0
    v_add_f32_dpp v12, v12, v12 row_half_mirror row_mask:0xf bank_mask:0xf
    v_add_f32_dpp v13, v13, v13 row_half_mirror row_mask:0xf bank_mask:0xf
    s_nop 0
    v_add_f32_dpp v12, v12, v12 row_mirror row_mask:0xf bank_mask:0xf
    v_add_f32_dpp v13, v13, v13 row_mirror row_mask:0xf bank_mask:0xf
    ds_write_b64 v8, v[12:13] offset:128
    ds_write_b32 v11, v10
    s_cmp_eq_u32 s26, 0
    s_cbranch_scc0 L_nc2
    buffer_load_dwordx2 v[62:63], v16, s[4:7], s16 offen offset:128
L_nc2:
    v_dot2_f32_bf16 v24, v96, v48, 0
    v_dot2_f32_bf16 v25, v97, v49, 0
    v_dot2_f32_bf16 v26, v98, v50, 0
    v_dot2_f32_bf16 v27, v99, v51, 0
    v_dot2_f32_bf16 v28, v100, v52, 0
    v_dot2_f32_bf16 v29, v101, v53, 0
    v_dot2_f32_bf16 v30, v102, v54, 0
    v_dot2_f32_bf16 v31, v103, v55, 0
    v_dot2_f32_bf16 v32, v104, v56, 0
    v_dot2_f32_bf16 v33, v105, v57, 0
    v_dot2_f32_bf16 v34, v106, v58, 0
    v_dot2_f32_bf16 v35, v107, v59, 0
    v_add_u32 v6, s19, v5
    v_pk_add_f32 v[14:15], v[24:25], v[26:27]
    v_pk_add_f32 v[14:15], v[14:15], v[28:29]
    v_pk_add_f32 v[14:15], v[14:15], v[30:31]
    v_pk_add_f32 v[14:15], v[14:15], v[32:33]
    v_pk_add_f32 v[14:15], v[14:15], v[34:35]
    s_cmp_ge_i32 s18, s17
    s_nop 0
    s_cbranch_scc1 L_kw2g
L_kw2:
    ds_read_b32 v4, v3 offset:16
    s_waitcnt lgkmcnt(0)
    v_readfirstlane_b32 s18, v4
    s_nop 0
    s_cmp_ge_i32 s18, s17
    s_nop 2
    s_cbranch_scc1 L_kw2g
    s_sleep 1
    s_branch L_kw2
L_kw2g:
    ds_read_b128 v[36:39], v6 offset:0
    ds_read_b128 v[40:43], v6 offset:256
    ds_read_b128 v[44:47], v6 offset:512
    v_add_u32 v10, 1, v10
    s_add_u32 s19, s19, 12288
    s_cmp_eq_u32 s19, 110592
    s_cselect_b32 s19, 0, s19
    s_add_u32 s17, s17, 12
    s_waitcnt lgkmcnt(2)
    v_cvt_f32_i32 v36, v36
    v_cvt_f32_i32 v37, v37
    v_cvt_f32_i32 v38, v38
    v_cvt_f32_i32 v39, v39
    v_pk_mul_f32 v[12:13], v[36:37], v[24:25]
    v_pk_fma_f32 v[12:13], v[38:39], v[26:27], v[12:13]
    s_waitcnt lgkmcnt(1)
    v_cvt_f32_i32 v40, v40
    v_cvt_f32_i32 v41, v41
    v_cvt_f32_i32 v42, v42
    v_cvt_f32_i32 v43, v43
    v_pk_fma_f32 v[12:13], v[40:41], v[28:29], v[12:13]
    v_pk_fma_f32 v[12:13], v[42:43], v[30:31], v[12:13]
    s_waitcnt lgkmcnt(0)
    v_cvt_f32_i32 v44, v44
    v_cvt_f32_i32 v45, v45
    v_cvt_f32_i32 v46, v46
    v_cvt_f32_i32 v47, v47
    v_pk_fma_f32 v[12:13], v[44:45], v[32:33], v[12:13]
    v_pk_fma_f32 v[12:13], v[46:47], v[34:35], v[12:13]
    v_add_f32 v12, v12, v13
    v_add_f32 v13, v14, v15
    s_nop 0
    v_add_f32_dpp v12, v12, v12 quad_perm:[1,0,3,2] row_mask:0xf bank_mask:0xf
    v_add_f32_dpp v13, v13, v13 quad_perm:[1,0,3,2] row_mask:0xf bank_mask:0xf
    s_nop 0
    v_add_f32_dpp v12, v12, v12 quad_perm:[2,3,0,1] row_mask:0xf bank_mask:0xf
    v_add_f32_dpp v13, v13, v13 quad_perm:[2,3,0,1] row_mask:0xf bank_mask:0xf
    s_nop 0
    v_add_f32_dpp v12, v12, v12 row_half_mirror row_mask:0xf bank_mask:0xf
    v_add_f32_dpp v13, v13, v13 row_half_mirror row_mask:0xf bank_mask:0xf
    s_nop 0
    v_add_f32_dpp v12, v12, v12 row_mirror row_mask:0xf bank_mask:0xf
    v_add_f32_dpp v13, v13, v13 row_mirror row_mask:0xf bank_mask:0xf
    ds_write_b64 v8, v[12:13] offset:256
    ds_write_b32 v11, v10
    s_cmp_eq_u32 s26, 0
    s_cbranch_scc0 L_nc3
    buffer_load_dwordx2 v[68:69], v17, s[8:11], s16 offen offset:128
L_nc3:
    v_dot2_f32_bf16 v24, v108, v48, 0
    v_dot2_f32_bf16 v25, v109, v49, 0
    v_dot2_f32_bf16 v26, v110, v50, 0
    v_dot2_f32_bf16 v27, v111, v51, 0
    v_dot2_f32_bf16 v28, v112, v52, 0
    v_dot2_f32_bf16 v29, v113, v53, 0
    v_dot2_f32_bf16 v30, v114, v54, 0
    v_dot2_f32_bf16 v31, v115, v55, 0
    v_dot2_f32_bf16 v32, v116, v56, 0
    v_dot2_f32_bf16 v33, v117, v57, 0
    v_dot2_f32_bf16 v34, v118, v58, 0
    v_dot2_f32_bf16 v35, v119, v59, 0
    v_add_u32 v6, s19, v5
    v_pk_add_f32 v[14:15], v[24:25], v[26:27]
    v_pk_add_f32 v[14:15], v[14:15], v[28:29]
    v_pk_add_f32 v[14:15], v[14:15], v[30:31]
    v_pk_add_f32 v[14:15], v[14:15], v[32:33]
    v_pk_add_f32 v[14:15], v[14:15], v[34:35]
    s_cmp_ge_i32 s18, s17
    s_nop 0
    s_cbranch_scc1 L_kw3g
L_kw3:
    ds_read_b32 v4, v3 offset:16
    s_waitcnt lgkmcnt(0)
    v_readfirstlane_b32 s18, v4
    s_nop 0
    s_cmp_ge_i32 s18, s17
    s_nop 2
    s_cbranch_scc1 L_kw3g
    s_sleep 1
    s_branch L_kw3
L_kw3g:
    ds_read_b128 v[36:39], v6 offset:0
    ds_read_b128 v[40:43], v6 offset:256
    ds_read_b128 v[44:47], v6 offset:512
    v_add_u32 v10, 1, v10
    s_add_u32 s19, s19, 12288
    s_cmp_eq_u32 s19, 110592
    s_cselect_b32 s19, 0, s19
    s_add_u32 s17, s17, 12
    s_waitcnt lgkmcnt(2)
    v_cvt_f32_i32 v36, v36
    v_cvt_f32_i32 v37, v37
    v_cvt_f32_i32 v38, v38
    v_cvt_f32_i32 v39, v39
    v_pk_mul_f32 v[12:13], v[36:37], v[24:25]
    v_pk_fma_f32 v[12:13], v[38:39], v[26:27], v[12:13]
    s_waitcnt lgkmcnt(1)
    v_cvt_f32_i32 v40, v40
    v_cvt_f32_i32 v41, v41
    v_cvt_f32_i32 v42, v42
    v_cvt_f32_i32 v43, v43
    v_pk_fma_f32 v[12:13], v[40:41], v[28:29], v[12:13]
    v_pk_fma_f32 v[12:13], v[42:43], v[30:31], v[12:13]
    s_waitcnt lgkmcnt(0)
    v_cvt_f32_i32 v44, v44
    v_cvt_f32_i32 v45, v45
    v_cvt_f32_i32 v46, v46
    v_cvt_f32_i32 v47, v47
    v_pk_fma_f32 v[12:13], v[44:45], v[32:33], v[12:13]
    v_pk_fma_f32 v[12:13], v[46:47], v[34:35], v[12:13]
    v_add_f32 v12, v12, v13
    v_add_f32 v13, v14, v15
    s_nop 0
    v_add_f32_dpp v12, v12, v12 quad_perm:[1,0,3,2] row_mask:0xf bank_mask:0xf
    v_add_f32_dpp v13, v13, v13 quad_perm:[1,0,3,2] row_mask:0xf bank_mask:0xf
    s_nop 0
    v_add_f32_dpp v12, v12, v12 quad_perm:[2,3,0,1] row_mask:0xf bank_mask:0xf
    v_add_f32_dpp v13, v13, v13 quad_perm:[2,3,0,1] row_mask:0xf bank_mask:0xf
    s_nop 0
    v_add_f32_dpp v12, v12, v12 row_half_mirror row_mask:0xf bank_mask:0xf
    v_add_f32_dpp v13, v13, v13 row_half_mirror row_mask:0xf bank_mask:0xf
    s_nop 0
    v_add_f32_dpp v12, v12, v12 row_mirror row_mask:0xf bank_mask:0xf
    v_add_f32_dpp v13, v13, v13 row_mirror row_mask:0xf bank_mask:0xf
    ds_write_b64 v8, v[12:13] offset:384
    ds_write_b32 v11, v10
    s_add_u32 s20, s20, 1
    s_and_b32 s80, s20, 1
    s_cbranch_scc1 L_kvisit
    v_mov_b64 v[120:121], v[132:133]
    v_mov_b64 v[122:123], v[134:135]
    v_mov_b64 v[124:125], v[136:137]
    v_mov_b64 v[126:127], v[138:139]
    v_mov_b64 v[128:129], v[140:141]
    v_mov_b64 v[130:131], v[142:143]
    v_mov_b64 v[132:133], v[144:145]
    v_mov_b64 v[134:135], v[146:147]
    v_mov_b64 v[136:137], v[148:149]
    v_mov_b64 v[138:139], v[150:151]
    v_mov_b64 v[140:141], v[152:153]
    v_mov_b64 v[142:143], v[154:155]
    v_mov_b64 v[144:145], v[156:157]
    v_mov_b64 v[146:147], v[158:159]
    v_mov_b64 v[148:149], v[160:161]
    v_mov_b64 v[150:151], v[162:163]
    v_mov_b64 v[152:153], v[164:165]
    v_mov_b64 v[154:155], v[166:167]
    s_waitcnt vmcnt(0)
    v_cndmask_b32 v24, v70, v68, vcc
    v_cndmask_b32 v25, v71, v69, vcc
    v_cndmask_b32 v26, v66, v70, vcc
    v_cndmask_b32 v27, v67, v71, vcc
    v_cndmask_b32 v28, v68, v66, vcc
    v_cndmask_b32 v29, v69, v67, vcc
    v_perm_b32 v156, v24, v60, s22
    v_perm_b32 v157, v24, v60, s23
    v_perm_b32 v158, v25, v61, s22
    v_perm_b32 v159, v25, v61, s23
    v_perm_b32 v160, v26, v62, s22
    v_perm_b32 v161, v26, v62, s23
    v_perm_b32 v162, v27, v63, s22
    v_perm_b32 v163, v27, v63, s23
    v_perm_b32 v164, v28, v64, s22
    v_perm_b32 v165, v28, v64, s23
    v_perm_b32 v166, v29, v65, s22
    v_perm_b32 v167, v29, v65, s23
    s_cmp_lt_u32 s20, 8
    s_nop 0
    s_cbranch_scc1 L_kvisit
    v_mov_b64 v[72:73], v[120:121]
    v_mov_b64 v[74:75], v[122:123]
    v_mov_b64 v[76:77], v[124:125]
    v_mov_b64 v[78:79], v[126:127]
    v_mov_b64 v[80:81], v[128:129]
    v_mov_b64 v[82:83], v[130:131]
    v_mov_b64 v[84:85], v[132:133]
    v_mov_b64 v[86:87], v[134:135]
    v_mov_b64 v[88:89], v[136:137]
    v_mov_b64 v[90:91], v[138:139]
    v_mov_b64 v[92:93], v[140:141]
    v_mov_b64 v[94:95], v[142:143]
    v_mov_b64 v[96:97], v[144:145]
    v_mov_b64 v[98:99], v[146:147]
    v_mov_b64 v[100:101], v[148:149]
    v_mov_b64 v[102:103], v[150:151]
    v_mov_b64 v[104:105], v[152:153]
    v_mov_b64 v[106:107], v[154:155]
    v_mov_b64 v[108:109], v[156:157]
    v_mov_b64 v[110:111], v[158:159]
    v_mov_b64 v[112:113], v[160:161]
    v_mov_b64 v[114:115], v[162:163]
    v_mov_b64 v[116:117], v[164:165]
    v_mov_b64 v[118:119], v[166:167]
    s_mov_b32 s20, 0
    s_add_u32 s24, s24, 4
    s_and_b32 s24, s24, 15
    s_add_u32 s21, s21, 1
    s_cmp_lt_u32 s21, 4
    s_cbranch_scc1 L_kvisit
    v_lshrrev_b32 v21, 2, v1
    v_and_b32 v22, 3, v1
    v_mul_u32_u24 v5, 768, v21
    v_lshl_add_u32 v5, v22, 4, v5
    s_mul_i32 s80, s76, 192
    v_add_u32 v5, s80, v5
    v_lshlrev_b32 v19, 3, v21
    v_add_u32 v19, 126976, v19
    v_lshrrev_b32 v21, 4, v1
    v_lshl_add_u32 v7, v21, 2, v22
    v_and_b32 v21, 1, v7
    v_lshlrev_b32 v7, 4, v7
    s_lshl_b32 s80, s76, 8
    v_add_u32 v7, s80, v7
    v_lshlrev_b32 v18, 3, v21
    v_add_u32 v18, 157696, v18
    v_add_u32 v16, 143360, v7
    s_mov_b32 s32, 0x000f000f
    s_mov_b32 s33, 0x000f000f
    s_mov_b32 s17, 1548
    s_mul_i32 s24, s77, 4
    s_and_b32 s24, s24, 15
    s_mov_b32 s20, 0
    s_add_u32 s25, s77, 0
    s_mul_i32 s25, s25, 64
    s_add_u32 s25, s25, s78
    s_lshl_b32 s25, s25, 10
L_vhead:
    v_mov_b64 v[24:25], 0
    v_mov_b64 v[26:27], 0
    v_mov_b64 v[28:29], 0
    v_mov_b64 v[30:31], 0
    v_mov_b64 v[32:33], 0
    v_mov_b64 v[34:35], 0
    s_mov_b32 s21, 0
    s_nop 0
L_pw:
    ds_read_b64 v[36:37], v3 offset:32
    ds_read_b32 v4, v3 offset:40
    ds_read_b64 v[14:15], v18
    s_waitcnt lgkmcnt(0)
    v_readfirstlane_b32 s80, v37
    v_readfirstlane_b32 s28, v4
    s_cmp_gt_u32 s80, s20
    s_nop 3
    s_cbranch_scc1 L_pwg
    s_sleep 2
    s_branch L_pw
L_pwg:
    s_lshr_b32 s29, s28, 8
    s_lshr_b32 s30, s28, 16
L_vstep:
    s_xor_b32 s80, s20, 7
    s_lshl_b32 s80, s80, 4
    s_add_u32 s80, s80, s24
    s_lshl_b32 s80, s80, 7
    v_add_u32 v8, s80, v19
    v_add_u32 v6, s19, v5
    ds_read_b32 v12, v8
    s_cmp_ge_i32 s18, s17
    s_cbranch_scc1 L_vwg
L_vw:
    ds_read_b32 v4, v3 offset:16
    s_waitcnt lgkmcnt(0)
    v_readfirstlane_b32 s18, v4
    s_nop 0
    s_cmp_ge_i32 s18, s17
    s_nop 2
    s_cbranch_scc1 L_vwg
    s_sleep 1
    s_branch L_vw
L_vwg:
    ds_read_b128 v[36:39], v6 offset:0
    ds_read_b128 v[40:43], v6 offset:64
    ds_read_b128 v[44:47], v6 offset:128
    v_add_u32 v10, 1, v10
    s_add_u32 s19, s19, 12288
    s_cmp_eq_u32 s19, 110592
    s_cselect_b32 s19, 0, s19
    s_add_u32 s17, s17, 12
    s_add_u32 s24, s24, 1
    s_and_b32 s24, s24, 15
    s_add_u32 s21, s21, 1
    s_cmp_lt_u32 s21, 16
    s_waitcnt lgkmcnt(2)
    v_cvt_f32_i32 v36, v36
    v_cvt_f32_i32 v37, v37
    v_cvt_f32_i32 v38, v38
    v_cvt_f32_i32 v39, v39
    v_pk_fma_f32 v[24:25], v[36:37], v[12:13], v[24:25] op_sel_hi:[1,0,1]
    v_pk_fma_f32 v[26:27], v[38:39], v[12:13], v[26:27] op_sel_hi:[1,0,1]
    s_waitcnt lgkmcnt(1)
    v_cvt_f32_i32 v40, v40
    v_cvt_f32_i32 v41, v41
    v_cvt_f32_i32 v42, v42
    v_cvt_f32_i32 v43, v43
    v_pk_fma_f32 v[28:29], v[40:41], v[12:13], v[28:29] op_sel_hi:[1,0,1]
    v_pk_fma_f32 v[30:31], v[42:43], v[12:13], v[30:31] op_sel_hi:[1,0,1]
    s_waitcnt lgkmcnt(0)
    v_cvt_f32_i32 v44, v44
    v_cvt_f32_i32 v45, v45
    v_cvt_f32_i32 v46, v46
    v_cvt_f32_i32 v47, v47
    v_pk_fma_f32 v[32:33], v[44:45], v[12:13], v[32:33] op_sel_hi:[1,0,1]
    v_pk_fma_f32 v[34:35], v[46:47], v[12:13], v[34:35] op_sel_hi:[1,0,1]
    s_nop 1
    s_cbranch_scc0 L_vend
    ds_write_b32 v11, v10
    s_branch L_vstep
L_vend:
    v_permlane32_swap_b32 v24, v26
    v_permlane32_swap_b32 v25, v27
    v_permlane32_swap_b32 v28, v30
    v_permlane32_swap_b32 v29, v31
    v_permlane32_swap_b32 v32, v34
    v_permlane32_swap_b32 v33, v35
    v_pk_add_f32 v[24:25], v[24:25], v[26:27]
    v_pk_add_f32 v[28:29], v[28:29], v[30:31]
    v_pk_add_f32 v[32:33], v[32:33], v[34:35]
    v_permlane16_swap_b32 v24, v25
    v_permlane16_swap_b32 v28, v29
    v_permlane16_swap_b32 v32, v33
    v_add_f32 v36, v24, v25
    v_add_f32 v37, v28, v29
    v_add_f32 v38, v32, v33
    v_mov_b32 v39, v14
    v_add_f32_dpp v36, v36, v36 row_ror:4 row_mask:0xf bank_mask:0xf
    v_add_f32_dpp v37, v37, v37 row_ror:4 row_mask:0xf bank_mask:0xf
    v_add_f32_dpp v38, v38, v38 row_ror:4 row_mask:0xf bank_mask:0xf
    v_add_f32_dpp v36, v36, v36 row_ror:8 row_mask:0xf bank_mask:0xf
    v_add_f32_dpp v37, v37, v37 row_ror:8 row_mask:0xf bank_mask:0xf
    v_add_f32_dpp v38, v38, v38 row_ror:8 row_mask:0xf bank_mask:0xf
    v_sub_f32 v36, v36, v15
    v_sub_f32 v37, v37, v15
    v_sub_f32 v38, v38, v15
    v_bfi_b32 v36, v23, s28, v36
    v_bfi_b32 v37, v23, s29, v37
    v_bfi_b32 v38, v23, s30, v38
    s_add_u32 s20, s20, 1
    s_cmp_eq_u32 s20, 8
    s_mov_b64 exec, s[32:33]
    s_cbranch_scc1 L_vlast
    ds_write_b128 v16, v[36:39]
    s_mov_b64 exec, -1
    ds_write_b32 v11, v10
    v_add_u32 v16, 1024, v16
    v_add_u32 v18, 16, v18
    s_nop 1
    s_branch L_vhead
L_vlast:
    buffer_store_dwordx4 v[36:39], v7, s[12:15], s25 offen sc0 sc1
    s_endpgm
    s_nop 0
L_aux:
    s_cmp_eq_u32 s76, 5
    s_cbranch_scc0 L_pacer
    v_lshlrev_b32 v5, 3, v1
    v_cmp_gt_u32 vcc, 24, v1
    v_mov_b32 v13, 0xffffff40
    v_mov_b32 v10, 192
    v_cndmask_b32 v13, v13, v10, vcc
    v_add_u32 v6, v5, v13
    v_mov_b32 v10, 0x80008000
    v_cndmask_b32 v7, 0, v10, vcc
    v_lshrrev_b32 v10, 1, v1
    v_and_b32 v11, 15, v10
    v_lshrrev_b32 v10, 4, v10
    v_mul_u32_u24 v10, 131072, v10
    v_mul_u32_u24 v11, 2048, v11
    v_add_u32 v10, v10, v11
    v_and_b32 v11, 1, v1
    v_lshl_add_u32 v17, v11, 4, v10
    v_add_u32 v10, 0, v1
    v_mul_u32_u24 v12, 2731, v10
    v_lshrrev_b32 v12, 16, v12
    v_mul_u32_u24 v12, 1152, v12
    v_lshl_add_u32 v56, v10, 4, v12
    v_add_u32 v10, 64, v1
    v_mul_u32_u24 v12, 2731, v10
    v_lshrrev_b32 v12, 16, v12
    v_mul_u32_u24 v12, 1152, v12
    v_lshl_add_u32 v57, v10, 4, v12
    v_add_u32 v10, 128, v1
    v_mul_u32_u24 v12, 2731, v10
    v_lshrrev_b32 v12, 16, v12
    v_mul_u32_u24 v12, 1152, v12
    v_lshl_add_u32 v58, v10, 4, v12
    v_cmp_eq_u32 s[32:33], 0, v11
    s_lshl_b32 s27, s77, 15
    s_lshl_b32 s80, s78, 5
    s_add_u32 s27, s27, s80
    s_mov_b32 m0, 143360
    s_waitcnt lgkmcnt(0)
    s_mov_b32 s4, s62
    s_mov_b32 s5, s63
    s_mov_b32 s6, 384
    s_mov_b32 s7, 0x20000
    s_mov_b32 s20, s64
    s_mov_b32 s21, s65
    s_mov_b32 s22, 384
    s_mov_b32 s23, 0x20000
    buffer_load_dwordx2 v[28:29], v5, s[4:7], 0 offen
    buffer_load_dwordx2 v[30:31], v5, s[20:23], 0 offen
    s_mov_b32 s4, s48
    s_mov_b32 s5, s49
    s_mov_b32 s6, 12288
    s_mov_b32 s7, 0x20000
    s_mul_i32 s80, s77, 384
    buffer_load_dwordx4 v56, s[4:7], s80 offen lds
    s_add_u32 m0, m0, 1024
    s_nop 0
    buffer_load_dwordx4 v57, s[4:7], s80 offen lds
    s_add_u32 m0, m0, 1024
    s_nop 0
    buffer_load_dwordx4 v58, s[4:7], s80 offen lds
    s_add_u32 m0, m0, 1024
    s_and_b32 s80, s78, 3
    s_lshl_b32 s80, s80, 3
    v_lshrrev_b32 v10, 3, v1
    v_add_u32 v10, s80, v10
    v_and_b32 v11, 15, v10
    v_lshrrev_b32 v10, 4, v10
    v_mul_u32_u24 v10, 131072, v10
    v_mul_u32_u24 v11, 2048, v11
    v_add_u32 v10, v10, v11
    v_and_b32 v11, 7, v1
    v_lshl_add_u32 v62, v11, 4, v10
    s_mov_b32 s20, s52
    s_mov_b32 s21, s53
    s_mov_b32 s22, 1048576
    s_mov_b32 s23, 0x20000
    s_andn2_b32 s80, s27, 127
    buffer_load_dwordx4 v[64:67], v62, s[20:23], s80 offen
    s_add_u32 s80, s80, 262144
    buffer_load_dwordx4 v[64:67], v62, s[20:23], s80 offen
    s_add_u32 s80, s80, 262144
    buffer_load_dwordx4 v[64:67], v62, s[20:23], s80 offen
    s_add_u32 s80, s80, 262144
    buffer_load_dwordx4 v[64:67], v62, s[20:23], s80 offen
    s_add_u32 s80, s80, 262144
    s_mov_b32 s20, s54
    s_mov_b32 s21, s55
    s_mov_b32 s22, 1048576
    s_mov_b32 s23, 0x20000
    s_andn2_b32 s80, s27, 127
    buffer_load_dwordx4 v[64:67], v62, s[20:23], s80 offen
    s_add_u32 s80, s80, 262144
    buffer_load_dwordx4 v[64:67], v62, s[20:23], s80 offen
    s_add_u32 s80, s80, 262144
    buffer_load_dwordx4 v[64:67], v62, s[20:23], s80 offen
    s_add_u32 s80, s80, 262144
    buffer_load_dwordx4 v[64:67], v62, s[20:23], s80 offen
    s_add_u32 s80, s80, 262144
    s_mov_b32 s20, s58
    s_mov_b32 s21, s59
    s_mov_b32 s22, 1048576
    s_mov_b32 s23, 0x20000
    s_andn2_b32 s80, s27, 127
    buffer_load_dwordx4 v[64:67], v62, s[20:23], s80 offen
    s_add_u32 s80, s80, 262144
    buffer_load_dwordx4 v[64:67], v62, s[20:23], s80 offen
    s_add_u32 s80, s80, 262144
    buffer_load_dwordx4 v[64:67], v62, s[20:23], s80 offen
    s_add_u32 s80, s80, 262144
    buffer_load_dwordx4 v[64:67], v62, s[20:23], s80 offen
    s_add_u32 s80, s80, 262144
    s_mov_b32 s20, s60
    s_mov_b32 s21, s61
    s_mov_b32 s22, 1048576
    s_mov_b32 s23, 0x20000
    s_andn2_b32 s80, s27, 127
    buffer_load_dwordx4 v[64:67], v62, s[20:23], s80 offen
    s_add_u32 s80, s80, 262144
    buffer_load_dwordx4 v[64:67], v62, s[20:23], s80 offen
    s_add_u32 s80, s80, 262144
    buffer_load_dwordx4 v[64:67], v62, s[20:23], s80 offen
    s_add_u32 s80, s80, 262144
    buffer_load_dwordx4 v[64:67], v62, s[20:23], s80 offen
    s_add_u32 s80, s80, 262144
    s_mov_b32 s12, s74
    s_mov_b32 s13, s75
    s_mov_b32 s14, 1610612736
    s_mov_b32 s15, 0x20000
    s_mov_b32 s8, s72
    s_mov_b32 s9, s73
    s_mov_b32 s10, 256
    s_mov_b32 s11, 0x20000
    s_mov_b32 s16, s70
    s_mov_b32 s17, s71
    s_mov_b32 s18, 12288
    s_mov_b32 s19, 0x20000
    v_mov_b32 v14, 0xff
    v_add_u32 v15, 143360, v5
    v_add_u32 v16, 143360, v6
    v_lshlrev_b32 v8, 1, v5
    v_lshlrev_b32 v9, 1, v6
    v_add_u32 v8, 151552, v8
    v_add_u32 v9, 151552, v9
    v_mov_b32 v12, 0
    s_mov_b32 s24, 0
    s_waitcnt vmcnt(19)
    v_xor_b32 v30, v30, v7
    v_xor_b32 v31, v31, v7
    v_lshlrev_b32 v32, 16, v28
    v_and_b32 v33, 0xffff0000, v28
    v_lshlrev_b32 v34, 16, v29
    v_and_b32 v35, 0xffff0000, v29
    v_lshlrev_b32 v36, 16, v30
    v_and_b32 v37, 0xffff0000, v30
    v_lshlrev_b32 v38, 16, v31
    v_and_b32 v39, 0xffff0000, v31
    v_and_b32 v7, 0x80000000, v7
    s_waitcnt vmcnt(16)
    s_mov_b32 exec_hi, 0xffff
L_hq:
    ds_read_b64 v[20:21], v15
    ds_read_b64 v[22:23], v16
    v_add_u32 v15, 384, v15
    v_add_u32 v16, 384, v16
    v_add_u32 v12, 1, v12
    s_waitcnt lgkmcnt(0)
    v_lshlrev_b32 v40, 16, v20
    v_and_b32 v41, 0xffff0000, v20
    v_lshlrev_b32 v42, 16, v21
    v_and_b32 v43, 0xffff0000, v21
    v_lshlrev_b32 v44, 16, v22
    v_and_b32 v45, 0xffff0000, v22
    v_lshlrev_b32 v46, 16, v23
    v_and_b32 v47, 0xffff0000, v23
    v_pk_mul_f32 v[40:41], v[40:41], v[32:33]
    v_pk_mul_f32 v[44:45], v[44:45], v[36:37]
    v_pk_mul_f32 v[42:43], v[42:43], v[34:35]
    v_pk_mul_f32 v[46:47], v[46:47], v[38:39]
    v_cvt_pk_bf16_f32 v40, v40, v44
    v_cvt_pk_bf16_f32 v41, v41, v45
    v_cvt_pk_bf16_f32 v42, v42, v46
    v_cvt_pk_bf16_f32 v43, v43, v47
    v_and_b32 v44, 0xffff0000, v40
    v_lshlrev_b32 v40, 16, v40
    v_and_b32 v45, 0xffff0000, v41
    v_lshlrev_b32 v41, 16, v41
    v_and_b32 v46, 0xffff0000, v42
    v_lshlrev_b32 v42, 16, v42
    v_and_b32 v47, 0xffff0000, v43
    v_lshlrev_b32 v43, 16, v43
    v_pk_add_f32 v[40:41], v[40:41], v[44:45]
    v_pk_add_f32 v[42:43], v[42:43], v[46:47]
    v_cvt_pk_bf16_f32 v48, v40, v40
    v_cvt_pk_bf16_f32 v49, v41, v41
    v_cvt_pk_bf16_f32 v50, v42, v42
    v_cvt_pk_bf16_f32 v51, v43, v43
    v_xor_b32 v48, v48, v7
    v_xor_b32 v49, v49, v7
    v_xor_b32 v50, v50, v7
    v_xor_b32 v51, v51, v7
    ds_write_b16 v8, v48 offset:0
    ds_write_b16_d16_hi v9, v48 offset:2
    ds_write_b16 v8, v49 offset:4
    ds_write_b16_d16_hi v9, v49 offset:6
    ds_write_b16 v8, v50 offset:8
    ds_write_b16_d16_hi v9, v50 offset:10
    ds_write_b16 v8, v51 offset:12
    ds_write_b16_d16_hi v9, v51 offset:14
    ds_write_b32 v3, v12 offset:32
    v_add_u32 v8, 768, v8
    v_add_u32 v9, 768, v9
    s_add_u32 s24, s24, 1
    s_cmp_lt_u32 s24, 8
    s_cbranch_scc1 L_hq
    s_mov_b32 exec_hi, -1
    s_add_u32 s80, s77, 0
    s_mul_i32 s80, s80, 64
    s_add_u32 s80, s80, s78
    s_lshl_b32 s80, s80, 10
    buffer_load_dwordx4 v[64:67], v2, s[12:15], s80 offen
    s_add_u32 s80, s80, 262144
    v_mov_b32 v15, 0
    s_mov_b32 s25, 0
    s_cmp_eq_u32 s2, 0
    s_cbranch_scc1 L_epc
L_epw:
    s_sleep 16
    ds_read_b32 v4, v3 offset:20
    s_waitcnt lgkmcnt(0)
    v_readfirstlane_b32 s80, v4
    s_nop 0
    s_cmp_lt_i32 s80, 16
    s_nop 2
    s_cbranch_scc1 L_epw
    s_load_dword s28, s[72:73], 0
    s_waitcnt lgkmcnt(0)
    s_cmp_lg_u32 s28, 0
    s_cbranch_scc1 L_epd
L_ep:
    s_mov_b64 exec, 1
    buffer_load_dword v11, v15, s[8:11], 0 offen sc0 sc1
    s_waitcnt vmcnt(0)
    v_readfirstlane_b32 s28, v11
    s_mov_b64 exec, -1
    s_cmp_lg_u32 s28, 0
    s_nop 2
    s_cbranch_scc1 L_epd
    s_sleep 32
    s_add_u32 s25, s25, 1
    s_cmp_lt_u32 s25, 8
    s_cbranch_scc1 L_ep
L_epc:
    s_mul_i32 s28, s84, 0x9e3779b1
    s_lshr_b32 s81, s28, 15
    s_xor_b32 s28, s28, s81
    s_mul_i32 s28, s28, 0x85ebca6b
    s_lshr_b32 s81, s28, 13
    s_xor_b32 s28, s28, s81
    s_max_u32 s28, s28, 1
    v_mov_b32 v20, s28
    v_mov_b32 v21, 0
    s_mov_b64 exec, 1
    buffer_atomic_cmpswap v[20:21], v15, s[8:11], 0 offen sc0 sc1
    s_waitcnt vmcnt(0)
    v_readfirstlane_b32 s80, v20
    s_mov_b64 exec, -1
    s_cmp_eq_u32 s80, 0
    s_cselect_b32 s28, s28, s80
    s_nop 1
L_epd:
    v_mov_b32 v12, s28
    ds_write_b32 v3, v12 offset:40
    s_lshr_b32 s29, s28, 8
    s_lshr_b32 s30, s28, 16
    s_lshr_b32 s31, s28, 24
    s_add_u32 s24, s77, 16
    s_mov_b32 s25, 0
    s_mov_b32 s20, s52
    s_mov_b32 s21, s53
    s_mov_b32 s22, 1048576
    s_mov_b32 s23, 0x20000
L_sc:
    s_sleep 16
    ds_read_b32 v4, v3 offset:20
    s_waitcnt lgkmcnt(0)
    v_readfirstlane_b32 s80, v4
    s_nop 0
    s_cmp_lt_i32 s80, s24
    s_nop 2
    s_cbranch_scc1 L_sc
    s_lshr_b32 s80, s78, 2
    s_add_u32 s80, s80, s25
    s_and_b32 s80, s80, 15
    s_lshl_b32 s81, s80, 10
    s_add_u32 m0, s81, 110592
    s_mov_b64 s[20:21], s[52:53]
    s_cmp_ge_u32 s80, 4
    s_cselect_b64 s[20:21], s[54:55], s[20:21]
    s_cmp_ge_u32 s80, 8
    s_cselect_b64 s[20:21], s[58:59], s[20:21]
    s_cmp_ge_u32 s80, 12
    s_cselect_b64 s[20:21], s[60:61], s[20:21]
    s_and_b32 s80, s80, 3
    s_mul_i32 s80, s80, 262144
    s_add_u32 s80, s80, s27
    buffer_load_dwordx4 v17, s[20:23], s80 offen  lds
    s_add_u32 s25, s25, 1
    s_add_u32 s24, s24, 4
    s_cmp_lt_u32 s25, 16
    s_cbranch_scc1 L_sc
    s_waitcnt vmcnt(0)
    v_mov_b32 v28, 0
    v_mov_b32 v29, 0
    v_mov_b32 v30, 0
    v_mov_b32 v31, 0
    v_mov_b32 v32, 0
    v_mov_b32 v33, 0
    v_mov_b32 v34, 0
    v_mov_b32 v35, 0
    v_mov_b32 v36, 0
    v_mov_b32 v37, 0
    v_mov_b32 v38, 0
    v_mov_b32 v39, 0
    v_mov_b32 v40, 0
    v_mov_b32 v41, 0
    v_mov_b32 v42, 0
    v_mov_b32 v43, 0
    v_mov_b32 v44, 0
    v_mov_b32 v45, 0
    v_mov_b32 v46, 0
    v_mov_b32 v47, 0
    v_mov_b32 v48, 0
    v_mov_b32 v49, 0
    v_mov_b32 v50, 0
    v_mov_b32 v51, 0
    v_mov_b32 v64, 0
    v_mov_b32 v65, 0
    v_mov_b32 v66, 0
    v_mov_b32 v67, 0
    v_mov_b32 v68, 0
    v_mov_b32 v69, 0
    v_mov_b32 v70, 0
    v_mov_b32 v71, 0
    v_lshlrev_b32 v15, 3, v1
    v_add_u32 v15, 141312, v15
    v_lshlrev_b32 v16, 1, v1
    v_add_u32 v16, 114176, v16
    v_mov_b32 v8, 157696
    v_mov_b32 v9, 0
    s_mov_b32 s24, 100
    s_nop 0
L_hp:
    s_sleep 8
    ds_read_b128 v[56:59], v3
    s_waitcnt lgkmcnt(0)
    v_min3_i32 v56, v56, v57, v58
    v_min_i32 v56, v56, v59
    s_nop 0
    v_readfirstlane_b32 s80, v56
    s_nop 0
    s_cmp_lt_i32 s80, s24
    s_nop 2
    s_cbranch_scc1 L_hp
    ds_read_b64 v[72:73], v15 offset:0
    ds_read_u16_d16_hi v28, v16 offset:0
    ds_read_u16_d16_hi v64, v16 offset:4096
    ds_read_b64 v[74:75], v15 offset:512
    ds_read_u16_d16_hi v29, v16 offset:128
    ds_read_u16_d16_hi v65, v16 offset:4224
    ds_read_b64 v[76:77], v15 offset:1024
    ds_read_u16_d16_hi v30, v16 offset:256
    ds_read_u16_d16_hi v66, v16 offset:4352
    ds_read_b64 v[78:79], v15 offset:1536
    ds_read_u16_d16_hi v31, v16 offset:384
    ds_read_u16_d16_hi v67, v16 offset:4480
    s_waitcnt lgkmcnt(0)
    ds_read_u16_d16_hi v36, v16 offset:8192
    ds_read_u16_d16_hi v44, v16 offset:12288
    ds_read_u16_d16_hi v37, v16 offset:8320
    ds_read_u16_d16_hi v45, v16 offset:12416
    ds_read_u16_d16_hi v38, v16 offset:8448
    ds_read_u16_d16_hi v46, v16 offset:12544
    ds_read_u16_d16_hi v39, v16 offset:8576
    ds_read_u16_d16_hi v47, v16 offset:12672
    v_fma_f32 v20, -v64, v73, v72
    v_fma_f32 v21, -v65, v75, v74
    v_fma_f32 v22, -v66, v77, v76
    v_fma_f32 v23, -v67, v79, v78
    v_mul_f32 v20, v20, v28
    v_mul_f32 v21, v21, v29
    v_mul_f32 v22, v22, v30
    v_mul_f32 v23, v23, v31
    v_mul_f32 v20, 0x3dd53b95, v20
    v_mul_f32 v21, 0x3dd53b95, v21
    v_mul_f32 v22, 0x3dd53b95, v22
    v_mul_f32 v23, 0x3dd53b95, v23
    v_mov_b32 v52, v20
    v_max_f32 v52, v52, v21
    v_max_f32 v52, v52, v22
    v_max_f32 v52, v52, v23
    s_nop 1
    v_max_f32_dpp v52, v52, v52 quad_perm:[1,0,3,2] row_mask:0xf bank_mask:0xf
    s_nop 1
    v_max_f32_dpp v52, v52, v52 quad_perm:[2,3,0,1] row_mask:0xf bank_mask:0xf
    s_nop 1
    v_max_f32_dpp v52, v52, v52 row_half_mirror row_mask:0xf bank_mask:0xf
    s_nop 1
    v_max_f32_dpp v52, v52, v52 row_mirror row_mask:0xf bank_mask:0xf
    v_mov_b32 v13, v52
    s_nop 1
    v_permlane32_swap_b32 v52, v13
    v_max_f32 v52, v52, v13
    v_mov_b32 v13, v52
    s_nop 1
    v_permlane16_swap_b32 v52, v13
    v_max_f32 v52, v52, v13
    v_sub_f32 v20, v20, v52
    v_sub_f32 v21, v21, v52
    v_sub_f32 v22, v22, v52
    v_sub_f32 v23, v23, v52
    v_exp_f32 v20, v20
    v_exp_f32 v21, v21
    v_exp_f32 v22, v22
    v_exp_f32 v23, v23
    v_mov_b32 v54, v20
    v_add_f32 v54, v54, v21
    v_add_f32 v54, v54, v22
    v_add_f32 v54, v54, v23
    s_waitcnt lgkmcnt(0)
    v_mul_f32 v20, v20, v36
    v_mul_f32 v21, v21, v37
    v_mul_f32 v22, v22, v38
    v_mul_f32 v23, v23, v39
    v_mul_f32 v53, v20, v44
    v_fmac_f32 v53, v21, v45
    v_fmac_f32 v53, v22, v46
    v_fmac_f32 v53, v23, v47
    ds_write_b32 v15, v20 offset:0
    ds_write_b32 v15, v21 offset:512
    ds_write_b32 v15, v22 offset:1024
    ds_write_b32 v15, v23 offset:1536
    v_add_f32_dpp v54, v54, v54 quad_perm:[1,0,3,2] row_mask:0xf bank_mask:0xf
    s_nop 1
    v_add_f32_dpp v54, v54, v54 quad_perm:[2,3,0,1] row_mask:0xf bank_mask:0xf
    s_nop 1
    v_add_f32_dpp v54, v54, v54 row_half_mirror row_mask:0xf bank_mask:0xf
    s_nop 1
    v_add_f32_dpp v54, v54, v54 row_mirror row_mask:0xf bank_mask:0xf
    v_mov_b32 v13, v54
    s_nop 1
    v_permlane32_swap_b32 v54, v13
    v_add_f32 v54, v54, v13
    v_mov_b32 v13, v54
    s_nop 1
    v_permlane16_swap_b32 v54, v13
    v_add_f32 v54, v54, v13
    v_add_f32_dpp v53, v53, v53 quad_perm:[1,0,3,2] row_mask:0xf bank_mask:0xf
    s_nop 1
    v_add_f32_dpp v53, v53, v53 quad_perm:[2,3,0,1] row_mask:0xf bank_mask:0xf
    s_nop 1
    v_add_f32_dpp v53, v53, v53 row_half_mirror row_mask:0xf bank_mask:0xf
    s_nop 1
    v_add_f32_dpp v53, v53, v53 row_mirror row_mask:0xf bank_mask:0xf
    v_mov_b32 v13, v53
    s_nop 1
    v_permlane32_swap_b32 v53, v13
    v_add_f32 v53, v53, v13
    v_mov_b32 v13, v53
    s_nop 1
    v_permlane16_swap_b32 v53, v13
    v_add_f32 v53, v53, v13
    v_bfi_b32 v54, v14, s31, v54
    v_mov_b32 v55, v53
    v_add_u32 v9, 1, v9
    s_mov_b64 exec, 1
    ds_write_b128 v8, v[52:55]
    ds_write_b32 v3, v9 offset:36
    s_mov_b64 exec, -1
    v_add_u32 v15, -2048, v15
    v_add_u32 v16, -512, v16
    v_add_u32 v8, 16, v8
    s_add_u32 s24, s24, 4
    s_cmp_le_u32 s24, 128
    s_cbranch_scc1 L_hp
    s_add_u32 s26, s77, 28
    s_mul_i32 s26, s26, 64
    s_add_u32 s26, s26, s78
    s_lshl_b32 s26, s26, 10
    s_lshr_b32 s34, s2, 3
    s_and_b32 s35, s2, 7
    v_lshrrev_b32 v10, 3, v1
    v_and_b32 v16, 7, v1
    v_lshlrev_b32 v10, 10, v10
    v_lshl_add_u32 v15, v16, 4, v10
    v_lshrrev_b32 v10, 2, v16
    v_and_b32 v16, 3, v16
    v_lshl_add_u32 v16, v16, 2, v10
    v_lshlrev_b32 v16, 1, v16
    v_bfe_u32 v10, v1, 4, 1
    v_lshl_add_u32 v16, v10, 6, v16
    v_lshrrev_b32 v10, 5, v1
    v_lshl_add_u32 v16, v10, 5, v16
    s_mov_b32 s25, 0
    s_mov_b32 s38, 0
    s_mul_i32 s36, s34, 65536
    s_lshl_b32 s83, s35, 7
    s_add_u32 s36, s36, s83
    s_mul_i32 s37, s34, 384
    s_lshr_b32 s83, s35, 1
    s_mul_i32 s83, s83, 96
    s_add_u32 s37, s37, s83
    s_and_b32 s83, s35, 1
    s_lshl_b32 s83, s83, 2
    s_add_u32 s37, s37, s83
    s_mov_b32 s40, s74
    s_mov_b32 s41, s75
    s_mov_b32 s42, 1610612736
    s_mov_b32 s43, 0x20000
    s_mov_b32 s16, s70
    s_mov_b32 s17, s71
    s_mov_b32 s18, 12288
    s_mov_b32 s19, 0x20000
    v_add_u32 v13, 143360, v2
    s_nop 1
L_hf:
    s_sleep 32
    ds_read_b128 v[56:59], v3
    s_waitcnt lgkmcnt(0)
    v_min3_i32 v56, v56, v57, v58
    v_min_i32 v56, v56, v59
    s_nop 0
    v_readfirstlane_b32 s80, v56
    s_nop 0
    s_cmp_lt_i32 s80, 240
    s_nop 2
    s_cbranch_scc1 L_hf
    ds_read_b128 v[140:143], v13 offset:0
    ds_read_b128 v[144:147], v13 offset:1024
    ds_read_b128 v[148:151], v13 offset:2048
    ds_read_b128 v[152:155], v13 offset:3072
    ds_read_b128 v[156:159], v13 offset:4096
    ds_read_b128 v[160:163], v13 offset:5120
    ds_read_b128 v[164:167], v13 offset:6144
L_hn:
    s_sleep 2
    ds_read_b32 v4, v3 offset:20
    s_waitcnt lgkmcnt(0)
    v_readfirstlane_b32 s80, v4
    s_nop 0
    s_cmp_lt_i32 s80, 253
    s_nop 2
    s_cbranch_scc1 L_hn
    buffer_store_dwordx4 v[140:143], v2, s[12:15], s26 offen sc0 sc1
    s_sub_u32 s26, s26, 262144
    buffer_store_dwordx4 v[144:147], v2, s[12:15], s26 offen sc0 sc1
    s_sub_u32 s26, s26, 262144
    buffer_store_dwordx4 v[148:151], v2, s[12:15], s26 offen sc0 sc1
    s_sub_u32 s26, s26, 262144
    buffer_store_dwordx4 v[152:155], v2, s[12:15], s26 offen sc0 sc1
    s_sub_u32 s26, s26, 262144
    buffer_store_dwordx4 v[156:159], v2, s[12:15], s26 offen sc0 sc1
    s_sub_u32 s26, s26, 262144
    buffer_store_dwordx4 v[160:163], v2, s[12:15], s26 offen sc0 sc1
    s_sub_u32 s26, s26, 262144
    buffer_store_dwordx4 v[164:167], v2, s[12:15], s26 offen sc0 sc1
    s_sub_u32 s26, s26, 262144
    s_nop 0
L_hl:
    s_sleep 1
    ds_read_b32 v4, v3 offset:16
    s_waitcnt lgkmcnt(0)
    v_readfirstlane_b32 s80, v4
    s_nop 0
    s_cmp_lt_i32 s80, 3072
    s_nop 2
    s_cbranch_scc1 L_hl
    s_mov_b32 s80, s36
    buffer_load_dwordx4 v[44:47], v15, s[40:43], s80 offen sc0 sc1
    s_add_u32 s80, s80, 8192
    buffer_load_dwordx4 v[48:51], v15, s[40:43], s80 offen sc0 sc1
    s_add_u32 s80, s80, 8192
    buffer_load_dwordx4 v[52:55], v15, s[40:43], s80 offen sc0 sc1
    s_add_u32 s80, s80, 8192
    buffer_load_dwordx4 v[56:59], v15, s[40:43], s80 offen sc0 sc1
    s_add_u32 s80, s80, 8192
    buffer_load_dwordx4 v[60:63], v15, s[40:43], s80 offen sc0 sc1
    s_add_u32 s80, s80, 8192
    buffer_load_dwordx4 v[64:67], v15, s[40:43], s80 offen sc0 sc1
    s_add_u32 s80, s80, 8192
    buffer_load_dwordx4 v[68:71], v15, s[40:43], s80 offen sc0 sc1
    s_add_u32 s80, s80, 8192
    buffer_load_dwordx4 v[72:75], v15, s[40:43], s80 offen sc0 sc1
    s_waitcnt vmcnt(7)
    v_xor_b32 v12, s28, v44
    v_bitop3_b32 v12, v12, v45, s29 bitop3:0xf6
    v_bitop3_b32 v12, v12, v46, s30 bitop3:0xf6
    v_xor_b32 v13, s31, v47
    s_waitcnt vmcnt(6)
    v_bitop3_b32 v12, v12, v48, s28 bitop3:0xf6
    v_bitop3_b32 v12, v12, v49, s29 bitop3:0xf6
    v_bitop3_b32 v12, v12, v50, s30 bitop3:0xf6
    v_bitop3_b32 v13, v13, v51, s31 bitop3:0xf6
    s_waitcnt vmcnt(5)
    v_bitop3_b32 v12, v12, v52, s28 bitop3:0xf6
    v_bitop3_b32 v12, v12, v53, s29 bitop3:0xf6
    v_bitop3_b32 v12, v12, v54, s30 bitop3:0xf6
    v_bitop3_b32 v13, v13, v55, s31 bitop3:0xf6
    s_waitcnt vmcnt(4)
    v_bitop3_b32 v12, v12, v56, s28 bitop3:0xf6
    v_bitop3_b32 v12, v12, v57, s29 bitop3:0xf6
    v_bitop3_b32 v12, v12, v58, s30 bitop3:0xf6
    v_bitop3_b32 v13, v13, v59, s31 bitop3:0xf6
    s_waitcnt vmcnt(3)
    v_bitop3_b32 v12, v12, v60, s28 bitop3:0xf6
    v_bitop3_b32 v12, v12, v61, s29 bitop3:0xf6
    v_bitop3_b32 v12, v12, v62, s30 bitop3:0xf6
    v_bitop3_b32 v13, v13, v63, s31 bitop3:0xf6
    s_waitcnt vmcnt(2)
    v_bitop3_b32 v12, v12, v64, s28 bitop3:0xf6
    v_bitop3_b32 v12, v12, v65, s29 bitop3:0xf6
    v_bitop3_b32 v12, v12, v66, s30 bitop3:0xf6
    v_bitop3_b32 v13, v13, v67, s31 bitop3:0xf6
    s_waitcnt vmcnt(1)
    v_bitop3_b32 v12, v12, v68, s28 bitop3:0xf6
    v_bitop3_b32 v12, v12, v69, s29 bitop3:0xf6
    v_bitop3_b32 v12, v12, v70, s30 bitop3:0xf6
    v_bitop3_b32 v13, v13, v71, s31 bitop3:0xf6
    s_waitcnt vmcnt(0)
    v_bitop3_b32 v12, v12, v72, s28 bitop3:0xf6
    v_bitop3_b32 v12, v12, v73, s29 bitop3:0xf6
    v_bitop3_b32 v12, v12, v74, s30 bitop3:0xf6
    v_bitop3_b32 v13, v13, v75, s31 bitop3:0xf6
    v_cndmask_b32 v13, v13, 0, s[32:33]
    v_bitop3_b32 v12, v12, v13, v14 bitop3:0xa8
    v_cmp_ne_u32 vcc, 0, v12
    s_nop 4
    s_cbranch_vccz L_ok0
    s_mov_b32 s80, s36
    buffer_load_dwordx4 v[44:47], v15, s[40:43], s80 offen sc0 sc1
    s_add_u32 s80, s80, 8192
    buffer_load_dwordx4 v[48:51], v15, s[40:43], s80 offen sc0 sc1
    s_add_u32 s80, s80, 8192
    buffer_load_dwordx4 v[52:55], v15, s[40:43], s80 offen sc0 sc1
    s_add_u32 s80, s80, 8192
    buffer_load_dwordx4 v[56:59], v15, s[40:43], s80 offen sc0 sc1
    s_add_u32 s80, s80, 8192
    buffer_load_dwordx4 v[60:63], v15, s[40:43], s80 offen sc0 sc1
    s_add_u32 s80, s80, 8192
    buffer_load_dwordx4 v[64:67], v15, s[40:43], s80 offen sc0 sc1
    s_add_u32 s80, s80, 8192
    buffer_load_dwordx4 v[68:71], v15, s[40:43], s80 offen sc0 sc1
    s_add_u32 s80, s80, 8192
    buffer_load_dwordx4 v[72:75], v15, s[40:43], s80 offen sc0 sc1
    s_sleep 6
L_try:
    s_mov_b32 s80, s36
    buffer_load_dwordx4 v[76:79], v15, s[40:43], s80 offen sc0 sc1
    s_add_u32 s80, s80, 8192
    buffer_load_dwordx4 v[80:83], v15, s[40:43], s80 offen sc0 sc1
    s_add_u32 s80, s80, 8192
    buffer_load_dwordx4 v[84:87], v15, s[40:43], s80 offen sc0 sc1
    s_add_u32 s80, s80, 8192
    buffer_load_dwordx4 v[88:91], v15, s[40:43], s80 offen sc0 sc1
    s_add_u32 s80, s80, 8192
    buffer_load_dwordx4 v[92:95], v15, s[40:43], s80 offen sc0 sc1
    s_add_u32 s80, s80, 8192
    buffer_load_dwordx4 v[96:99], v15, s[40:43], s80 offen sc0 sc1
    s_add_u32 s80, s80, 8192
    buffer_load_dwordx4 v[100:103], v15, s[40:43], s80 offen sc0 sc1
    s_add_u32 s80, s80, 8192
    buffer_load_dwordx4 v[104:107], v15, s[40:43], s80 offen sc0 sc1
    s_waitcnt vmcnt(15)
    v_xor_b32 v12, s28, v44
    v_bitop3_b32 v12, v12, v45, s29 bitop3:0xf6
    v_bitop3_b32 v12, v12, v46, s30 bitop3:0xf6
    v_xor_b32 v13, s31, v47
    s_waitcnt vmcnt(14)
    v_bitop3_b32 v12, v12, v48, s28 bitop3:0xf6
    v_bitop3_b32 v12, v12, v49, s29 bitop3:0xf6
    v_bitop3_b32 v12, v12, v50, s30 bitop3:0xf6
    v_bitop3_b32 v13, v13, v51, s31 bitop3:0xf6
    s_waitcnt vmcnt(13)
    v_bitop3_b32 v12, v12, v52, s28 bitop3:0xf6
    v_bitop3_b32 v12, v12, v53, s29 bitop3:0xf6
    v_bitop3_b32 v12, v12, v54, s30 bitop3:0xf6
    v_bitop3_b32 v13, v13, v55, s31 bitop3:0xf6
    s_waitcnt vmcnt(12)
    v_bitop3_b32 v12, v12, v56, s28 bitop3:0xf6
    v_bitop3_b32 v12, v12, v57, s29 bitop3:0xf6
    v_bitop3_b32 v12, v12, v58, s30 bitop3:0xf6
    v_bitop3_b32 v13, v13, v59, s31 bitop3:0xf6
    s_waitcnt vmcnt(11)
    v_bitop3_b32 v12, v12, v60, s28 bitop3:0xf6
    v_bitop3_b32 v12, v12, v61, s29 bitop3:0xf6
    v_bitop3_b32 v12, v12, v62, s30 bitop3:0xf6
    v_bitop3_b32 v13, v13, v63, s31 bitop3:0xf6
    s_waitcnt vmcnt(10)
    v_bitop3_b32 v12, v12, v64, s28 bitop3:0xf6
    v_bitop3_b32 v12, v12, v65, s29 bitop3:0xf6
    v_bitop3_b32 v12, v12, v66, s30 bitop3:0xf6
    v_bitop3_b32 v13, v13, v67, s31 bitop3:0xf6
    s_waitcnt vmcnt(9)
    v_bitop3_b32 v12, v12, v68, s28 bitop3:0xf6
    v_bitop3_b32 v12, v12, v69, s29 bitop3:0xf6
    v_bitop3_b32 v12, v12, v70, s30 bitop3:0xf6
    v_bitop3_b32 v13, v13, v71, s31 bitop3:0xf6
    s_waitcnt vmcnt(8)
    v_bitop3_b32 v12, v12, v72, s28 bitop3:0xf6
    v_bitop3_b32 v12, v12, v73, s29 bitop3:0xf6
    v_bitop3_b32 v12, v12, v74, s30 bitop3:0xf6
    v_bitop3_b32 v13, v13, v75, s31 bitop3:0xf6
    v_cndmask_b32 v13, v13, 0, s[32:33]
    v_bitop3_b32 v12, v12, v13, v14 bitop3:0xa8
    v_cmp_ne_u32 vcc, 0, v12
    s_nop 4
    s_cbranch_vccz L_ok0
    s_mov_b32 s80, s36
    buffer_load_dwordx4 v[44:47], v15, s[40:43], s80 offen sc0 sc1
    s_add_u32 s80, s80, 8192
    buffer_load_dwordx4 v[48:51], v15, s[40:43], s80 offen sc0 sc1
    s_add_u32 s80, s80, 8192
    buffer_load_dwordx4 v[52:55], v15, s[40:43], s80 offen sc0 sc1
    s_add_u32 s80, s80, 8192
    buffer_load_dwordx4 v[56:59], v15, s[40:43], s80 offen sc0 sc1
    s_add_u32 s80, s80, 8192
    buffer_load_dwordx4 v[60:63], v15, s[40:43], s80 offen sc0 sc1
    s_add_u32 s80, s80, 8192
    buffer_load_dwordx4 v[64:67], v15, s[40:43], s80 offen sc0 sc1
    s_add_u32 s80, s80, 8192
    buffer_load_dwordx4 v[68:71], v15, s[40:43], s80 offen sc0 sc1
    s_add_u32 s80, s80, 8192
    buffer_load_dwordx4 v[72:75], v15, s[40:43], s80 offen sc0 sc1
    s_waitcnt vmcnt(15)
    v_xor_b32 v12, s28, v76
    v_bitop3_b32 v12, v12, v77, s29 bitop3:0xf6
    v_bitop3_b32 v12, v12, v78, s30 bitop3:0xf6
    v_xor_b32 v13, s31, v79
    s_waitcnt vmcnt(14)
    v_bitop3_b32 v12, v12, v80, s28 bitop3:0xf6
    v_bitop3_b32 v12, v12, v81, s29 bitop3:0xf6
    v_bitop3_b32 v12, v12, v82, s30 bitop3:0xf6
    v_bitop3_b32 v13, v13, v83, s31 bitop3:0xf6
    s_waitcnt vmcnt(13)
    v_bitop3_b32 v12, v12, v84, s28 bitop3:0xf6
    v_bitop3_b32 v12, v12, v85, s29 bitop3:0xf6
    v_bitop3_b32 v12, v12, v86, s30 bitop3:0xf6
    v_bitop3_b32 v13, v13, v87, s31 bitop3:0xf6
    s_waitcnt vmcnt(12)
    v_bitop3_b32 v12, v12, v88, s28 bitop3:0xf6
    v_bitop3_b32 v12, v12, v89, s29 bitop3:0xf6
    v_bitop3_b32 v12, v12, v90, s30 bitop3:0xf6
    v_bitop3_b32 v13, v13, v91, s31 bitop3:0xf6
    s_waitcnt vmcnt(11)
    v_bitop3_b32 v12, v12, v92, s28 bitop3:0xf6
    v_bitop3_b32 v12, v12, v93, s29 bitop3:0xf6
    v_bitop3_b32 v12, v12, v94, s30 bitop3:0xf6
    v_bitop3_b32 v13, v13, v95, s31 bitop3:0xf6
    s_waitcnt vmcnt(10)
    v_bitop3_b32 v12, v12, v96, s28 bitop3:0xf6
    v_bitop3_b32 v12, v12, v97, s29 bitop3:0xf6
    v_bitop3_b32 v12, v12, v98, s30 bitop3:0xf6
    v_bitop3_b32 v13, v13, v99, s31 bitop3:0xf6
    s_waitcnt vmcnt(9)
    v_bitop3_b32 v12, v12, v100, s28 bitop3:0xf6
    v_bitop3_b32 v12, v12, v101, s29 bitop3:0xf6
    v_bitop3_b32 v12, v12, v102, s30 bitop3:0xf6
    v_bitop3_b32 v13, v13, v103, s31 bitop3:0xf6
    s_waitcnt vmcnt(8)
    v_bitop3_b32 v12, v12, v104, s28 bitop3:0xf6
    v_bitop3_b32 v12, v12, v105, s29 bitop3:0xf6
    v_bitop3_b32 v12, v12, v106, s30 bitop3:0xf6
    v_bitop3_b32 v13, v13, v107, s31 bitop3:0xf6
    v_cndmask_b32 v13, v13, 0, s[32:33]
    v_bitop3_b32 v12, v12, v13, v14 bitop3:0xa8
    v_cmp_ne_u32 vcc, 0, v12
    s_nop 4
    s_cbranch_vccz L_ok1
    s_add_u32 s25, s25, 1
    s_cmp_lt_u32 s25, 2000000
    s_cbranch_scc1 L_try
L_ok1:
    v_max_f32 v11, v79, v83
    v_max3_f32 v11, v11, v87, v91
    v_max3_f32 v11, v11, v95, v99
    v_max3_f32 v11, v11, v103, v107
    s_nop 1
    v_max_f32_dpp v11, v11, v11 row_ror:8 row_mask:0xf bank_mask:0xf
    v_mov_b32 v13, v11
    s_nop 1
    v_permlane32_swap_b32 v11, v13
    v_max_f32 v11, v11, v13
    v_mov_b32 v13, v11
    s_nop 1
    v_permlane16_swap_b32 v11, v13
    v_max_f32 v11, v11, v13
    s_nop 1
    v_mov_b32_dpp v11, v11 quad_perm:[0,0,2,2] row_mask:0xf bank_mask:0xf
    s_nop 1
    v_sub_f32_dpp v20, v79, v11 quad_perm:[0,0,2,2] row_mask:0xf bank_mask:0xf
    v_sub_f32_dpp v21, v83, v11 quad_perm:[0,0,2,2] row_mask:0xf bank_mask:0xf
    v_sub_f32_dpp v22, v87, v11 quad_perm:[0,0,2,2] row_mask:0xf bank_mask:0xf
    v_sub_f32_dpp v23, v91, v11 quad_perm:[0,0,2,2] row_mask:0xf bank_mask:0xf
    v_sub_f32_dpp v24, v95, v11 quad_perm:[0,0,2,2] row_mask:0xf bank_mask:0xf
    v_sub_f32_dpp v25, v99, v11 quad_perm:[0,0,2,2] row_mask:0xf bank_mask:0xf
    v_sub_f32_dpp v26, v103, v11 quad_perm:[0,0,2,2] row_mask:0xf bank_mask:0xf
    v_sub_f32_dpp v27, v107, v11 quad_perm:[0,0,2,2] row_mask:0xf bank_mask:0xf
    v_exp_f32 v20, v20
    v_exp_f32 v21, v21
    v_exp_f32 v22, v22
    v_exp_f32 v23, v23
    v_exp_f32 v24, v24
    v_exp_f32 v25, v25
    v_exp_f32 v26, v26
    v_exp_f32 v27, v27
    v_pk_mul_f32 v[40:41], v[76:77], v[20:21] op_sel:[0,0] op_sel_hi:[1,0]
    v_pk_mul_f32 v[42:43], v[78:79], v[20:21] op_sel:[0,0] op_sel_hi:[1,0]
    v_pk_fma_f32 v[40:41], v[80:81], v[20:21], v[40:41] op_sel:[0,1,0] op_sel_hi:[1,1,1]
    v_pk_fma_f32 v[42:43], v[82:83], v[20:21], v[42:43] op_sel:[0,1,0] op_sel_hi:[1,1,1]
    v_pk_fma_f32 v[40:41], v[84:85], v[22:23], v[40:41] op_sel:[0,0,0] op_sel_hi:[1,0,1]
    v_pk_fma_f32 v[42:43], v[86:87], v[22:23], v[42:43] op_sel:[0,0,0] op_sel_hi:[1,0,1]
    v_pk_fma_f32 v[40:41], v[88:89], v[22:23], v[40:41] op_sel:[0,1,0] op_sel_hi:[1,1,1]
    v_pk_fma_f32 v[42:43], v[90:91], v[22:23], v[42:43] op_sel:[0,1,0] op_sel_hi:[1,1,1]
    v_pk_fma_f32 v[40:41], v[92:93], v[24:25], v[40:41] op_sel:[0,0,0] op_sel_hi:[1,0,1]
    v_pk_fma_f32 v[42:43], v[94:95], v[24:25], v[42:43] op_sel:[0,0,0] op_sel_hi:[1,0,1]
    v_pk_fma_f32 v[40:41], v[96:97], v[24:25], v[40:41] op_sel:[0,1,0] op_sel_hi:[1,1,1]
    v_pk_fma_f32 v[42:43], v[98:99], v[24:25], v[42:43] op_sel:[0,1,0] op_sel_hi:[1,1,1]
    v_pk_fma_f32 v[40:41], v[100:101], v[26:27], v[40:41] op_sel:[0,0,0] op_sel_hi:[1,0,1]
    v_pk_fma_f32 v[42:43], v[102:103], v[26:27], v[42:43] op_sel:[0,0,0] op_sel_hi:[1,0,1]
    v_pk_fma_f32 v[40:41], v[104:105], v[26:27], v[40:41] op_sel:[0,1,0] op_sel_hi:[1,1,1]
    v_pk_fma_f32 v[42:43], v[106:107], v[26:27], v[42:43] op_sel:[0,1,0] op_sel_hi:[1,1,1]
    s_nop 1
    s_branch L_fin
L_ok0:
    v_max_f32 v11, v47, v51
    v_max3_f32 v11, v11, v55, v59
    v_max3_f32 v11, v11, v63, v67
    v_max3_f32 v11, v11, v71, v75
    s_nop 1
    v_max_f32_dpp v11, v11, v11 row_ror:8 row_mask:0xf bank_mask:0xf
    v_mov_b32 v13, v11
    s_nop 1
    v_permlane32_swap_b32 v11, v13
    v_max_f32 v11, v11, v13
    v_mov_b32 v13, v11
    s_nop 1
    v_permlane16_swap_b32 v11, v13
    v_max_f32 v11, v11, v13
    s_nop 1
    v_mov_b32_dpp v11, v11 quad_perm:[0,0,2,2] row_mask:0xf bank_mask:0xf
    s_nop 1
    v_sub_f32_dpp v20, v47, v11 quad_perm:[0,0,2,2] row_mask:0xf bank_mask:0xf
    v_sub_f32_dpp v21, v51, v11 quad_perm:[0,0,2,2] row_mask:0xf bank_mask:0xf
    v_sub_f32_dpp v22, v55, v11 quad_perm:[0,0,2,2] row_mask:0xf bank_mask:0xf
    v_sub_f32_dpp v23, v59, v11 quad_perm:[0,0,2,2] row_mask:0xf bank_mask:0xf
    v_sub_f32_dpp v24, v63, v11 quad_perm:[0,0,2,2] row_mask:0xf bank_mask:0xf
    v_sub_f32_dpp v25, v67, v11 quad_perm:[0,0,2,2] row_mask:0xf bank_mask:0xf
    v_sub_f32_dpp v26, v71, v11 quad_perm:[0,0,2,2] row_mask:0xf bank_mask:0xf
    v_sub_f32_dpp v27, v75, v11 quad_perm:[0,0,2,2] row_mask:0xf bank_mask:0xf
    v_exp_f32 v20, v20
    v_exp_f32 v21, v21
    v_exp_f32 v22, v22
    v_exp_f32 v23, v23
    v_exp_f32 v24, v24
    v_exp_f32 v25, v25
    v_exp_f32 v26, v26
    v_exp_f32 v27, v27
    v_pk_mul_f32 v[40:41], v[44:45], v[20:21] op_sel:[0,0] op_sel_hi:[1,0]
    v_pk_mul_f32 v[42:43], v[46:47], v[20:21] op_sel:[0,0] op_sel_hi:[1,0]
    v_pk_fma_f32 v[40:41], v[48:49], v[20:21], v[40:41] op_sel:[0,1,0] op_sel_hi:[1,1,1]
    v_pk_fma_f32 v[42:43], v[50:51], v[20:21], v[42:43] op_sel:[0,1,0] op_sel_hi:[1,1,1]
    v_pk_fma_f32 v[40:41], v[52:53], v[22:23], v[40:41] op_sel:[0,0,0] op_sel_hi:[1,0,1]
    v_pk_fma_f32 v[42:43], v[54:55], v[22:23], v[42:43] op_sel:[0,0,0] op_sel_hi:[1,0,1]
    v_pk_fma_f32 v[40:41], v[56:57], v[22:23], v[40:41] op_sel:[0,1,0] op_sel_hi:[1,1,1]
    v_pk_fma_f32 v[42:43], v[58:59], v[22:23], v[42:43] op_sel:[0,1,0] op_sel_hi:[1,1,1]
    v_pk_fma_f32 v[40:41], v[60:61], v[24:25], v[40:41] op_sel:[0,0,0] op_sel_hi:[1,0,1]
    v_pk_fma_f32 v[42:43], v[62:63], v[24:25], v[42:43] op_sel:[0,0,0] op_sel_hi:[1,0,1]
    v_pk_fma_f32 v[40:41], v[64:65], v[24:25], v[40:41] op_sel:[0,1,0] op_sel_hi:[1,1,1]
    v_pk_fma_f32 v[42:43], v[66:67], v[24:25], v[42:43] op_sel:[0,1,0] op_sel_hi:[1,1,1]
    v_pk_fma_f32 v[40:41], v[68:69], v[26:27], v[40:41] op_sel:[0,0,0] op_sel_hi:[1,0,1]
    v_pk_fma_f32 v[42:43], v[70:71], v[26:27], v[42:43] op_sel:[0,0,0] op_sel_hi:[1,0,1]
    v_pk_fma_f32 v[40:41], v[72:73], v[26:27], v[40:41] op_sel:[0,1,0] op_sel_hi:[1,1,1]
    v_pk_fma_f32 v[42:43], v[74:75], v[26:27], v[42:43] op_sel:[0,1,0] op_sel_hi:[1,1,1]
    s_nop 1
L_fin:
    v_permlane32_swap_b32 v40, v41
    v_permlane32_swap_b32 v42, v43
    v_add_f32 v40, v40, v41
    v_add_f32 v42, v42, v43
    s_nop 1
    v_permlane16_swap_b32 v40, v42
    v_add_f32 v40, v40, v42
    s_nop 1
    v_add_f32_dpp v40, v40, v40 row_ror:8 row_mask:0xf bank_mask:0xf
    v_rcp_f32 v10, v40
    s_nop 0
    v_readlane_b32 s81, v10, 49
    s_nop 1
    v_mul_f32 v40, s81, v40
    v_cvt_pk_bf16_f32 v40, v40, v40
    s_mov_b32 exec_lo, 0x00ff00ff
    s_mov_b32 exec_hi, 0xff
    buffer_store_short v40, v16, s[16:19], s37 offen
    s_endpgm
L_pacer:
    s_cmp_eq_u32 s76, 6
    s_cbranch_scc0 L_exch
    s_mov_b32 s4, 0
    s_mov_b32 s5, 12
    s_mov_b32 s6, 0
    s_mov_b32 s7, 128
    s_mov_b32 s8, 24
    s_mov_b32 s9, 0
    v_mov_b32 v14, 157824
    s_waitcnt lgkmcnt(0)
    s_lshl_b32 s80, s84, 12
    s_add_u32 s80, s80, 1351680
    v_mov_b32 v12, s80
    v_mov_b32 v13, 5104
    ds_write_b64 v3, v[12:13] offset:24
    v_mov_b32 v15, s84
    ds_write_b32 v14, v15
    s_nop 0
L_g:
    s_sleep 1
    ds_read_b32 v4, v3 offset:16
    s_memrealtime s[10:11]
    ds_read_b128 v[8:11], v3
    ds_read_b64 v[12:13], v3 offset:24
    s_waitcnt lgkmcnt(0)
    v_readfirstlane_b32 s83, v4
    v_min3_i32 v15, v8, v9, v10
    v_min_i32 v8, v15, v11
    v_readfirstlane_b32 s80, v12
    v_readfirstlane_b32 s81, v13
    s_max_i32 s9, s9, s83
    s_cmp_ge_i32 s9, s5
    s_nop 2
    s_cbranch_scc0 L_gn
    s_add_u32 s4, s4, 1
    s_add_u32 s5, s5, 12
    v_add_u32 v14, 4, v14
    v_mov_b32 v15, s10
    ds_write_b32 v14, v15
    v_mov_b32 v15, s4
    ds_write_b32 v3, v15 offset:20
    s_nop 0
L_gn:
    s_mul_i32 s6, s9, 43691
    s_lshr_b32 s6, s6, 14
    s_mul_i32 s81, s81, s6
    s_add_u32 s80, s80, s81
    s_lshl_b32 s81, s10, 12
    s_sub_u32 s80, s81, s80
    s_ashr_i32 s80, s80, 6
    s_min_i32 s80, s80, 0x40000
    s_max_i32 s80, s80, 0xfffc0000
    s_mul_i32 s80, s80, 983
    s_ashr_i32 s80, s80, 12
    s_and_b32 s7, s7, 255
    s_add_u32 s7, s7, s80
    s_add_u32 s7, s7, 5632
    s_ashr_i32 s8, s7, 8
    s_min_i32 s8, s8, 36
    s_max_i32 s8, s8, 16
    s_cmp_lt_u32 s4, 8
    s_cselect_b32 s8, 24, s8
L_gw:
    s_add_u32 s80, s8, 2304
    v_lshl_add_u32 v15, v8, 8, s80
    ds_write_b32 v3, v15 offset:44
    s_cmp_lt_u32 s4, 256
    s_cbranch_scc1 L_g
    s_endpgm
L_exch:
    s_mov_b32 s12, s74
    s_mov_b32 s13, s75
    s_mov_b32 s14, 1610612736
    s_mov_b32 s15, 0x20000
    s_mov_b32 s80, 4352
    v_mul_lo_u32 v5, v1, s80
    s_lshr_b32 s80, s2, 3
    s_mul_i32 s21, s79, 5
    s_add_u32 s21, s21, s80
    s_and_b32 s21, s21, 31
    s_lshr_b32 s80, s80, 5
    s_lshl_b32 s80, s80, 3
    s_add_u32 s80, s80, s79
    s_mul_i32 s80, s80, 4352
    s_waitcnt vmcnt(0)
    v_mov_b32 v7, s80
    s_mov_b32 s16, 0
    s_mov_b32 s17, 33554432
    s_mov_b32 s18, 8
    s_mov_b32 s20, 0
    s_mov_b32 s19, 0
    s_mov_b32 s24, 0
L_pc0:
L_pw1:
    s_sleep 8
    ds_read_b32 v4, v3 offset:20
    s_waitcnt lgkmcnt(0)
    v_readfirstlane_b32 s80, v4
    s_nop 0
    s_cmp_lt_i32 s80, s18
    s_nop 2
    s_cbranch_scc1 L_pw1
    s_lshl_b32 s80, s18, 2
    s_add_u32 s80, s80, 157824
    v_mov_b32 v8, s80
    ds_read_b32 v6, v8
    s_waitcnt lgkmcnt(0)
    s_and_b32 s80, s16, 31
    s_cmp_eq_u32 s80, s21
    s_cbranch_scc0 L_np
    s_mov_b64 exec, 1
    buffer_store_dword v6, v7, s[12:15], s17 offen sc0 sc1
    s_mov_b64 exec, -1
L_np:
    s_add_u32 s81, s18, 4
L_pw2:
    s_sleep 8
    ds_read_b32 v4, v3 offset:20
    s_waitcnt lgkmcnt(0)
    v_readfirstlane_b32 s80, v4
    s_nop 0
    s_cmp_lt_i32 s80, s81
    s_nop 2
    s_cbranch_scc1 L_pw2
    s_add_u32 s30, s74, s17
    s_addc_u32 s31, s75, 0
    s_load_dword s32, s[30:31], 0
    s_load_dword s33, s[30:31], 4352
    s_load_dword s34, s[30:31], 8704
    s_load_dword s35, s[30:31], 13056
    s_load_dword s36, s[30:31], 17408
    s_load_dword s37, s[30:31], 21760
    s_load_dword s38, s[30:31], 26112
    s_load_dword s39, s[30:31], 30464
    s_memrealtime s[22:23]
    v_readfirstlane_b32 s26, v6
    s_mov_b32 s27, 0
    s_mov_b32 s28, 0
    s_mov_b32 s29, -4096
    s_waitcnt lgkmcnt(0)
    s_sub_u32 s83, s22, s26
    s_sub_u32 s80, s32, s26
    s_add_u32 s81, s80, 4096
    s_cmp_lt_u32 s81, 0x2000
    s_cselect_b32 s80, s80, s83
    s_addc_u32 s28, s28, 0
    s_add_u32 s27, s27, s80
    s_max_i32 s29, s29, s80
    s_sub_u32 s80, s33, s26
    s_add_u32 s81, s80, 4096
    s_cmp_lt_u32 s81, 0x2000
    s_cselect_b32 s80, s80, s83
    s_addc_u32 s28, s28, 0
    s_add_u32 s27, s27, s80
    s_max_i32 s29, s29, s80
    s_sub_u32 s80, s34, s26
    s_add_u32 s81, s80, 4096
    s_cmp_lt_u32 s81, 0x2000
    s_cselect_b32 s80, s80, s83
    s_addc_u32 s28, s28, 0
    s_add_u32 s27, s27, s80
    s_max_i32 s29, s29, s80
    s_sub_u32 s80, s35, s26
    s_add_u32 s81, s80, 4096
    s_cmp_lt_u32 s81, 0x2000
    s_cselect_b32 s80, s80, s83
    s_addc_u32 s28, s28, 0
    s_add_u32 s27, s27, s80
    s_max_i32 s29, s29, s80
    s_sub_u32 s80, s36, s26
    s_add_u32 s81, s80, 4096
    s_cmp_lt_u32 s81, 0x2000
    s_cselect_b32 s80, s80, s83
    s_addc_u32 s28, s28, 0
    s_add_u32 s27, s27, s80
    s_max_i32 s29, s29, s80
    s_sub_u32 s80, s37, s26
    s_add_u32 s81, s80, 4096
    s_cmp_lt_u32 s81, 0x2000
    s_cselect_b32 s80, s80, s83
    s_addc_u32 s28, s28, 0
    s_add_u32 s27, s27, s80
    s_max_i32 s29, s29, s80
    s_sub_u32 s80, s38, s26
    s_add_u32 s81, s80, 4096
    s_cmp_lt_u32 s81, 0x2000
    s_cselect_b32 s80, s80, s83
    s_addc_u32 s28, s28, 0
    s_add_u32 s27, s27, s80
    s_max_i32 s29, s29, s80
    s_sub_u32 s80, s39, s26
    s_add_u32 s81, s80, 4096
    s_cmp_lt_u32 s81, 0x2000
    s_cselect_b32 s80, s80, s83
    s_addc_u32 s28, s28, 0
    s_add_u32 s27, s27, s80
    s_max_i32 s29, s29, s80
    s_cmp_lt_u32 s28, 4
    s_cbranch_scc1 L_pskip
    s_mul_i32 s27, s27, 410
    s_lshl_b32 s80, s26, 12
    s_add_u32 s80, s80, s27
    s_mul_i32 s29, s29, 819
    s_add_u32 s80, s80, s29
    s_min_u32 s82, s18, 0
    s_lshl_b32 s83, s18, 5
    s_add_u32 s82, s82, s83
    s_sub_u32 s81, s80, s19
    s_sub_u32 s83, s82, s24
    v_cvt_f32_u32 v8, s81
    v_cvt_f32_u32 v9, s83
    v_rcp_f32 v9, v9
    v_mul_f32 v8, 0x3f800000, v8
    v_mul_f32 v8, v8, v9
    v_mul_f32 v9, 0x3f7851ec, v8
    v_mov_b32 v10, 0x459f8000
    v_mul_f32 v8, 0x3f828f5c, v8
    v_med3_f32 v8, v8, v9, v10
    v_cvt_u32_f32 v8, v8
    s_nop 0
    v_readfirstlane_b32 s81, v8
    s_mov_b32 s19, s80
    s_mov_b32 s24, s82
    s_cmp_eq_u32 s20, 0
    s_cselect_b32 s81, 5104, s81
    s_mov_b32 s20, 1
    s_mul_i32 s82, s82, s81
    s_sub_u32 s80, s80, s82
    v_mov_b32 v8, s80
    v_mov_b32 v9, s81
    ds_write_b64 v3, v[8:9] offset:24
    s_nop 0
L_pskip:
    s_add_u32 s16, s16, 1
    s_add_u32 s17, s17, 34816
    s_add_u32 s18, s18, 16
    s_cmp_lt_u32 s18, 250
    s_cbranch_scc1 L_pc0
L_end:
    s_endpgm
.section .rodata,"a"
.p2align 6
.amdhsa_kernel standalone__kv_cache_quant_pre_rope_vs_post_rope__decode_kernel
  .amdhsa_next_free_vgpr 168
  .amdhsa_next_free_sgpr 96
  .amdhsa_accum_offset 168
  .amdhsa_group_segment_fixed_size 0
  .amdhsa_kernarg_size 112
  .amdhsa_user_sgpr_count 2
  .amdhsa_user_sgpr_kernarg_segment_ptr 1
  .amdhsa_system_sgpr_workgroup_id_x 1
.end_amdhsa_kernel
```

```asm
; @launch grid=(256,1,1) block=(512,1,1) lds=159168
.amdgcn_target "amdgcn-amd-amdhsa--gfx950"
.text
.globl standalone__kv_cache_quant_pre_rope_vs_post_rope__decode_kernel
.p2align 8
.type standalone__kv_cache_quant_pre_rope_vs_post_rope__decode_kernel,@function
standalone__kv_cache_quant_pre_rope_vs_post_rope__decode_kernel:
    s_cmp_ge_u32 s2, 256
    s_cbranch_scc1 L_end
    s_load_dwordx2 s[4:5], s[0:1], 8
    v_readfirstlane_b32 s76, v0
    s_and_b32 s79, s2, 7
    s_lshr_b32 s78, s2, 7
    s_lshl3_add_u32 s78, s78, s79
    s_lshr_b32 s77, s2, 3
    s_lshr_b32 s80, s77, 2
    s_and_b32 s77, s77, 3
    s_and_b32 s80, s80, 3
    s_lshl2_add_u32 s78, s78, s80
    s_cmp_lt_u32 s76, 64
    s_cbranch_scc0 L_init
    s_getpc_b64 s[26:27]
L_pc:
    s_lshl_b32 s81, s2, 6
    s_and_b32 s81, s81, 0x3e00
    v_lshl_add_u32 v5, v0, 3, s81
    v_min_u32 v5, L_end-L_pc, v5
    global_load_dword v7, v5, s[26:27]
    v_lshlrev_b32 v2, 4, v0
    s_mul_i32 s9, s77, 15728640
    s_mul_i32 s80, s78, 12288
    s_mov_b32 m0, 0
    s_add_u32 s9, s9, s80
    s_mov_b32 s6, 402653184
    s_mov_b32 s7, 0x20000
    s_movk_i32 s12, 12288
    s_waitcnt lgkmcnt(0)
L_first:
    s_waitcnt vmcnt(22)
    buffer_load_dwordx4 v2, s[4:7], s9 offen offset:0 nt lds
    buffer_load_dwordx4 v2, s[4:7], s9 offen offset:1024 nt lds
    s_waitcnt vmcnt(22)
    buffer_load_dwordx4 v2, s[4:7], s9 offen offset:2048 nt lds
    buffer_load_dwordx4 v2, s[4:7], s9 offen offset:3072 nt lds
    s_addk_i32 m0, 4096
    s_addk_i32 s9, 4096
    s_cmp_lg_u32 m0, s12
    s_cbranch_scc1 L_first
    s_addk_i32 s12, 12288
    s_add_u32 s9, s9, 774144
    s_cmp_lt_u32 m0, 36864
    s_cbranch_scc1 L_first
    s_sub_u32 s9, s9, 774144
    s_barrier
    s_load_dwordx2 s[56:57], s[0:1], 32
    s_setprio 3
    s_mul_i32 s8, s77, 12582912
    s_add_u32 s8, s8, s80
    s_mul_i32 s16, s77, 4
    s_mul_i32 s17, s77, 4
    v_mov_b32 v3, 158912
    s_waitcnt vmcnt(24)
    s_mov_b32 s10, 2
    v_mov_b32 v5, 36
    v_mov_b32 v7, 2328
    s_waitcnt lgkmcnt(0)
    s_nop 0
    s_branch L_next
L_init:
    s_load_dwordx16 s[48:63], s[0:1], 0
    s_load_dwordx8 s[64:71], s[0:1], 64
    s_load_dwordx4 s[72:75], s[0:1], 96
    s_memrealtime s[84:85]
    v_and_b32 v1, 63, v0
    s_lshr_b32 s76, s76, 4
    s_lshr_b32 s76, 0x65372104, s76
    s_and_b32 s76, s76, 7
    v_lshlrev_b32 v2, 4, v1
    v_mov_b32 v3, 158912
    v_cmp_eq_u32 vcc, 11, v1
    v_mov_b32 v5, 2328
    v_lshl_add_u32 v6, v1, 2, v3
    v_cndmask_b32 v5, 0, v5, vcc
    ds_write_b32 v6, v5
    s_waitcnt lgkmcnt(0)
    s_barrier
    s_branch L_notld
L_next:
    s_add_u32 s10, s10, 1
    s_cmp_eq_u32 m0, 110592
    s_cselect_b32 m0, 0, m0
    s_waitcnt lgkmcnt(1)
    v_readfirstlane_b32 s11, v7
    s_add_u32 s12, m0, 12288
    s_add_u32 s9, s9, 774144
    s_and_b32 s80, s10, 3
    s_cbranch_scc0 L_addr
L_aj:
    s_lshr_b32 s80, s11, 8
    s_cmp_gt_u32 s80, s10
    s_cbranch_scc0 L_full
    s_and_b32 s15, s11, 255
    s_cmp_ge_i32 s15, 24
    s_cbranch_scc1 L_t_24_36
    s_cmp_ge_i32 s15, 18
    s_cbranch_scc1 L_t_18_23
    s_cmp_ge_i32 s15, 15
    s_cbranch_scc1 L_t_15_17
    s_cmp_ge_i32 s15, 13
    s_cbranch_scc1 L_t_13_14
    s_branch L_v12
L_t_13_14:
    s_cmp_ge_i32 s15, 14
    s_cbranch_scc1 L_v14
    s_branch L_v13
L_t_15_17:
    s_cmp_ge_i32 s15, 16
    s_cbranch_scc1 L_t_16_17
    s_branch L_v15
L_t_16_17:
    s_cmp_ge_i32 s15, 17
    s_cbranch_scc1 L_v17
    s_branch L_v16
L_t_18_23:
    s_cmp_ge_i32 s15, 21
    s_cbranch_scc1 L_t_21_23
    s_cmp_ge_i32 s15, 19
    s_cbranch_scc1 L_t_19_20
    s_branch L_v18
L_t_19_20:
    s_cmp_ge_i32 s15, 20
    s_cbranch_scc1 L_v20
    s_branch L_v19
L_t_21_23:
    s_cmp_ge_i32 s15, 22
    s_cbranch_scc1 L_t_22_23
    s_branch L_v21
L_t_22_23:
    s_cmp_ge_i32 s15, 23
    s_cbranch_scc1 L_v23
    s_branch L_v22
L_t_24_36:
    s_cmp_ge_i32 s15, 30
    s_cbranch_scc1 L_t_30_36
    s_cmp_ge_i32 s15, 27
    s_cbranch_scc1 L_t_27_29
    s_cmp_ge_i32 s15, 25
    s_cbranch_scc1 L_t_25_26
    s_branch L_v24
L_t_25_26:
    s_cmp_ge_i32 s15, 26
    s_cbranch_scc1 L_v26
    s_branch L_v25
L_t_27_29:
    s_cmp_ge_i32 s15, 28
    s_cbranch_scc1 L_t_28_29
    s_branch L_v27
L_t_28_29:
    s_cmp_ge_i32 s15, 29
    s_cbranch_scc1 L_v29
    s_branch L_v28
L_t_30_36:
    s_cmp_ge_i32 s15, 33
    s_cbranch_scc1 L_t_33_36
    s_cmp_ge_i32 s15, 31
    s_cbranch_scc1 L_t_31_32
    s_branch L_v30
L_t_31_32:
    s_cmp_ge_i32 s15, 32
    s_cbranch_scc1 L_v32
    s_branch L_v31
L_t_33_36:
    s_cmp_ge_i32 s15, 35
    s_cbranch_scc1 L_t_35_36
    s_cmp_ge_i32 s15, 34
    s_cbranch_scc1 L_v34
    s_branch L_v33
L_t_35_36:
    s_cmp_ge_i32 s15, 36
    s_cbranch_scc1 L_v36
    s_branch L_v35
L_v12:
    s_waitcnt vmcnt(11)
    buffer_load_dwordx4 v2, s[4:7], s9 offen offset:0 nt lds
    s_waitcnt vmcnt(11)
    buffer_load_dwordx4 v2, s[4:7], s9 offen offset:1024 nt lds
    ds_read_b32 v7, v3 offset:44
    s_waitcnt vmcnt(11)
    buffer_load_dwordx4 v2, s[4:7], s9 offen offset:2048 nt lds
    v_subrev_u32 v6, 9, v5
    s_add_u32 m0, m0, 3072
    ds_write_b32 v3, v6 offset:16
    v_add_u32 v5, 3, v5
    s_add_u32 s9, s9, 3072
    s_cmp_lg_u32 m0, s12
    s_cbranch_scc1 L_v12
    s_branch L_next
L_v13:
    s_waitcnt vmcnt(12)
    buffer_load_dwordx4 v2, s[4:7], s9 offen offset:0 nt lds
    s_waitcnt vmcnt(12)
    buffer_load_dwordx4 v2, s[4:7], s9 offen offset:1024 nt lds
    ds_read_b32 v7, v3 offset:44
    s_waitcnt vmcnt(12)
    buffer_load_dwordx4 v2, s[4:7], s9 offen offset:2048 nt lds
    v_subrev_u32 v6, 10, v5
    s_add_u32 m0, m0, 3072
    ds_write_b32 v3, v6 offset:16
    v_add_u32 v5, 3, v5
    s_add_u32 s9, s9, 3072
    s_cmp_lg_u32 m0, s12
    s_cbranch_scc1 L_v13
    s_branch L_next
L_v14:
    s_waitcnt vmcnt(13)
    buffer_load_dwordx4 v2, s[4:7], s9 offen offset:0 nt lds
    s_waitcnt vmcnt(13)
    buffer_load_dwordx4 v2, s[4:7], s9 offen offset:1024 nt lds
    ds_read_b32 v7, v3 offset:44
    s_waitcnt vmcnt(13)
    buffer_load_dwordx4 v2, s[4:7], s9 offen offset:2048 nt lds
    v_subrev_u32 v6, 11, v5
    s_add_u32 m0, m0, 3072
    ds_write_b32 v3, v6 offset:16
    v_add_u32 v5, 3, v5
    s_add_u32 s9, s9, 3072
    s_cmp_lg_u32 m0, s12
    s_cbranch_scc1 L_v14
    s_branch L_next
L_v15:
    s_waitcnt vmcnt(14)
    buffer_load_dwordx4 v2, s[4:7], s9 offen offset:0 nt lds
    s_waitcnt vmcnt(14)
    buffer_load_dwordx4 v2, s[4:7], s9 offen offset:1024 nt lds
    ds_read_b32 v7, v3 offset:44
    s_waitcnt vmcnt(14)
    buffer_load_dwordx4 v2, s[4:7], s9 offen offset:2048 nt lds
    v_subrev_u32 v6, 12, v5
    s_add_u32 m0, m0, 3072
    ds_write_b32 v3, v6 offset:16
    v_add_u32 v5, 3, v5
    s_add_u32 s9, s9, 3072
    s_cmp_lg_u32 m0, s12
    s_cbranch_scc1 L_v15
    s_branch L_next
L_v16:
    s_waitcnt vmcnt(15)
    buffer_load_dwordx4 v2, s[4:7], s9 offen offset:0 nt lds
    s_waitcnt vmcnt(15)
    buffer_load_dwordx4 v2, s[4:7], s9 offen offset:1024 nt lds
    ds_read_b32 v7, v3 offset:44
    s_waitcnt vmcnt(15)
    buffer_load_dwordx4 v2, s[4:7], s9 offen offset:2048 nt lds
    v_subrev_u32 v6, 13, v5
    s_add_u32 m0, m0, 3072
    ds_write_b32 v3, v6 offset:16
    v_add_u32 v5, 3, v5
    s_add_u32 s9, s9, 3072
    s_cmp_lg_u32 m0, s12
    s_cbranch_scc1 L_v16
    s_branch L_next
L_v17:
    s_waitcnt vmcnt(16)
    buffer_load_dwordx4 v2, s[4:7], s9 offen offset:0 nt lds
    s_waitcnt vmcnt(16)
    buffer_load_dwordx4 v2, s[4:7], s9 offen offset:1024 nt lds
    ds_read_b32 v7, v3 offset:44
    s_waitcnt vmcnt(16)
    buffer_load_dwordx4 v2, s[4:7], s9 offen offset:2048 nt lds
    v_subrev_u32 v6, 14, v5
    s_add_u32 m0, m0, 3072
    ds_write_b32 v3, v6 offset:16
    v_add_u32 v5, 3, v5
    s_add_u32 s9, s9, 3072
    s_cmp_lg_u32 m0, s12
    s_cbranch_scc1 L_v17
    s_branch L_next
L_v18:
    s_waitcnt vmcnt(17)
    buffer_load_dwordx4 v2, s[4:7], s9 offen offset:0 nt lds
    s_waitcnt vmcnt(17)
    buffer_load_dwordx4 v2, s[4:7], s9 offen offset:1024 nt lds
    ds_read_b32 v7, v3 offset:44
    s_waitcnt vmcnt(17)
    buffer_load_dwordx4 v2, s[4:7], s9 offen offset:2048 nt lds
    v_subrev_u32 v6, 15, v5
    s_add_u32 m0, m0, 3072
    ds_write_b32 v3, v6 offset:16
    v_add_u32 v5, 3, v5
    s_add_u32 s9, s9, 3072
    s_cmp_lg_u32 m0, s12
    s_cbranch_scc1 L_v18
    s_branch L_next
L_v19:
    s_waitcnt vmcnt(18)
    buffer_load_dwordx4 v2, s[4:7], s9 offen offset:0 nt lds
    s_waitcnt vmcnt(18)
    buffer_load_dwordx4 v2, s[4:7], s9 offen offset:1024 nt lds
    ds_read_b32 v7, v3 offset:44
    s_waitcnt vmcnt(18)
    buffer_load_dwordx4 v2, s[4:7], s9 offen offset:2048 nt lds
    v_subrev_u32 v6, 16, v5
    s_add_u32 m0, m0, 3072
    ds_write_b32 v3, v6 offset:16
    v_add_u32 v5, 3, v5
    s_add_u32 s9, s9, 3072
    s_cmp_lg_u32 m0, s12
    s_cbranch_scc1 L_v19
    s_branch L_next
L_v20:
    s_waitcnt vmcnt(19)
    buffer_load_dwordx4 v2, s[4:7], s9 offen offset:0 nt lds
    s_waitcnt vmcnt(19)
    buffer_load_dwordx4 v2, s[4:7], s9 offen offset:1024 nt lds
    ds_read_b32 v7, v3 offset:44
    s_waitcnt vmcnt(19)
    buffer_load_dwordx4 v2, s[4:7], s9 offen offset:2048 nt lds
    v_subrev_u32 v6, 17, v5
    s_add_u32 m0, m0, 3072
    ds_write_b32 v3, v6 offset:16
    v_add_u32 v5, 3, v5
    s_add_u32 s9, s9, 3072
    s_cmp_lg_u32 m0, s12
    s_cbranch_scc1 L_v20
    s_branch L_next
L_v21:
    s_waitcnt vmcnt(20)
    buffer_load_dwordx4 v2, s[4:7], s9 offen offset:0 nt lds
    s_waitcnt vmcnt(20)
    buffer_load_dwordx4 v2, s[4:7], s9 offen offset:1024 nt lds
    ds_read_b32 v7, v3 offset:44
    s_waitcnt vmcnt(20)
    buffer_load_dwordx4 v2, s[4:7], s9 offen offset:2048 nt lds
    v_subrev_u32 v6, 18, v5
    s_add_u32 m0, m0, 3072
    ds_write_b32 v3, v6 offset:16
    v_add_u32 v5, 3, v5
    s_add_u32 s9, s9, 3072
    s_cmp_lg_u32 m0, s12
    s_cbranch_scc1 L_v21
    s_branch L_next
L_v22:
    s_waitcnt vmcnt(21)
    buffer_load_dwordx4 v2, s[4:7], s9 offen offset:0 nt lds
    s_waitcnt vmcnt(21)
    buffer_load_dwordx4 v2, s[4:7], s9 offen offset:1024 nt lds
    ds_read_b32 v7, v3 offset:44
    s_waitcnt vmcnt(21)
    buffer_load_dwordx4 v2, s[4:7], s9 offen offset:2048 nt lds
    v_subrev_u32 v6, 19, v5
    s_add_u32 m0, m0, 3072
    ds_write_b32 v3, v6 offset:16
    v_add_u32 v5, 3, v5
    s_add_u32 s9, s9, 3072
    s_cmp_lg_u32 m0, s12
    s_cbranch_scc1 L_v22
    s_branch L_next
L_v23:
    s_waitcnt vmcnt(22)
    buffer_load_dwordx4 v2, s[4:7], s9 offen offset:0 nt lds
    s_waitcnt vmcnt(22)
    buffer_load_dwordx4 v2, s[4:7], s9 offen offset:1024 nt lds
    ds_read_b32 v7, v3 offset:44
    s_waitcnt vmcnt(22)
    buffer_load_dwordx4 v2, s[4:7], s9 offen offset:2048 nt lds
    v_subrev_u32 v6, 20, v5
    s_add_u32 m0, m0, 3072
    ds_write_b32 v3, v6 offset:16
    v_add_u32 v5, 3, v5
    s_add_u32 s9, s9, 3072
    s_cmp_lg_u32 m0, s12
    s_cbranch_scc1 L_v23
    s_branch L_next
L_v24:
    s_waitcnt vmcnt(23)
    buffer_load_dwordx4 v2, s[4:7], s9 offen offset:0 nt lds
    s_waitcnt vmcnt(23)
    buffer_load_dwordx4 v2, s[4:7], s9 offen offset:1024 nt lds
    ds_read_b32 v7, v3 offset:44
    s_waitcnt vmcnt(23)
    buffer_load_dwordx4 v2, s[4:7], s9 offen offset:2048 nt lds
    v_subrev_u32 v6, 21, v5
    s_add_u32 m0, m0, 3072
    ds_write_b32 v3, v6 offset:16
    v_add_u32 v5, 3, v5
    s_add_u32 s9, s9, 3072
    s_cmp_lg_u32 m0, s12
    s_cbranch_scc1 L_v24
    s_branch L_next
L_v25:
    s_waitcnt vmcnt(24)
    buffer_load_dwordx4 v2, s[4:7], s9 offen offset:0 nt lds
    s_waitcnt vmcnt(24)
    buffer_load_dwordx4 v2, s[4:7], s9 offen offset:1024 nt lds
    ds_read_b32 v7, v3 offset:44
    s_waitcnt vmcnt(24)
    buffer_load_dwordx4 v2, s[4:7], s9 offen offset:2048 nt lds
    v_subrev_u32 v6, 22, v5
    s_add_u32 m0, m0, 3072
    ds_write_b32 v3, v6 offset:16
    v_add_u32 v5, 3, v5
    s_add_u32 s9, s9, 3072
    s_cmp_lg_u32 m0, s12
    s_cbranch_scc1 L_v25
    s_branch L_next
L_v26:
    s_waitcnt vmcnt(25)
    buffer_load_dwordx4 v2, s[4:7], s9 offen offset:0 nt lds
    s_waitcnt vmcnt(25)
    buffer_load_dwordx4 v2, s[4:7], s9 offen offset:1024 nt lds
    ds_read_b32 v7, v3 offset:44
    s_waitcnt vmcnt(25)
    buffer_load_dwordx4 v2, s[4:7], s9 offen offset:2048 nt lds
    v_subrev_u32 v6, 23, v5
    s_add_u32 m0, m0, 3072
    ds_write_b32 v3, v6 offset:16
    v_add_u32 v5, 3, v5
    s_add_u32 s9, s9, 3072
    s_cmp_lg_u32 m0, s12
    s_cbranch_scc1 L_v26
    s_branch L_next
L_v27:
    s_waitcnt vmcnt(26)
    buffer_load_dwordx4 v2, s[4:7], s9 offen offset:0 nt lds
    s_waitcnt vmcnt(26)
    buffer_load_dwordx4 v2, s[4:7], s9 offen offset:1024 nt lds
    ds_read_b32 v7, v3 offset:44
    s_waitcnt vmcnt(26)
    buffer_load_dwordx4 v2, s[4:7], s9 offen offset:2048 nt lds
    v_subrev_u32 v6, 24, v5
    s_add_u32 m0, m0, 3072
    ds_write_b32 v3, v6 offset:16
    v_add_u32 v5, 3, v5
    s_add_u32 s9, s9, 3072
    s_cmp_lg_u32 m0, s12
    s_cbranch_scc1 L_v27
    s_branch L_next
L_v28:
    s_waitcnt vmcnt(27)
    buffer_load_dwordx4 v2, s[4:7], s9 offen offset:0 nt lds
    s_waitcnt vmcnt(27)
    buffer_load_dwordx4 v2, s[4:7], s9 offen offset:1024 nt lds
    ds_read_b32 v7, v3 offset:44
    s_waitcnt vmcnt(27)
    buffer_load_dwordx4 v2, s[4:7], s9 offen offset:2048 nt lds
    v_subrev_u32 v6, 25, v5
    s_add_u32 m0, m0, 3072
    ds_write_b32 v3, v6 offset:16
    v_add_u32 v5, 3, v5
    s_add_u32 s9, s9, 3072
    s_cmp_lg_u32 m0, s12
    s_cbranch_scc1 L_v28
    s_branch L_next
L_v29:
    s_waitcnt vmcnt(28)
    buffer_load_dwordx4 v2, s[4:7], s9 offen offset:0 nt lds
    s_waitcnt vmcnt(28)
    buffer_load_dwordx4 v2, s[4:7], s9 offen offset:1024 nt lds
    ds_read_b32 v7, v3 offset:44
    s_waitcnt vmcnt(28)
    buffer_load_dwordx4 v2, s[4:7], s9 offen offset:2048 nt lds
    v_subrev_u32 v6, 26, v5
    s_add_u32 m0, m0, 3072
    ds_write_b32 v3, v6 offset:16
    v_add_u32 v5, 3, v5
    s_add_u32 s9, s9, 3072
    s_cmp_lg_u32 m0, s12
    s_cbranch_scc1 L_v29
    s_branch L_next
L_v30:
    s_waitcnt vmcnt(29)
    buffer_load_dwordx4 v2, s[4:7], s9 offen offset:0 nt lds
    s_waitcnt vmcnt(29)
    buffer_load_dwordx4 v2, s[4:7], s9 offen offset:1024 nt lds
    ds_read_b32 v7, v3 offset:44
    s_waitcnt vmcnt(29)
    buffer_load_dwordx4 v2, s[4:7], s9 offen offset:2048 nt lds
    v_subrev_u32 v6, 27, v5
    s_add_u32 m0, m0, 3072
    ds_write_b32 v3, v6 offset:16
    v_add_u32 v5, 3, v5
    s_add_u32 s9, s9, 3072
    s_cmp_lg_u32 m0, s12
    s_cbranch_scc1 L_v30
    s_branch L_next
L_v31:
    s_waitcnt vmcnt(30)
    buffer_load_dwordx4 v2, s[4:7], s9 offen offset:0 nt lds
    s_waitcnt vmcnt(30)
    buffer_load_dwordx4 v2, s[4:7], s9 offen offset:1024 nt lds
    ds_read_b32 v7, v3 offset:44
    s_waitcnt vmcnt(30)
    buffer_load_dwordx4 v2, s[4:7], s9 offen offset:2048 nt lds
    v_subrev_u32 v6, 28, v5
    s_add_u32 m0, m0, 3072
    ds_write_b32 v3, v6 offset:16
    v_add_u32 v5, 3, v5
    s_add_u32 s9, s9, 3072
    s_cmp_lg_u32 m0, s12
    s_cbranch_scc1 L_v31
    s_branch L_next
L_v32:
    s_waitcnt vmcnt(31)
    buffer_load_dwordx4 v2, s[4:7], s9 offen offset:0 nt lds
    s_waitcnt vmcnt(31)
    buffer_load_dwordx4 v2, s[4:7], s9 offen offset:1024 nt lds
    ds_read_b32 v7, v3 offset:44
    s_waitcnt vmcnt(31)
    buffer_load_dwordx4 v2, s[4:7], s9 offen offset:2048 nt lds
    v_subrev_u32 v6, 29, v5
    s_add_u32 m0, m0, 3072
    ds_write_b32 v3, v6 offset:16
    v_add_u32 v5, 3, v5
    s_add_u32 s9, s9, 3072
    s_cmp_lg_u32 m0, s12
    s_cbranch_scc1 L_v32
    s_branch L_next
L_v33:
    s_waitcnt vmcnt(32)
    buffer_load_dwordx4 v2, s[4:7], s9 offen offset:0 nt lds
    s_waitcnt vmcnt(32)
    buffer_load_dwordx4 v2, s[4:7], s9 offen offset:1024 nt lds
    ds_read_b32 v7, v3 offset:44
    s_waitcnt vmcnt(32)
    buffer_load_dwordx4 v2, s[4:7], s9 offen offset:2048 nt lds
    v_subrev_u32 v6, 30, v5
    s_add_u32 m0, m0, 3072
    ds_write_b32 v3, v6 offset:16
    v_add_u32 v5, 3, v5
    s_add_u32 s9, s9, 3072
    s_cmp_lg_u32 m0, s12
    s_cbranch_scc1 L_v33
    s_branch L_next
L_v34:
    s_waitcnt vmcnt(33)
    buffer_load_dwordx4 v2, s[4:7], s9 offen offset:0 nt lds
    s_waitcnt vmcnt(33)
    buffer_load_dwordx4 v2, s[4:7], s9 offen offset:1024 nt lds
    ds_read_b32 v7, v3 offset:44
    s_waitcnt vmcnt(33)
    buffer_load_dwordx4 v2, s[4:7], s9 offen offset:2048 nt lds
    v_subrev_u32 v6, 31, v5
    s_add_u32 m0, m0, 3072
    ds_write_b32 v3, v6 offset:16
    v_add_u32 v5, 3, v5
    s_add_u32 s9, s9, 3072
    s_cmp_lg_u32 m0, s12
    s_cbranch_scc1 L_v34
    s_branch L_next
L_v35:
    s_waitcnt vmcnt(34)
    buffer_load_dwordx4 v2, s[4:7], s9 offen offset:0 nt lds
    s_waitcnt vmcnt(34)
    buffer_load_dwordx4 v2, s[4:7], s9 offen offset:1024 nt lds
    ds_read_b32 v7, v3 offset:44
    s_waitcnt vmcnt(34)
    buffer_load_dwordx4 v2, s[4:7], s9 offen offset:2048 nt lds
    v_subrev_u32 v6, 32, v5
    s_add_u32 m0, m0, 3072
    ds_write_b32 v3, v6 offset:16
    v_add_u32 v5, 3, v5
    s_add_u32 s9, s9, 3072
    s_cmp_lg_u32 m0, s12
    s_cbranch_scc1 L_v35
    s_branch L_next
L_v36:
    s_waitcnt vmcnt(35)
    buffer_load_dwordx4 v2, s[4:7], s9 offen offset:0 nt lds
    s_waitcnt vmcnt(35)
    buffer_load_dwordx4 v2, s[4:7], s9 offen offset:1024 nt lds
    ds_read_b32 v7, v3 offset:44
    s_waitcnt vmcnt(35)
    buffer_load_dwordx4 v2, s[4:7], s9 offen offset:2048 nt lds
    v_subrev_u32 v6, 33, v5
    s_add_u32 m0, m0, 3072
    ds_write_b32 v3, v6 offset:16
    v_add_u32 v5, 3, v5
    s_add_u32 s9, s9, 3072
    s_cmp_lg_u32 m0, s12
    s_cbranch_scc1 L_v36
    s_branch L_next
L_full:
    ds_read_b32 v7, v3 offset:44
    s_waitcnt lgkmcnt(0)
    v_readfirstlane_b32 s11, v7
    s_nop 4
    s_branch L_aj
L_addr:
    s_cmp_lt_u32 s10, 128
    s_cbranch_scc0 L_av
    s_lshr_b32 s80, s10, 5
    s_lshl_b32 s80, s80, 2
    s_add_u32 s80, s80, s16
    s_bfe_u32 s81, s10, 0x30002
    s_bitcmp1_b32 s10, 5
    s_cselect_b32 s82, 7, 0
    s_xor_b32 s81, s81, s82
    s_branch L_ak
L_av:
    s_cmp_eq_u32 s10, 256
    s_cbranch_scc1 L_drain
    s_mov_b32 s4, s56
    s_mov_b32 s5, s57
    s_add_u32 s80, s10, s17
    s_bfe_u32 s81, s10, 0x30004
    s_xor_b32 s81, s81, 7
L_ak:
    s_and_b32 s80, s80, 15
    s_mul_i32 s80, s80, 786432
    s_mul_i32 s81, s81, 50331648
    s_add_u32 s9, s80, s81
    s_add_u32 s9, s9, s8
    s_branch L_aj
L_drain:
    v_mov_b32 v6, 3048
    s_waitcnt vmcnt(24)
    ds_write_b32 v3, v6 offset:16
    v_mov_b32 v6, 3060
    s_waitcnt vmcnt(12)
    ds_write_b32 v3, v6 offset:16
    v_mov_b32 v6, 3072
    s_waitcnt vmcnt(0)
    ds_write_b32 v3, v6 offset:16
    s_endpgm
L_notld:
    s_cmp_gt_u32 s76, 4
    s_cbranch_scc1 L_aux
    v_lshrrev_b32 v21, 4, v1
    v_and_b32 v22, 15, v1
    v_mul_u32_u24 v16, 384, v21
    v_lshl_add_u32 v16, v22, 3, v16
    v_cmp_gt_u32 vcc, 8, v22
    v_xor_b32 v17, 64, v16
    s_mul_i32 s24, s77, 4
    s_and_b32 s24, s24, 15
    s_lshl_b32 s80, s78, 2
    s_add_u32 s80, s80, s76
    s_mul_i32 s83, s80, 1536
    s_mul_i32 s16, s24, 393216
    s_add_u32 s16, s16, s83
    s_waitcnt lgkmcnt(0)
    s_mov_b32 s4, s66
    s_mov_b32 s5, s67
    s_mov_b32 s6, 6291456
    s_mov_b32 s7, 0x20000
    s_mov_b32 s8, s68
    s_mov_b32 s9, s69
    s_mov_b32 s10, 6291456
    s_mov_b32 s11, 0x20000
    buffer_load_dwordx2 v[120:121], v16, s[4:7], s16 offen offset:0
    buffer_load_dwordx2 v[126:127], v17, s[8:11], s16 offen offset:0
    buffer_load_dwordx2 v[122:123], v16, s[4:7], s16 offen offset:128
    buffer_load_dwordx2 v[128:129], v17, s[8:11], s16 offen offset:128
    buffer_load_dwordx2 v[124:125], v16, s[4:7], s16 offen offset:256
    buffer_load_dwordx2 v[130:131], v17, s[8:11], s16 offen offset:256
    s_add_u32 s16, s16, 393216
    buffer_load_dwordx2 v[132:133], v16, s[4:7], s16 offen offset:0
    buffer_load_dwordx2 v[138:139], v17, s[8:11], s16 offen offset:0
    buffer_load_dwordx2 v[134:135], v16, s[4:7], s16 offen offset:128
    buffer_load_dwordx2 v[140:141], v17, s[8:11], s16 offen offset:128
    buffer_load_dwordx2 v[136:137], v16, s[4:7], s16 offen offset:256
    buffer_load_dwordx2 v[142:143], v17, s[8:11], s16 offen offset:256
    s_add_u32 s16, s16, 393216
    buffer_load_dwordx2 v[144:145], v16, s[4:7], s16 offen offset:0
    buffer_load_dwordx2 v[150:151], v17, s[8:11], s16 offen offset:0
    buffer_load_dwordx2 v[146:147], v16, s[4:7], s16 offen offset:128
    buffer_load_dwordx2 v[152:153], v17, s[8:11], s16 offen offset:128
    buffer_load_dwordx2 v[148:149], v16, s[4:7], s16 offen offset:256
    buffer_load_dwordx2 v[154:155], v17, s[8:11], s16 offen offset:256
    s_add_u32 s16, s16, 393216
    buffer_load_dwordx2 v[156:157], v16, s[4:7], s16 offen offset:0
    buffer_load_dwordx2 v[162:163], v17, s[8:11], s16 offen offset:0
    buffer_load_dwordx2 v[158:159], v16, s[4:7], s16 offen offset:128
    buffer_load_dwordx2 v[164:165], v17, s[8:11], s16 offen offset:128
    buffer_load_dwordx2 v[160:161], v16, s[4:7], s16 offen offset:256
    buffer_load_dwordx2 v[166:167], v17, s[8:11], s16 offen offset:256
    s_add_u32 s16, s16, 393216
    s_mov_b32 s12, s74
    s_mov_b32 s13, s75
    s_mov_b32 s14, 1610612736
    s_mov_b32 s15, 0x20000
    s_mov_b32 s22, 0x05040100
    s_mov_b32 s23, 0x07060302
    s_lshl_b32 s80, s76, 2
    v_add_u32 v21, s80, v21
    v_mul_u32_u24 v5, 768, v21
    v_lshl_add_u32 v5, v22, 4, v5
    v_lshlrev_b32 v19, 3, v21
    v_add_u32 v19, 126976, v19
    v_lshlrev_b32 v18, 4, v22
    v_add_u32 v18, 151552, v18
    v_add_u32 v11, s80, v3
    v_mov_b32 v10, 0
    v_mov_b32 v23, 0xff
    s_mul_i32 s17, s76, 3
    s_add_u32 s17, s17, 3
    s_mov_b32 s18, 0
    s_mov_b32 s19, 0
    s_mov_b32 s20, 0
    s_mov_b32 s21, 0
    s_waitcnt vmcnt(18)
    v_cndmask_b32 v24, v130, v128, vcc
    v_cndmask_b32 v25, v131, v129, vcc
    v_cndmask_b32 v26, v126, v130, vcc
    v_cndmask_b32 v27, v127, v131, vcc
    v_cndmask_b32 v28, v128, v126, vcc
    v_cndmask_b32 v29, v129, v127, vcc
    v_perm_b32 v72, v24, v120, s22
    v_perm_b32 v73, v24, v120, s23
    v_perm_b32 v74, v25, v121, s22
    v_perm_b32 v75, v25, v121, s23
    v_perm_b32 v76, v26, v122, s22
    v_perm_b32 v77, v26, v122, s23
    v_perm_b32 v78, v27, v123, s22
    v_perm_b32 v79, v27, v123, s23
    v_perm_b32 v80, v28, v124, s22
    v_perm_b32 v81, v28, v124, s23
    v_perm_b32 v82, v29, v125, s22
    v_perm_b32 v83, v29, v125, s23
    s_waitcnt vmcnt(12)
    v_cndmask_b32 v24, v142, v140, vcc
    v_cndmask_b32 v25, v143, v141, vcc
    v_cndmask_b32 v26, v138, v142, vcc
    v_cndmask_b32 v27, v139, v143, vcc
    v_cndmask_b32 v28, v140, v138, vcc
    v_cndmask_b32 v29, v141, v139, vcc
    v_perm_b32 v84, v24, v132, s22
    v_perm_b32 v85, v24, v132, s23
    v_perm_b32 v86, v25, v133, s22
    v_perm_b32 v87, v25, v133, s23
    v_perm_b32 v88, v26, v134, s22
    v_perm_b32 v89, v26, v134, s23
    v_perm_b32 v90, v27, v135, s22
    v_perm_b32 v91, v27, v135, s23
    v_perm_b32 v92, v28, v136, s22
    v_perm_b32 v93, v28, v136, s23
    v_perm_b32 v94, v29, v137, s22
    v_perm_b32 v95, v29, v137, s23
    s_waitcnt vmcnt(6)
    v_cndmask_b32 v24, v154, v152, vcc
    v_cndmask_b32 v25, v155, v153, vcc
    v_cndmask_b32 v26, v150, v154, vcc
    v_cndmask_b32 v27, v151, v155, vcc
    v_cndmask_b32 v28, v152, v150, vcc
    v_cndmask_b32 v29, v153, v151, vcc
    v_perm_b32 v96, v24, v144, s22
    v_perm_b32 v97, v24, v144, s23
    v_perm_b32 v98, v25, v145, s22
    v_perm_b32 v99, v25, v145, s23
    v_perm_b32 v100, v26, v146, s22
    v_perm_b32 v101, v26, v146, s23
    v_perm_b32 v102, v27, v147, s22
    v_perm_b32 v103, v27, v147, s23
    v_perm_b32 v104, v28, v148, s22
    v_perm_b32 v105, v28, v148, s23
    v_perm_b32 v106, v29, v149, s22
    v_perm_b32 v107, v29, v149, s23
    s_waitcnt vmcnt(0)
    v_cndmask_b32 v24, v166, v164, vcc
    v_cndmask_b32 v25, v167, v165, vcc
    v_cndmask_b32 v26, v162, v166, vcc
    v_cndmask_b32 v27, v163, v167, vcc
    v_cndmask_b32 v28, v164, v162, vcc
    v_cndmask_b32 v29, v165, v163, vcc
    v_perm_b32 v108, v24, v156, s22
    v_perm_b32 v109, v24, v156, s23
    v_perm_b32 v110, v25, v157, s22
    v_perm_b32 v111, v25, v157, s23
    v_perm_b32 v112, v26, v158, s22
    v_perm_b32 v113, v26, v158, s23
    v_perm_b32 v114, v27, v159, s22
    v_perm_b32 v115, v27, v159, s23
    v_perm_b32 v116, v28, v160, s22
    v_perm_b32 v117, v28, v160, s23
    v_perm_b32 v118, v29, v161, s22
    v_perm_b32 v119, v29, v161, s23
    s_nop 1
L_kvisit:
    s_cmp_ge_u32 s16, 6291456
    s_cselect_b32 s80, 6291456, 0
    s_sub_u32 s16, s16, s80
    s_and_b32 s26, s20, 1
    s_cmp_lt_u32 s21, 3
    s_cselect_b32 s26, s26, 9
    s_bitcmp1_b32 s21, 0
    s_cselect_b32 s82, 7, 0
    s_xor_b32 s82, s82, s20
    s_mul_i32 s80, s82, 768
    v_add_u32 v6, s80, v18
    s_lshl_b32 s80, s82, 4
    s_add_u32 s80, s80, s24
    s_lshl_b32 s81, s80, 7
    v_add_u32 v8, s81, v19
    s_nop 1
L_qw:
    ds_read_b32 v4, v3 offset:32
    ds_read_b128 v[48:51], v6 offset:0
    ds_read_b128 v[52:55], v6 offset:256
    ds_read_b128 v[56:59], v6 offset:512
    s_waitcnt lgkmcnt(0)
    v_readfirstlane_b32 s80, v4
    s_nop 0
    s_cmp_gt_u32 s80, s82
    s_nop 2
    s_cbranch_scc1 L_qwg
    s_sleep 2
    s_branch L_qw
L_qwg:
    s_cmp_eq_u32 s26, 0
    s_cbranch_scc0 L_nc0
    buffer_load_dwordx2 v[60:61], v16, s[4:7], s16 offen offset:0
L_nc0:
    s_cmp_eq_u32 s26, 1
    s_cbranch_scc0 L_nd0
    buffer_load_dwordx2 v[64:65], v16, s[4:7], s16 offen offset:256
L_nd0:
    v_dot2_f32_bf16 v24, v72, v48, 0
    v_dot2_f32_bf16 v25, v73, v49, 0
    v_dot2_f32_bf16 v26, v74, v50, 0
    v_dot2_f32_bf16 v27, v75, v51, 0
    v_dot2_f32_bf16 v28, v76, v52, 0
    v_dot2_f32_bf16 v29, v77, v53, 0
    v_dot2_f32_bf16 v30, v78, v54, 0
    v_dot2_f32_bf16 v31, v79, v55, 0
    v_dot2_f32_bf16 v32, v80, v56, 0
    v_dot2_f32_bf16 v33, v81, v57, 0
    v_dot2_f32_bf16 v34, v82, v58, 0
    v_dot2_f32_bf16 v35, v83, v59, 0
    v_add_u32 v6, s19, v5
    v_pk_add_f32 v[14:15], v[24:25], v[26:27]
    v_pk_add_f32 v[14:15], v[14:15], v[28:29]
    v_pk_add_f32 v[14:15], v[14:15], v[30:31]
    v_pk_add_f32 v[14:15], v[14:15], v[32:33]
    v_pk_add_f32 v[14:15], v[14:15], v[34:35]
    s_cmp_ge_i32 s18, s17
    s_nop 0
    s_cbranch_scc1 L_kw0g
L_kw0:
    ds_read_b32 v4, v3 offset:16
    s_waitcnt lgkmcnt(0)
    v_readfirstlane_b32 s18, v4
    s_nop 0
    s_cmp_ge_i32 s18, s17
    s_nop 2
    s_cbranch_scc1 L_kw0g
    s_sleep 1
    s_branch L_kw0
L_kw0g:
    ds_read_b128 v[36:39], v6 offset:0
    ds_read_b128 v[40:43], v6 offset:256
    ds_read_b128 v[44:47], v6 offset:512
    v_add_u32 v10, 1, v10
    s_add_u32 s19, s19, 12288
    s_cmp_eq_u32 s19, 110592
    s_cselect_b32 s19, 0, s19
    s_add_u32 s17, s17, 12
    s_waitcnt lgkmcnt(2)
    v_cvt_f32_i32 v36, v36
    v_cvt_f32_i32 v37, v37
    v_cvt_f32_i32 v38, v38
    v_cvt_f32_i32 v39, v39
    v_pk_mul_f32 v[12:13], v[36:37], v[24:25]
    v_pk_fma_f32 v[12:13], v[38:39], v[26:27], v[12:13]
    s_waitcnt lgkmcnt(1)
    v_cvt_f32_i32 v40, v40
    v_cvt_f32_i32 v41, v41
    v_cvt_f32_i32 v42, v42
    v_cvt_f32_i32 v43, v43
    v_pk_fma_f32 v[12:13], v[40:41], v[28:29], v[12:13]
    v_pk_fma_f32 v[12:13], v[42:43], v[30:31], v[12:13]
    s_waitcnt lgkmcnt(0)
    v_cvt_f32_i32 v44, v44
    v_cvt_f32_i32 v45, v45
    v_cvt_f32_i32 v46, v46
    v_cvt_f32_i32 v47, v47
    v_pk_fma_f32 v[12:13], v[44:45], v[32:33], v[12:13]
    v_pk_fma_f32 v[12:13], v[46:47], v[34:35], v[12:13]
    v_add_f32 v12, v12, v13
    v_add_f32 v13, v14, v15
    s_nop 0
    v_add_f32_dpp v12, v12, v12 quad_perm:[1,0,3,2] row_mask:0xf bank_mask:0xf
    v_add_f32_dpp v13, v13, v13 quad_perm:[1,0,3,2] row_mask:0xf bank_mask:0xf
    s_nop 0
    v_add_f32_dpp v12, v12, v12 quad_perm:[2,3,0,1] row_mask:0xf bank_mask:0xf
    v_add_f32_dpp v13, v13, v13 quad_perm:[2,3,0,1] row_mask:0xf bank_mask:0xf
    s_nop 0
    v_add_f32_dpp v12, v12, v12 row_half_mirror row_mask:0xf bank_mask:0xf
    v_add_f32_dpp v13, v13, v13 row_half_mirror row_mask:0xf bank_mask:0xf
    s_nop 0
    v_add_f32_dpp v12, v12, v12 row_mirror row_mask:0xf bank_mask:0xf
    v_add_f32_dpp v13, v13, v13 row_mirror row_mask:0xf bank_mask:0xf
    ds_write_b64 v8, v[12:13] offset:0
    ds_write_b32 v11, v10
    s_cmp_eq_u32 s26, 0
    s_cbranch_scc0 L_nc1
    buffer_load_dwordx2 v[66:67], v17, s[8:11], s16 offen offset:0
L_nc1:
    s_cmp_eq_u32 s26, 1
    s_cbranch_scc0 L_nd1
    buffer_load_dwordx2 v[70:71], v17, s[8:11], s16 offen offset:256
    s_add_u32 s16, s16, 393216
L_nd1:
    v_dot2_f32_bf16 v24, v84, v48, 0
    v_dot2_f32_bf16 v25, v85, v49, 0
    v_dot2_f32_bf16 v26, v86, v50, 0
    v_dot2_f32_bf16 v27, v87, v51, 0
    v_dot2_f32_bf16 v28, v88, v52, 0
    v_dot2_f32_bf16 v29, v89, v53, 0
    v_dot2_f32_bf16 v30, v90, v54, 0
    v_dot2_f32_bf16 v31, v91, v55, 0
    v_dot2_f32_bf16 v32, v92, v56, 0
    v_dot2_f32_bf16 v33, v93, v57, 0
    v_dot2_f32_bf16 v34, v94, v58, 0
    v_dot2_f32_bf16 v35, v95, v59, 0
    v_add_u32 v6, s19, v5
    v_pk_add_f32 v[14:15], v[24:25], v[26:27]
    v_pk_add_f32 v[14:15], v[14:15], v[28:29]
    v_pk_add_f32 v[14:15], v[14:15], v[30:31]
    v_pk_add_f32 v[14:15], v[14:15], v[32:33]
    v_pk_add_f32 v[14:15], v[14:15], v[34:35]
    s_cmp_ge_i32 s18, s17
    s_nop 0
    s_cbranch_scc1 L_kw1g
L_kw1:
    ds_read_b32 v4, v3 offset:16
    s_waitcnt lgkmcnt(0)
    v_readfirstlane_b32 s18, v4
    s_nop 0
    s_cmp_ge_i32 s18, s17
    s_nop 2
    s_cbranch_scc1 L_kw1g
    s_sleep 1
    s_branch L_kw1
L_kw1g:
    ds_read_b128 v[36:39], v6 offset:0
    ds_read_b128 v[40:43], v6 offset:256
    ds_read_b128 v[44:47], v6 offset:512
    v_add_u32 v10, 1, v10
    s_add_u32 s19, s19, 12288
    s_cmp_eq_u32 s19, 110592
    s_cselect_b32 s19, 0, s19
    s_add_u32 s17, s17, 12
    s_waitcnt lgkmcnt(2)
    v_cvt_f32_i32 v36, v36
    v_cvt_f32_i32 v37, v37
    v_cvt_f32_i32 v38, v38
    v_cvt_f32_i32 v39, v39
    v_pk_mul_f32 v[12:13], v[36:37], v[24:25]
    v_pk_fma_f32 v[12:13], v[38:39], v[26:27], v[12:13]
    s_waitcnt lgkmcnt(1)
    v_cvt_f32_i32 v40, v40
    v_cvt_f32_i32 v41, v41
    v_cvt_f32_i32 v42, v42
    v_cvt_f32_i32 v43, v43
    v_pk_fma_f32 v[12:13], v[40:41], v[28:29], v[12:13]
    v_pk_fma_f32 v[12:13], v[42:43], v[30:31], v[12:13]
    s_waitcnt lgkmcnt(0)
    v_cvt_f32_i32 v44, v44
    v_cvt_f32_i32 v45, v45
    v_cvt_f32_i32 v46, v46
    v_cvt_f32_i32 v47, v47
    v_pk_fma_f32 v[12:13], v[44:45], v[32:33], v[12:13]
    v_pk_fma_f32 v[12:13], v[46:47], v[34:35], v[12:13]
    v_add_f32 v12, v12, v13
    v_add_f32 v13, v14, v15
    s_nop 0
    v_add_f32_dpp v12, v12, v12 quad_perm:[1,0,3,2] row_mask:0xf bank_mask:0xf
    v_add_f32_dpp v13, v13, v13 quad_perm:[1,0,3,2] row_mask:0xf bank_mask:0xf
    s_nop 0
    v_add_f32_dpp v12, v12, v12 quad_perm:[2,3,0,1] row_mask:0xf bank_mask:0xf
    v_add_f32_dpp v13, v13, v13 quad_perm:[2,3,0,1] row_mask:0xf bank_mask:0xf
    s_nop 0
    v_add_f32_dpp v12, v12, v12 row_half_mirror row_mask:0xf bank_mask:0xf
    v_add_f32_dpp v13, v13, v13 row_half_mirror row_mask:0xf bank_mask:0xf
    s_nop 0
    v_add_f32_dpp v12, v12, v12 row_mirror row_mask:0xf bank_mask:0xf
    v_add_f32_dpp v13, v13, v13 row_mirror row_mask:0xf bank_mask:0xf
    ds_write_b64 v8, v[12:13] offset:128
    ds_write_b32 v11, v10
    s_cmp_eq_u32 s26, 0
    s_cbranch_scc0 L_nc2
    buffer_load_dwordx2 v[62:63], v16, s[4:7], s16 offen offset:128
L_nc2:
    v_dot2_f32_bf16 v24, v96, v48, 0
    v_dot2_f32_bf16 v25, v97, v49, 0
    v_dot2_f32_bf16 v26, v98, v50, 0
    v_dot2_f32_bf16 v27, v99, v51, 0
    v_dot2_f32_bf16 v28, v100, v52, 0
    v_dot2_f32_bf16 v29, v101, v53, 0
    v_dot2_f32_bf16 v30, v102, v54, 0
    v_dot2_f32_bf16 v31, v103, v55, 0
    v_dot2_f32_bf16 v32, v104, v56, 0
    v_dot2_f32_bf16 v33, v105, v57, 0
    v_dot2_f32_bf16 v34, v106, v58, 0
    v_dot2_f32_bf16 v35, v107, v59, 0
    v_add_u32 v6, s19, v5
    v_pk_add_f32 v[14:15], v[24:25], v[26:27]
    v_pk_add_f32 v[14:15], v[14:15], v[28:29]
    v_pk_add_f32 v[14:15], v[14:15], v[30:31]
    v_pk_add_f32 v[14:15], v[14:15], v[32:33]
    v_pk_add_f32 v[14:15], v[14:15], v[34:35]
    s_cmp_ge_i32 s18, s17
    s_nop 0
    s_cbranch_scc1 L_kw2g
L_kw2:
    ds_read_b32 v4, v3 offset:16
    s_waitcnt lgkmcnt(0)
    v_readfirstlane_b32 s18, v4
    s_nop 0
    s_cmp_ge_i32 s18, s17
    s_nop 2
    s_cbranch_scc1 L_kw2g
    s_sleep 1
    s_branch L_kw2
L_kw2g:
    ds_read_b128 v[36:39], v6 offset:0
    ds_read_b128 v[40:43], v6 offset:256
    ds_read_b128 v[44:47], v6 offset:512
    v_add_u32 v10, 1, v10
    s_add_u32 s19, s19, 12288
    s_cmp_eq_u32 s19, 110592
    s_cselect_b32 s19, 0, s19
    s_add_u32 s17, s17, 12
    s_waitcnt lgkmcnt(2)
    v_cvt_f32_i32 v36, v36
    v_cvt_f32_i32 v37, v37
    v_cvt_f32_i32 v38, v38
    v_cvt_f32_i32 v39, v39
    v_pk_mul_f32 v[12:13], v[36:37], v[24:25]
    v_pk_fma_f32 v[12:13], v[38:39], v[26:27], v[12:13]
    s_waitcnt lgkmcnt(1)
    v_cvt_f32_i32 v40, v40
    v_cvt_f32_i32 v41, v41
    v_cvt_f32_i32 v42, v42
    v_cvt_f32_i32 v43, v43
    v_pk_fma_f32 v[12:13], v[40:41], v[28:29], v[12:13]
    v_pk_fma_f32 v[12:13], v[42:43], v[30:31], v[12:13]
    s_waitcnt lgkmcnt(0)
    v_cvt_f32_i32 v44, v44
    v_cvt_f32_i32 v45, v45
    v_cvt_f32_i32 v46, v46
    v_cvt_f32_i32 v47, v47
    v_pk_fma_f32 v[12:13], v[44:45], v[32:33], v[12:13]
    v_pk_fma_f32 v[12:13], v[46:47], v[34:35], v[12:13]
    v_add_f32 v12, v12, v13
    v_add_f32 v13, v14, v15
    s_nop 0
    v_add_f32_dpp v12, v12, v12 quad_perm:[1,0,3,2] row_mask:0xf bank_mask:0xf
    v_add_f32_dpp v13, v13, v13 quad_perm:[1,0,3,2] row_mask:0xf bank_mask:0xf
    s_nop 0
    v_add_f32_dpp v12, v12, v12 quad_perm:[2,3,0,1] row_mask:0xf bank_mask:0xf
    v_add_f32_dpp v13, v13, v13 quad_perm:[2,3,0,1] row_mask:0xf bank_mask:0xf
    s_nop 0
    v_add_f32_dpp v12, v12, v12 row_half_mirror row_mask:0xf bank_mask:0xf
    v_add_f32_dpp v13, v13, v13 row_half_mirror row_mask:0xf bank_mask:0xf
    s_nop 0
    v_add_f32_dpp v12, v12, v12 row_mirror row_mask:0xf bank_mask:0xf
    v_add_f32_dpp v13, v13, v13 row_mirror row_mask:0xf bank_mask:0xf
    ds_write_b64 v8, v[12:13] offset:256
    ds_write_b32 v11, v10
    s_cmp_eq_u32 s26, 0
    s_cbranch_scc0 L_nc3
    buffer_load_dwordx2 v[68:69], v17, s[8:11], s16 offen offset:128
L_nc3:
    v_dot2_f32_bf16 v24, v108, v48, 0
    v_dot2_f32_bf16 v25, v109, v49, 0
    v_dot2_f32_bf16 v26, v110, v50, 0
    v_dot2_f32_bf16 v27, v111, v51, 0
    v_dot2_f32_bf16 v28, v112, v52, 0
    v_dot2_f32_bf16 v29, v113, v53, 0
    v_dot2_f32_bf16 v30, v114, v54, 0
    v_dot2_f32_bf16 v31, v115, v55, 0
    v_dot2_f32_bf16 v32, v116, v56, 0
    v_dot2_f32_bf16 v33, v117, v57, 0
    v_dot2_f32_bf16 v34, v118, v58, 0
    v_dot2_f32_bf16 v35, v119, v59, 0
    v_add_u32 v6, s19, v5
    v_pk_add_f32 v[14:15], v[24:25], v[26:27]
    v_pk_add_f32 v[14:15], v[14:15], v[28:29]
    v_pk_add_f32 v[14:15], v[14:15], v[30:31]
    v_pk_add_f32 v[14:15], v[14:15], v[32:33]
    v_pk_add_f32 v[14:15], v[14:15], v[34:35]
    s_cmp_ge_i32 s18, s17
    s_nop 0
    s_cbranch_scc1 L_kw3g
L_kw3:
    ds_read_b32 v4, v3 offset:16
    s_waitcnt lgkmcnt(0)
    v_readfirstlane_b32 s18, v4
    s_nop 0
    s_cmp_ge_i32 s18, s17
    s_nop 2
    s_cbranch_scc1 L_kw3g
    s_sleep 1
    s_branch L_kw3
L_kw3g:
    ds_read_b128 v[36:39], v6 offset:0
    ds_read_b128 v[40:43], v6 offset:256
    ds_read_b128 v[44:47], v6 offset:512
    v_add_u32 v10, 1, v10
    s_add_u32 s19, s19, 12288
    s_cmp_eq_u32 s19, 110592
    s_cselect_b32 s19, 0, s19
    s_add_u32 s17, s17, 12
    s_waitcnt lgkmcnt(2)
    v_cvt_f32_i32 v36, v36
    v_cvt_f32_i32 v37, v37
    v_cvt_f32_i32 v38, v38
    v_cvt_f32_i32 v39, v39
    v_pk_mul_f32 v[12:13], v[36:37], v[24:25]
    v_pk_fma_f32 v[12:13], v[38:39], v[26:27], v[12:13]
    s_waitcnt lgkmcnt(1)
    v_cvt_f32_i32 v40, v40
    v_cvt_f32_i32 v41, v41
    v_cvt_f32_i32 v42, v42
    v_cvt_f32_i32 v43, v43
    v_pk_fma_f32 v[12:13], v[40:41], v[28:29], v[12:13]
    v_pk_fma_f32 v[12:13], v[42:43], v[30:31], v[12:13]
    s_waitcnt lgkmcnt(0)
    v_cvt_f32_i32 v44, v44
    v_cvt_f32_i32 v45, v45
    v_cvt_f32_i32 v46, v46
    v_cvt_f32_i32 v47, v47
    v_pk_fma_f32 v[12:13], v[44:45], v[32:33], v[12:13]
    v_pk_fma_f32 v[12:13], v[46:47], v[34:35], v[12:13]
    v_add_f32 v12, v12, v13
    v_add_f32 v13, v14, v15
    s_nop 0
    v_add_f32_dpp v12, v12, v12 quad_perm:[1,0,3,2] row_mask:0xf bank_mask:0xf
    v_add_f32_dpp v13, v13, v13 quad_perm:[1,0,3,2] row_mask:0xf bank_mask:0xf
    s_nop 0
    v_add_f32_dpp v12, v12, v12 quad_perm:[2,3,0,1] row_mask:0xf bank_mask:0xf
    v_add_f32_dpp v13, v13, v13 quad_perm:[2,3,0,1] row_mask:0xf bank_mask:0xf
    s_nop 0
    v_add_f32_dpp v12, v12, v12 row_half_mirror row_mask:0xf bank_mask:0xf
    v_add_f32_dpp v13, v13, v13 row_half_mirror row_mask:0xf bank_mask:0xf
    s_nop 0
    v_add_f32_dpp v12, v12, v12 row_mirror row_mask:0xf bank_mask:0xf
    v_add_f32_dpp v13, v13, v13 row_mirror row_mask:0xf bank_mask:0xf
    ds_write_b64 v8, v[12:13] offset:384
    ds_write_b32 v11, v10
    s_add_u32 s20, s20, 1
    s_and_b32 s80, s20, 1
    s_cbranch_scc1 L_kvisit
    v_mov_b64 v[120:121], v[132:133]
    v_mov_b64 v[122:123], v[134:135]
    v_mov_b64 v[124:125], v[136:137]
    v_mov_b64 v[126:127], v[138:139]
    v_mov_b64 v[128:129], v[140:141]
    v_mov_b64 v[130:131], v[142:143]
    v_mov_b64 v[132:133], v[144:145]
    v_mov_b64 v[134:135], v[146:147]
    v_mov_b64 v[136:137], v[148:149]
    v_mov_b64 v[138:139], v[150:151]
    v_mov_b64 v[140:141], v[152:153]
    v_mov_b64 v[142:143], v[154:155]
    v_mov_b64 v[144:145], v[156:157]
    v_mov_b64 v[146:147], v[158:159]
    v_mov_b64 v[148:149], v[160:161]
    v_mov_b64 v[150:151], v[162:163]
    v_mov_b64 v[152:153], v[164:165]
    v_mov_b64 v[154:155], v[166:167]
    s_waitcnt vmcnt(0)
    v_cndmask_b32 v24, v70, v68, vcc
    v_cndmask_b32 v25, v71, v69, vcc
    v_cndmask_b32 v26, v66, v70, vcc
    v_cndmask_b32 v27, v67, v71, vcc
    v_cndmask_b32 v28, v68, v66, vcc
    v_cndmask_b32 v29, v69, v67, vcc
    v_perm_b32 v156, v24, v60, s22
    v_perm_b32 v157, v24, v60, s23
    v_perm_b32 v158, v25, v61, s22
    v_perm_b32 v159, v25, v61, s23
    v_perm_b32 v160, v26, v62, s22
    v_perm_b32 v161, v26, v62, s23
    v_perm_b32 v162, v27, v63, s22
    v_perm_b32 v163, v27, v63, s23
    v_perm_b32 v164, v28, v64, s22
    v_perm_b32 v165, v28, v64, s23
    v_perm_b32 v166, v29, v65, s22
    v_perm_b32 v167, v29, v65, s23
    s_cmp_lt_u32 s20, 8
    s_nop 0
    s_cbranch_scc1 L_kvisit
    v_mov_b64 v[72:73], v[120:121]
    v_mov_b64 v[74:75], v[122:123]
    v_mov_b64 v[76:77], v[124:125]
    v_mov_b64 v[78:79], v[126:127]
    v_mov_b64 v[80:81], v[128:129]
    v_mov_b64 v[82:83], v[130:131]
    v_mov_b64 v[84:85], v[132:133]
    v_mov_b64 v[86:87], v[134:135]
    v_mov_b64 v[88:89], v[136:137]
    v_mov_b64 v[90:91], v[138:139]
    v_mov_b64 v[92:93], v[140:141]
    v_mov_b64 v[94:95], v[142:143]
    v_mov_b64 v[96:97], v[144:145]
    v_mov_b64 v[98:99], v[146:147]
    v_mov_b64 v[100:101], v[148:149]
    v_mov_b64 v[102:103], v[150:151]
    v_mov_b64 v[104:105], v[152:153]
    v_mov_b64 v[106:107], v[154:155]
    v_mov_b64 v[108:109], v[156:157]
    v_mov_b64 v[110:111], v[158:159]
    v_mov_b64 v[112:113], v[160:161]
    v_mov_b64 v[114:115], v[162:163]
    v_mov_b64 v[116:117], v[164:165]
    v_mov_b64 v[118:119], v[166:167]
    s_mov_b32 s20, 0
    s_add_u32 s24, s24, 4
    s_and_b32 s24, s24, 15
    s_add_u32 s21, s21, 1
    s_cmp_lt_u32 s21, 4
    s_cbranch_scc1 L_kvisit
    v_lshrrev_b32 v21, 2, v1
    v_and_b32 v22, 3, v1
    v_mul_u32_u24 v5, 768, v21
    v_lshl_add_u32 v5, v22, 4, v5
    s_mul_i32 s80, s76, 192
    v_add_u32 v5, s80, v5
    v_lshlrev_b32 v19, 3, v21
    v_add_u32 v19, 126976, v19
    v_lshrrev_b32 v21, 4, v1
    v_lshl_add_u32 v7, v21, 2, v22
    v_and_b32 v21, 1, v7
    v_lshlrev_b32 v7, 4, v7
    s_lshl_b32 s80, s76, 8
    v_add_u32 v7, s80, v7
    v_lshlrev_b32 v18, 3, v21
    v_add_u32 v18, 157696, v18
    v_add_u32 v16, 143360, v7
    s_mov_b32 s32, 0x000f000f
    s_mov_b32 s33, 0x000f000f
    s_mov_b32 s17, 1548
    s_mul_i32 s24, s77, 4
    s_and_b32 s24, s24, 15
    s_mov_b32 s20, 0
    s_add_u32 s25, s77, 0
    s_mul_i32 s25, s25, 64
    s_add_u32 s25, s25, s78
    s_lshl_b32 s25, s25, 10
L_vhead:
    v_mov_b64 v[24:25], 0
    v_mov_b64 v[26:27], 0
    v_mov_b64 v[28:29], 0
    v_mov_b64 v[30:31], 0
    v_mov_b64 v[32:33], 0
    v_mov_b64 v[34:35], 0
    s_mov_b32 s21, 0
    s_nop 0
L_pw:
    ds_read_b64 v[36:37], v3 offset:32
    ds_read_b32 v4, v3 offset:40
    ds_read_b64 v[14:15], v18
    s_waitcnt lgkmcnt(0)
    v_readfirstlane_b32 s80, v37
    v_readfirstlane_b32 s28, v4
    s_cmp_gt_u32 s80, s20
    s_nop 3
    s_cbranch_scc1 L_pwg
    s_sleep 2
    s_branch L_pw
L_pwg:
    s_lshr_b32 s29, s28, 8
    s_lshr_b32 s30, s28, 16
L_vstep:
    s_xor_b32 s80, s20, 7
    s_lshl_b32 s80, s80, 4
    s_add_u32 s80, s80, s24
    s_lshl_b32 s80, s80, 7
    v_add_u32 v8, s80, v19
    v_add_u32 v6, s19, v5
    ds_read_b32 v12, v8
    s_cmp_ge_i32 s18, s17
    s_cbranch_scc1 L_vwg
L_vw:
    ds_read_b32 v4, v3 offset:16
    s_waitcnt lgkmcnt(0)
    v_readfirstlane_b32 s18, v4
    s_nop 0
    s_cmp_ge_i32 s18, s17
    s_nop 2
    s_cbranch_scc1 L_vwg
    s_sleep 1
    s_branch L_vw
L_vwg:
    ds_read_b128 v[36:39], v6 offset:0
    ds_read_b128 v[40:43], v6 offset:64
    ds_read_b128 v[44:47], v6 offset:128
    v_add_u32 v10, 1, v10
    s_add_u32 s19, s19, 12288
    s_cmp_eq_u32 s19, 110592
    s_cselect_b32 s19, 0, s19
    s_add_u32 s17, s17, 12
    s_add_u32 s24, s24, 1
    s_and_b32 s24, s24, 15
    s_add_u32 s21, s21, 1
    s_cmp_lt_u32 s21, 16
    s_waitcnt lgkmcnt(2)
    v_cvt_f32_i32 v36, v36
    v_cvt_f32_i32 v37, v37
    v_cvt_f32_i32 v38, v38
    v_cvt_f32_i32 v39, v39
    v_pk_fma_f32 v[24:25], v[36:37], v[12:13], v[24:25] op_sel_hi:[1,0,1]
    v_pk_fma_f32 v[26:27], v[38:39], v[12:13], v[26:27] op_sel_hi:[1,0,1]
    s_waitcnt lgkmcnt(1)
    v_cvt_f32_i32 v40, v40
    v_cvt_f32_i32 v41, v41
    v_cvt_f32_i32 v42, v42
    v_cvt_f32_i32 v43, v43
    v_pk_fma_f32 v[28:29], v[40:41], v[12:13], v[28:29] op_sel_hi:[1,0,1]
    v_pk_fma_f32 v[30:31], v[42:43], v[12:13], v[30:31] op_sel_hi:[1,0,1]
    s_waitcnt lgkmcnt(0)
    v_cvt_f32_i32 v44, v44
    v_cvt_f32_i32 v45, v45
    v_cvt_f32_i32 v46, v46
    v_cvt_f32_i32 v47, v47
    v_pk_fma_f32 v[32:33], v[44:45], v[12:13], v[32:33] op_sel_hi:[1,0,1]
    v_pk_fma_f32 v[34:35], v[46:47], v[12:13], v[34:35] op_sel_hi:[1,0,1]
    s_nop 1
    s_cbranch_scc0 L_vend
    ds_write_b32 v11, v10
    s_branch L_vstep
L_vend:
    v_permlane32_swap_b32 v24, v26
    v_permlane32_swap_b32 v25, v27
    v_permlane32_swap_b32 v28, v30
    v_permlane32_swap_b32 v29, v31
    v_permlane32_swap_b32 v32, v34
    v_permlane32_swap_b32 v33, v35
    v_pk_add_f32 v[24:25], v[24:25], v[26:27]
    v_pk_add_f32 v[28:29], v[28:29], v[30:31]
    v_pk_add_f32 v[32:33], v[32:33], v[34:35]
    v_permlane16_swap_b32 v24, v25
    v_permlane16_swap_b32 v28, v29
    v_permlane16_swap_b32 v32, v33
    v_add_f32 v36, v24, v25
    v_add_f32 v37, v28, v29
    v_add_f32 v38, v32, v33
    v_mov_b32 v39, v14
    v_add_f32_dpp v36, v36, v36 row_ror:4 row_mask:0xf bank_mask:0xf
    v_add_f32_dpp v37, v37, v37 row_ror:4 row_mask:0xf bank_mask:0xf
    v_add_f32_dpp v38, v38, v38 row_ror:4 row_mask:0xf bank_mask:0xf
    v_add_f32_dpp v36, v36, v36 row_ror:8 row_mask:0xf bank_mask:0xf
    v_add_f32_dpp v37, v37, v37 row_ror:8 row_mask:0xf bank_mask:0xf
    v_add_f32_dpp v38, v38, v38 row_ror:8 row_mask:0xf bank_mask:0xf
    v_sub_f32 v36, v36, v15
    v_sub_f32 v37, v37, v15
    v_sub_f32 v38, v38, v15
    v_bfi_b32 v36, v23, s28, v36
    v_bfi_b32 v37, v23, s29, v37
    v_bfi_b32 v38, v23, s30, v38
    s_add_u32 s20, s20, 1
    s_cmp_eq_u32 s20, 8
    s_mov_b64 exec, s[32:33]
    s_cbranch_scc1 L_vlast
    ds_write_b128 v16, v[36:39]
    s_mov_b64 exec, -1
    ds_write_b32 v11, v10
    v_add_u32 v16, 1024, v16
    v_add_u32 v18, 16, v18
    s_nop 1
    s_branch L_vhead
L_vlast:
    buffer_store_dwordx4 v[36:39], v7, s[12:15], s25 offen sc0 sc1
    s_endpgm
    s_nop 0
L_aux:
    s_cmp_eq_u32 s76, 5
    s_cbranch_scc0 L_pacer
    v_lshlrev_b32 v5, 3, v1
    v_cmp_gt_u32 vcc, 24, v1
    v_mov_b32 v13, 0xffffff40
    v_mov_b32 v10, 192
    v_cndmask_b32 v13, v13, v10, vcc
    v_add_u32 v6, v5, v13
    v_mov_b32 v10, 0x80008000
    v_cndmask_b32 v7, 0, v10, vcc
    v_lshrrev_b32 v10, 1, v1
    v_and_b32 v11, 15, v10
    v_lshrrev_b32 v10, 4, v10
    v_mul_u32_u24 v10, 131072, v10
    v_mul_u32_u24 v11, 2048, v11
    v_add_u32 v10, v10, v11
    v_and_b32 v11, 1, v1
    v_lshl_add_u32 v17, v11, 4, v10
    v_add_u32 v10, 0, v1
    v_mul_u32_u24 v12, 2731, v10
    v_lshrrev_b32 v12, 16, v12
    v_mul_u32_u24 v12, 1152, v12
    v_lshl_add_u32 v56, v10, 4, v12
    v_add_u32 v10, 64, v1
    v_mul_u32_u24 v12, 2731, v10
    v_lshrrev_b32 v12, 16, v12
    v_mul_u32_u24 v12, 1152, v12
    v_lshl_add_u32 v57, v10, 4, v12
    v_add_u32 v10, 128, v1
    v_mul_u32_u24 v12, 2731, v10
    v_lshrrev_b32 v12, 16, v12
    v_mul_u32_u24 v12, 1152, v12
    v_lshl_add_u32 v58, v10, 4, v12
    v_cmp_eq_u32 s[32:33], 0, v11
    s_lshl_b32 s27, s77, 15
    s_lshl_b32 s80, s78, 5
    s_add_u32 s27, s27, s80
    s_mov_b32 m0, 143360
    s_waitcnt lgkmcnt(0)
    s_mov_b32 s4, s62
    s_mov_b32 s5, s63
    s_mov_b32 s6, 384
    s_mov_b32 s7, 0x20000
    s_mov_b32 s20, s64
    s_mov_b32 s21, s65
    s_mov_b32 s22, 384
    s_mov_b32 s23, 0x20000
    buffer_load_dwordx2 v[28:29], v5, s[4:7], 0 offen
    buffer_load_dwordx2 v[30:31], v5, s[20:23], 0 offen
    s_mov_b32 s4, s48
    s_mov_b32 s5, s49
    s_mov_b32 s6, 12288
    s_mov_b32 s7, 0x20000
    s_mul_i32 s80, s77, 384
    buffer_load_dwordx4 v56, s[4:7], s80 offen lds
    s_add_u32 m0, m0, 1024
    s_nop 0
    buffer_load_dwordx4 v57, s[4:7], s80 offen lds
    s_add_u32 m0, m0, 1024
    s_nop 0
    buffer_load_dwordx4 v58, s[4:7], s80 offen lds
    s_add_u32 m0, m0, 1024
    s_and_b32 s80, s78, 3
    s_lshl_b32 s80, s80, 3
    v_lshrrev_b32 v10, 3, v1
    v_add_u32 v10, s80, v10
    v_and_b32 v11, 15, v10
    v_lshrrev_b32 v10, 4, v10
    v_mul_u32_u24 v10, 131072, v10
    v_mul_u32_u24 v11, 2048, v11
    v_add_u32 v10, v10, v11
    v_and_b32 v11, 7, v1
    v_lshl_add_u32 v62, v11, 4, v10
    s_mov_b32 s20, s52
    s_mov_b32 s21, s53
    s_mov_b32 s22, 1048576
    s_mov_b32 s23, 0x20000
    s_andn2_b32 s80, s27, 127
    buffer_load_dwordx4 v[64:67], v62, s[20:23], s80 offen
    s_add_u32 s80, s80, 262144
    buffer_load_dwordx4 v[64:67], v62, s[20:23], s80 offen
    s_add_u32 s80, s80, 262144
    buffer_load_dwordx4 v[64:67], v62, s[20:23], s80 offen
    s_add_u32 s80, s80, 262144
    buffer_load_dwordx4 v[64:67], v62, s[20:23], s80 offen
    s_add_u32 s80, s80, 262144
    s_mov_b32 s20, s54
    s_mov_b32 s21, s55
    s_mov_b32 s22, 1048576
    s_mov_b32 s23, 0x20000
    s_andn2_b32 s80, s27, 127
    buffer_load_dwordx4 v[64:67], v62, s[20:23], s80 offen
    s_add_u32 s80, s80, 262144
    buffer_load_dwordx4 v[64:67], v62, s[20:23], s80 offen
    s_add_u32 s80, s80, 262144
    buffer_load_dwordx4 v[64:67], v62, s[20:23], s80 offen
    s_add_u32 s80, s80, 262144
    buffer_load_dwordx4 v[64:67], v62, s[20:23], s80 offen
    s_add_u32 s80, s80, 262144
    s_mov_b32 s20, s58
    s_mov_b32 s21, s59
    s_mov_b32 s22, 1048576
    s_mov_b32 s23, 0x20000
    s_andn2_b32 s80, s27, 127
    buffer_load_dwordx4 v[64:67], v62, s[20:23], s80 offen
    s_add_u32 s80, s80, 262144
    buffer_load_dwordx4 v[64:67], v62, s[20:23], s80 offen
    s_add_u32 s80, s80, 262144
    buffer_load_dwordx4 v[64:67], v62, s[20:23], s80 offen
    s_add_u32 s80, s80, 262144
    buffer_load_dwordx4 v[64:67], v62, s[20:23], s80 offen
    s_add_u32 s80, s80, 262144
    s_mov_b32 s20, s60
    s_mov_b32 s21, s61
    s_mov_b32 s22, 1048576
    s_mov_b32 s23, 0x20000
    s_andn2_b32 s80, s27, 127
    buffer_load_dwordx4 v[64:67], v62, s[20:23], s80 offen
    s_add_u32 s80, s80, 262144
    buffer_load_dwordx4 v[64:67], v62, s[20:23], s80 offen
    s_add_u32 s80, s80, 262144
    buffer_load_dwordx4 v[64:67], v62, s[20:23], s80 offen
    s_add_u32 s80, s80, 262144
    buffer_load_dwordx4 v[64:67], v62, s[20:23], s80 offen
    s_add_u32 s80, s80, 262144
    s_mov_b32 s12, s74
    s_mov_b32 s13, s75
    s_mov_b32 s14, 1610612736
    s_mov_b32 s15, 0x20000
    s_mov_b32 s8, s72
    s_mov_b32 s9, s73
    s_mov_b32 s10, 256
    s_mov_b32 s11, 0x20000
    s_mov_b32 s16, s70
    s_mov_b32 s17, s71
    s_mov_b32 s18, 12288
    s_mov_b32 s19, 0x20000
    v_mov_b32 v14, 0xff
    v_add_u32 v15, 143360, v5
    v_add_u32 v16, 143360, v6
    v_lshlrev_b32 v8, 1, v5
    v_lshlrev_b32 v9, 1, v6
    v_add_u32 v8, 151552, v8
    v_add_u32 v9, 151552, v9
    v_mov_b32 v12, 0
    s_mov_b32 s24, 0
    s_waitcnt vmcnt(19)
    v_xor_b32 v30, v30, v7
    v_xor_b32 v31, v31, v7
    v_lshlrev_b32 v32, 16, v28
    v_and_b32 v33, 0xffff0000, v28
    v_lshlrev_b32 v34, 16, v29
    v_and_b32 v35, 0xffff0000, v29
    v_lshlrev_b32 v36, 16, v30
    v_and_b32 v37, 0xffff0000, v30
    v_lshlrev_b32 v38, 16, v31
    v_and_b32 v39, 0xffff0000, v31
    v_and_b32 v7, 0x80000000, v7
    s_waitcnt vmcnt(16)
    s_mov_b32 exec_hi, 0xffff
L_hq:
    ds_read_b64 v[20:21], v15
    ds_read_b64 v[22:23], v16
    v_add_u32 v15, 384, v15
    v_add_u32 v16, 384, v16
    v_add_u32 v12, 1, v12
    s_waitcnt lgkmcnt(0)
    v_lshlrev_b32 v40, 16, v20
    v_and_b32 v41, 0xffff0000, v20
    v_lshlrev_b32 v42, 16, v21
    v_and_b32 v43, 0xffff0000, v21
    v_lshlrev_b32 v44, 16, v22
    v_and_b32 v45, 0xffff0000, v22
    v_lshlrev_b32 v46, 16, v23
    v_and_b32 v47, 0xffff0000, v23
    v_pk_mul_f32 v[40:41], v[40:41], v[32:33]
    v_pk_mul_f32 v[44:45], v[44:45], v[36:37]
    v_pk_mul_f32 v[42:43], v[42:43], v[34:35]
    v_pk_mul_f32 v[46:47], v[46:47], v[38:39]
    v_cvt_pk_bf16_f32 v40, v40, v44
    v_cvt_pk_bf16_f32 v41, v41, v45
    v_cvt_pk_bf16_f32 v42, v42, v46
    v_cvt_pk_bf16_f32 v43, v43, v47
    v_and_b32 v44, 0xffff0000, v40
    v_lshlrev_b32 v40, 16, v40
    v_and_b32 v45, 0xffff0000, v41
    v_lshlrev_b32 v41, 16, v41
    v_and_b32 v46, 0xffff0000, v42
    v_lshlrev_b32 v42, 16, v42
    v_and_b32 v47, 0xffff0000, v43
    v_lshlrev_b32 v43, 16, v43
    v_pk_add_f32 v[40:41], v[40:41], v[44:45]
    v_pk_add_f32 v[42:43], v[42:43], v[46:47]
    v_cvt_pk_bf16_f32 v48, v40, v40
    v_cvt_pk_bf16_f32 v49, v41, v41
    v_cvt_pk_bf16_f32 v50, v42, v42
    v_cvt_pk_bf16_f32 v51, v43, v43
    v_xor_b32 v48, v48, v7
    v_xor_b32 v49, v49, v7
    v_xor_b32 v50, v50, v7
    v_xor_b32 v51, v51, v7
    ds_write_b16 v8, v48 offset:0
    ds_write_b16_d16_hi v9, v48 offset:2
    ds_write_b16 v8, v49 offset:4
    ds_write_b16_d16_hi v9, v49 offset:6
    ds_write_b16 v8, v50 offset:8
    ds_write_b16_d16_hi v9, v50 offset:10
    ds_write_b16 v8, v51 offset:12
    ds_write_b16_d16_hi v9, v51 offset:14
    ds_write_b32 v3, v12 offset:32
    v_add_u32 v8, 768, v8
    v_add_u32 v9, 768, v9
    s_add_u32 s24, s24, 1
    s_cmp_lt_u32 s24, 8
    s_cbranch_scc1 L_hq
    s_mov_b32 exec_hi, -1
    s_add_u32 s80, s77, 0
    s_mul_i32 s80, s80, 64
    s_add_u32 s80, s80, s78
    s_lshl_b32 s80, s80, 10
    buffer_load_dwordx4 v[64:67], v2, s[12:15], s80 offen
    s_add_u32 s80, s80, 262144
    v_mov_b32 v15, 0
    s_mov_b32 s25, 0
    s_cmp_eq_u32 s2, 0
    s_cbranch_scc1 L_epc
L_epw:
    s_sleep 16
    ds_read_b32 v4, v3 offset:20
    s_waitcnt lgkmcnt(0)
    v_readfirstlane_b32 s80, v4
    s_nop 0
    s_cmp_lt_i32 s80, 16
    s_nop 2
    s_cbranch_scc1 L_epw
    s_load_dword s28, s[72:73], 0
    s_waitcnt lgkmcnt(0)
    s_cmp_lg_u32 s28, 0
    s_cbranch_scc1 L_epd
L_ep:
    s_mov_b64 exec, 1
    buffer_load_dword v11, v15, s[8:11], 0 offen sc0 sc1
    s_waitcnt vmcnt(0)
    v_readfirstlane_b32 s28, v11
    s_mov_b64 exec, -1
    s_cmp_lg_u32 s28, 0
    s_nop 2
    s_cbranch_scc1 L_epd
    s_sleep 32
    s_add_u32 s25, s25, 1
    s_cmp_lt_u32 s25, 8
    s_cbranch_scc1 L_ep
L_epc:
    s_mul_i32 s28, s84, 0x9e3779b1
    s_lshr_b32 s81, s28, 15
    s_xor_b32 s28, s28, s81
    s_mul_i32 s28, s28, 0x85ebca6b
    s_lshr_b32 s81, s28, 13
    s_xor_b32 s28, s28, s81
    s_max_u32 s28, s28, 1
    v_mov_b32 v20, s28
    v_mov_b32 v21, 0
    s_mov_b64 exec, 1
    buffer_atomic_cmpswap v[20:21], v15, s[8:11], 0 offen sc0 sc1
    s_waitcnt vmcnt(0)
    v_readfirstlane_b32 s80, v20
    s_mov_b64 exec, -1
    s_cmp_eq_u32 s80, 0
    s_cselect_b32 s28, s28, s80
    s_nop 1
L_epd:
    v_mov_b32 v12, s28
    ds_write_b32 v3, v12 offset:40
    s_lshr_b32 s29, s28, 8
    s_lshr_b32 s30, s28, 16
    s_lshr_b32 s31, s28, 24
    s_add_u32 s24, s77, 16
    s_mov_b32 s25, 0
    s_mov_b32 s20, s52
    s_mov_b32 s21, s53
    s_mov_b32 s22, 1048576
    s_mov_b32 s23, 0x20000
L_sc:
    s_sleep 16
    ds_read_b32 v4, v3 offset:20
    s_waitcnt lgkmcnt(0)
    v_readfirstlane_b32 s80, v4
    s_nop 0
    s_cmp_lt_i32 s80, s24
    s_nop 2
    s_cbranch_scc1 L_sc
    s_lshr_b32 s80, s78, 2
    s_add_u32 s80, s80, s25
    s_and_b32 s80, s80, 15
    s_lshl_b32 s81, s80, 10
    s_add_u32 m0, s81, 110592
    s_mov_b64 s[20:21], s[52:53]
    s_cmp_ge_u32 s80, 4
    s_cselect_b64 s[20:21], s[54:55], s[20:21]
    s_cmp_ge_u32 s80, 8
    s_cselect_b64 s[20:21], s[58:59], s[20:21]
    s_cmp_ge_u32 s80, 12
    s_cselect_b64 s[20:21], s[60:61], s[20:21]
    s_and_b32 s80, s80, 3
    s_mul_i32 s80, s80, 262144
    s_add_u32 s80, s80, s27
    buffer_load_dwordx4 v17, s[20:23], s80 offen  lds
    s_add_u32 s25, s25, 1
    s_add_u32 s24, s24, 4
    s_cmp_lt_u32 s25, 16
    s_cbranch_scc1 L_sc
    s_waitcnt vmcnt(0)
    v_mov_b32 v28, 0
    v_mov_b32 v29, 0
    v_mov_b32 v30, 0
    v_mov_b32 v31, 0
    v_mov_b32 v32, 0
    v_mov_b32 v33, 0
    v_mov_b32 v34, 0
    v_mov_b32 v35, 0
    v_mov_b32 v36, 0
    v_mov_b32 v37, 0
    v_mov_b32 v38, 0
    v_mov_b32 v39, 0
    v_mov_b32 v40, 0
    v_mov_b32 v41, 0
    v_mov_b32 v42, 0
    v_mov_b32 v43, 0
    v_mov_b32 v44, 0
    v_mov_b32 v45, 0
    v_mov_b32 v46, 0
    v_mov_b32 v47, 0
    v_mov_b32 v48, 0
    v_mov_b32 v49, 0
    v_mov_b32 v50, 0
    v_mov_b32 v51, 0
    v_mov_b32 v64, 0
    v_mov_b32 v65, 0
    v_mov_b32 v66, 0
    v_mov_b32 v67, 0
    v_mov_b32 v68, 0
    v_mov_b32 v69, 0
    v_mov_b32 v70, 0
    v_mov_b32 v71, 0
    v_lshlrev_b32 v15, 3, v1
    v_add_u32 v15, 141312, v15
    v_lshlrev_b32 v16, 1, v1
    v_add_u32 v16, 114176, v16
    v_mov_b32 v8, 157696
    v_mov_b32 v9, 0
    s_mov_b32 s24, 100
    s_nop 0
L_hp:
    s_sleep 8
    ds_read_b128 v[56:59], v3
    s_waitcnt lgkmcnt(0)
    v_min3_i32 v56, v56, v57, v58
    v_min_i32 v56, v56, v59
    s_nop 0
    v_readfirstlane_b32 s80, v56
    s_nop 0
    s_cmp_lt_i32 s80, s24
    s_nop 2
    s_cbranch_scc1 L_hp
    ds_read_b64 v[72:73], v15 offset:0
    ds_read_u16_d16_hi v28, v16 offset:0
    ds_read_u16_d16_hi v64, v16 offset:4096
    ds_read_b64 v[74:75], v15 offset:512
    ds_read_u16_d16_hi v29, v16 offset:128
    ds_read_u16_d16_hi v65, v16 offset:4224
    ds_read_b64 v[76:77], v15 offset:1024
    ds_read_u16_d16_hi v30, v16 offset:256
    ds_read_u16_d16_hi v66, v16 offset:4352
    ds_read_b64 v[78:79], v15 offset:1536
    ds_read_u16_d16_hi v31, v16 offset:384
    ds_read_u16_d16_hi v67, v16 offset:4480
    s_waitcnt lgkmcnt(0)
    ds_read_u16_d16_hi v36, v16 offset:8192
    ds_read_u16_d16_hi v44, v16 offset:12288
    ds_read_u16_d16_hi v37, v16 offset:8320
    ds_read_u16_d16_hi v45, v16 offset:12416
    ds_read_u16_d16_hi v38, v16 offset:8448
    ds_read_u16_d16_hi v46, v16 offset:12544
    ds_read_u16_d16_hi v39, v16 offset:8576
    ds_read_u16_d16_hi v47, v16 offset:12672
    v_fma_f32 v20, -v64, v73, v72
    v_fma_f32 v21, -v65, v75, v74
    v_fma_f32 v22, -v66, v77, v76
    v_fma_f32 v23, -v67, v79, v78
    v_mul_f32 v20, v20, v28
    v_mul_f32 v21, v21, v29
    v_mul_f32 v22, v22, v30
    v_mul_f32 v23, v23, v31
    v_mul_f32 v20, 0x3dd53b95, v20
    v_mul_f32 v21, 0x3dd53b95, v21
    v_mul_f32 v22, 0x3dd53b95, v22
    v_mul_f32 v23, 0x3dd53b95, v23
    v_mov_b32 v52, v20
    v_max_f32 v52, v52, v21
    v_max_f32 v52, v52, v22
    v_max_f32 v52, v52, v23
    s_nop 1
    v_max_f32_dpp v52, v52, v52 quad_perm:[1,0,3,2] row_mask:0xf bank_mask:0xf
    s_nop 1
    v_max_f32_dpp v52, v52, v52 quad_perm:[2,3,0,1] row_mask:0xf bank_mask:0xf
    s_nop 1
    v_max_f32_dpp v52, v52, v52 row_half_mirror row_mask:0xf bank_mask:0xf
    s_nop 1
    v_max_f32_dpp v52, v52, v52 row_mirror row_mask:0xf bank_mask:0xf
    v_mov_b32 v13, v52
    s_nop 1
    v_permlane32_swap_b32 v52, v13
    v_max_f32 v52, v52, v13
    v_mov_b32 v13, v52
    s_nop 1
    v_permlane16_swap_b32 v52, v13
    v_max_f32 v52, v52, v13
    v_sub_f32 v20, v20, v52
    v_sub_f32 v21, v21, v52
    v_sub_f32 v22, v22, v52
    v_sub_f32 v23, v23, v52
    v_exp_f32 v20, v20
    v_exp_f32 v21, v21
    v_exp_f32 v22, v22
    v_exp_f32 v23, v23
    v_mov_b32 v54, v20
    v_add_f32 v54, v54, v21
    v_add_f32 v54, v54, v22
    v_add_f32 v54, v54, v23
    s_waitcnt lgkmcnt(0)
    v_mul_f32 v20, v20, v36
    v_mul_f32 v21, v21, v37
    v_mul_f32 v22, v22, v38
    v_mul_f32 v23, v23, v39
    v_mul_f32 v53, v20, v44
    v_fmac_f32 v53, v21, v45
    v_fmac_f32 v53, v22, v46
    v_fmac_f32 v53, v23, v47
    ds_write_b32 v15, v20 offset:0
    ds_write_b32 v15, v21 offset:512
    ds_write_b32 v15, v22 offset:1024
    ds_write_b32 v15, v23 offset:1536
    v_add_f32_dpp v54, v54, v54 quad_perm:[1,0,3,2] row_mask:0xf bank_mask:0xf
    s_nop 1
    v_add_f32_dpp v54, v54, v54 quad_perm:[2,3,0,1] row_mask:0xf bank_mask:0xf
    s_nop 1
    v_add_f32_dpp v54, v54, v54 row_half_mirror row_mask:0xf bank_mask:0xf
    s_nop 1
    v_add_f32_dpp v54, v54, v54 row_mirror row_mask:0xf bank_mask:0xf
    v_mov_b32 v13, v54
    s_nop 1
    v_permlane32_swap_b32 v54, v13
    v_add_f32 v54, v54, v13
    v_mov_b32 v13, v54
    s_nop 1
    v_permlane16_swap_b32 v54, v13
    v_add_f32 v54, v54, v13
    v_add_f32_dpp v53, v53, v53 quad_perm:[1,0,3,2] row_mask:0xf bank_mask:0xf
    s_nop 1
    v_add_f32_dpp v53, v53, v53 quad_perm:[2,3,0,1] row_mask:0xf bank_mask:0xf
    s_nop 1
    v_add_f32_dpp v53, v53, v53 row_half_mirror row_mask:0xf bank_mask:0xf
    s_nop 1
    v_add_f32_dpp v53, v53, v53 row_mirror row_mask:0xf bank_mask:0xf
    v_mov_b32 v13, v53
    s_nop 1
    v_permlane32_swap_b32 v53, v13
    v_add_f32 v53, v53, v13
    v_mov_b32 v13, v53
    s_nop 1
    v_permlane16_swap_b32 v53, v13
    v_add_f32 v53, v53, v13
    v_bfi_b32 v54, v14, s31, v54
    v_mov_b32 v55, v53
    v_add_u32 v9, 1, v9
    s_mov_b64 exec, 1
    ds_write_b128 v8, v[52:55]
    ds_write_b32 v3, v9 offset:36
    s_mov_b64 exec, -1
    v_add_u32 v15, -2048, v15
    v_add_u32 v16, -512, v16
    v_add_u32 v8, 16, v8
    s_add_u32 s24, s24, 4
    s_cmp_le_u32 s24, 128
    s_cbranch_scc1 L_hp
    s_add_u32 s26, s77, 28
    s_mul_i32 s26, s26, 64
    s_add_u32 s26, s26, s78
    s_lshl_b32 s26, s26, 10
    s_lshr_b32 s34, s2, 3
    s_and_b32 s35, s2, 7
    v_lshrrev_b32 v10, 3, v1
    v_and_b32 v16, 7, v1
    v_lshlrev_b32 v10, 10, v10
    v_lshl_add_u32 v15, v16, 4, v10
    v_lshrrev_b32 v10, 2, v16
    v_and_b32 v16, 3, v16
    v_lshl_add_u32 v16, v16, 2, v10
    v_lshlrev_b32 v16, 1, v16
    v_bfe_u32 v10, v1, 4, 1
    v_lshl_add_u32 v16, v10, 6, v16
    v_lshrrev_b32 v10, 5, v1
    v_lshl_add_u32 v16, v10, 5, v16
    s_mov_b32 s25, 0
    s_mov_b32 s38, 0
    s_mul_i32 s36, s34, 65536
    s_lshl_b32 s83, s35, 7
    s_add_u32 s36, s36, s83
    s_mul_i32 s37, s34, 384
    s_lshr_b32 s83, s35, 1
    s_mul_i32 s83, s83, 96
    s_add_u32 s37, s37, s83
    s_and_b32 s83, s35, 1
    s_lshl_b32 s83, s83, 2
    s_add_u32 s37, s37, s83
    s_mov_b32 s40, s74
    s_mov_b32 s41, s75
    s_mov_b32 s42, 1610612736
    s_mov_b32 s43, 0x20000
    s_mov_b32 s16, s70
    s_mov_b32 s17, s71
    s_mov_b32 s18, 12288
    s_mov_b32 s19, 0x20000
    v_add_u32 v13, 143360, v2
    s_nop 1
L_hf:
    s_sleep 32
    ds_read_b128 v[56:59], v3
    s_waitcnt lgkmcnt(0)
    v_min3_i32 v56, v56, v57, v58
    v_min_i32 v56, v56, v59
    s_nop 0
    v_readfirstlane_b32 s80, v56
    s_nop 0
    s_cmp_lt_i32 s80, 240
    s_nop 2
    s_cbranch_scc1 L_hf
    ds_read_b128 v[140:143], v13 offset:0
    ds_read_b128 v[144:147], v13 offset:1024
    ds_read_b128 v[148:151], v13 offset:2048
    ds_read_b128 v[152:155], v13 offset:3072
    ds_read_b128 v[156:159], v13 offset:4096
    ds_read_b128 v[160:163], v13 offset:5120
    ds_read_b128 v[164:167], v13 offset:6144
L_hn:
    s_sleep 2
    ds_read_b32 v4, v3 offset:16
    s_waitcnt lgkmcnt(0)
    v_readfirstlane_b32 s80, v4
    s_nop 0
    s_cmp_lt_i32 s80, 3042
    s_nop 2
    s_cbranch_scc1 L_hn
    buffer_store_dwordx4 v[140:143], v2, s[12:15], s26 offen sc0 sc1
    s_sub_u32 s26, s26, 262144
    buffer_store_dwordx4 v[144:147], v2, s[12:15], s26 offen sc0 sc1
    s_sub_u32 s26, s26, 262144
    buffer_store_dwordx4 v[148:151], v2, s[12:15], s26 offen sc0 sc1
    s_sub_u32 s26, s26, 262144
    buffer_store_dwordx4 v[152:155], v2, s[12:15], s26 offen sc0 sc1
    s_sub_u32 s26, s26, 262144
    buffer_store_dwordx4 v[156:159], v2, s[12:15], s26 offen sc0 sc1
    s_sub_u32 s26, s26, 262144
    buffer_store_dwordx4 v[160:163], v2, s[12:15], s26 offen sc0 sc1
    s_sub_u32 s26, s26, 262144
    buffer_store_dwordx4 v[164:167], v2, s[12:15], s26 offen sc0 sc1
    s_sub_u32 s26, s26, 262144
    s_nop 0
L_hl:
    s_sleep 1
    ds_read_b32 v4, v3 offset:16
    s_waitcnt lgkmcnt(0)
    v_readfirstlane_b32 s80, v4
    s_nop 0
    s_cmp_lt_i32 s80, 3072
    s_nop 2
    s_cbranch_scc1 L_hl
    s_mov_b32 s80, s36
    buffer_load_dwordx4 v[44:47], v15, s[40:43], s80 offen sc0 sc1
    s_add_u32 s80, s80, 8192
    buffer_load_dwordx4 v[48:51], v15, s[40:43], s80 offen sc0 sc1
    s_add_u32 s80, s80, 8192
    buffer_load_dwordx4 v[52:55], v15, s[40:43], s80 offen sc0 sc1
    s_add_u32 s80, s80, 8192
    buffer_load_dwordx4 v[56:59], v15, s[40:43], s80 offen sc0 sc1
    s_add_u32 s80, s80, 8192
    buffer_load_dwordx4 v[60:63], v15, s[40:43], s80 offen sc0 sc1
    s_add_u32 s80, s80, 8192
    buffer_load_dwordx4 v[64:67], v15, s[40:43], s80 offen sc0 sc1
    s_add_u32 s80, s80, 8192
    buffer_load_dwordx4 v[68:71], v15, s[40:43], s80 offen sc0 sc1
    s_add_u32 s80, s80, 8192
    buffer_load_dwordx4 v[72:75], v15, s[40:43], s80 offen sc0 sc1
    s_waitcnt vmcnt(7)
    v_xor_b32 v12, s28, v44
    v_bitop3_b32 v12, v12, v45, s29 bitop3:0xf6
    v_bitop3_b32 v12, v12, v46, s30 bitop3:0xf6
    v_xor_b32 v13, s31, v47
    s_waitcnt vmcnt(6)
    v_bitop3_b32 v12, v12, v48, s28 bitop3:0xf6
    v_bitop3_b32 v12, v12, v49, s29 bitop3:0xf6
    v_bitop3_b32 v12, v12, v50, s30 bitop3:0xf6
    v_bitop3_b32 v13, v13, v51, s31 bitop3:0xf6
    s_waitcnt vmcnt(5)
    v_bitop3_b32 v12, v12, v52, s28 bitop3:0xf6
    v_bitop3_b32 v12, v12, v53, s29 bitop3:0xf6
    v_bitop3_b32 v12, v12, v54, s30 bitop3:0xf6
    v_bitop3_b32 v13, v13, v55, s31 bitop3:0xf6
    s_waitcnt vmcnt(4)
    v_bitop3_b32 v12, v12, v56, s28 bitop3:0xf6
    v_bitop3_b32 v12, v12, v57, s29 bitop3:0xf6
    v_bitop3_b32 v12, v12, v58, s30 bitop3:0xf6
    v_bitop3_b32 v13, v13, v59, s31 bitop3:0xf6
    s_waitcnt vmcnt(3)
    v_bitop3_b32 v12, v12, v60, s28 bitop3:0xf6
    v_bitop3_b32 v12, v12, v61, s29 bitop3:0xf6
    v_bitop3_b32 v12, v12, v62, s30 bitop3:0xf6
    v_bitop3_b32 v13, v13, v63, s31 bitop3:0xf6
    s_waitcnt vmcnt(2)
    v_bitop3_b32 v12, v12, v64, s28 bitop3:0xf6
    v_bitop3_b32 v12, v12, v65, s29 bitop3:0xf6
    v_bitop3_b32 v12, v12, v66, s30 bitop3:0xf6
    v_bitop3_b32 v13, v13, v67, s31 bitop3:0xf6
    s_waitcnt vmcnt(1)
    v_bitop3_b32 v12, v12, v68, s28 bitop3:0xf6
    v_bitop3_b32 v12, v12, v69, s29 bitop3:0xf6
    v_bitop3_b32 v12, v12, v70, s30 bitop3:0xf6
    v_bitop3_b32 v13, v13, v71, s31 bitop3:0xf6
    s_waitcnt vmcnt(0)
    v_bitop3_b32 v12, v12, v72, s28 bitop3:0xf6
    v_bitop3_b32 v12, v12, v73, s29 bitop3:0xf6
    v_bitop3_b32 v12, v12, v74, s30 bitop3:0xf6
    v_bitop3_b32 v13, v13, v75, s31 bitop3:0xf6
    v_cndmask_b32 v13, v13, 0, s[32:33]
    v_bitop3_b32 v12, v12, v13, v14 bitop3:0xa8
    v_cmp_ne_u32 vcc, 0, v12
    s_nop 4
    s_cbranch_vccz L_ok0
    s_mov_b32 s80, s36
    buffer_load_dwordx4 v[44:47], v15, s[40:43], s80 offen sc0 sc1
    s_add_u32 s80, s80, 8192
    buffer_load_dwordx4 v[48:51], v15, s[40:43], s80 offen sc0 sc1
    s_add_u32 s80, s80, 8192
    buffer_load_dwordx4 v[52:55], v15, s[40:43], s80 offen sc0 sc1
    s_add_u32 s80, s80, 8192
    buffer_load_dwordx4 v[56:59], v15, s[40:43], s80 offen sc0 sc1
    s_add_u32 s80, s80, 8192
    buffer_load_dwordx4 v[60:63], v15, s[40:43], s80 offen sc0 sc1
    s_add_u32 s80, s80, 8192
    buffer_load_dwordx4 v[64:67], v15, s[40:43], s80 offen sc0 sc1
    s_add_u32 s80, s80, 8192
    buffer_load_dwordx4 v[68:71], v15, s[40:43], s80 offen sc0 sc1
    s_add_u32 s80, s80, 8192
    buffer_load_dwordx4 v[72:75], v15, s[40:43], s80 offen sc0 sc1
    s_sleep 6
L_try:
    s_mov_b32 s80, s36
    buffer_load_dwordx4 v[76:79], v15, s[40:43], s80 offen sc0 sc1
    s_add_u32 s80, s80, 8192
    buffer_load_dwordx4 v[80:83], v15, s[40:43], s80 offen sc0 sc1
    s_add_u32 s80, s80, 8192
    buffer_load_dwordx4 v[84:87], v15, s[40:43], s80 offen sc0 sc1
    s_add_u32 s80, s80, 8192
    buffer_load_dwordx4 v[88:91], v15, s[40:43], s80 offen sc0 sc1
    s_add_u32 s80, s80, 8192
    buffer_load_dwordx4 v[92:95], v15, s[40:43], s80 offen sc0 sc1
    s_add_u32 s80, s80, 8192
    buffer_load_dwordx4 v[96:99], v15, s[40:43], s80 offen sc0 sc1
    s_add_u32 s80, s80, 8192
    buffer_load_dwordx4 v[100:103], v15, s[40:43], s80 offen sc0 sc1
    s_add_u32 s80, s80, 8192
    buffer_load_dwordx4 v[104:107], v15, s[40:43], s80 offen sc0 sc1
    s_waitcnt vmcnt(15)
    v_xor_b32 v12, s28, v44
    v_bitop3_b32 v12, v12, v45, s29 bitop3:0xf6
    v_bitop3_b32 v12, v12, v46, s30 bitop3:0xf6
    v_xor_b32 v13, s31, v47
    s_waitcnt vmcnt(14)
    v_bitop3_b32 v12, v12, v48, s28 bitop3:0xf6
    v_bitop3_b32 v12, v12, v49, s29 bitop3:0xf6
    v_bitop3_b32 v12, v12, v50, s30 bitop3:0xf6
    v_bitop3_b32 v13, v13, v51, s31 bitop3:0xf6
    s_waitcnt vmcnt(13)
    v_bitop3_b32 v12, v12, v52, s28 bitop3:0xf6
    v_bitop3_b32 v12, v12, v53, s29 bitop3:0xf6
    v_bitop3_b32 v12, v12, v54, s30 bitop3:0xf6
    v_bitop3_b32 v13, v13, v55, s31 bitop3:0xf6
    s_waitcnt vmcnt(12)
    v_bitop3_b32 v12, v12, v56, s28 bitop3:0xf6
    v_bitop3_b32 v12, v12, v57, s29 bitop3:0xf6
    v_bitop3_b32 v12, v12, v58, s30 bitop3:0xf6
    v_bitop3_b32 v13, v13, v59, s31 bitop3:0xf6
    s_waitcnt vmcnt(11)
    v_bitop3_b32 v12, v12, v60, s28 bitop3:0xf6
    v_bitop3_b32 v12, v12, v61, s29 bitop3:0xf6
    v_bitop3_b32 v12, v12, v62, s30 bitop3:0xf6
    v_bitop3_b32 v13, v13, v63, s31 bitop3:0xf6
    s_waitcnt vmcnt(10)
    v_bitop3_b32 v12, v12, v64, s28 bitop3:0xf6
    v_bitop3_b32 v12, v12, v65, s29 bitop3:0xf6
    v_bitop3_b32 v12, v12, v66, s30 bitop3:0xf6
    v_bitop3_b32 v13, v13, v67, s31 bitop3:0xf6
    s_waitcnt vmcnt(9)
    v_bitop3_b32 v12, v12, v68, s28 bitop3:0xf6
    v_bitop3_b32 v12, v12, v69, s29 bitop3:0xf6
    v_bitop3_b32 v12, v12, v70, s30 bitop3:0xf6
    v_bitop3_b32 v13, v13, v71, s31 bitop3:0xf6
    s_waitcnt vmcnt(8)
    v_bitop3_b32 v12, v12, v72, s28 bitop3:0xf6
    v_bitop3_b32 v12, v12, v73, s29 bitop3:0xf6
    v_bitop3_b32 v12, v12, v74, s30 bitop3:0xf6
    v_bitop3_b32 v13, v13, v75, s31 bitop3:0xf6
    v_cndmask_b32 v13, v13, 0, s[32:33]
    v_bitop3_b32 v12, v12, v13, v14 bitop3:0xa8
    v_cmp_ne_u32 vcc, 0, v12
    s_nop 4
    s_cbranch_vccz L_ok0
    s_mov_b32 s80, s36
    buffer_load_dwordx4 v[44:47], v15, s[40:43], s80 offen sc0 sc1
    s_add_u32 s80, s80, 8192
    buffer_load_dwordx4 v[48:51], v15, s[40:43], s80 offen sc0 sc1
    s_add_u32 s80, s80, 8192
    buffer_load_dwordx4 v[52:55], v15, s[40:43], s80 offen sc0 sc1
    s_add_u32 s80, s80, 8192
    buffer_load_dwordx4 v[56:59], v15, s[40:43], s80 offen sc0 sc1
    s_add_u32 s80, s80, 8192
    buffer_load_dwordx4 v[60:63], v15, s[40:43], s80 offen sc0 sc1
    s_add_u32 s80, s80, 8192
    buffer_load_dwordx4 v[64:67], v15, s[40:43], s80 offen sc0 sc1
    s_add_u32 s80, s80, 8192
    buffer_load_dwordx4 v[68:71], v15, s[40:43], s80 offen sc0 sc1
    s_add_u32 s80, s80, 8192
    buffer_load_dwordx4 v[72:75], v15, s[40:43], s80 offen sc0 sc1
    s_waitcnt vmcnt(15)
    v_xor_b32 v12, s28, v76
    v_bitop3_b32 v12, v12, v77, s29 bitop3:0xf6
    v_bitop3_b32 v12, v12, v78, s30 bitop3:0xf6
    v_xor_b32 v13, s31, v79
    s_waitcnt vmcnt(14)
    v_bitop3_b32 v12, v12, v80, s28 bitop3:0xf6
    v_bitop3_b32 v12, v12, v81, s29 bitop3:0xf6
    v_bitop3_b32 v12, v12, v82, s30 bitop3:0xf6
    v_bitop3_b32 v13, v13, v83, s31 bitop3:0xf6
    s_waitcnt vmcnt(13)
    v_bitop3_b32 v12, v12, v84, s28 bitop3:0xf6
    v_bitop3_b32 v12, v12, v85, s29 bitop3:0xf6
    v_bitop3_b32 v12, v12, v86, s30 bitop3:0xf6
    v_bitop3_b32 v13, v13, v87, s31 bitop3:0xf6
    s_waitcnt vmcnt(12)
    v_bitop3_b32 v12, v12, v88, s28 bitop3:0xf6
    v_bitop3_b32 v12, v12, v89, s29 bitop3:0xf6
    v_bitop3_b32 v12, v12, v90, s30 bitop3:0xf6
    v_bitop3_b32 v13, v13, v91, s31 bitop3:0xf6
    s_waitcnt vmcnt(11)
    v_bitop3_b32 v12, v12, v92, s28 bitop3:0xf6
    v_bitop3_b32 v12, v12, v93, s29 bitop3:0xf6
    v_bitop3_b32 v12, v12, v94, s30 bitop3:0xf6
    v_bitop3_b32 v13, v13, v95, s31 bitop3:0xf6
    s_waitcnt vmcnt(10)
    v_bitop3_b32 v12, v12, v96, s28 bitop3:0xf6
    v_bitop3_b32 v12, v12, v97, s29 bitop3:0xf6
    v_bitop3_b32 v12, v12, v98, s30 bitop3:0xf6
    v_bitop3_b32 v13, v13, v99, s31 bitop3:0xf6
    s_waitcnt vmcnt(9)
    v_bitop3_b32 v12, v12, v100, s28 bitop3:0xf6
    v_bitop3_b32 v12, v12, v101, s29 bitop3:0xf6
    v_bitop3_b32 v12, v12, v102, s30 bitop3:0xf6
    v_bitop3_b32 v13, v13, v103, s31 bitop3:0xf6
    s_waitcnt vmcnt(8)
    v_bitop3_b32 v12, v12, v104, s28 bitop3:0xf6
    v_bitop3_b32 v12, v12, v105, s29 bitop3:0xf6
    v_bitop3_b32 v12, v12, v106, s30 bitop3:0xf6
    v_bitop3_b32 v13, v13, v107, s31 bitop3:0xf6
    v_cndmask_b32 v13, v13, 0, s[32:33]
    v_bitop3_b32 v12, v12, v13, v14 bitop3:0xa8
    v_cmp_ne_u32 vcc, 0, v12
    s_nop 4
    s_cbranch_vccz L_ok1
    s_add_u32 s25, s25, 1
    s_cmp_lt_u32 s25, 2000000
    s_cbranch_scc1 L_try
L_ok1:
    v_max_f32 v11, v79, v83
    v_max3_f32 v11, v11, v87, v91
    v_max3_f32 v11, v11, v95, v99
    v_max3_f32 v11, v11, v103, v107
    s_nop 1
    v_max_f32_dpp v11, v11, v11 row_ror:8 row_mask:0xf bank_mask:0xf
    v_mov_b32 v13, v11
    s_nop 1
    v_permlane32_swap_b32 v11, v13
    v_max_f32 v11, v11, v13
    v_mov_b32 v13, v11
    s_nop 1
    v_permlane16_swap_b32 v11, v13
    v_max_f32 v11, v11, v13
    s_nop 1
    v_mov_b32_dpp v11, v11 quad_perm:[0,0,2,2] row_mask:0xf bank_mask:0xf
    s_nop 1
    v_sub_f32_dpp v20, v79, v11 quad_perm:[0,0,2,2] row_mask:0xf bank_mask:0xf
    v_sub_f32_dpp v21, v83, v11 quad_perm:[0,0,2,2] row_mask:0xf bank_mask:0xf
    v_sub_f32_dpp v22, v87, v11 quad_perm:[0,0,2,2] row_mask:0xf bank_mask:0xf
    v_sub_f32_dpp v23, v91, v11 quad_perm:[0,0,2,2] row_mask:0xf bank_mask:0xf
    v_sub_f32_dpp v24, v95, v11 quad_perm:[0,0,2,2] row_mask:0xf bank_mask:0xf
    v_sub_f32_dpp v25, v99, v11 quad_perm:[0,0,2,2] row_mask:0xf bank_mask:0xf
    v_sub_f32_dpp v26, v103, v11 quad_perm:[0,0,2,2] row_mask:0xf bank_mask:0xf
    v_sub_f32_dpp v27, v107, v11 quad_perm:[0,0,2,2] row_mask:0xf bank_mask:0xf
    v_exp_f32 v20, v20
    v_exp_f32 v21, v21
    v_exp_f32 v22, v22
    v_exp_f32 v23, v23
    v_exp_f32 v24, v24
    v_exp_f32 v25, v25
    v_exp_f32 v26, v26
    v_exp_f32 v27, v27
    v_pk_mul_f32 v[40:41], v[76:77], v[20:21] op_sel:[0,0] op_sel_hi:[1,0]
    v_pk_mul_f32 v[42:43], v[78:79], v[20:21] op_sel:[0,0] op_sel_hi:[1,0]
    v_pk_fma_f32 v[40:41], v[80:81], v[20:21], v[40:41] op_sel:[0,1,0] op_sel_hi:[1,1,1]
    v_pk_fma_f32 v[42:43], v[82:83], v[20:21], v[42:43] op_sel:[0,1,0] op_sel_hi:[1,1,1]
    v_pk_fma_f32 v[40:41], v[84:85], v[22:23], v[40:41] op_sel:[0,0,0] op_sel_hi:[1,0,1]
    v_pk_fma_f32 v[42:43], v[86:87], v[22:23], v[42:43] op_sel:[0,0,0] op_sel_hi:[1,0,1]
    v_pk_fma_f32 v[40:41], v[88:89], v[22:23], v[40:41] op_sel:[0,1,0] op_sel_hi:[1,1,1]
    v_pk_fma_f32 v[42:43], v[90:91], v[22:23], v[42:43] op_sel:[0,1,0] op_sel_hi:[1,1,1]
    v_pk_fma_f32 v[40:41], v[92:93], v[24:25], v[40:41] op_sel:[0,0,0] op_sel_hi:[1,0,1]
    v_pk_fma_f32 v[42:43], v[94:95], v[24:25], v[42:43] op_sel:[0,0,0] op_sel_hi:[1,0,1]
    v_pk_fma_f32 v[40:41], v[96:97], v[24:25], v[40:41] op_sel:[0,1,0] op_sel_hi:[1,1,1]
    v_pk_fma_f32 v[42:43], v[98:99], v[24:25], v[42:43] op_sel:[0,1,0] op_sel_hi:[1,1,1]
    v_pk_fma_f32 v[40:41], v[100:101], v[26:27], v[40:41] op_sel:[0,0,0] op_sel_hi:[1,0,1]
    v_pk_fma_f32 v[42:43], v[102:103], v[26:27], v[42:43] op_sel:[0,0,0] op_sel_hi:[1,0,1]
    v_pk_fma_f32 v[40:41], v[104:105], v[26:27], v[40:41] op_sel:[0,1,0] op_sel_hi:[1,1,1]
    v_pk_fma_f32 v[42:43], v[106:107], v[26:27], v[42:43] op_sel:[0,1,0] op_sel_hi:[1,1,1]
    s_nop 1
    s_branch L_fin
L_ok0:
    v_max_f32 v11, v47, v51
    v_max3_f32 v11, v11, v55, v59
    v_max3_f32 v11, v11, v63, v67
    v_max3_f32 v11, v11, v71, v75
    s_nop 1
    v_max_f32_dpp v11, v11, v11 row_ror:8 row_mask:0xf bank_mask:0xf
    v_mov_b32 v13, v11
    s_nop 1
    v_permlane32_swap_b32 v11, v13
    v_max_f32 v11, v11, v13
    v_mov_b32 v13, v11
    s_nop 1
    v_permlane16_swap_b32 v11, v13
    v_max_f32 v11, v11, v13
    s_nop 1
    v_mov_b32_dpp v11, v11 quad_perm:[0,0,2,2] row_mask:0xf bank_mask:0xf
    s_nop 1
    v_sub_f32_dpp v20, v47, v11 quad_perm:[0,0,2,2] row_mask:0xf bank_mask:0xf
    v_sub_f32_dpp v21, v51, v11 quad_perm:[0,0,2,2] row_mask:0xf bank_mask:0xf
    v_sub_f32_dpp v22, v55, v11 quad_perm:[0,0,2,2] row_mask:0xf bank_mask:0xf
    v_sub_f32_dpp v23, v59, v11 quad_perm:[0,0,2,2] row_mask:0xf bank_mask:0xf
    v_sub_f32_dpp v24, v63, v11 quad_perm:[0,0,2,2] row_mask:0xf bank_mask:0xf
    v_sub_f32_dpp v25, v67, v11 quad_perm:[0,0,2,2] row_mask:0xf bank_mask:0xf
    v_sub_f32_dpp v26, v71, v11 quad_perm:[0,0,2,2] row_mask:0xf bank_mask:0xf
    v_sub_f32_dpp v27, v75, v11 quad_perm:[0,0,2,2] row_mask:0xf bank_mask:0xf
    v_exp_f32 v20, v20
    v_exp_f32 v21, v21
    v_exp_f32 v22, v22
    v_exp_f32 v23, v23
    v_exp_f32 v24, v24
    v_exp_f32 v25, v25
    v_exp_f32 v26, v26
    v_exp_f32 v27, v27
    v_pk_mul_f32 v[40:41], v[44:45], v[20:21] op_sel:[0,0] op_sel_hi:[1,0]
    v_pk_mul_f32 v[42:43], v[46:47], v[20:21] op_sel:[0,0] op_sel_hi:[1,0]
    v_pk_fma_f32 v[40:41], v[48:49], v[20:21], v[40:41] op_sel:[0,1,0] op_sel_hi:[1,1,1]
    v_pk_fma_f32 v[42:43], v[50:51], v[20:21], v[42:43] op_sel:[0,1,0] op_sel_hi:[1,1,1]
    v_pk_fma_f32 v[40:41], v[52:53], v[22:23], v[40:41] op_sel:[0,0,0] op_sel_hi:[1,0,1]
    v_pk_fma_f32 v[42:43], v[54:55], v[22:23], v[42:43] op_sel:[0,0,0] op_sel_hi:[1,0,1]
    v_pk_fma_f32 v[40:41], v[56:57], v[22:23], v[40:41] op_sel:[0,1,0] op_sel_hi:[1,1,1]
    v_pk_fma_f32 v[42:43], v[58:59], v[22:23], v[42:43] op_sel:[0,1,0] op_sel_hi:[1,1,1]
    v_pk_fma_f32 v[40:41], v[60:61], v[24:25], v[40:41] op_sel:[0,0,0] op_sel_hi:[1,0,1]
    v_pk_fma_f32 v[42:43], v[62:63], v[24:25], v[42:43] op_sel:[0,0,0] op_sel_hi:[1,0,1]
    v_pk_fma_f32 v[40:41], v[64:65], v[24:25], v[40:41] op_sel:[0,1,0] op_sel_hi:[1,1,1]
    v_pk_fma_f32 v[42:43], v[66:67], v[24:25], v[42:43] op_sel:[0,1,0] op_sel_hi:[1,1,1]
    v_pk_fma_f32 v[40:41], v[68:69], v[26:27], v[40:41] op_sel:[0,0,0] op_sel_hi:[1,0,1]
    v_pk_fma_f32 v[42:43], v[70:71], v[26:27], v[42:43] op_sel:[0,0,0] op_sel_hi:[1,0,1]
    v_pk_fma_f32 v[40:41], v[72:73], v[26:27], v[40:41] op_sel:[0,1,0] op_sel_hi:[1,1,1]
    v_pk_fma_f32 v[42:43], v[74:75], v[26:27], v[42:43] op_sel:[0,1,0] op_sel_hi:[1,1,1]
    s_nop 1
L_fin:
    v_permlane32_swap_b32 v40, v41
    v_permlane32_swap_b32 v42, v43
    v_add_f32 v40, v40, v41
    v_add_f32 v42, v42, v43
    s_nop 1
    v_permlane16_swap_b32 v40, v42
    v_add_f32 v40, v40, v42
    s_nop 1
    v_add_f32_dpp v40, v40, v40 row_ror:8 row_mask:0xf bank_mask:0xf
    v_rcp_f32 v10, v40
    s_nop 0
    v_readlane_b32 s81, v10, 49
    s_nop 1
    v_mul_f32 v40, s81, v40
    v_cvt_pk_bf16_f32 v40, v40, v40
    s_mov_b32 exec_lo, 0x00ff00ff
    s_mov_b32 exec_hi, 0xff
    buffer_store_short v40, v16, s[16:19], s37 offen
    s_endpgm
L_pacer:
    s_cmp_eq_u32 s76, 6
    s_cbranch_scc0 L_exch
    v_mov_b32 v16, -1
    s_mov_b32 s80, 0x14141418
    v_writelane_b32 v16, s80, 0
    s_mov_b32 s80, 0x18181810
    v_writelane_b32 v16, s80, 1
    s_mov_b32 s80, 0x28282830
    v_writelane_b32 v16, s80, 2
    s_mov_b32 s80, 0x18181410
    v_writelane_b32 v16, s80, 3
    s_mov_b32 s80, 0x14141818
    v_writelane_b32 v16, s80, 4
    s_mov_b32 s80, 0x30302c20
    v_writelane_b32 v16, s80, 5
    s_mov_b32 s80, 0x50505460
    v_writelane_b32 v16, s80, 6
    s_lshl_b32 s80, s77, 3
    v_sad_u8 v17, v16, 0, 0
    v_bfe_u32 v16, v16, s80, 8
    v_cvt_f32_u32 v15, v17
    v_cvt_f32_u32 v4, v16
    v_rcp_f32 v18, v4
    v_rcp_f32 v19, v15
    v_mul_f32 v15, 0x472aaaab, v15
    v_mul_f32 v4, 0x46b00000, v4
    v_mul_f32 v18, v18, v15
    v_mul_f32 v19, v19, v4
    v_cvt_u32_f32 v18, v18
    v_cvt_u32_f32 v19, v19
    v_mul_u32_u24 v16, 12, v16
    v_lshlrev_b32 v17, 3, v17
    s_mov_b32 s4, 0
    s_mov_b32 s9, 0
    s_mov_b32 s13, 0
    s_mov_b32 s15, 0
    s_mov_b32 s17, 0
    s_mov_b32 s18, 0
    s_mov_b32 s19, 0
    s_mov_b32 s5, 32
    s_mov_b32 s7, 128
    v_mov_b32 v14, 157824
    s_lshl_b32 s80, s84, 12
    s_add_u32 s80, s80, 1351680
    v_mov_b32 v12, s80
    v_mov_b32 v13, 5104
    ds_write_b64 v3, v[12:13] offset:24
    v_mov_b32 v15, s84
    ds_write_b32 v14, v15
    s_nop 0
L_g:
    s_sleep 1
    ds_read_b32 v4, v3 offset:16
    s_memrealtime s[10:11]
    ds_read_b128 v[8:11], v3
    ds_read_b64 v[12:13], v3 offset:24
    s_waitcnt lgkmcnt(0)
    v_readfirstlane_b32 s83, v4
    v_min3_i32 v15, v8, v9, v10
    v_min_i32 v8, v15, v11
    v_readfirstlane_b32 s80, v12
    v_readfirstlane_b32 s81, v13
    s_max_i32 s9, s9, s83
    s_cmp_ge_u32 s9, s13
    s_nop 2
    s_cbranch_scc0 L_gs
    s_mov_b32 s12, s13
    s_mov_b32 s14, s15
    v_readlane_b32 s82, v16, s17
    v_readlane_b32 s83, v17, s17
    v_readlane_b32 s16, v18, s17
    s_add_u32 s17, s17, 1
    s_add_u32 s13, s13, s82
    s_add_u32 s15, s15, s83
    s_nop 1
L_gs:
    s_add_u32 s82, s9, 22
    s_cmp_ge_u32 s82, s18
    s_cbranch_scc0 L_gf
    v_readlane_b32 s82, v16, s19
    v_readlane_b32 s20, v19, s19
    s_add_u32 s19, s19, 1
    s_add_u32 s18, s18, s82
    s_nop 2
L_gf:
    s_sub_u32 s6, s9, s12
    s_mul_i32 s6, s6, s16
    s_lshr_b32 s6, s6, 16
    s_add_u32 s6, s6, s14
    s_cmp_ge_u32 s6, s5
    s_cbranch_scc0 L_gn
    s_add_u32 s4, s4, 1
    s_add_u32 s5, s5, 32
    v_add_u32 v14, 4, v14
    v_mov_b32 v15, s10
    ds_write_b32 v14, v15
    v_mov_b32 v15, s4
    ds_write_b32 v3, v15 offset:20
    s_nop 0
L_gn:
    s_mul_i32 s81, s81, s6
    s_add_u32 s80, s80, s81
    s_lshl_b32 s81, s10, 12
    s_sub_u32 s80, s81, s80
    s_ashr_i32 s80, s80, 6
    s_min_i32 s80, s80, 0x40000
    s_max_i32 s80, s80, 0xfffc0000
    s_mul_i32 s80, s80, 983
    s_ashr_i32 s80, s80, 12
    s_and_b32 s7, s7, 255
    s_add_u32 s7, s7, s80
    s_add_u32 s7, s7, s20
    s_ashr_i32 s8, s7, 8
    s_min_i32 s8, s8, 36
    s_max_i32 s8, s8, 12
    s_cmp_lt_u32 s4, 4
    s_cselect_b32 s8, 24, s8
    s_add_u32 s80, s8, 2304
    v_lshl_add_u32 v15, v8, 8, s80
    ds_write_b32 v3, v15 offset:44
    s_cmp_lt_u32 s4, 256
    s_cbranch_scc1 L_g
    s_endpgm
L_exch:
    s_mov_b32 s12, s74
    s_mov_b32 s13, s75
    s_mov_b32 s14, 1610612736
    s_mov_b32 s15, 0x20000
    s_mov_b32 s80, 4352
    v_mul_lo_u32 v5, v1, s80
    s_lshr_b32 s80, s2, 3
    s_mul_i32 s21, s79, 5
    s_add_u32 s21, s21, s80
    s_and_b32 s21, s21, 31
    s_lshr_b32 s80, s80, 5
    s_lshl_b32 s80, s80, 3
    s_add_u32 s80, s80, s79
    s_mul_i32 s80, s80, 4352
    s_waitcnt vmcnt(0)
    v_mov_b32 v7, s80
    s_mov_b32 s16, 0
    s_mov_b32 s17, 33554432
    s_mov_b32 s18, 8
    s_mov_b32 s20, 0
    s_mov_b32 s19, 0
    s_mov_b32 s24, 0
L_pc0:
L_pw1:
    s_sleep 8
    ds_read_b32 v4, v3 offset:20
    s_waitcnt lgkmcnt(0)
    v_readfirstlane_b32 s80, v4
    s_nop 0
    s_cmp_lt_i32 s80, s18
    s_nop 2
    s_cbranch_scc1 L_pw1
    s_lshl_b32 s80, s18, 2
    s_add_u32 s80, s80, 157824
    v_mov_b32 v8, s80
    ds_read_b32 v6, v8
    s_waitcnt lgkmcnt(0)
    s_and_b32 s80, s16, 31
    s_cmp_eq_u32 s80, s21
    s_cbranch_scc0 L_np
    s_mov_b64 exec, 1
    buffer_store_dword v6, v7, s[12:15], s17 offen sc0 sc1
    s_mov_b64 exec, -1
L_np:
    s_add_u32 s81, s18, 4
L_pw2:
    s_sleep 8
    ds_read_b32 v4, v3 offset:20
    s_waitcnt lgkmcnt(0)
    v_readfirstlane_b32 s80, v4
    s_nop 0
    s_cmp_lt_i32 s80, s81
    s_nop 2
    s_cbranch_scc1 L_pw2
    s_add_u32 s30, s74, s17
    s_addc_u32 s31, s75, 0
    s_load_dword s32, s[30:31], 0
    s_load_dword s33, s[30:31], 4352
    s_load_dword s34, s[30:31], 8704
    s_load_dword s35, s[30:31], 13056
    s_load_dword s36, s[30:31], 17408
    s_load_dword s37, s[30:31], 21760
    s_load_dword s38, s[30:31], 26112
    s_load_dword s39, s[30:31], 30464
    s_memrealtime s[22:23]
    v_readfirstlane_b32 s26, v6
    s_mov_b32 s27, 0
    s_mov_b32 s28, 0
    s_mov_b32 s29, -4096
    s_waitcnt lgkmcnt(0)
    s_sub_u32 s83, s22, s26
    s_sub_u32 s80, s32, s26
    s_add_u32 s81, s80, 4096
    s_cmp_lt_u32 s81, 0x2000
    s_cselect_b32 s80, s80, s83
    s_addc_u32 s28, s28, 0
    s_add_u32 s27, s27, s80
    s_max_i32 s29, s29, s80
    s_sub_u32 s80, s33, s26
    s_add_u32 s81, s80, 4096
    s_cmp_lt_u32 s81, 0x2000
    s_cselect_b32 s80, s80, s83
    s_addc_u32 s28, s28, 0
    s_add_u32 s27, s27, s80
    s_max_i32 s29, s29, s80
    s_sub_u32 s80, s34, s26
    s_add_u32 s81, s80, 4096
    s_cmp_lt_u32 s81, 0x2000
    s_cselect_b32 s80, s80, s83
    s_addc_u32 s28, s28, 0
    s_add_u32 s27, s27, s80
    s_max_i32 s29, s29, s80
    s_sub_u32 s80, s35, s26
    s_add_u32 s81, s80, 4096
    s_cmp_lt_u32 s81, 0x2000
    s_cselect_b32 s80, s80, s83
    s_addc_u32 s28, s28, 0
    s_add_u32 s27, s27, s80
    s_max_i32 s29, s29, s80
    s_sub_u32 s80, s36, s26
    s_add_u32 s81, s80, 4096
    s_cmp_lt_u32 s81, 0x2000
    s_cselect_b32 s80, s80, s83
    s_addc_u32 s28, s28, 0
    s_add_u32 s27, s27, s80
    s_max_i32 s29, s29, s80
    s_sub_u32 s80, s37, s26
    s_add_u32 s81, s80, 4096
    s_cmp_lt_u32 s81, 0x2000
    s_cselect_b32 s80, s80, s83
    s_addc_u32 s28, s28, 0
    s_add_u32 s27, s27, s80
    s_max_i32 s29, s29, s80
    s_sub_u32 s80, s38, s26
    s_add_u32 s81, s80, 4096
    s_cmp_lt_u32 s81, 0x2000
    s_cselect_b32 s80, s80, s83
    s_addc_u32 s28, s28, 0
    s_add_u32 s27, s27, s80
    s_max_i32 s29, s29, s80
    s_sub_u32 s80, s39, s26
    s_add_u32 s81, s80, 4096
    s_cmp_lt_u32 s81, 0x2000
    s_cselect_b32 s80, s80, s83
    s_addc_u32 s28, s28, 0
    s_add_u32 s27, s27, s80
    s_max_i32 s29, s29, s80
    s_cmp_lt_u32 s28, 4
    s_cbranch_scc1 L_pskip
    s_mul_i32 s27, s27, 410
    s_lshl_b32 s80, s26, 12
    s_add_u32 s80, s80, s27
    s_mul_i32 s29, s29, 819
    s_add_u32 s80, s80, s29
    s_min_u32 s82, s18, 0
    s_lshl_b32 s83, s18, 5
    s_add_u32 s82, s82, s83
    s_sub_u32 s81, s80, s19
    s_sub_u32 s83, s82, s24
    v_cvt_f32_u32 v8, s81
    v_cvt_f32_u32 v9, s83
    v_rcp_f32 v9, v9
    v_mul_f32 v8, 0x3f800000, v8
    v_mul_f32 v8, v8, v9
    v_mul_f32 v9, 0x3f7851ec, v8
    v_mov_b32 v10, 0x459f8000
    v_mul_f32 v8, 0x3f828f5c, v8
    v_med3_f32 v8, v8, v9, v10
    v_cvt_u32_f32 v8, v8
    s_nop 0
    v_readfirstlane_b32 s81, v8
    s_mov_b32 s19, s80
    s_mov_b32 s24, s82
    s_cmp_eq_u32 s20, 0
    s_cselect_b32 s81, 5104, s81
    s_mov_b32 s20, 1
    s_mul_i32 s82, s82, s81
    s_sub_u32 s80, s80, s82
    v_mov_b32 v8, s80
    v_mov_b32 v9, s81
    ds_write_b64 v3, v[8:9] offset:24
    s_nop 0
L_pskip:
    s_add_u32 s16, s16, 1
    s_add_u32 s17, s17, 34816
    s_add_u32 s18, s18, 16
    s_cmp_lt_u32 s18, 250
    s_cbranch_scc1 L_pc0
L_end:
    s_endpgm
.section .rodata,"a"
.p2align 6
.amdhsa_kernel standalone__kv_cache_quant_pre_rope_vs_post_rope__decode_kernel
  .amdhsa_next_free_vgpr 168
  .amdhsa_next_free_sgpr 96
  .amdhsa_accum_offset 168
  .amdhsa_group_segment_fixed_size 0
  .amdhsa_kernarg_size 112
  .amdhsa_user_sgpr_count 2
  .amdhsa_user_sgpr_kernarg_segment_ptr 1
  .amdhsa_system_sgpr_workgroup_id_x 1
.end_amdhsa_kernel
```

```asm
; @launch grid=(256,1,1) block=(512,1,1) lds=159168
.amdgcn_target "amdgcn-amd-amdhsa--gfx950"
.text
.globl standalone__kv_cache_quant_pre_rope_vs_post_rope__decode_kernel
.p2align 8
.type standalone__kv_cache_quant_pre_rope_vs_post_rope__decode_kernel,@function
standalone__kv_cache_quant_pre_rope_vs_post_rope__decode_kernel:
    s_cmp_ge_u32 s2, 256
    s_cbranch_scc1 L_end
    s_load_dwordx2 s[4:5], s[0:1], 8
    v_readfirstlane_b32 s76, v0
    s_and_b32 s79, s2, 7
    s_lshr_b32 s78, s2, 7
    s_lshl3_add_u32 s78, s78, s79
    s_lshr_b32 s77, s2, 3
    s_lshr_b32 s80, s77, 2
    s_and_b32 s77, s77, 3
    s_and_b32 s80, s80, 3
    s_lshl2_add_u32 s78, s78, s80
    s_cmp_lt_u32 s76, 64
    s_cbranch_scc0 L_init
    s_getpc_b64 s[26:27]
L_pc:
    s_lshl_b32 s81, s2, 6
    s_and_b32 s81, s81, 0x3e00
    v_lshl_add_u32 v5, v0, 3, s81
    v_min_u32 v5, L_end-L_pc, v5
    global_load_dword v7, v5, s[26:27]
    v_lshlrev_b32 v2, 4, v0
    s_mul_i32 s9, s77, 15728640
    s_mul_i32 s80, s78, 12288
    s_mov_b32 m0, 0
    s_add_u32 s9, s9, s80
    s_mov_b32 s6, 402653184
    s_mov_b32 s7, 0x20000
    s_movk_i32 s12, 12288
    s_waitcnt lgkmcnt(0)
L_first:
    s_waitcnt vmcnt(22)
    buffer_load_dwordx4 v2, s[4:7], s9 offen offset:0 nt lds
    buffer_load_dwordx4 v2, s[4:7], s9 offen offset:1024 nt lds
    s_waitcnt vmcnt(22)
    buffer_load_dwordx4 v2, s[4:7], s9 offen offset:2048 nt lds
    buffer_load_dwordx4 v2, s[4:7], s9 offen offset:3072 nt lds
    s_addk_i32 m0, 4096
    s_addk_i32 s9, 4096
    s_cmp_lg_u32 m0, s12
    s_cbranch_scc1 L_first
    s_addk_i32 s12, 12288
    s_add_u32 s9, s9, 774144
    s_cmp_lt_u32 m0, 36864
    s_cbranch_scc1 L_first
    s_sub_u32 s9, s9, 774144
    s_barrier
    s_load_dwordx2 s[56:57], s[0:1], 32
    s_setprio 3
    s_mul_i32 s8, s77, 12582912
    s_add_u32 s8, s8, s80
    s_mul_i32 s16, s77, 4
    s_mul_i32 s17, s77, 4
    v_mov_b32 v3, 158912
    s_waitcnt vmcnt(24)
    s_mov_b32 s10, 2
    v_mov_b32 v5, 36
    v_mov_b32 v7, 2328
    s_waitcnt lgkmcnt(0)
    s_nop 0
    s_branch L_next
L_init:
    s_load_dwordx16 s[48:63], s[0:1], 0
    s_load_dwordx8 s[64:71], s[0:1], 64
    s_load_dwordx4 s[72:75], s[0:1], 96
    s_memrealtime s[84:85]
    v_and_b32 v1, 63, v0
    s_lshr_b32 s76, s76, 4
    s_lshr_b32 s76, 0x65372104, s76
    s_and_b32 s76, s76, 7
    v_lshlrev_b32 v2, 4, v1
    v_mov_b32 v3, 158912
    v_cmp_eq_u32 vcc, 11, v1
    v_mov_b32 v5, 2328
    v_lshl_add_u32 v6, v1, 2, v3
    v_cndmask_b32 v5, 0, v5, vcc
    ds_write_b32 v6, v5
    s_waitcnt lgkmcnt(0)
    s_barrier
    s_branch L_notld
L_next:
    s_add_u32 s10, s10, 1
    s_cmp_eq_u32 m0, 110592
    s_cselect_b32 m0, 0, m0
    s_waitcnt lgkmcnt(1)
    v_readfirstlane_b32 s11, v7
    s_add_u32 s12, m0, 12288
    s_add_u32 s9, s9, 774144
    s_and_b32 s80, s10, 3
    s_cbranch_scc0 L_addr
L_aj:
    s_lshr_b32 s80, s11, 8
    s_cmp_gt_u32 s80, s10
    s_cbranch_scc0 L_full
    s_and_b32 s15, s11, 255
    s_cmp_ge_i32 s15, 24
    s_cbranch_scc1 L_t_24_36
    s_cmp_ge_i32 s15, 18
    s_cbranch_scc1 L_t_18_23
    s_cmp_ge_i32 s15, 15
    s_cbranch_scc1 L_t_15_17
    s_cmp_ge_i32 s15, 13
    s_cbranch_scc1 L_t_13_14
    s_branch L_v12
L_t_13_14:
    s_cmp_ge_i32 s15, 14
    s_cbranch_scc1 L_v14
    s_branch L_v13
L_t_15_17:
    s_cmp_ge_i32 s15, 16
    s_cbranch_scc1 L_t_16_17
    s_branch L_v15
L_t_16_17:
    s_cmp_ge_i32 s15, 17
    s_cbranch_scc1 L_v17
    s_branch L_v16
L_t_18_23:
    s_cmp_ge_i32 s15, 21
    s_cbranch_scc1 L_t_21_23
    s_cmp_ge_i32 s15, 19
    s_cbranch_scc1 L_t_19_20
    s_branch L_v18
L_t_19_20:
    s_cmp_ge_i32 s15, 20
    s_cbranch_scc1 L_v20
    s_branch L_v19
L_t_21_23:
    s_cmp_ge_i32 s15, 22
    s_cbranch_scc1 L_t_22_23
    s_branch L_v21
L_t_22_23:
    s_cmp_ge_i32 s15, 23
    s_cbranch_scc1 L_v23
    s_branch L_v22
L_t_24_36:
    s_cmp_ge_i32 s15, 30
    s_cbranch_scc1 L_t_30_36
    s_cmp_ge_i32 s15, 27
    s_cbranch_scc1 L_t_27_29
    s_cmp_ge_i32 s15, 25
    s_cbranch_scc1 L_t_25_26
    s_branch L_v24
L_t_25_26:
    s_cmp_ge_i32 s15, 26
    s_cbranch_scc1 L_v26
    s_branch L_v25
L_t_27_29:
    s_cmp_ge_i32 s15, 28
    s_cbranch_scc1 L_t_28_29
    s_branch L_v27
L_t_28_29:
    s_cmp_ge_i32 s15, 29
    s_cbranch_scc1 L_v29
    s_branch L_v28
L_t_30_36:
    s_cmp_ge_i32 s15, 33
    s_cbranch_scc1 L_t_33_36
    s_cmp_ge_i32 s15, 31
    s_cbranch_scc1 L_t_31_32
    s_branch L_v30
L_t_31_32:
    s_cmp_ge_i32 s15, 32
    s_cbranch_scc1 L_v32
    s_branch L_v31
L_t_33_36:
    s_cmp_ge_i32 s15, 35
    s_cbranch_scc1 L_t_35_36
    s_cmp_ge_i32 s15, 34
    s_cbranch_scc1 L_v34
    s_branch L_v33
L_t_35_36:
    s_cmp_ge_i32 s15, 36
    s_cbranch_scc1 L_v36
    s_branch L_v35
L_v12:
    s_waitcnt vmcnt(11)
    buffer_load_dwordx4 v2, s[4:7], s9 offen offset:0 nt lds
    s_waitcnt vmcnt(11)
    buffer_load_dwordx4 v2, s[4:7], s9 offen offset:1024 nt lds
    ds_read_b32 v7, v3 offset:44
    s_waitcnt vmcnt(11)
    buffer_load_dwordx4 v2, s[4:7], s9 offen offset:2048 nt lds
    v_subrev_u32 v6, 9, v5
    s_add_u32 m0, m0, 3072
    ds_write_b32 v3, v6 offset:16
    v_add_u32 v5, 3, v5
    s_add_u32 s9, s9, 3072
    s_cmp_lg_u32 m0, s12
    s_cbranch_scc1 L_v12
    s_branch L_next
L_v13:
    s_waitcnt vmcnt(12)
    buffer_load_dwordx4 v2, s[4:7], s9 offen offset:0 nt lds
    s_waitcnt vmcnt(12)
    buffer_load_dwordx4 v2, s[4:7], s9 offen offset:1024 nt lds
    ds_read_b32 v7, v3 offset:44
    s_waitcnt vmcnt(12)
    buffer_load_dwordx4 v2, s[4:7], s9 offen offset:2048 nt lds
    v_subrev_u32 v6, 10, v5
    s_add_u32 m0, m0, 3072
    ds_write_b32 v3, v6 offset:16
    v_add_u32 v5, 3, v5
    s_add_u32 s9, s9, 3072
    s_cmp_lg_u32 m0, s12
    s_cbranch_scc1 L_v13
    s_branch L_next
L_v14:
    s_waitcnt vmcnt(13)
    buffer_load_dwordx4 v2, s[4:7], s9 offen offset:0 nt lds
    s_waitcnt vmcnt(13)
    buffer_load_dwordx4 v2, s[4:7], s9 offen offset:1024 nt lds
    ds_read_b32 v7, v3 offset:44
    s_waitcnt vmcnt(13)
    buffer_load_dwordx4 v2, s[4:7], s9 offen offset:2048 nt lds
    v_subrev_u32 v6, 11, v5
    s_add_u32 m0, m0, 3072
    ds_write_b32 v3, v6 offset:16
    v_add_u32 v5, 3, v5
    s_add_u32 s9, s9, 3072
    s_cmp_lg_u32 m0, s12
    s_cbranch_scc1 L_v14
    s_branch L_next
L_v15:
    s_waitcnt vmcnt(14)
    buffer_load_dwordx4 v2, s[4:7], s9 offen offset:0 nt lds
    s_waitcnt vmcnt(14)
    buffer_load_dwordx4 v2, s[4:7], s9 offen offset:1024 nt lds
    ds_read_b32 v7, v3 offset:44
    s_waitcnt vmcnt(14)
    buffer_load_dwordx4 v2, s[4:7], s9 offen offset:2048 nt lds
    v_subrev_u32 v6, 12, v5
    s_add_u32 m0, m0, 3072
    ds_write_b32 v3, v6 offset:16
    v_add_u32 v5, 3, v5
    s_add_u32 s9, s9, 3072
    s_cmp_lg_u32 m0, s12
    s_cbranch_scc1 L_v15
    s_branch L_next
L_v16:
    s_waitcnt vmcnt(15)
    buffer_load_dwordx4 v2, s[4:7], s9 offen offset:0 nt lds
    s_waitcnt vmcnt(15)
    buffer_load_dwordx4 v2, s[4:7], s9 offen offset:1024 nt lds
    ds_read_b32 v7, v3 offset:44
    s_waitcnt vmcnt(15)
    buffer_load_dwordx4 v2, s[4:7], s9 offen offset:2048 nt lds
    v_subrev_u32 v6, 13, v5
    s_add_u32 m0, m0, 3072
    ds_write_b32 v3, v6 offset:16
    v_add_u32 v5, 3, v5
    s_add_u32 s9, s9, 3072
    s_cmp_lg_u32 m0, s12
    s_cbranch_scc1 L_v16
    s_branch L_next
L_v17:
    s_waitcnt vmcnt(16)
    buffer_load_dwordx4 v2, s[4:7], s9 offen offset:0 nt lds
    s_waitcnt vmcnt(16)
    buffer_load_dwordx4 v2, s[4:7], s9 offen offset:1024 nt lds
    ds_read_b32 v7, v3 offset:44
    s_waitcnt vmcnt(16)
    buffer_load_dwordx4 v2, s[4:7], s9 offen offset:2048 nt lds
    v_subrev_u32 v6, 14, v5
    s_add_u32 m0, m0, 3072
    ds_write_b32 v3, v6 offset:16
    v_add_u32 v5, 3, v5
    s_add_u32 s9, s9, 3072
    s_cmp_lg_u32 m0, s12
    s_cbranch_scc1 L_v17
    s_branch L_next
L_v18:
    s_waitcnt vmcnt(17)
    buffer_load_dwordx4 v2, s[4:7], s9 offen offset:0 nt lds
    s_waitcnt vmcnt(17)
    buffer_load_dwordx4 v2, s[4:7], s9 offen offset:1024 nt lds
    ds_read_b32 v7, v3 offset:44
    s_waitcnt vmcnt(17)
    buffer_load_dwordx4 v2, s[4:7], s9 offen offset:2048 nt lds
    v_subrev_u32 v6, 15, v5
    s_add_u32 m0, m0, 3072
    ds_write_b32 v3, v6 offset:16
    v_add_u32 v5, 3, v5
    s_add_u32 s9, s9, 3072
    s_cmp_lg_u32 m0, s12
    s_cbranch_scc1 L_v18
    s_branch L_next
L_v19:
    s_waitcnt vmcnt(18)
    buffer_load_dwordx4 v2, s[4:7], s9 offen offset:0 nt lds
    s_waitcnt vmcnt(18)
    buffer_load_dwordx4 v2, s[4:7], s9 offen offset:1024 nt lds
    ds_read_b32 v7, v3 offset:44
    s_waitcnt vmcnt(18)
    buffer_load_dwordx4 v2, s[4:7], s9 offen offset:2048 nt lds
    v_subrev_u32 v6, 16, v5
    s_add_u32 m0, m0, 3072
    ds_write_b32 v3, v6 offset:16
    v_add_u32 v5, 3, v5
    s_add_u32 s9, s9, 3072
    s_cmp_lg_u32 m0, s12
    s_cbranch_scc1 L_v19
    s_branch L_next
L_v20:
    s_waitcnt vmcnt(19)
    buffer_load_dwordx4 v2, s[4:7], s9 offen offset:0 nt lds
    s_waitcnt vmcnt(19)
    buffer_load_dwordx4 v2, s[4:7], s9 offen offset:1024 nt lds
    ds_read_b32 v7, v3 offset:44
    s_waitcnt vmcnt(19)
    buffer_load_dwordx4 v2, s[4:7], s9 offen offset:2048 nt lds
    v_subrev_u32 v6, 17, v5
    s_add_u32 m0, m0, 3072
    ds_write_b32 v3, v6 offset:16
    v_add_u32 v5, 3, v5
    s_add_u32 s9, s9, 3072
    s_cmp_lg_u32 m0, s12
    s_cbranch_scc1 L_v20
    s_branch L_next
L_v21:
    s_waitcnt vmcnt(20)
    buffer_load_dwordx4 v2, s[4:7], s9 offen offset:0 nt lds
    s_waitcnt vmcnt(20)
    buffer_load_dwordx4 v2, s[4:7], s9 offen offset:1024 nt lds
    ds_read_b32 v7, v3 offset:44
    s_waitcnt vmcnt(20)
    buffer_load_dwordx4 v2, s[4:7], s9 offen offset:2048 nt lds
    v_subrev_u32 v6, 18, v5
    s_add_u32 m0, m0, 3072
    ds_write_b32 v3, v6 offset:16
    v_add_u32 v5, 3, v5
    s_add_u32 s9, s9, 3072
    s_cmp_lg_u32 m0, s12
    s_cbranch_scc1 L_v21
    s_branch L_next
L_v22:
    s_waitcnt vmcnt(21)
    buffer_load_dwordx4 v2, s[4:7], s9 offen offset:0 nt lds
    s_waitcnt vmcnt(21)
    buffer_load_dwordx4 v2, s[4:7], s9 offen offset:1024 nt lds
    ds_read_b32 v7, v3 offset:44
    s_waitcnt vmcnt(21)
    buffer_load_dwordx4 v2, s[4:7], s9 offen offset:2048 nt lds
    v_subrev_u32 v6, 19, v5
    s_add_u32 m0, m0, 3072
    ds_write_b32 v3, v6 offset:16
    v_add_u32 v5, 3, v5
    s_add_u32 s9, s9, 3072
    s_cmp_lg_u32 m0, s12
    s_cbranch_scc1 L_v22
    s_branch L_next
L_v23:
    s_waitcnt vmcnt(22)
    buffer_load_dwordx4 v2, s[4:7], s9 offen offset:0 nt lds
    s_waitcnt vmcnt(22)
    buffer_load_dwordx4 v2, s[4:7], s9 offen offset:1024 nt lds
    ds_read_b32 v7, v3 offset:44
    s_waitcnt vmcnt(22)
    buffer_load_dwordx4 v2, s[4:7], s9 offen offset:2048 nt lds
    v_subrev_u32 v6, 20, v5
    s_add_u32 m0, m0, 3072
    ds_write_b32 v3, v6 offset:16
    v_add_u32 v5, 3, v5
    s_add_u32 s9, s9, 3072
    s_cmp_lg_u32 m0, s12
    s_cbranch_scc1 L_v23
    s_branch L_next
L_v24:
    s_waitcnt vmcnt(23)
    buffer_load_dwordx4 v2, s[4:7], s9 offen offset:0 nt lds
    s_waitcnt vmcnt(23)
    buffer_load_dwordx4 v2, s[4:7], s9 offen offset:1024 nt lds
    ds_read_b32 v7, v3 offset:44
    s_waitcnt vmcnt(23)
    buffer_load_dwordx4 v2, s[4:7], s9 offen offset:2048 nt lds
    v_subrev_u32 v6, 21, v5
    s_add_u32 m0, m0, 3072
    ds_write_b32 v3, v6 offset:16
    v_add_u32 v5, 3, v5
    s_add_u32 s9, s9, 3072
    s_cmp_lg_u32 m0, s12
    s_cbranch_scc1 L_v24
    s_branch L_next
L_v25:
    s_waitcnt vmcnt(24)
    buffer_load_dwordx4 v2, s[4:7], s9 offen offset:0 nt lds
    s_waitcnt vmcnt(24)
    buffer_load_dwordx4 v2, s[4:7], s9 offen offset:1024 nt lds
    ds_read_b32 v7, v3 offset:44
    s_waitcnt vmcnt(24)
    buffer_load_dwordx4 v2, s[4:7], s9 offen offset:2048 nt lds
    v_subrev_u32 v6, 22, v5
    s_add_u32 m0, m0, 3072
    ds_write_b32 v3, v6 offset:16
    v_add_u32 v5, 3, v5
    s_add_u32 s9, s9, 3072
    s_cmp_lg_u32 m0, s12
    s_cbranch_scc1 L_v25
    s_branch L_next
L_v26:
    s_waitcnt vmcnt(25)
    buffer_load_dwordx4 v2, s[4:7], s9 offen offset:0 nt lds
    s_waitcnt vmcnt(25)
    buffer_load_dwordx4 v2, s[4:7], s9 offen offset:1024 nt lds
    ds_read_b32 v7, v3 offset:44
    s_waitcnt vmcnt(25)
    buffer_load_dwordx4 v2, s[4:7], s9 offen offset:2048 nt lds
    v_subrev_u32 v6, 23, v5
    s_add_u32 m0, m0, 3072
    ds_write_b32 v3, v6 offset:16
    v_add_u32 v5, 3, v5
    s_add_u32 s9, s9, 3072
    s_cmp_lg_u32 m0, s12
    s_cbranch_scc1 L_v26
    s_branch L_next
L_v27:
    s_waitcnt vmcnt(26)
    buffer_load_dwordx4 v2, s[4:7], s9 offen offset:0 nt lds
    s_waitcnt vmcnt(26)
    buffer_load_dwordx4 v2, s[4:7], s9 offen offset:1024 nt lds
    ds_read_b32 v7, v3 offset:44
    s_waitcnt vmcnt(26)
    buffer_load_dwordx4 v2, s[4:7], s9 offen offset:2048 nt lds
    v_subrev_u32 v6, 24, v5
    s_add_u32 m0, m0, 3072
    ds_write_b32 v3, v6 offset:16
    v_add_u32 v5, 3, v5
    s_add_u32 s9, s9, 3072
    s_cmp_lg_u32 m0, s12
    s_cbranch_scc1 L_v27
    s_branch L_next
L_v28:
    s_waitcnt vmcnt(27)
    buffer_load_dwordx4 v2, s[4:7], s9 offen offset:0 nt lds
    s_waitcnt vmcnt(27)
    buffer_load_dwordx4 v2, s[4:7], s9 offen offset:1024 nt lds
    ds_read_b32 v7, v3 offset:44
    s_waitcnt vmcnt(27)
    buffer_load_dwordx4 v2, s[4:7], s9 offen offset:2048 nt lds
    v_subrev_u32 v6, 25, v5
    s_add_u32 m0, m0, 3072
    ds_write_b32 v3, v6 offset:16
    v_add_u32 v5, 3, v5
    s_add_u32 s9, s9, 3072
    s_cmp_lg_u32 m0, s12
    s_cbranch_scc1 L_v28
    s_branch L_next
L_v29:
    s_waitcnt vmcnt(28)
    buffer_load_dwordx4 v2, s[4:7], s9 offen offset:0 nt lds
    s_waitcnt vmcnt(28)
    buffer_load_dwordx4 v2, s[4:7], s9 offen offset:1024 nt lds
    ds_read_b32 v7, v3 offset:44
    s_waitcnt vmcnt(28)
    buffer_load_dwordx4 v2, s[4:7], s9 offen offset:2048 nt lds
    v_subrev_u32 v6, 26, v5
    s_add_u32 m0, m0, 3072
    ds_write_b32 v3, v6 offset:16
    v_add_u32 v5, 3, v5
    s_add_u32 s9, s9, 3072
    s_cmp_lg_u32 m0, s12
    s_cbranch_scc1 L_v29
    s_branch L_next
L_v30:
    s_waitcnt vmcnt(29)
    buffer_load_dwordx4 v2, s[4:7], s9 offen offset:0 nt lds
    s_waitcnt vmcnt(29)
    buffer_load_dwordx4 v2, s[4:7], s9 offen offset:1024 nt lds
    ds_read_b32 v7, v3 offset:44
    s_waitcnt vmcnt(29)
    buffer_load_dwordx4 v2, s[4:7], s9 offen offset:2048 nt lds
    v_subrev_u32 v6, 27, v5
    s_add_u32 m0, m0, 3072
    ds_write_b32 v3, v6 offset:16
    v_add_u32 v5, 3, v5
    s_add_u32 s9, s9, 3072
    s_cmp_lg_u32 m0, s12
    s_cbranch_scc1 L_v30
    s_branch L_next
L_v31:
    s_waitcnt vmcnt(30)
    buffer_load_dwordx4 v2, s[4:7], s9 offen offset:0 nt lds
    s_waitcnt vmcnt(30)
    buffer_load_dwordx4 v2, s[4:7], s9 offen offset:1024 nt lds
    ds_read_b32 v7, v3 offset:44
    s_waitcnt vmcnt(30)
    buffer_load_dwordx4 v2, s[4:7], s9 offen offset:2048 nt lds
    v_subrev_u32 v6, 28, v5
    s_add_u32 m0, m0, 3072
    ds_write_b32 v3, v6 offset:16
    v_add_u32 v5, 3, v5
    s_add_u32 s9, s9, 3072
    s_cmp_lg_u32 m0, s12
    s_cbranch_scc1 L_v31
    s_branch L_next
L_v32:
    s_waitcnt vmcnt(31)
    buffer_load_dwordx4 v2, s[4:7], s9 offen offset:0 nt lds
    s_waitcnt vmcnt(31)
    buffer_load_dwordx4 v2, s[4:7], s9 offen offset:1024 nt lds
    ds_read_b32 v7, v3 offset:44
    s_waitcnt vmcnt(31)
    buffer_load_dwordx4 v2, s[4:7], s9 offen offset:2048 nt lds
    v_subrev_u32 v6, 29, v5
    s_add_u32 m0, m0, 3072
    ds_write_b32 v3, v6 offset:16
    v_add_u32 v5, 3, v5
    s_add_u32 s9, s9, 3072
    s_cmp_lg_u32 m0, s12
    s_cbranch_scc1 L_v32
    s_branch L_next
L_v33:
    s_waitcnt vmcnt(32)
    buffer_load_dwordx4 v2, s[4:7], s9 offen offset:0 nt lds
    s_waitcnt vmcnt(32)
    buffer_load_dwordx4 v2, s[4:7], s9 offen offset:1024 nt lds
    ds_read_b32 v7, v3 offset:44
    s_waitcnt vmcnt(32)
    buffer_load_dwordx4 v2, s[4:7], s9 offen offset:2048 nt lds
    v_subrev_u32 v6, 30, v5
    s_add_u32 m0, m0, 3072
    ds_write_b32 v3, v6 offset:16
    v_add_u32 v5, 3, v5
    s_add_u32 s9, s9, 3072
    s_cmp_lg_u32 m0, s12
    s_cbranch_scc1 L_v33
    s_branch L_next
L_v34:
    s_waitcnt vmcnt(33)
    buffer_load_dwordx4 v2, s[4:7], s9 offen offset:0 nt lds
    s_waitcnt vmcnt(33)
    buffer_load_dwordx4 v2, s[4:7], s9 offen offset:1024 nt lds
    ds_read_b32 v7, v3 offset:44
    s_waitcnt vmcnt(33)
    buffer_load_dwordx4 v2, s[4:7], s9 offen offset:2048 nt lds
    v_subrev_u32 v6, 31, v5
    s_add_u32 m0, m0, 3072
    ds_write_b32 v3, v6 offset:16
    v_add_u32 v5, 3, v5
    s_add_u32 s9, s9, 3072
    s_cmp_lg_u32 m0, s12
    s_cbranch_scc1 L_v34
    s_branch L_next
L_v35:
    s_waitcnt vmcnt(34)
    buffer_load_dwordx4 v2, s[4:7], s9 offen offset:0 nt lds
    s_waitcnt vmcnt(34)
    buffer_load_dwordx4 v2, s[4:7], s9 offen offset:1024 nt lds
    ds_read_b32 v7, v3 offset:44
    s_waitcnt vmcnt(34)
    buffer_load_dwordx4 v2, s[4:7], s9 offen offset:2048 nt lds
    v_subrev_u32 v6, 32, v5
    s_add_u32 m0, m0, 3072
    ds_write_b32 v3, v6 offset:16
    v_add_u32 v5, 3, v5
    s_add_u32 s9, s9, 3072
    s_cmp_lg_u32 m0, s12
    s_cbranch_scc1 L_v35
    s_branch L_next
L_v36:
    s_waitcnt vmcnt(35)
    buffer_load_dwordx4 v2, s[4:7], s9 offen offset:0 nt lds
    s_waitcnt vmcnt(35)
    buffer_load_dwordx4 v2, s[4:7], s9 offen offset:1024 nt lds
    ds_read_b32 v7, v3 offset:44
    s_waitcnt vmcnt(35)
    buffer_load_dwordx4 v2, s[4:7], s9 offen offset:2048 nt lds
    v_subrev_u32 v6, 33, v5
    s_add_u32 m0, m0, 3072
    ds_write_b32 v3, v6 offset:16
    v_add_u32 v5, 3, v5
    s_add_u32 s9, s9, 3072
    s_cmp_lg_u32 m0, s12
    s_cbranch_scc1 L_v36
    s_branch L_next
L_full:
    ds_read_b32 v7, v3 offset:44
    s_waitcnt lgkmcnt(0)
    v_readfirstlane_b32 s11, v7
    s_nop 4
    s_branch L_aj
L_addr:
    s_cmp_lt_u32 s10, 128
    s_cbranch_scc0 L_av
    s_lshr_b32 s80, s10, 5
    s_lshl_b32 s80, s80, 2
    s_add_u32 s80, s80, s16
    s_bfe_u32 s81, s10, 0x30002
    s_bitcmp1_b32 s10, 5
    s_cselect_b32 s82, 7, 0
    s_xor_b32 s81, s81, s82
    s_branch L_ak
L_av:
    s_cmp_eq_u32 s10, 256
    s_cbranch_scc1 L_drain
    s_mov_b32 s4, s56
    s_mov_b32 s5, s57
    s_add_u32 s80, s10, s17
    s_bfe_u32 s81, s10, 0x30004
    s_xor_b32 s81, s81, 7
L_ak:
    s_and_b32 s80, s80, 15
    s_mul_i32 s80, s80, 786432
    s_mul_i32 s81, s81, 50331648
    s_add_u32 s9, s80, s81
    s_add_u32 s9, s9, s8
    s_branch L_aj
L_drain:
    v_mov_b32 v6, 3048
    s_waitcnt vmcnt(24)
    ds_write_b32 v3, v6 offset:16
    v_mov_b32 v6, 3060
    s_waitcnt vmcnt(12)
    ds_write_b32 v3, v6 offset:16
    v_mov_b32 v6, 3072
    s_waitcnt vmcnt(0)
    ds_write_b32 v3, v6 offset:16
    s_endpgm
L_notld:
    s_cmp_gt_u32 s76, 4
    s_cbranch_scc1 L_aux
    v_lshrrev_b32 v21, 4, v1
    v_and_b32 v22, 15, v1
    v_mul_u32_u24 v16, 384, v21
    v_lshl_add_u32 v16, v22, 3, v16
    v_cmp_gt_u32 vcc, 8, v22
    v_xor_b32 v17, 64, v16
    s_mul_i32 s24, s77, 4
    s_and_b32 s24, s24, 15
    s_lshl_b32 s80, s78, 2
    s_add_u32 s80, s80, s76
    s_mul_i32 s83, s80, 1536
    s_mul_i32 s16, s24, 393216
    s_add_u32 s16, s16, s83
    s_waitcnt lgkmcnt(0)
    s_mov_b32 s4, s66
    s_mov_b32 s5, s67
    s_mov_b32 s6, 6291456
    s_mov_b32 s7, 0x20000
    s_mov_b32 s8, s68
    s_mov_b32 s9, s69
    s_mov_b32 s10, 6291456
    s_mov_b32 s11, 0x20000
    buffer_load_dwordx2 v[120:121], v16, s[4:7], s16 offen offset:0
    buffer_load_dwordx2 v[126:127], v17, s[8:11], s16 offen offset:0
    buffer_load_dwordx2 v[122:123], v16, s[4:7], s16 offen offset:128
    buffer_load_dwordx2 v[128:129], v17, s[8:11], s16 offen offset:128
    buffer_load_dwordx2 v[124:125], v16, s[4:7], s16 offen offset:256
    buffer_load_dwordx2 v[130:131], v17, s[8:11], s16 offen offset:256
    s_add_u32 s16, s16, 393216
    buffer_load_dwordx2 v[132:133], v16, s[4:7], s16 offen offset:0
    buffer_load_dwordx2 v[138:139], v17, s[8:11], s16 offen offset:0
    buffer_load_dwordx2 v[134:135], v16, s[4:7], s16 offen offset:128
    buffer_load_dwordx2 v[140:141], v17, s[8:11], s16 offen offset:128
    buffer_load_dwordx2 v[136:137], v16, s[4:7], s16 offen offset:256
    buffer_load_dwordx2 v[142:143], v17, s[8:11], s16 offen offset:256
    s_add_u32 s16, s16, 393216
    buffer_load_dwordx2 v[144:145], v16, s[4:7], s16 offen offset:0
    buffer_load_dwordx2 v[150:151], v17, s[8:11], s16 offen offset:0
    buffer_load_dwordx2 v[146:147], v16, s[4:7], s16 offen offset:128
    buffer_load_dwordx2 v[152:153], v17, s[8:11], s16 offen offset:128
    buffer_load_dwordx2 v[148:149], v16, s[4:7], s16 offen offset:256
    buffer_load_dwordx2 v[154:155], v17, s[8:11], s16 offen offset:256
    s_add_u32 s16, s16, 393216
    buffer_load_dwordx2 v[156:157], v16, s[4:7], s16 offen offset:0
    buffer_load_dwordx2 v[162:163], v17, s[8:11], s16 offen offset:0
    buffer_load_dwordx2 v[158:159], v16, s[4:7], s16 offen offset:128
    buffer_load_dwordx2 v[164:165], v17, s[8:11], s16 offen offset:128
    buffer_load_dwordx2 v[160:161], v16, s[4:7], s16 offen offset:256
    buffer_load_dwordx2 v[166:167], v17, s[8:11], s16 offen offset:256
    s_add_u32 s16, s16, 393216
    s_mov_b32 s12, s74
    s_mov_b32 s13, s75
    s_mov_b32 s14, 1610612736
    s_mov_b32 s15, 0x20000
    s_mov_b32 s22, 0x05040100
    s_mov_b32 s23, 0x07060302
    s_lshl_b32 s80, s76, 2
    v_add_u32 v21, s80, v21
    v_mul_u32_u24 v5, 768, v21
    v_lshl_add_u32 v5, v22, 4, v5
    v_lshlrev_b32 v19, 3, v21
    v_add_u32 v19, 126976, v19
    v_lshlrev_b32 v18, 4, v22
    v_add_u32 v18, 151552, v18
    v_add_u32 v11, s80, v3
    v_mov_b32 v10, 0
    v_mov_b32 v23, 0xff
    s_mul_i32 s17, s76, 3
    s_add_u32 s17, s17, 3
    s_mov_b32 s18, 0
    s_mov_b32 s19, 0
    s_mov_b32 s20, 0
    s_mov_b32 s21, 0
    s_waitcnt vmcnt(18)
    v_cndmask_b32 v24, v130, v128, vcc
    v_cndmask_b32 v25, v131, v129, vcc
    v_cndmask_b32 v26, v126, v130, vcc
    v_cndmask_b32 v27, v127, v131, vcc
    v_cndmask_b32 v28, v128, v126, vcc
    v_cndmask_b32 v29, v129, v127, vcc
    v_perm_b32 v72, v24, v120, s22
    v_perm_b32 v73, v24, v120, s23
    v_perm_b32 v74, v25, v121, s22
    v_perm_b32 v75, v25, v121, s23
    v_perm_b32 v76, v26, v122, s22
    v_perm_b32 v77, v26, v122, s23
    v_perm_b32 v78, v27, v123, s22
    v_perm_b32 v79, v27, v123, s23
    v_perm_b32 v80, v28, v124, s22
    v_perm_b32 v81, v28, v124, s23
    v_perm_b32 v82, v29, v125, s22
    v_perm_b32 v83, v29, v125, s23
    s_waitcnt vmcnt(12)
    v_cndmask_b32 v24, v142, v140, vcc
    v_cndmask_b32 v25, v143, v141, vcc
    v_cndmask_b32 v26, v138, v142, vcc
    v_cndmask_b32 v27, v139, v143, vcc
    v_cndmask_b32 v28, v140, v138, vcc
    v_cndmask_b32 v29, v141, v139, vcc
    v_perm_b32 v84, v24, v132, s22
    v_perm_b32 v85, v24, v132, s23
    v_perm_b32 v86, v25, v133, s22
    v_perm_b32 v87, v25, v133, s23
    v_perm_b32 v88, v26, v134, s22
    v_perm_b32 v89, v26, v134, s23
    v_perm_b32 v90, v27, v135, s22
    v_perm_b32 v91, v27, v135, s23
    v_perm_b32 v92, v28, v136, s22
    v_perm_b32 v93, v28, v136, s23
    v_perm_b32 v94, v29, v137, s22
    v_perm_b32 v95, v29, v137, s23
    s_waitcnt vmcnt(6)
    v_cndmask_b32 v24, v154, v152, vcc
    v_cndmask_b32 v25, v155, v153, vcc
    v_cndmask_b32 v26, v150, v154, vcc
    v_cndmask_b32 v27, v151, v155, vcc
    v_cndmask_b32 v28, v152, v150, vcc
    v_cndmask_b32 v29, v153, v151, vcc
    v_perm_b32 v96, v24, v144, s22
    v_perm_b32 v97, v24, v144, s23
    v_perm_b32 v98, v25, v145, s22
    v_perm_b32 v99, v25, v145, s23
    v_perm_b32 v100, v26, v146, s22
    v_perm_b32 v101, v26, v146, s23
    v_perm_b32 v102, v27, v147, s22
    v_perm_b32 v103, v27, v147, s23
    v_perm_b32 v104, v28, v148, s22
    v_perm_b32 v105, v28, v148, s23
    v_perm_b32 v106, v29, v149, s22
    v_perm_b32 v107, v29, v149, s23
    s_waitcnt vmcnt(0)
    v_cndmask_b32 v24, v166, v164, vcc
    v_cndmask_b32 v25, v167, v165, vcc
    v_cndmask_b32 v26, v162, v166, vcc
    v_cndmask_b32 v27, v163, v167, vcc
    v_cndmask_b32 v28, v164, v162, vcc
    v_cndmask_b32 v29, v165, v163, vcc
    v_perm_b32 v108, v24, v156, s22
    v_perm_b32 v109, v24, v156, s23
    v_perm_b32 v110, v25, v157, s22
    v_perm_b32 v111, v25, v157, s23
    v_perm_b32 v112, v26, v158, s22
    v_perm_b32 v113, v26, v158, s23
    v_perm_b32 v114, v27, v159, s22
    v_perm_b32 v115, v27, v159, s23
    v_perm_b32 v116, v28, v160, s22
    v_perm_b32 v117, v28, v160, s23
    v_perm_b32 v118, v29, v161, s22
    v_perm_b32 v119, v29, v161, s23
    s_nop 1
L_kvisit:
    s_cmp_ge_u32 s16, 6291456
    s_cselect_b32 s80, 6291456, 0
    s_sub_u32 s16, s16, s80
    s_and_b32 s26, s20, 1
    s_cmp_lt_u32 s21, 3
    s_cselect_b32 s26, s26, 9
    s_bitcmp1_b32 s21, 0
    s_cselect_b32 s82, 7, 0
    s_xor_b32 s82, s82, s20
    s_mul_i32 s80, s82, 768
    v_add_u32 v6, s80, v18
    s_lshl_b32 s80, s82, 4
    s_add_u32 s80, s80, s24
    s_lshl_b32 s81, s80, 7
    v_add_u32 v8, s81, v19
    s_nop 1
L_qw:
    ds_read_b32 v4, v3 offset:32
    ds_read_b128 v[48:51], v6 offset:0
    ds_read_b128 v[52:55], v6 offset:256
    ds_read_b128 v[56:59], v6 offset:512
    s_waitcnt lgkmcnt(0)
    v_readfirstlane_b32 s80, v4
    s_nop 0
    s_cmp_gt_u32 s80, s82
    s_nop 2
    s_cbranch_scc1 L_qwg
    s_sleep 2
    s_branch L_qw
L_qwg:
    s_cmp_eq_u32 s26, 0
    s_cbranch_scc0 L_nc0
    buffer_load_dwordx2 v[60:61], v16, s[4:7], s16 offen offset:0
L_nc0:
    s_cmp_eq_u32 s26, 1
    s_cbranch_scc0 L_nd0
    buffer_load_dwordx2 v[64:65], v16, s[4:7], s16 offen offset:256
L_nd0:
    v_dot2_f32_bf16 v24, v72, v48, 0
    v_dot2_f32_bf16 v25, v73, v49, 0
    v_dot2_f32_bf16 v26, v74, v50, 0
    v_dot2_f32_bf16 v27, v75, v51, 0
    v_dot2_f32_bf16 v28, v76, v52, 0
    v_dot2_f32_bf16 v29, v77, v53, 0
    v_dot2_f32_bf16 v30, v78, v54, 0
    v_dot2_f32_bf16 v31, v79, v55, 0
    v_dot2_f32_bf16 v32, v80, v56, 0
    v_dot2_f32_bf16 v33, v81, v57, 0
    v_dot2_f32_bf16 v34, v82, v58, 0
    v_dot2_f32_bf16 v35, v83, v59, 0
    v_add_u32 v6, s19, v5
    v_pk_add_f32 v[14:15], v[24:25], v[26:27]
    v_pk_add_f32 v[14:15], v[14:15], v[28:29]
    v_pk_add_f32 v[14:15], v[14:15], v[30:31]
    v_pk_add_f32 v[14:15], v[14:15], v[32:33]
    v_pk_add_f32 v[14:15], v[14:15], v[34:35]
    s_cmp_ge_i32 s18, s17
    s_nop 0
    s_cbranch_scc1 L_kw0g
L_kw0:
    ds_read_b32 v4, v3 offset:16
    s_waitcnt lgkmcnt(0)
    v_readfirstlane_b32 s18, v4
    s_nop 0
    s_cmp_ge_i32 s18, s17
    s_nop 2
    s_cbranch_scc1 L_kw0g
    s_sleep 1
    s_branch L_kw0
L_kw0g:
    ds_read_b128 v[36:39], v6 offset:0
    ds_read_b128 v[40:43], v6 offset:256
    ds_read_b128 v[44:47], v6 offset:512
    v_add_u32 v10, 1, v10
    s_add_u32 s19, s19, 12288
    s_cmp_eq_u32 s19, 110592
    s_cselect_b32 s19, 0, s19
    s_add_u32 s17, s17, 12
    s_waitcnt lgkmcnt(2)
    v_cvt_f32_i32 v36, v36
    v_cvt_f32_i32 v37, v37
    v_cvt_f32_i32 v38, v38
    v_cvt_f32_i32 v39, v39
    v_pk_mul_f32 v[12:13], v[36:37], v[24:25]
    v_pk_fma_f32 v[12:13], v[38:39], v[26:27], v[12:13]
    s_waitcnt lgkmcnt(1)
    v_cvt_f32_i32 v40, v40
    v_cvt_f32_i32 v41, v41
    v_cvt_f32_i32 v42, v42
    v_cvt_f32_i32 v43, v43
    v_pk_fma_f32 v[12:13], v[40:41], v[28:29], v[12:13]
    v_pk_fma_f32 v[12:13], v[42:43], v[30:31], v[12:13]
    s_waitcnt lgkmcnt(0)
    v_cvt_f32_i32 v44, v44
    v_cvt_f32_i32 v45, v45
    v_cvt_f32_i32 v46, v46
    v_cvt_f32_i32 v47, v47
    v_pk_fma_f32 v[12:13], v[44:45], v[32:33], v[12:13]
    v_pk_fma_f32 v[12:13], v[46:47], v[34:35], v[12:13]
    v_add_f32 v12, v12, v13
    v_add_f32 v13, v14, v15
    s_nop 0
    v_add_f32_dpp v12, v12, v12 quad_perm:[1,0,3,2] row_mask:0xf bank_mask:0xf
    v_add_f32_dpp v13, v13, v13 quad_perm:[1,0,3,2] row_mask:0xf bank_mask:0xf
    s_nop 0
    v_add_f32_dpp v12, v12, v12 quad_perm:[2,3,0,1] row_mask:0xf bank_mask:0xf
    v_add_f32_dpp v13, v13, v13 quad_perm:[2,3,0,1] row_mask:0xf bank_mask:0xf
    s_nop 0
    v_add_f32_dpp v12, v12, v12 row_half_mirror row_mask:0xf bank_mask:0xf
    v_add_f32_dpp v13, v13, v13 row_half_mirror row_mask:0xf bank_mask:0xf
    s_nop 0
    v_add_f32_dpp v12, v12, v12 row_mirror row_mask:0xf bank_mask:0xf
    v_add_f32_dpp v13, v13, v13 row_mirror row_mask:0xf bank_mask:0xf
    ds_write_b64 v8, v[12:13] offset:0
    ds_write_b32 v11, v10
    s_cmp_eq_u32 s26, 0
    s_cbranch_scc0 L_nc1
    buffer_load_dwordx2 v[66:67], v17, s[8:11], s16 offen offset:0
L_nc1:
    s_cmp_eq_u32 s26, 1
    s_cbranch_scc0 L_nd1
    buffer_load_dwordx2 v[70:71], v17, s[8:11], s16 offen offset:256
    s_add_u32 s16, s16, 393216
L_nd1:
    v_dot2_f32_bf16 v24, v84, v48, 0
    v_dot2_f32_bf16 v25, v85, v49, 0
    v_dot2_f32_bf16 v26, v86, v50, 0
    v_dot2_f32_bf16 v27, v87, v51, 0
    v_dot2_f32_bf16 v28, v88, v52, 0
    v_dot2_f32_bf16 v29, v89, v53, 0
    v_dot2_f32_bf16 v30, v90, v54, 0
    v_dot2_f32_bf16 v31, v91, v55, 0
    v_dot2_f32_bf16 v32, v92, v56, 0
    v_dot2_f32_bf16 v33, v93, v57, 0
    v_dot2_f32_bf16 v34, v94, v58, 0
    v_dot2_f32_bf16 v35, v95, v59, 0
    v_add_u32 v6, s19, v5
    v_pk_add_f32 v[14:15], v[24:25], v[26:27]
    v_pk_add_f32 v[14:15], v[14:15], v[28:29]
    v_pk_add_f32 v[14:15], v[14:15], v[30:31]
    v_pk_add_f32 v[14:15], v[14:15], v[32:33]
    v_pk_add_f32 v[14:15], v[14:15], v[34:35]
    s_cmp_ge_i32 s18, s17
    s_nop 0
    s_cbranch_scc1 L_kw1g
L_kw1:
    ds_read_b32 v4, v3 offset:16
    s_waitcnt lgkmcnt(0)
    v_readfirstlane_b32 s18, v4
    s_nop 0
    s_cmp_ge_i32 s18, s17
    s_nop 2
    s_cbranch_scc1 L_kw1g
    s_sleep 1
    s_branch L_kw1
L_kw1g:
    ds_read_b128 v[36:39], v6 offset:0
    ds_read_b128 v[40:43], v6 offset:256
    ds_read_b128 v[44:47], v6 offset:512
    v_add_u32 v10, 1, v10
    s_add_u32 s19, s19, 12288
    s_cmp_eq_u32 s19, 110592
    s_cselect_b32 s19, 0, s19
    s_add_u32 s17, s17, 12
    s_waitcnt lgkmcnt(2)
    v_cvt_f32_i32 v36, v36
    v_cvt_f32_i32 v37, v37
    v_cvt_f32_i32 v38, v38
    v_cvt_f32_i32 v39, v39
    v_pk_mul_f32 v[12:13], v[36:37], v[24:25]
    v_pk_fma_f32 v[12:13], v[38:39], v[26:27], v[12:13]
    s_waitcnt lgkmcnt(1)
    v_cvt_f32_i32 v40, v40
    v_cvt_f32_i32 v41, v41
    v_cvt_f32_i32 v42, v42
    v_cvt_f32_i32 v43, v43
    v_pk_fma_f32 v[12:13], v[40:41], v[28:29], v[12:13]
    v_pk_fma_f32 v[12:13], v[42:43], v[30:31], v[12:13]
    s_waitcnt lgkmcnt(0)
    v_cvt_f32_i32 v44, v44
    v_cvt_f32_i32 v45, v45
    v_cvt_f32_i32 v46, v46
    v_cvt_f32_i32 v47, v47
    v_pk_fma_f32 v[12:13], v[44:45], v[32:33], v[12:13]
    v_pk_fma_f32 v[12:13], v[46:47], v[34:35], v[12:13]
    v_add_f32 v12, v12, v13
    v_add_f32 v13, v14, v15
    s_nop 0
    v_add_f32_dpp v12, v12, v12 quad_perm:[1,0,3,2] row_mask:0xf bank_mask:0xf
    v_add_f32_dpp v13, v13, v13 quad_perm:[1,0,3,2] row_mask:0xf bank_mask:0xf
    s_nop 0
    v_add_f32_dpp v12, v12, v12 quad_perm:[2,3,0,1] row_mask:0xf bank_mask:0xf
    v_add_f32_dpp v13, v13, v13 quad_perm:[2,3,0,1] row_mask:0xf bank_mask:0xf
    s_nop 0
    v_add_f32_dpp v12, v12, v12 row_half_mirror row_mask:0xf bank_mask:0xf
    v_add_f32_dpp v13, v13, v13 row_half_mirror row_mask:0xf bank_mask:0xf
    s_nop 0
    v_add_f32_dpp v12, v12, v12 row_mirror row_mask:0xf bank_mask:0xf
    v_add_f32_dpp v13, v13, v13 row_mirror row_mask:0xf bank_mask:0xf
    ds_write_b64 v8, v[12:13] offset:128
    ds_write_b32 v11, v10
    s_cmp_eq_u32 s26, 0
    s_cbranch_scc0 L_nc2
    buffer_load_dwordx2 v[62:63], v16, s[4:7], s16 offen offset:128
L_nc2:
    v_dot2_f32_bf16 v24, v96, v48, 0
    v_dot2_f32_bf16 v25, v97, v49, 0
    v_dot2_f32_bf16 v26, v98, v50, 0
    v_dot2_f32_bf16 v27, v99, v51, 0
    v_dot2_f32_bf16 v28, v100, v52, 0
    v_dot2_f32_bf16 v29, v101, v53, 0
    v_dot2_f32_bf16 v30, v102, v54, 0
    v_dot2_f32_bf16 v31, v103, v55, 0
    v_dot2_f32_bf16 v32, v104, v56, 0
    v_dot2_f32_bf16 v33, v105, v57, 0
    v_dot2_f32_bf16 v34, v106, v58, 0
    v_dot2_f32_bf16 v35, v107, v59, 0
    v_add_u32 v6, s19, v5
    v_pk_add_f32 v[14:15], v[24:25], v[26:27]
    v_pk_add_f32 v[14:15], v[14:15], v[28:29]
    v_pk_add_f32 v[14:15], v[14:15], v[30:31]
    v_pk_add_f32 v[14:15], v[14:15], v[32:33]
    v_pk_add_f32 v[14:15], v[14:15], v[34:35]
    s_cmp_ge_i32 s18, s17
    s_nop 0
    s_cbranch_scc1 L_kw2g
L_kw2:
    ds_read_b32 v4, v3 offset:16
    s_waitcnt lgkmcnt(0)
    v_readfirstlane_b32 s18, v4
    s_nop 0
    s_cmp_ge_i32 s18, s17
    s_nop 2
    s_cbranch_scc1 L_kw2g
    s_sleep 1
    s_branch L_kw2
L_kw2g:
    ds_read_b128 v[36:39], v6 offset:0
    ds_read_b128 v[40:43], v6 offset:256
    ds_read_b128 v[44:47], v6 offset:512
    v_add_u32 v10, 1, v10
    s_add_u32 s19, s19, 12288
    s_cmp_eq_u32 s19, 110592
    s_cselect_b32 s19, 0, s19
    s_add_u32 s17, s17, 12
    s_waitcnt lgkmcnt(2)
    v_cvt_f32_i32 v36, v36
    v_cvt_f32_i32 v37, v37
    v_cvt_f32_i32 v38, v38
    v_cvt_f32_i32 v39, v39
    v_pk_mul_f32 v[12:13], v[36:37], v[24:25]
    v_pk_fma_f32 v[12:13], v[38:39], v[26:27], v[12:13]
    s_waitcnt lgkmcnt(1)
    v_cvt_f32_i32 v40, v40
    v_cvt_f32_i32 v41, v41
    v_cvt_f32_i32 v42, v42
    v_cvt_f32_i32 v43, v43
    v_pk_fma_f32 v[12:13], v[40:41], v[28:29], v[12:13]
    v_pk_fma_f32 v[12:13], v[42:43], v[30:31], v[12:13]
    s_waitcnt lgkmcnt(0)
    v_cvt_f32_i32 v44, v44
    v_cvt_f32_i32 v45, v45
    v_cvt_f32_i32 v46, v46
    v_cvt_f32_i32 v47, v47
    v_pk_fma_f32 v[12:13], v[44:45], v[32:33], v[12:13]
    v_pk_fma_f32 v[12:13], v[46:47], v[34:35], v[12:13]
    v_add_f32 v12, v12, v13
    v_add_f32 v13, v14, v15
    s_nop 0
    v_add_f32_dpp v12, v12, v12 quad_perm:[1,0,3,2] row_mask:0xf bank_mask:0xf
    v_add_f32_dpp v13, v13, v13 quad_perm:[1,0,3,2] row_mask:0xf bank_mask:0xf
    s_nop 0
    v_add_f32_dpp v12, v12, v12 quad_perm:[2,3,0,1] row_mask:0xf bank_mask:0xf
    v_add_f32_dpp v13, v13, v13 quad_perm:[2,3,0,1] row_mask:0xf bank_mask:0xf
    s_nop 0
    v_add_f32_dpp v12, v12, v12 row_half_mirror row_mask:0xf bank_mask:0xf
    v_add_f32_dpp v13, v13, v13 row_half_mirror row_mask:0xf bank_mask:0xf
    s_nop 0
    v_add_f32_dpp v12, v12, v12 row_mirror row_mask:0xf bank_mask:0xf
    v_add_f32_dpp v13, v13, v13 row_mirror row_mask:0xf bank_mask:0xf
    ds_write_b64 v8, v[12:13] offset:256
    ds_write_b32 v11, v10
    s_cmp_eq_u32 s26, 0
    s_cbranch_scc0 L_nc3
    buffer_load_dwordx2 v[68:69], v17, s[8:11], s16 offen offset:128
L_nc3:
    v_dot2_f32_bf16 v24, v108, v48, 0
    v_dot2_f32_bf16 v25, v109, v49, 0
    v_dot2_f32_bf16 v26, v110, v50, 0
    v_dot2_f32_bf16 v27, v111, v51, 0
    v_dot2_f32_bf16 v28, v112, v52, 0
    v_dot2_f32_bf16 v29, v113, v53, 0
    v_dot2_f32_bf16 v30, v114, v54, 0
    v_dot2_f32_bf16 v31, v115, v55, 0
    v_dot2_f32_bf16 v32, v116, v56, 0
    v_dot2_f32_bf16 v33, v117, v57, 0
    v_dot2_f32_bf16 v34, v118, v58, 0
    v_dot2_f32_bf16 v35, v119, v59, 0
    v_add_u32 v6, s19, v5
    v_pk_add_f32 v[14:15], v[24:25], v[26:27]
    v_pk_add_f32 v[14:15], v[14:15], v[28:29]
    v_pk_add_f32 v[14:15], v[14:15], v[30:31]
    v_pk_add_f32 v[14:15], v[14:15], v[32:33]
    v_pk_add_f32 v[14:15], v[14:15], v[34:35]
    s_cmp_ge_i32 s18, s17
    s_nop 0
    s_cbranch_scc1 L_kw3g
L_kw3:
    ds_read_b32 v4, v3 offset:16
    s_waitcnt lgkmcnt(0)
    v_readfirstlane_b32 s18, v4
    s_nop 0
    s_cmp_ge_i32 s18, s17
    s_nop 2
    s_cbranch_scc1 L_kw3g
    s_sleep 1
    s_branch L_kw3
L_kw3g:
    ds_read_b128 v[36:39], v6 offset:0
    ds_read_b128 v[40:43], v6 offset:256
    ds_read_b128 v[44:47], v6 offset:512
    v_add_u32 v10, 1, v10
    s_add_u32 s19, s19, 12288
    s_cmp_eq_u32 s19, 110592
    s_cselect_b32 s19, 0, s19
    s_add_u32 s17, s17, 12
    s_waitcnt lgkmcnt(2)
    v_cvt_f32_i32 v36, v36
    v_cvt_f32_i32 v37, v37
    v_cvt_f32_i32 v38, v38
    v_cvt_f32_i32 v39, v39
    v_pk_mul_f32 v[12:13], v[36:37], v[24:25]
    v_pk_fma_f32 v[12:13], v[38:39], v[26:27], v[12:13]
    s_waitcnt lgkmcnt(1)
    v_cvt_f32_i32 v40, v40
    v_cvt_f32_i32 v41, v41
    v_cvt_f32_i32 v42, v42
    v_cvt_f32_i32 v43, v43
    v_pk_fma_f32 v[12:13], v[40:41], v[28:29], v[12:13]
    v_pk_fma_f32 v[12:13], v[42:43], v[30:31], v[12:13]
    s_waitcnt lgkmcnt(0)
    v_cvt_f32_i32 v44, v44
    v_cvt_f32_i32 v45, v45
    v_cvt_f32_i32 v46, v46
    v_cvt_f32_i32 v47, v47
    v_pk_fma_f32 v[12:13], v[44:45], v[32:33], v[12:13]
    v_pk_fma_f32 v[12:13], v[46:47], v[34:35], v[12:13]
    v_add_f32 v12, v12, v13
    v_add_f32 v13, v14, v15
    s_nop 0
    v_add_f32_dpp v12, v12, v12 quad_perm:[1,0,3,2] row_mask:0xf bank_mask:0xf
    v_add_f32_dpp v13, v13, v13 quad_perm:[1,0,3,2] row_mask:0xf bank_mask:0xf
    s_nop 0
    v_add_f32_dpp v12, v12, v12 quad_perm:[2,3,0,1] row_mask:0xf bank_mask:0xf
    v_add_f32_dpp v13, v13, v13 quad_perm:[2,3,0,1] row_mask:0xf bank_mask:0xf
    s_nop 0
    v_add_f32_dpp v12, v12, v12 row_half_mirror row_mask:0xf bank_mask:0xf
    v_add_f32_dpp v13, v13, v13 row_half_mirror row_mask:0xf bank_mask:0xf
    s_nop 0
    v_add_f32_dpp v12, v12, v12 row_mirror row_mask:0xf bank_mask:0xf
    v_add_f32_dpp v13, v13, v13 row_mirror row_mask:0xf bank_mask:0xf
    ds_write_b64 v8, v[12:13] offset:384
    ds_write_b32 v11, v10
    s_add_u32 s20, s20, 1
    s_and_b32 s80, s20, 1
    s_cbranch_scc1 L_kvisit
    v_mov_b64 v[120:121], v[132:133]
    v_mov_b64 v[122:123], v[134:135]
    v_mov_b64 v[124:125], v[136:137]
    v_mov_b64 v[126:127], v[138:139]
    v_mov_b64 v[128:129], v[140:141]
    v_mov_b64 v[130:131], v[142:143]
    v_mov_b64 v[132:133], v[144:145]
    v_mov_b64 v[134:135], v[146:147]
    v_mov_b64 v[136:137], v[148:149]
    v_mov_b64 v[138:139], v[150:151]
    v_mov_b64 v[140:141], v[152:153]
    v_mov_b64 v[142:143], v[154:155]
    v_mov_b64 v[144:145], v[156:157]
    v_mov_b64 v[146:147], v[158:159]
    v_mov_b64 v[148:149], v[160:161]
    v_mov_b64 v[150:151], v[162:163]
    v_mov_b64 v[152:153], v[164:165]
    v_mov_b64 v[154:155], v[166:167]
    s_waitcnt vmcnt(0)
    v_cndmask_b32 v24, v70, v68, vcc
    v_cndmask_b32 v25, v71, v69, vcc
    v_cndmask_b32 v26, v66, v70, vcc
    v_cndmask_b32 v27, v67, v71, vcc
    v_cndmask_b32 v28, v68, v66, vcc
    v_cndmask_b32 v29, v69, v67, vcc
    v_perm_b32 v156, v24, v60, s22
    v_perm_b32 v157, v24, v60, s23
    v_perm_b32 v158, v25, v61, s22
    v_perm_b32 v159, v25, v61, s23
    v_perm_b32 v160, v26, v62, s22
    v_perm_b32 v161, v26, v62, s23
    v_perm_b32 v162, v27, v63, s22
    v_perm_b32 v163, v27, v63, s23
    v_perm_b32 v164, v28, v64, s22
    v_perm_b32 v165, v28, v64, s23
    v_perm_b32 v166, v29, v65, s22
    v_perm_b32 v167, v29, v65, s23
    s_cmp_lt_u32 s20, 8
    s_nop 0
    s_cbranch_scc1 L_kvisit
    v_mov_b64 v[72:73], v[120:121]
    v_mov_b64 v[74:75], v[122:123]
    v_mov_b64 v[76:77], v[124:125]
    v_mov_b64 v[78:79], v[126:127]
    v_mov_b64 v[80:81], v[128:129]
    v_mov_b64 v[82:83], v[130:131]
    v_mov_b64 v[84:85], v[132:133]
    v_mov_b64 v[86:87], v[134:135]
    v_mov_b64 v[88:89], v[136:137]
    v_mov_b64 v[90:91], v[138:139]
    v_mov_b64 v[92:93], v[140:141]
    v_mov_b64 v[94:95], v[142:143]
    v_mov_b64 v[96:97], v[144:145]
    v_mov_b64 v[98:99], v[146:147]
    v_mov_b64 v[100:101], v[148:149]
    v_mov_b64 v[102:103], v[150:151]
    v_mov_b64 v[104:105], v[152:153]
    v_mov_b64 v[106:107], v[154:155]
    v_mov_b64 v[108:109], v[156:157]
    v_mov_b64 v[110:111], v[158:159]
    v_mov_b64 v[112:113], v[160:161]
    v_mov_b64 v[114:115], v[162:163]
    v_mov_b64 v[116:117], v[164:165]
    v_mov_b64 v[118:119], v[166:167]
    s_mov_b32 s20, 0
    s_add_u32 s24, s24, 4
    s_and_b32 s24, s24, 15
    s_add_u32 s21, s21, 1
    s_cmp_lt_u32 s21, 4
    s_cbranch_scc1 L_kvisit
    v_lshrrev_b32 v21, 2, v1
    v_and_b32 v22, 3, v1
    v_mul_u32_u24 v5, 768, v21
    v_lshl_add_u32 v5, v22, 4, v5
    s_mul_i32 s80, s76, 192
    v_add_u32 v5, s80, v5
    v_lshlrev_b32 v19, 3, v21
    v_add_u32 v19, 126976, v19
    v_lshrrev_b32 v21, 4, v1
    v_lshl_add_u32 v7, v21, 2, v22
    v_and_b32 v21, 1, v7
    v_lshlrev_b32 v7, 4, v7
    s_lshl_b32 s80, s76, 8
    v_add_u32 v7, s80, v7
    v_lshlrev_b32 v18, 3, v21
    v_add_u32 v18, 157696, v18
    v_add_u32 v16, 143360, v7
    s_mov_b32 s32, 0x000f000f
    s_mov_b32 s33, 0x000f000f
    s_mov_b32 s17, 1548
    s_mul_i32 s24, s77, 4
    s_and_b32 s24, s24, 15
    s_mov_b32 s20, 0
    s_add_u32 s25, s77, 0
    s_mul_i32 s25, s25, 64
    s_add_u32 s25, s25, s78
    s_lshl_b32 s25, s25, 10
L_vhead:
    v_mov_b64 v[24:25], 0
    v_mov_b64 v[26:27], 0
    v_mov_b64 v[28:29], 0
    v_mov_b64 v[30:31], 0
    v_mov_b64 v[32:33], 0
    v_mov_b64 v[34:35], 0
    s_mov_b32 s21, 0
    s_nop 0
L_pw:
    ds_read_b64 v[36:37], v3 offset:32
    ds_read_b32 v4, v3 offset:40
    ds_read_b64 v[14:15], v18
    s_waitcnt lgkmcnt(0)
    v_readfirstlane_b32 s80, v37
    v_readfirstlane_b32 s28, v4
    s_cmp_gt_u32 s80, s20
    s_nop 3
    s_cbranch_scc1 L_pwg
    s_sleep 2
    s_branch L_pw
L_pwg:
    s_lshr_b32 s29, s28, 8
    s_lshr_b32 s30, s28, 16
L_vstep:
    s_xor_b32 s80, s20, 7
    s_lshl_b32 s80, s80, 4
    s_add_u32 s80, s80, s24
    s_lshl_b32 s80, s80, 7
    v_add_u32 v8, s80, v19
    v_add_u32 v6, s19, v5
    ds_read_b32 v12, v8
    s_cmp_ge_i32 s18, s17
    s_cbranch_scc1 L_vwg
L_vw:
    ds_read_b32 v4, v3 offset:16
    s_waitcnt lgkmcnt(0)
    v_readfirstlane_b32 s18, v4
    s_nop 0
    s_cmp_ge_i32 s18, s17
    s_nop 2
    s_cbranch_scc1 L_vwg
    s_sleep 1
    s_branch L_vw
L_vwg:
    ds_read_b128 v[36:39], v6 offset:0
    ds_read_b128 v[40:43], v6 offset:64
    ds_read_b128 v[44:47], v6 offset:128
    v_add_u32 v10, 1, v10
    s_add_u32 s19, s19, 12288
    s_cmp_eq_u32 s19, 110592
    s_cselect_b32 s19, 0, s19
    s_add_u32 s17, s17, 12
    s_add_u32 s24, s24, 1
    s_and_b32 s24, s24, 15
    s_add_u32 s21, s21, 1
    s_cmp_lt_u32 s21, 16
    s_waitcnt lgkmcnt(2)
    v_cvt_f32_i32 v36, v36
    v_cvt_f32_i32 v37, v37
    v_cvt_f32_i32 v38, v38
    v_cvt_f32_i32 v39, v39
    v_pk_fma_f32 v[24:25], v[36:37], v[12:13], v[24:25] op_sel_hi:[1,0,1]
    v_pk_fma_f32 v[26:27], v[38:39], v[12:13], v[26:27] op_sel_hi:[1,0,1]
    s_waitcnt lgkmcnt(1)
    v_cvt_f32_i32 v40, v40
    v_cvt_f32_i32 v41, v41
    v_cvt_f32_i32 v42, v42
    v_cvt_f32_i32 v43, v43
    v_pk_fma_f32 v[28:29], v[40:41], v[12:13], v[28:29] op_sel_hi:[1,0,1]
    v_pk_fma_f32 v[30:31], v[42:43], v[12:13], v[30:31] op_sel_hi:[1,0,1]
    s_waitcnt lgkmcnt(0)
    v_cvt_f32_i32 v44, v44
    v_cvt_f32_i32 v45, v45
    v_cvt_f32_i32 v46, v46
    v_cvt_f32_i32 v47, v47
    v_pk_fma_f32 v[32:33], v[44:45], v[12:13], v[32:33] op_sel_hi:[1,0,1]
    v_pk_fma_f32 v[34:35], v[46:47], v[12:13], v[34:35] op_sel_hi:[1,0,1]
    s_nop 1
    s_cbranch_scc0 L_vend
    ds_write_b32 v11, v10
    s_branch L_vstep
L_vend:
    v_permlane32_swap_b32 v24, v26
    v_permlane32_swap_b32 v25, v27
    v_permlane32_swap_b32 v28, v30
    v_permlane32_swap_b32 v29, v31
    v_permlane32_swap_b32 v32, v34
    v_permlane32_swap_b32 v33, v35
    v_pk_add_f32 v[24:25], v[24:25], v[26:27]
    v_pk_add_f32 v[28:29], v[28:29], v[30:31]
    v_pk_add_f32 v[32:33], v[32:33], v[34:35]
    v_permlane16_swap_b32 v24, v25
    v_permlane16_swap_b32 v28, v29
    v_permlane16_swap_b32 v32, v33
    v_add_f32 v36, v24, v25
    v_add_f32 v37, v28, v29
    v_add_f32 v38, v32, v33
    v_mov_b32 v39, v14
    v_add_f32_dpp v36, v36, v36 row_ror:4 row_mask:0xf bank_mask:0xf
    v_add_f32_dpp v37, v37, v37 row_ror:4 row_mask:0xf bank_mask:0xf
    v_add_f32_dpp v38, v38, v38 row_ror:4 row_mask:0xf bank_mask:0xf
    v_add_f32_dpp v36, v36, v36 row_ror:8 row_mask:0xf bank_mask:0xf
    v_add_f32_dpp v37, v37, v37 row_ror:8 row_mask:0xf bank_mask:0xf
    v_add_f32_dpp v38, v38, v38 row_ror:8 row_mask:0xf bank_mask:0xf
    v_sub_f32 v36, v36, v15
    v_sub_f32 v37, v37, v15
    v_sub_f32 v38, v38, v15
    v_bfi_b32 v36, v23, s28, v36
    v_bfi_b32 v37, v23, s29, v37
    v_bfi_b32 v38, v23, s30, v38
    s_add_u32 s20, s20, 1
    s_cmp_eq_u32 s20, 8
    s_mov_b64 exec, s[32:33]
    s_cbranch_scc1 L_vlast
    ds_write_b128 v16, v[36:39]
    s_mov_b64 exec, -1
    ds_write_b32 v11, v10
    v_add_u32 v16, 1024, v16
    v_add_u32 v18, 16, v18
    s_nop 1
    s_branch L_vhead
L_vlast:
    buffer_store_dwordx4 v[36:39], v7, s[12:15], s25 offen sc0 sc1
    s_endpgm
    s_nop 0
L_aux:
    s_cmp_eq_u32 s76, 5
    s_cbranch_scc0 L_pacer
    v_lshlrev_b32 v5, 3, v1
    v_cmp_gt_u32 vcc, 24, v1
    v_mov_b32 v13, 0xffffff40
    v_mov_b32 v10, 192
    v_cndmask_b32 v13, v13, v10, vcc
    v_add_u32 v6, v5, v13
    v_mov_b32 v10, 0x80008000
    v_cndmask_b32 v7, 0, v10, vcc
    v_lshrrev_b32 v10, 1, v1
    v_and_b32 v11, 15, v10
    v_lshrrev_b32 v10, 4, v10
    v_mul_u32_u24 v10, 131072, v10
    v_mul_u32_u24 v11, 2048, v11
    v_add_u32 v10, v10, v11
    v_and_b32 v11, 1, v1
    v_lshl_add_u32 v17, v11, 4, v10
    v_add_u32 v10, 0, v1
    v_mul_u32_u24 v12, 2731, v10
    v_lshrrev_b32 v12, 16, v12
    v_mul_u32_u24 v12, 1152, v12
    v_lshl_add_u32 v56, v10, 4, v12
    v_add_u32 v10, 64, v1
    v_mul_u32_u24 v12, 2731, v10
    v_lshrrev_b32 v12, 16, v12
    v_mul_u32_u24 v12, 1152, v12
    v_lshl_add_u32 v57, v10, 4, v12
    v_add_u32 v10, 128, v1
    v_mul_u32_u24 v12, 2731, v10
    v_lshrrev_b32 v12, 16, v12
    v_mul_u32_u24 v12, 1152, v12
    v_lshl_add_u32 v58, v10, 4, v12
    v_cmp_eq_u32 s[32:33], 0, v11
    s_lshl_b32 s27, s77, 15
    s_lshl_b32 s80, s78, 5
    s_add_u32 s27, s27, s80
    s_mov_b32 m0, 143360
    s_waitcnt lgkmcnt(0)
    s_mov_b32 s4, s62
    s_mov_b32 s5, s63
    s_mov_b32 s6, 384
    s_mov_b32 s7, 0x20000
    s_mov_b32 s20, s64
    s_mov_b32 s21, s65
    s_mov_b32 s22, 384
    s_mov_b32 s23, 0x20000
    buffer_load_dwordx2 v[28:29], v5, s[4:7], 0 offen
    buffer_load_dwordx2 v[30:31], v5, s[20:23], 0 offen
    s_mov_b32 s4, s48
    s_mov_b32 s5, s49
    s_mov_b32 s6, 12288
    s_mov_b32 s7, 0x20000
    s_mul_i32 s80, s77, 384
    buffer_load_dwordx4 v56, s[4:7], s80 offen lds
    s_add_u32 m0, m0, 1024
    s_nop 0
    buffer_load_dwordx4 v57, s[4:7], s80 offen lds
    s_add_u32 m0, m0, 1024
    s_nop 0
    buffer_load_dwordx4 v58, s[4:7], s80 offen lds
    s_add_u32 m0, m0, 1024
    s_and_b32 s80, s78, 3
    s_lshl_b32 s80, s80, 3
    v_lshrrev_b32 v10, 3, v1
    v_add_u32 v10, s80, v10
    v_and_b32 v11, 15, v10
    v_lshrrev_b32 v10, 4, v10
    v_mul_u32_u24 v10, 131072, v10
    v_mul_u32_u24 v11, 2048, v11
    v_add_u32 v10, v10, v11
    v_and_b32 v11, 7, v1
    v_lshl_add_u32 v62, v11, 4, v10
    s_mov_b32 s20, s52
    s_mov_b32 s21, s53
    s_mov_b32 s22, 1048576
    s_mov_b32 s23, 0x20000
    s_andn2_b32 s80, s27, 127
    buffer_load_dwordx4 v[64:67], v62, s[20:23], s80 offen
    s_add_u32 s80, s80, 262144
    buffer_load_dwordx4 v[64:67], v62, s[20:23], s80 offen
    s_add_u32 s80, s80, 262144
    buffer_load_dwordx4 v[64:67], v62, s[20:23], s80 offen
    s_add_u32 s80, s80, 262144
    buffer_load_dwordx4 v[64:67], v62, s[20:23], s80 offen
    s_add_u32 s80, s80, 262144
    s_mov_b32 s20, s54
    s_mov_b32 s21, s55
    s_mov_b32 s22, 1048576
    s_mov_b32 s23, 0x20000
    s_andn2_b32 s80, s27, 127
    buffer_load_dwordx4 v[64:67], v62, s[20:23], s80 offen
    s_add_u32 s80, s80, 262144
    buffer_load_dwordx4 v[64:67], v62, s[20:23], s80 offen
    s_add_u32 s80, s80, 262144
    buffer_load_dwordx4 v[64:67], v62, s[20:23], s80 offen
    s_add_u32 s80, s80, 262144
    buffer_load_dwordx4 v[64:67], v62, s[20:23], s80 offen
    s_add_u32 s80, s80, 262144
    s_mov_b32 s20, s58
    s_mov_b32 s21, s59
    s_mov_b32 s22, 1048576
    s_mov_b32 s23, 0x20000
    s_andn2_b32 s80, s27, 127
    buffer_load_dwordx4 v[64:67], v62, s[20:23], s80 offen
    s_add_u32 s80, s80, 262144
    buffer_load_dwordx4 v[64:67], v62, s[20:23], s80 offen
    s_add_u32 s80, s80, 262144
    buffer_load_dwordx4 v[64:67], v62, s[20:23], s80 offen
    s_add_u32 s80, s80, 262144
    buffer_load_dwordx4 v[64:67], v62, s[20:23], s80 offen
    s_add_u32 s80, s80, 262144
    s_mov_b32 s20, s60
    s_mov_b32 s21, s61
    s_mov_b32 s22, 1048576
    s_mov_b32 s23, 0x20000
    s_andn2_b32 s80, s27, 127
    buffer_load_dwordx4 v[64:67], v62, s[20:23], s80 offen
    s_add_u32 s80, s80, 262144
    buffer_load_dwordx4 v[64:67], v62, s[20:23], s80 offen
    s_add_u32 s80, s80, 262144
    buffer_load_dwordx4 v[64:67], v62, s[20:23], s80 offen
    s_add_u32 s80, s80, 262144
    buffer_load_dwordx4 v[64:67], v62, s[20:23], s80 offen
    s_add_u32 s80, s80, 262144
    s_mov_b32 s12, s74
    s_mov_b32 s13, s75
    s_mov_b32 s14, 1610612736
    s_mov_b32 s15, 0x20000
    s_mov_b32 s8, s72
    s_mov_b32 s9, s73
    s_mov_b32 s10, 256
    s_mov_b32 s11, 0x20000
    s_mov_b32 s16, s70
    s_mov_b32 s17, s71
    s_mov_b32 s18, 12288
    s_mov_b32 s19, 0x20000
    v_mov_b32 v14, 0xff
    v_add_u32 v15, 143360, v5
    v_add_u32 v16, 143360, v6
    v_lshlrev_b32 v8, 1, v5
    v_lshlrev_b32 v9, 1, v6
    v_add_u32 v8, 151552, v8
    v_add_u32 v9, 151552, v9
    v_mov_b32 v12, 0
    s_mov_b32 s24, 0
    s_waitcnt vmcnt(19)
    v_xor_b32 v30, v30, v7
    v_xor_b32 v31, v31, v7
    v_lshlrev_b32 v32, 16, v28
    v_and_b32 v33, 0xffff0000, v28
    v_lshlrev_b32 v34, 16, v29
    v_and_b32 v35, 0xffff0000, v29
    v_lshlrev_b32 v36, 16, v30
    v_and_b32 v37, 0xffff0000, v30
    v_lshlrev_b32 v38, 16, v31
    v_and_b32 v39, 0xffff0000, v31
    v_and_b32 v7, 0x80000000, v7
    s_waitcnt vmcnt(16)
    s_mov_b32 exec_hi, 0xffff
L_hq:
    ds_read_b64 v[20:21], v15
    ds_read_b64 v[22:23], v16
    v_add_u32 v15, 384, v15
    v_add_u32 v16, 384, v16
    v_add_u32 v12, 1, v12
    s_waitcnt lgkmcnt(0)
    v_lshlrev_b32 v40, 16, v20
    v_and_b32 v41, 0xffff0000, v20
    v_lshlrev_b32 v42, 16, v21
    v_and_b32 v43, 0xffff0000, v21
    v_lshlrev_b32 v44, 16, v22
    v_and_b32 v45, 0xffff0000, v22
    v_lshlrev_b32 v46, 16, v23
    v_and_b32 v47, 0xffff0000, v23
    v_pk_mul_f32 v[40:41], v[40:41], v[32:33]
    v_pk_mul_f32 v[44:45], v[44:45], v[36:37]
    v_pk_mul_f32 v[42:43], v[42:43], v[34:35]
    v_pk_mul_f32 v[46:47], v[46:47], v[38:39]
    v_cvt_pk_bf16_f32 v40, v40, v44
    v_cvt_pk_bf16_f32 v41, v41, v45
    v_cvt_pk_bf16_f32 v42, v42, v46
    v_cvt_pk_bf16_f32 v43, v43, v47
    v_and_b32 v44, 0xffff0000, v40
    v_lshlrev_b32 v40, 16, v40
    v_and_b32 v45, 0xffff0000, v41
    v_lshlrev_b32 v41, 16, v41
    v_and_b32 v46, 0xffff0000, v42
    v_lshlrev_b32 v42, 16, v42
    v_and_b32 v47, 0xffff0000, v43
    v_lshlrev_b32 v43, 16, v43
    v_pk_add_f32 v[40:41], v[40:41], v[44:45]
    v_pk_add_f32 v[42:43], v[42:43], v[46:47]
    v_cvt_pk_bf16_f32 v48, v40, v40
    v_cvt_pk_bf16_f32 v49, v41, v41
    v_cvt_pk_bf16_f32 v50, v42, v42
    v_cvt_pk_bf16_f32 v51, v43, v43
    v_xor_b32 v48, v48, v7
    v_xor_b32 v49, v49, v7
    v_xor_b32 v50, v50, v7
    v_xor_b32 v51, v51, v7
    ds_write_b16 v8, v48 offset:0
    ds_write_b16_d16_hi v9, v48 offset:2
    ds_write_b16 v8, v49 offset:4
    ds_write_b16_d16_hi v9, v49 offset:6
    ds_write_b16 v8, v50 offset:8
    ds_write_b16_d16_hi v9, v50 offset:10
    ds_write_b16 v8, v51 offset:12
    ds_write_b16_d16_hi v9, v51 offset:14
    ds_write_b32 v3, v12 offset:32
    v_add_u32 v8, 768, v8
    v_add_u32 v9, 768, v9
    s_add_u32 s24, s24, 1
    s_cmp_lt_u32 s24, 8
    s_cbranch_scc1 L_hq
    s_mov_b32 exec_hi, -1
    s_add_u32 s80, s77, 0
    s_mul_i32 s80, s80, 64
    s_add_u32 s80, s80, s78
    s_lshl_b32 s80, s80, 10
    buffer_load_dwordx4 v[64:67], v2, s[12:15], s80 offen
    s_add_u32 s80, s80, 262144
    v_mov_b32 v15, 0
    s_mov_b32 s25, 0
    s_cmp_eq_u32 s2, 0
    s_cbranch_scc1 L_epc
L_epw:
    s_sleep 16
    ds_read_b32 v4, v3 offset:20
    s_waitcnt lgkmcnt(0)
    v_readfirstlane_b32 s80, v4
    s_nop 0
    s_cmp_lt_i32 s80, 16
    s_nop 2
    s_cbranch_scc1 L_epw
    s_load_dword s28, s[72:73], 0
    s_waitcnt lgkmcnt(0)
    s_cmp_lg_u32 s28, 0
    s_cbranch_scc1 L_epd
L_ep:
    s_mov_b64 exec, 1
    buffer_load_dword v11, v15, s[8:11], 0 offen sc0 sc1
    s_waitcnt vmcnt(0)
    v_readfirstlane_b32 s28, v11
    s_mov_b64 exec, -1
    s_cmp_lg_u32 s28, 0
    s_nop 2
    s_cbranch_scc1 L_epd
    s_sleep 32
    s_add_u32 s25, s25, 1
    s_cmp_lt_u32 s25, 8
    s_cbranch_scc1 L_ep
L_epc:
    s_mul_i32 s28, s84, 0x9e3779b1
    s_lshr_b32 s81, s28, 15
    s_xor_b32 s28, s28, s81
    s_mul_i32 s28, s28, 0x85ebca6b
    s_lshr_b32 s81, s28, 13
    s_xor_b32 s28, s28, s81
    s_max_u32 s28, s28, 1
    v_mov_b32 v20, s28
    v_mov_b32 v21, 0
    s_mov_b64 exec, 1
    buffer_atomic_cmpswap v[20:21], v15, s[8:11], 0 offen sc0 sc1
    s_waitcnt vmcnt(0)
    v_readfirstlane_b32 s80, v20
    s_mov_b64 exec, -1
    s_cmp_eq_u32 s80, 0
    s_cselect_b32 s28, s28, s80
    s_nop 1
L_epd:
    v_mov_b32 v12, s28
    ds_write_b32 v3, v12 offset:40
    s_lshr_b32 s29, s28, 8
    s_lshr_b32 s30, s28, 16
    s_lshr_b32 s31, s28, 24
    s_add_u32 s24, s77, 16
    s_mov_b32 s25, 0
    s_mov_b32 s20, s52
    s_mov_b32 s21, s53
    s_mov_b32 s22, 1048576
    s_mov_b32 s23, 0x20000
L_sc:
    s_sleep 16
    ds_read_b32 v4, v3 offset:20
    s_waitcnt lgkmcnt(0)
    v_readfirstlane_b32 s80, v4
    s_nop 0
    s_cmp_lt_i32 s80, s24
    s_nop 2
    s_cbranch_scc1 L_sc
    s_lshr_b32 s80, s78, 2
    s_add_u32 s80, s80, s25
    s_and_b32 s80, s80, 15
    s_lshl_b32 s81, s80, 10
    s_add_u32 m0, s81, 110592
    s_mov_b64 s[20:21], s[52:53]
    s_cmp_ge_u32 s80, 4
    s_cselect_b64 s[20:21], s[54:55], s[20:21]
    s_cmp_ge_u32 s80, 8
    s_cselect_b64 s[20:21], s[58:59], s[20:21]
    s_cmp_ge_u32 s80, 12
    s_cselect_b64 s[20:21], s[60:61], s[20:21]
    s_and_b32 s80, s80, 3
    s_mul_i32 s80, s80, 262144
    s_add_u32 s80, s80, s27
    buffer_load_dwordx4 v17, s[20:23], s80 offen  lds
    s_add_u32 s25, s25, 1
    s_add_u32 s24, s24, 4
    s_cmp_lt_u32 s25, 16
    s_cbranch_scc1 L_sc
    s_waitcnt vmcnt(0)
    v_mov_b32 v28, 0
    v_mov_b32 v29, 0
    v_mov_b32 v30, 0
    v_mov_b32 v31, 0
    v_mov_b32 v32, 0
    v_mov_b32 v33, 0
    v_mov_b32 v34, 0
    v_mov_b32 v35, 0
    v_mov_b32 v36, 0
    v_mov_b32 v37, 0
    v_mov_b32 v38, 0
    v_mov_b32 v39, 0
    v_mov_b32 v40, 0
    v_mov_b32 v41, 0
    v_mov_b32 v42, 0
    v_mov_b32 v43, 0
    v_mov_b32 v44, 0
    v_mov_b32 v45, 0
    v_mov_b32 v46, 0
    v_mov_b32 v47, 0
    v_mov_b32 v48, 0
    v_mov_b32 v49, 0
    v_mov_b32 v50, 0
    v_mov_b32 v51, 0
    v_mov_b32 v64, 0
    v_mov_b32 v65, 0
    v_mov_b32 v66, 0
    v_mov_b32 v67, 0
    v_mov_b32 v68, 0
    v_mov_b32 v69, 0
    v_mov_b32 v70, 0
    v_mov_b32 v71, 0
    v_lshlrev_b32 v15, 3, v1
    v_add_u32 v15, 141312, v15
    v_lshlrev_b32 v16, 1, v1
    v_add_u32 v16, 114176, v16
    v_mov_b32 v8, 157696
    v_mov_b32 v9, 0
    s_mov_b32 s24, 100
    s_nop 0
L_hp:
    s_sleep 8
    ds_read_b128 v[56:59], v3
    s_waitcnt lgkmcnt(0)
    v_min3_i32 v56, v56, v57, v58
    v_min_i32 v56, v56, v59
    s_nop 0
    v_readfirstlane_b32 s80, v56
    s_nop 0
    s_cmp_lt_i32 s80, s24
    s_nop 2
    s_cbranch_scc1 L_hp
    ds_read_b64 v[72:73], v15 offset:0
    ds_read_u16_d16_hi v28, v16 offset:0
    ds_read_u16_d16_hi v64, v16 offset:4096
    ds_read_b64 v[74:75], v15 offset:512
    ds_read_u16_d16_hi v29, v16 offset:128
    ds_read_u16_d16_hi v65, v16 offset:4224
    ds_read_b64 v[76:77], v15 offset:1024
    ds_read_u16_d16_hi v30, v16 offset:256
    ds_read_u16_d16_hi v66, v16 offset:4352
    ds_read_b64 v[78:79], v15 offset:1536
    ds_read_u16_d16_hi v31, v16 offset:384
    ds_read_u16_d16_hi v67, v16 offset:4480
    s_waitcnt lgkmcnt(0)
    ds_read_u16_d16_hi v36, v16 offset:8192
    ds_read_u16_d16_hi v44, v16 offset:12288
    ds_read_u16_d16_hi v37, v16 offset:8320
    ds_read_u16_d16_hi v45, v16 offset:12416
    ds_read_u16_d16_hi v38, v16 offset:8448
    ds_read_u16_d16_hi v46, v16 offset:12544
    ds_read_u16_d16_hi v39, v16 offset:8576
    ds_read_u16_d16_hi v47, v16 offset:12672
    v_fma_f32 v20, -v64, v73, v72
    v_fma_f32 v21, -v65, v75, v74
    v_fma_f32 v22, -v66, v77, v76
    v_fma_f32 v23, -v67, v79, v78
    v_mul_f32 v20, v20, v28
    v_mul_f32 v21, v21, v29
    v_mul_f32 v22, v22, v30
    v_mul_f32 v23, v23, v31
    v_mul_f32 v20, 0x3dd53b95, v20
    v_mul_f32 v21, 0x3dd53b95, v21
    v_mul_f32 v22, 0x3dd53b95, v22
    v_mul_f32 v23, 0x3dd53b95, v23
    v_mov_b32 v52, v20
    v_max_f32 v52, v52, v21
    v_max_f32 v52, v52, v22
    v_max_f32 v52, v52, v23
    s_nop 1
    v_max_f32_dpp v52, v52, v52 quad_perm:[1,0,3,2] row_mask:0xf bank_mask:0xf
    s_nop 1
    v_max_f32_dpp v52, v52, v52 quad_perm:[2,3,0,1] row_mask:0xf bank_mask:0xf
    s_nop 1
    v_max_f32_dpp v52, v52, v52 row_half_mirror row_mask:0xf bank_mask:0xf
    s_nop 1
    v_max_f32_dpp v52, v52, v52 row_mirror row_mask:0xf bank_mask:0xf
    v_mov_b32 v13, v52
    s_nop 1
    v_permlane32_swap_b32 v52, v13
    v_max_f32 v52, v52, v13
    v_mov_b32 v13, v52
    s_nop 1
    v_permlane16_swap_b32 v52, v13
    v_max_f32 v52, v52, v13
    v_sub_f32 v20, v20, v52
    v_sub_f32 v21, v21, v52
    v_sub_f32 v22, v22, v52
    v_sub_f32 v23, v23, v52
    v_exp_f32 v20, v20
    v_exp_f32 v21, v21
    v_exp_f32 v22, v22
    v_exp_f32 v23, v23
    v_mov_b32 v54, v20
    v_add_f32 v54, v54, v21
    v_add_f32 v54, v54, v22
    v_add_f32 v54, v54, v23
    s_waitcnt lgkmcnt(0)
    v_mul_f32 v20, v20, v36
    v_mul_f32 v21, v21, v37
    v_mul_f32 v22, v22, v38
    v_mul_f32 v23, v23, v39
    v_mul_f32 v53, v20, v44
    v_fmac_f32 v53, v21, v45
    v_fmac_f32 v53, v22, v46
    v_fmac_f32 v53, v23, v47
    ds_write_b32 v15, v20 offset:0
    ds_write_b32 v15, v21 offset:512
    ds_write_b32 v15, v22 offset:1024
    ds_write_b32 v15, v23 offset:1536
    v_add_f32_dpp v54, v54, v54 quad_perm:[1,0,3,2] row_mask:0xf bank_mask:0xf
    s_nop 1
    v_add_f32_dpp v54, v54, v54 quad_perm:[2,3,0,1] row_mask:0xf bank_mask:0xf
    s_nop 1
    v_add_f32_dpp v54, v54, v54 row_half_mirror row_mask:0xf bank_mask:0xf
    s_nop 1
    v_add_f32_dpp v54, v54, v54 row_mirror row_mask:0xf bank_mask:0xf
    v_mov_b32 v13, v54
    s_nop 1
    v_permlane32_swap_b32 v54, v13
    v_add_f32 v54, v54, v13
    v_mov_b32 v13, v54
    s_nop 1
    v_permlane16_swap_b32 v54, v13
    v_add_f32 v54, v54, v13
    v_add_f32_dpp v53, v53, v53 quad_perm:[1,0,3,2] row_mask:0xf bank_mask:0xf
    s_nop 1
    v_add_f32_dpp v53, v53, v53 quad_perm:[2,3,0,1] row_mask:0xf bank_mask:0xf
    s_nop 1
    v_add_f32_dpp v53, v53, v53 row_half_mirror row_mask:0xf bank_mask:0xf
    s_nop 1
    v_add_f32_dpp v53, v53, v53 row_mirror row_mask:0xf bank_mask:0xf
    v_mov_b32 v13, v53
    s_nop 1
    v_permlane32_swap_b32 v53, v13
    v_add_f32 v53, v53, v13
    v_mov_b32 v13, v53
    s_nop 1
    v_permlane16_swap_b32 v53, v13
    v_add_f32 v53, v53, v13
    v_bfi_b32 v54, v14, s31, v54
    v_mov_b32 v55, v53
    v_add_u32 v9, 1, v9
    s_mov_b64 exec, 1
    ds_write_b128 v8, v[52:55]
    ds_write_b32 v3, v9 offset:36
    s_mov_b64 exec, -1
    v_add_u32 v15, -2048, v15
    v_add_u32 v16, -512, v16
    v_add_u32 v8, 16, v8
    s_add_u32 s24, s24, 4
    s_cmp_le_u32 s24, 128
    s_cbranch_scc1 L_hp
    s_add_u32 s26, s77, 28
    s_mul_i32 s26, s26, 64
    s_add_u32 s26, s26, s78
    s_lshl_b32 s26, s26, 10
    s_lshr_b32 s34, s2, 3
    s_and_b32 s35, s2, 7
    v_lshrrev_b32 v10, 3, v1
    v_and_b32 v16, 7, v1
    v_lshlrev_b32 v10, 10, v10
    v_lshl_add_u32 v15, v16, 4, v10
    v_lshrrev_b32 v10, 2, v16
    v_and_b32 v16, 3, v16
    v_lshl_add_u32 v16, v16, 2, v10
    v_lshlrev_b32 v16, 1, v16
    v_bfe_u32 v10, v1, 4, 1
    v_lshl_add_u32 v16, v10, 6, v16
    v_lshrrev_b32 v10, 5, v1
    v_lshl_add_u32 v16, v10, 5, v16
    s_mov_b32 s25, 0
    s_mov_b32 s38, 0
    s_mul_i32 s36, s34, 65536
    s_lshl_b32 s83, s35, 7
    s_add_u32 s36, s36, s83
    s_mul_i32 s37, s34, 384
    s_lshr_b32 s83, s35, 1
    s_mul_i32 s83, s83, 96
    s_add_u32 s37, s37, s83
    s_and_b32 s83, s35, 1
    s_lshl_b32 s83, s83, 2
    s_add_u32 s37, s37, s83
    s_mov_b32 s40, s74
    s_mov_b32 s41, s75
    s_mov_b32 s42, 1610612736
    s_mov_b32 s43, 0x20000
    s_mov_b32 s16, s70
    s_mov_b32 s17, s71
    s_mov_b32 s18, 12288
    s_mov_b32 s19, 0x20000
    v_add_u32 v13, 143360, v2
    s_nop 1
L_hf:
    s_sleep 32
    ds_read_b128 v[56:59], v3
    s_waitcnt lgkmcnt(0)
    v_min3_i32 v56, v56, v57, v58
    v_min_i32 v56, v56, v59
    s_nop 0
    v_readfirstlane_b32 s80, v56
    s_nop 0
    s_cmp_lt_i32 s80, 240
    s_nop 2
    s_cbranch_scc1 L_hf
    ds_read_b128 v[140:143], v13 offset:0
    ds_read_b128 v[144:147], v13 offset:1024
    ds_read_b128 v[148:151], v13 offset:2048
    ds_read_b128 v[152:155], v13 offset:3072
    ds_read_b128 v[156:159], v13 offset:4096
    ds_read_b128 v[160:163], v13 offset:5120
    ds_read_b128 v[164:167], v13 offset:6144
L_hn:
    s_sleep 2
    ds_read_b32 v4, v3 offset:16
    s_waitcnt lgkmcnt(0)
    v_readfirstlane_b32 s80, v4
    s_nop 0
    s_cmp_lt_i32 s80, 3042
    s_nop 2
    s_cbranch_scc1 L_hn
    buffer_store_dwordx4 v[140:143], v2, s[12:15], s26 offen sc0 sc1
    s_sub_u32 s26, s26, 262144
    buffer_store_dwordx4 v[144:147], v2, s[12:15], s26 offen sc0 sc1
    s_sub_u32 s26, s26, 262144
    buffer_store_dwordx4 v[148:151], v2, s[12:15], s26 offen sc0 sc1
    s_sub_u32 s26, s26, 262144
    buffer_store_dwordx4 v[152:155], v2, s[12:15], s26 offen sc0 sc1
    s_sub_u32 s26, s26, 262144
    buffer_store_dwordx4 v[156:159], v2, s[12:15], s26 offen sc0 sc1
    s_sub_u32 s26, s26, 262144
    buffer_store_dwordx4 v[160:163], v2, s[12:15], s26 offen sc0 sc1
    s_sub_u32 s26, s26, 262144
    buffer_store_dwordx4 v[164:167], v2, s[12:15], s26 offen sc0 sc1
    s_sub_u32 s26, s26, 262144
    s_nop 0
L_hl:
    s_sleep 1
    ds_read_b32 v4, v3 offset:16
    s_waitcnt lgkmcnt(0)
    v_readfirstlane_b32 s80, v4
    s_nop 0
    s_cmp_lt_i32 s80, 3072
    s_nop 2
    s_cbranch_scc1 L_hl
    s_mov_b32 s80, s36
    buffer_load_dwordx4 v[44:47], v15, s[40:43], s80 offen sc0 sc1
    s_add_u32 s80, s80, 8192
    buffer_load_dwordx4 v[48:51], v15, s[40:43], s80 offen sc0 sc1
    s_add_u32 s80, s80, 8192
    buffer_load_dwordx4 v[52:55], v15, s[40:43], s80 offen sc0 sc1
    s_add_u32 s80, s80, 8192
    buffer_load_dwordx4 v[56:59], v15, s[40:43], s80 offen sc0 sc1
    s_add_u32 s80, s80, 8192
    buffer_load_dwordx4 v[60:63], v15, s[40:43], s80 offen sc0 sc1
    s_add_u32 s80, s80, 8192
    buffer_load_dwordx4 v[64:67], v15, s[40:43], s80 offen sc0 sc1
    s_add_u32 s80, s80, 8192
    buffer_load_dwordx4 v[68:71], v15, s[40:43], s80 offen sc0 sc1
    s_add_u32 s80, s80, 8192
    buffer_load_dwordx4 v[72:75], v15, s[40:43], s80 offen sc0 sc1
    s_waitcnt vmcnt(7)
    v_xor_b32 v12, s28, v44
    v_bitop3_b32 v12, v12, v45, s29 bitop3:0xf6
    v_bitop3_b32 v12, v12, v46, s30 bitop3:0xf6
    v_xor_b32 v13, s31, v47
    s_waitcnt vmcnt(6)
    v_bitop3_b32 v12, v12, v48, s28 bitop3:0xf6
    v_bitop3_b32 v12, v12, v49, s29 bitop3:0xf6
    v_bitop3_b32 v12, v12, v50, s30 bitop3:0xf6
    v_bitop3_b32 v13, v13, v51, s31 bitop3:0xf6
    s_waitcnt vmcnt(5)
    v_bitop3_b32 v12, v12, v52, s28 bitop3:0xf6
    v_bitop3_b32 v12, v12, v53, s29 bitop3:0xf6
    v_bitop3_b32 v12, v12, v54, s30 bitop3:0xf6
    v_bitop3_b32 v13, v13, v55, s31 bitop3:0xf6
    s_waitcnt vmcnt(4)
    v_bitop3_b32 v12, v12, v56, s28 bitop3:0xf6
    v_bitop3_b32 v12, v12, v57, s29 bitop3:0xf6
    v_bitop3_b32 v12, v12, v58, s30 bitop3:0xf6
    v_bitop3_b32 v13, v13, v59, s31 bitop3:0xf6
    s_waitcnt vmcnt(3)
    v_bitop3_b32 v12, v12, v60, s28 bitop3:0xf6
    v_bitop3_b32 v12, v12, v61, s29 bitop3:0xf6
    v_bitop3_b32 v12, v12, v62, s30 bitop3:0xf6
    v_bitop3_b32 v13, v13, v63, s31 bitop3:0xf6
    s_waitcnt vmcnt(2)
    v_bitop3_b32 v12, v12, v64, s28 bitop3:0xf6
    v_bitop3_b32 v12, v12, v65, s29 bitop3:0xf6
    v_bitop3_b32 v12, v12, v66, s30 bitop3:0xf6
    v_bitop3_b32 v13, v13, v67, s31 bitop3:0xf6
    s_waitcnt vmcnt(1)
    v_bitop3_b32 v12, v12, v68, s28 bitop3:0xf6
    v_bitop3_b32 v12, v12, v69, s29 bitop3:0xf6
    v_bitop3_b32 v12, v12, v70, s30 bitop3:0xf6
    v_bitop3_b32 v13, v13, v71, s31 bitop3:0xf6
    s_waitcnt vmcnt(0)
    v_bitop3_b32 v12, v12, v72, s28 bitop3:0xf6
    v_bitop3_b32 v12, v12, v73, s29 bitop3:0xf6
    v_bitop3_b32 v12, v12, v74, s30 bitop3:0xf6
    v_bitop3_b32 v13, v13, v75, s31 bitop3:0xf6
    v_cndmask_b32 v13, v13, 0, s[32:33]
    v_bitop3_b32 v12, v12, v13, v14 bitop3:0xa8
    v_cmp_ne_u32 vcc, 0, v12
    s_nop 4
    s_cbranch_vccz L_ok0
    s_mov_b32 s80, s36
    buffer_load_dwordx4 v[44:47], v15, s[40:43], s80 offen sc0 sc1
    s_add_u32 s80, s80, 8192
    buffer_load_dwordx4 v[48:51], v15, s[40:43], s80 offen sc0 sc1
    s_add_u32 s80, s80, 8192
    buffer_load_dwordx4 v[52:55], v15, s[40:43], s80 offen sc0 sc1
    s_add_u32 s80, s80, 8192
    buffer_load_dwordx4 v[56:59], v15, s[40:43], s80 offen sc0 sc1
    s_add_u32 s80, s80, 8192
    buffer_load_dwordx4 v[60:63], v15, s[40:43], s80 offen sc0 sc1
    s_add_u32 s80, s80, 8192
    buffer_load_dwordx4 v[64:67], v15, s[40:43], s80 offen sc0 sc1
    s_add_u32 s80, s80, 8192
    buffer_load_dwordx4 v[68:71], v15, s[40:43], s80 offen sc0 sc1
    s_add_u32 s80, s80, 8192
    buffer_load_dwordx4 v[72:75], v15, s[40:43], s80 offen sc0 sc1
    s_sleep 6
L_try:
    s_mov_b32 s80, s36
    buffer_load_dwordx4 v[76:79], v15, s[40:43], s80 offen sc0 sc1
    s_add_u32 s80, s80, 8192
    buffer_load_dwordx4 v[80:83], v15, s[40:43], s80 offen sc0 sc1
    s_add_u32 s80, s80, 8192
    buffer_load_dwordx4 v[84:87], v15, s[40:43], s80 offen sc0 sc1
    s_add_u32 s80, s80, 8192
    buffer_load_dwordx4 v[88:91], v15, s[40:43], s80 offen sc0 sc1
    s_add_u32 s80, s80, 8192
    buffer_load_dwordx4 v[92:95], v15, s[40:43], s80 offen sc0 sc1
    s_add_u32 s80, s80, 8192
    buffer_load_dwordx4 v[96:99], v15, s[40:43], s80 offen sc0 sc1
    s_add_u32 s80, s80, 8192
    buffer_load_dwordx4 v[100:103], v15, s[40:43], s80 offen sc0 sc1
    s_add_u32 s80, s80, 8192
    buffer_load_dwordx4 v[104:107], v15, s[40:43], s80 offen sc0 sc1
    s_waitcnt vmcnt(15)
    v_xor_b32 v12, s28, v44
    v_bitop3_b32 v12, v12, v45, s29 bitop3:0xf6
    v_bitop3_b32 v12, v12, v46, s30 bitop3:0xf6
    v_xor_b32 v13, s31, v47
    s_waitcnt vmcnt(14)
    v_bitop3_b32 v12, v12, v48, s28 bitop3:0xf6
    v_bitop3_b32 v12, v12, v49, s29 bitop3:0xf6
    v_bitop3_b32 v12, v12, v50, s30 bitop3:0xf6
    v_bitop3_b32 v13, v13, v51, s31 bitop3:0xf6
    s_waitcnt vmcnt(13)
    v_bitop3_b32 v12, v12, v52, s28 bitop3:0xf6
    v_bitop3_b32 v12, v12, v53, s29 bitop3:0xf6
    v_bitop3_b32 v12, v12, v54, s30 bitop3:0xf6
    v_bitop3_b32 v13, v13, v55, s31 bitop3:0xf6
    s_waitcnt vmcnt(12)
    v_bitop3_b32 v12, v12, v56, s28 bitop3:0xf6
    v_bitop3_b32 v12, v12, v57, s29 bitop3:0xf6
    v_bitop3_b32 v12, v12, v58, s30 bitop3:0xf6
    v_bitop3_b32 v13, v13, v59, s31 bitop3:0xf6
    s_waitcnt vmcnt(11)
    v_bitop3_b32 v12, v12, v60, s28 bitop3:0xf6
    v_bitop3_b32 v12, v12, v61, s29 bitop3:0xf6
    v_bitop3_b32 v12, v12, v62, s30 bitop3:0xf6
    v_bitop3_b32 v13, v13, v63, s31 bitop3:0xf6
    s_waitcnt vmcnt(10)
    v_bitop3_b32 v12, v12, v64, s28 bitop3:0xf6
    v_bitop3_b32 v12, v12, v65, s29 bitop3:0xf6
    v_bitop3_b32 v12, v12, v66, s30 bitop3:0xf6
    v_bitop3_b32 v13, v13, v67, s31 bitop3:0xf6
    s_waitcnt vmcnt(9)
    v_bitop3_b32 v12, v12, v68, s28 bitop3:0xf6
    v_bitop3_b32 v12, v12, v69, s29 bitop3:0xf6
    v_bitop3_b32 v12, v12, v70, s30 bitop3:0xf6
    v_bitop3_b32 v13, v13, v71, s31 bitop3:0xf6
    s_waitcnt vmcnt(8)
    v_bitop3_b32 v12, v12, v72, s28 bitop3:0xf6
    v_bitop3_b32 v12, v12, v73, s29 bitop3:0xf6
    v_bitop3_b32 v12, v12, v74, s30 bitop3:0xf6
    v_bitop3_b32 v13, v13, v75, s31 bitop3:0xf6
    v_cndmask_b32 v13, v13, 0, s[32:33]
    v_bitop3_b32 v12, v12, v13, v14 bitop3:0xa8
    v_cmp_ne_u32 vcc, 0, v12
    s_nop 4
    s_cbranch_vccz L_ok0
    s_mov_b32 s80, s36
    buffer_load_dwordx4 v[44:47], v15, s[40:43], s80 offen sc0 sc1
    s_add_u32 s80, s80, 8192
    buffer_load_dwordx4 v[48:51], v15, s[40:43], s80 offen sc0 sc1
    s_add_u32 s80, s80, 8192
    buffer_load_dwordx4 v[52:55], v15, s[40:43], s80 offen sc0 sc1
    s_add_u32 s80, s80, 8192
    buffer_load_dwordx4 v[56:59], v15, s[40:43], s80 offen sc0 sc1
    s_add_u32 s80, s80, 8192
    buffer_load_dwordx4 v[60:63], v15, s[40:43], s80 offen sc0 sc1
    s_add_u32 s80, s80, 8192
    buffer_load_dwordx4 v[64:67], v15, s[40:43], s80 offen sc0 sc1
    s_add_u32 s80, s80, 8192
    buffer_load_dwordx4 v[68:71], v15, s[40:43], s80 offen sc0 sc1
    s_add_u32 s80, s80, 8192
    buffer_load_dwordx4 v[72:75], v15, s[40:43], s80 offen sc0 sc1
    s_waitcnt vmcnt(15)
    v_xor_b32 v12, s28, v76
    v_bitop3_b32 v12, v12, v77, s29 bitop3:0xf6
    v_bitop3_b32 v12, v12, v78, s30 bitop3:0xf6
    v_xor_b32 v13, s31, v79
    s_waitcnt vmcnt(14)
    v_bitop3_b32 v12, v12, v80, s28 bitop3:0xf6
    v_bitop3_b32 v12, v12, v81, s29 bitop3:0xf6
    v_bitop3_b32 v12, v12, v82, s30 bitop3:0xf6
    v_bitop3_b32 v13, v13, v83, s31 bitop3:0xf6
    s_waitcnt vmcnt(13)
    v_bitop3_b32 v12, v12, v84, s28 bitop3:0xf6
    v_bitop3_b32 v12, v12, v85, s29 bitop3:0xf6
    v_bitop3_b32 v12, v12, v86, s30 bitop3:0xf6
    v_bitop3_b32 v13, v13, v87, s31 bitop3:0xf6
    s_waitcnt vmcnt(12)
    v_bitop3_b32 v12, v12, v88, s28 bitop3:0xf6
    v_bitop3_b32 v12, v12, v89, s29 bitop3:0xf6
    v_bitop3_b32 v12, v12, v90, s30 bitop3:0xf6
    v_bitop3_b32 v13, v13, v91, s31 bitop3:0xf6
    s_waitcnt vmcnt(11)
    v_bitop3_b32 v12, v12, v92, s28 bitop3:0xf6
    v_bitop3_b32 v12, v12, v93, s29 bitop3:0xf6
    v_bitop3_b32 v12, v12, v94, s30 bitop3:0xf6
    v_bitop3_b32 v13, v13, v95, s31 bitop3:0xf6
    s_waitcnt vmcnt(10)
    v_bitop3_b32 v12, v12, v96, s28 bitop3:0xf6
    v_bitop3_b32 v12, v12, v97, s29 bitop3:0xf6
    v_bitop3_b32 v12, v12, v98, s30 bitop3:0xf6
    v_bitop3_b32 v13, v13, v99, s31 bitop3:0xf6
    s_waitcnt vmcnt(9)
    v_bitop3_b32 v12, v12, v100, s28 bitop3:0xf6
    v_bitop3_b32 v12, v12, v101, s29 bitop3:0xf6
    v_bitop3_b32 v12, v12, v102, s30 bitop3:0xf6
    v_bitop3_b32 v13, v13, v103, s31 bitop3:0xf6
    s_waitcnt vmcnt(8)
    v_bitop3_b32 v12, v12, v104, s28 bitop3:0xf6
    v_bitop3_b32 v12, v12, v105, s29 bitop3:0xf6
    v_bitop3_b32 v12, v12, v106, s30 bitop3:0xf6
    v_bitop3_b32 v13, v13, v107, s31 bitop3:0xf6
    v_cndmask_b32 v13, v13, 0, s[32:33]
    v_bitop3_b32 v12, v12, v13, v14 bitop3:0xa8
    v_cmp_ne_u32 vcc, 0, v12
    s_nop 4
    s_cbranch_vccz L_ok1
    s_add_u32 s25, s25, 1
    s_cmp_lt_u32 s25, 2000000
    s_cbranch_scc1 L_try
L_ok1:
    v_max_f32 v11, v79, v83
    v_max3_f32 v11, v11, v87, v91
    v_max3_f32 v11, v11, v95, v99
    v_max3_f32 v11, v11, v103, v107
    s_nop 1
    v_max_f32_dpp v11, v11, v11 row_ror:8 row_mask:0xf bank_mask:0xf
    v_mov_b32 v13, v11
    s_nop 1
    v_permlane32_swap_b32 v11, v13
    v_max_f32 v11, v11, v13
    v_mov_b32 v13, v11
    s_nop 1
    v_permlane16_swap_b32 v11, v13
    v_max_f32 v11, v11, v13
    s_nop 1
    v_mov_b32_dpp v11, v11 quad_perm:[0,0,2,2] row_mask:0xf bank_mask:0xf
    s_nop 1
    v_sub_f32_dpp v20, v79, v11 quad_perm:[0,0,2,2] row_mask:0xf bank_mask:0xf
    v_sub_f32_dpp v21, v83, v11 quad_perm:[0,0,2,2] row_mask:0xf bank_mask:0xf
    v_sub_f32_dpp v22, v87, v11 quad_perm:[0,0,2,2] row_mask:0xf bank_mask:0xf
    v_sub_f32_dpp v23, v91, v11 quad_perm:[0,0,2,2] row_mask:0xf bank_mask:0xf
    v_sub_f32_dpp v24, v95, v11 quad_perm:[0,0,2,2] row_mask:0xf bank_mask:0xf
    v_sub_f32_dpp v25, v99, v11 quad_perm:[0,0,2,2] row_mask:0xf bank_mask:0xf
    v_sub_f32_dpp v26, v103, v11 quad_perm:[0,0,2,2] row_mask:0xf bank_mask:0xf
    v_sub_f32_dpp v27, v107, v11 quad_perm:[0,0,2,2] row_mask:0xf bank_mask:0xf
    v_exp_f32 v20, v20
    v_exp_f32 v21, v21
    v_exp_f32 v22, v22
    v_exp_f32 v23, v23
    v_exp_f32 v24, v24
    v_exp_f32 v25, v25
    v_exp_f32 v26, v26
    v_exp_f32 v27, v27
    v_pk_mul_f32 v[40:41], v[76:77], v[20:21] op_sel:[0,0] op_sel_hi:[1,0]
    v_pk_mul_f32 v[42:43], v[78:79], v[20:21] op_sel:[0,0] op_sel_hi:[1,0]
    v_pk_fma_f32 v[40:41], v[80:81], v[20:21], v[40:41] op_sel:[0,1,0] op_sel_hi:[1,1,1]
    v_pk_fma_f32 v[42:43], v[82:83], v[20:21], v[42:43] op_sel:[0,1,0] op_sel_hi:[1,1,1]
    v_pk_fma_f32 v[40:41], v[84:85], v[22:23], v[40:41] op_sel:[0,0,0] op_sel_hi:[1,0,1]
    v_pk_fma_f32 v[42:43], v[86:87], v[22:23], v[42:43] op_sel:[0,0,0] op_sel_hi:[1,0,1]
    v_pk_fma_f32 v[40:41], v[88:89], v[22:23], v[40:41] op_sel:[0,1,0] op_sel_hi:[1,1,1]
    v_pk_fma_f32 v[42:43], v[90:91], v[22:23], v[42:43] op_sel:[0,1,0] op_sel_hi:[1,1,1]
    v_pk_fma_f32 v[40:41], v[92:93], v[24:25], v[40:41] op_sel:[0,0,0] op_sel_hi:[1,0,1]
    v_pk_fma_f32 v[42:43], v[94:95], v[24:25], v[42:43] op_sel:[0,0,0] op_sel_hi:[1,0,1]
    v_pk_fma_f32 v[40:41], v[96:97], v[24:25], v[40:41] op_sel:[0,1,0] op_sel_hi:[1,1,1]
    v_pk_fma_f32 v[42:43], v[98:99], v[24:25], v[42:43] op_sel:[0,1,0] op_sel_hi:[1,1,1]
    v_pk_fma_f32 v[40:41], v[100:101], v[26:27], v[40:41] op_sel:[0,0,0] op_sel_hi:[1,0,1]
    v_pk_fma_f32 v[42:43], v[102:103], v[26:27], v[42:43] op_sel:[0,0,0] op_sel_hi:[1,0,1]
    v_pk_fma_f32 v[40:41], v[104:105], v[26:27], v[40:41] op_sel:[0,1,0] op_sel_hi:[1,1,1]
    v_pk_fma_f32 v[42:43], v[106:107], v[26:27], v[42:43] op_sel:[0,1,0] op_sel_hi:[1,1,1]
    s_nop 1
    s_branch L_fin
L_ok0:
    v_max_f32 v11, v47, v51
    v_max3_f32 v11, v11, v55, v59
    v_max3_f32 v11, v11, v63, v67
    v_max3_f32 v11, v11, v71, v75
    s_nop 1
    v_max_f32_dpp v11, v11, v11 row_ror:8 row_mask:0xf bank_mask:0xf
    v_mov_b32 v13, v11
    s_nop 1
    v_permlane32_swap_b32 v11, v13
    v_max_f32 v11, v11, v13
    v_mov_b32 v13, v11
    s_nop 1
    v_permlane16_swap_b32 v11, v13
    v_max_f32 v11, v11, v13
    s_nop 1
    v_mov_b32_dpp v11, v11 quad_perm:[0,0,2,2] row_mask:0xf bank_mask:0xf
    s_nop 1
    v_sub_f32_dpp v20, v47, v11 quad_perm:[0,0,2,2] row_mask:0xf bank_mask:0xf
    v_sub_f32_dpp v21, v51, v11 quad_perm:[0,0,2,2] row_mask:0xf bank_mask:0xf
    v_sub_f32_dpp v22, v55, v11 quad_perm:[0,0,2,2] row_mask:0xf bank_mask:0xf
    v_sub_f32_dpp v23, v59, v11 quad_perm:[0,0,2,2] row_mask:0xf bank_mask:0xf
    v_sub_f32_dpp v24, v63, v11 quad_perm:[0,0,2,2] row_mask:0xf bank_mask:0xf
    v_sub_f32_dpp v25, v67, v11 quad_perm:[0,0,2,2] row_mask:0xf bank_mask:0xf
    v_sub_f32_dpp v26, v71, v11 quad_perm:[0,0,2,2] row_mask:0xf bank_mask:0xf
    v_sub_f32_dpp v27, v75, v11 quad_perm:[0,0,2,2] row_mask:0xf bank_mask:0xf
    v_exp_f32 v20, v20
    v_exp_f32 v21, v21
    v_exp_f32 v22, v22
    v_exp_f32 v23, v23
    v_exp_f32 v24, v24
    v_exp_f32 v25, v25
    v_exp_f32 v26, v26
    v_exp_f32 v27, v27
    v_pk_mul_f32 v[40:41], v[44:45], v[20:21] op_sel:[0,0] op_sel_hi:[1,0]
    v_pk_mul_f32 v[42:43], v[46:47], v[20:21] op_sel:[0,0] op_sel_hi:[1,0]
    v_pk_fma_f32 v[40:41], v[48:49], v[20:21], v[40:41] op_sel:[0,1,0] op_sel_hi:[1,1,1]
    v_pk_fma_f32 v[42:43], v[50:51], v[20:21], v[42:43] op_sel:[0,1,0] op_sel_hi:[1,1,1]
    v_pk_fma_f32 v[40:41], v[52:53], v[22:23], v[40:41] op_sel:[0,0,0] op_sel_hi:[1,0,1]
    v_pk_fma_f32 v[42:43], v[54:55], v[22:23], v[42:43] op_sel:[0,0,0] op_sel_hi:[1,0,1]
    v_pk_fma_f32 v[40:41], v[56:57], v[22:23], v[40:41] op_sel:[0,1,0] op_sel_hi:[1,1,1]
    v_pk_fma_f32 v[42:43], v[58:59], v[22:23], v[42:43] op_sel:[0,1,0] op_sel_hi:[1,1,1]
    v_pk_fma_f32 v[40:41], v[60:61], v[24:25], v[40:41] op_sel:[0,0,0] op_sel_hi:[1,0,1]
    v_pk_fma_f32 v[42:43], v[62:63], v[24:25], v[42:43] op_sel:[0,0,0] op_sel_hi:[1,0,1]
    v_pk_fma_f32 v[40:41], v[64:65], v[24:25], v[40:41] op_sel:[0,1,0] op_sel_hi:[1,1,1]
    v_pk_fma_f32 v[42:43], v[66:67], v[24:25], v[42:43] op_sel:[0,1,0] op_sel_hi:[1,1,1]
    v_pk_fma_f32 v[40:41], v[68:69], v[26:27], v[40:41] op_sel:[0,0,0] op_sel_hi:[1,0,1]
    v_pk_fma_f32 v[42:43], v[70:71], v[26:27], v[42:43] op_sel:[0,0,0] op_sel_hi:[1,0,1]
    v_pk_fma_f32 v[40:41], v[72:73], v[26:27], v[40:41] op_sel:[0,1,0] op_sel_hi:[1,1,1]
    v_pk_fma_f32 v[42:43], v[74:75], v[26:27], v[42:43] op_sel:[0,1,0] op_sel_hi:[1,1,1]
    s_nop 1
L_fin:
    v_permlane32_swap_b32 v40, v41
    v_permlane32_swap_b32 v42, v43
    v_add_f32 v40, v40, v41
    v_add_f32 v42, v42, v43
    s_nop 1
    v_permlane16_swap_b32 v40, v42
    v_add_f32 v40, v40, v42
    s_nop 1
    v_add_f32_dpp v40, v40, v40 row_ror:8 row_mask:0xf bank_mask:0xf
    v_rcp_f32 v10, v40
    s_nop 0
    v_readlane_b32 s81, v10, 49
    s_nop 1
    v_mul_f32 v40, s81, v40
    v_cvt_pk_bf16_f32 v40, v40, v40
    s_mov_b32 exec_lo, 0x00ff00ff
    s_mov_b32 exec_hi, 0xff
    buffer_store_short v40, v16, s[16:19], s37 offen
    s_endpgm
L_pacer:
    s_cmp_eq_u32 s76, 6
    s_cbranch_scc0 L_exch
    v_mov_b32 v16, -1
    s_mov_b32 s80, 0x14141418
    v_writelane_b32 v16, s80, 0
    s_mov_b32 s80, 0x18181810
    v_writelane_b32 v16, s80, 1
    s_mov_b32 s80, 0x28282830
    v_writelane_b32 v16, s80, 2
    s_mov_b32 s80, 0x18181410
    v_writelane_b32 v16, s80, 3
    s_mov_b32 s80, 0x14141818
    v_writelane_b32 v16, s80, 4
    s_mov_b32 s80, 0x30302c20
    v_writelane_b32 v16, s80, 5
    s_mov_b32 s80, 0x50505460
    v_writelane_b32 v16, s80, 6
    s_lshl_b32 s80, s77, 3
    v_sad_u8 v17, v16, 0, 0
    v_bfe_u32 v16, v16, s80, 8
    v_cvt_f32_u32 v15, v17
    v_cvt_f32_u32 v4, v16
    v_rcp_f32 v18, v4
    v_rcp_f32 v19, v15
    v_mul_f32 v15, 0x472aaaab, v15
    v_mul_f32 v4, 0x46b00000, v4
    v_mul_f32 v18, v18, v15
    v_mul_f32 v19, v19, v4
    v_cvt_u32_f32 v18, v18
    v_cvt_u32_f32 v19, v19
    v_mul_u32_u24 v16, 12, v16
    v_lshlrev_b32 v17, 3, v17
    s_mov_b32 s4, 0
    s_mov_b32 s9, 0
    s_mov_b32 s13, 0
    s_mov_b32 s15, 0
    s_mov_b32 s17, 0
    s_mov_b32 s18, 0
    s_mov_b32 s19, 0
    s_mov_b32 s22, 0
    s_mov_b32 s23, 0
    s_mov_b32 s24, 0
    s_mov_b32 s5, 32
    s_mov_b32 s7, 128
    v_mov_b32 v14, 157824
    s_lshl_b32 s80, s84, 12
    s_add_u32 s80, s80, 1351680
    v_mov_b32 v12, s80
    v_mov_b32 v13, 5104
    ds_write_b64 v3, v[12:13] offset:24
    v_mov_b32 v15, s84
    ds_write_b32 v14, v15
    s_nop 0
L_g:
    s_sleep 1
    ds_read_b32 v4, v3 offset:16
    s_memrealtime s[10:11]
    ds_read_b128 v[8:11], v3
    ds_read_b64 v[12:13], v3 offset:24
    s_waitcnt lgkmcnt(0)
    v_readfirstlane_b32 s83, v4
    v_min3_i32 v15, v8, v9, v10
    v_min_i32 v8, v15, v11
    v_readfirstlane_b32 s80, v12
    v_readfirstlane_b32 s81, v13
    s_nop 0
    s_lshr_b32 s21, s81, 16
    s_and_b32 s81, s81, 0xffff
    s_cmp_lt_u32 s21, s22
    s_cselect_b32 s23, s23, 0
    s_cmp_lt_u32 s4, 6
    s_cselect_b32 s24, s10, s24
    s_sub_u32 s82, s10, s24
    s_cmp_gt_u32 s82, 100
    s_cselect_b32 s82, s82, 15
    s_sub_u32 s82, s82, 15
    s_lshl_b32 s82, s82, 12
    s_add_u32 s82, s82, s23
    s_add_u32 s80, s80, s82
    s_cmp_gt_i32 s83, s9
    s_cbranch_scc0 L_gq
    s_mov_b32 s24, s10
    s_cmp_eq_u32 s82, s23
    s_cbranch_scc1 L_gq
    s_mov_b32 s23, s82
    s_add_u32 s22, s4, 1
L_gq:
    s_max_i32 s9, s9, s83
    s_cmp_ge_u32 s9, s13
    s_cbranch_scc0 L_gs
    s_mov_b32 s12, s13
    s_mov_b32 s14, s15
    v_readlane_b32 s82, v16, s17
    v_readlane_b32 s83, v17, s17
    v_readlane_b32 s16, v18, s17
    s_add_u32 s17, s17, 1
    s_add_u32 s13, s13, s82
    s_add_u32 s15, s15, s83
    s_nop 1
L_gs:
    s_add_u32 s82, s9, 22
    s_cmp_ge_u32 s82, s18
    s_cbranch_scc0 L_gf
    v_readlane_b32 s82, v16, s19
    v_readlane_b32 s20, v19, s19
    s_add_u32 s19, s19, 1
    s_add_u32 s18, s18, s82
    s_nop 2
L_gf:
    s_sub_u32 s6, s9, s12
    s_mul_i32 s6, s6, s16
    s_lshr_b32 s6, s6, 16
    s_add_u32 s6, s6, s14
    s_cmp_ge_u32 s6, s5
    s_cbranch_scc0 L_gn
    s_add_u32 s4, s4, 1
    s_add_u32 s5, s5, 32
    v_add_u32 v14, 4, v14
    v_mov_b32 v15, s10
    ds_write_b32 v14, v15
    v_mov_b32 v15, s4
    ds_write_b32 v3, v15 offset:20
    s_nop 0
L_gn:
    s_mul_i32 s81, s81, s6
    s_add_u32 s80, s80, s81
    s_lshl_b32 s81, s10, 12
    s_sub_u32 s80, s81, s80
    s_ashr_i32 s80, s80, 6
    s_min_i32 s80, s80, 0x40000
    s_max_i32 s80, s80, 0xfffc0000
    s_mul_i32 s80, s80, 983
    s_ashr_i32 s80, s80, 12
    s_and_b32 s7, s7, 255
    s_add_u32 s7, s7, s80
    s_add_u32 s7, s7, s20
    s_ashr_i32 s8, s7, 8
    s_min_i32 s8, s8, 36
    s_max_i32 s8, s8, 12
    s_cmp_lt_u32 s4, 4
    s_cselect_b32 s8, 24, s8
    s_add_u32 s80, s8, 2304
    v_lshl_add_u32 v15, v8, 8, s80
    ds_write_b32 v3, v15 offset:44
    s_cmp_lt_u32 s4, 256
    s_cbranch_scc1 L_g
    s_endpgm
L_exch:
    s_mov_b32 s12, s74
    s_mov_b32 s13, s75
    s_mov_b32 s14, 1610612736
    s_mov_b32 s15, 0x20000
    s_mov_b32 s80, 4352
    v_mul_lo_u32 v5, v1, s80
    s_lshr_b32 s80, s2, 3
    s_mul_i32 s21, s79, 5
    s_add_u32 s21, s21, s80
    s_and_b32 s21, s21, 31
    s_lshr_b32 s80, s80, 5
    s_lshl_b32 s80, s80, 3
    s_add_u32 s80, s80, s79
    s_mul_i32 s80, s80, 4352
    s_waitcnt vmcnt(0)
    v_mov_b32 v7, s80
    s_mov_b32 s16, 0
    s_mov_b32 s17, 33554432
    s_mov_b32 s18, 8
    s_mov_b32 s20, 0
    s_mov_b32 s19, 0
    s_mov_b32 s24, 0
    s_mov_b32 s25, 5104
L_pc0:
L_pw1:
    s_sleep 8
    ds_read_b32 v4, v3 offset:20
    s_waitcnt lgkmcnt(0)
    v_readfirstlane_b32 s80, v4
    s_nop 0
    s_cmp_lt_i32 s80, s18
    s_nop 2
    s_cbranch_scc1 L_pw1
    s_lshl_b32 s80, s18, 2
    s_add_u32 s80, s80, 157824
    v_mov_b32 v8, s80
    ds_read_b32 v6, v8
    s_waitcnt lgkmcnt(0)
    s_and_b32 s80, s16, 31
    s_cmp_eq_u32 s80, s21
    s_cbranch_scc0 L_np
    s_mov_b64 exec, 1
    buffer_store_dword v6, v7, s[12:15], s17 offen sc0 sc1
    s_mov_b64 exec, -1
L_np:
    s_add_u32 s81, s18, 4
L_pw2:
    s_sleep 8
    ds_read_b32 v4, v3 offset:20
    s_waitcnt lgkmcnt(0)
    v_readfirstlane_b32 s80, v4
    s_nop 0
    s_cmp_lt_i32 s80, s81
    s_nop 2
    s_cbranch_scc1 L_pw2
    s_add_u32 s30, s74, s17
    s_addc_u32 s31, s75, 0
    s_load_dword s32, s[30:31], 0
    s_load_dword s33, s[30:31], 4352
    s_load_dword s34, s[30:31], 8704
    s_load_dword s35, s[30:31], 13056
    s_load_dword s36, s[30:31], 17408
    s_load_dword s37, s[30:31], 21760
    s_load_dword s38, s[30:31], 26112
    s_load_dword s39, s[30:31], 30464
    s_memrealtime s[22:23]
    v_readfirstlane_b32 s26, v6
    s_mov_b32 s27, 0
    s_mov_b32 s28, 0
    s_mov_b32 s29, -4096
    s_waitcnt lgkmcnt(0)
    s_sub_u32 s83, s22, s26
    s_sub_u32 s80, s32, s26
    s_add_u32 s81, s80, 4096
    s_cmp_lt_u32 s81, 0x2000
    s_cselect_b32 s80, s80, s83
    s_addc_u32 s28, s28, 0
    s_add_u32 s27, s27, s80
    s_max_i32 s29, s29, s80
    s_sub_u32 s80, s33, s26
    s_add_u32 s81, s80, 4096
    s_cmp_lt_u32 s81, 0x2000
    s_cselect_b32 s80, s80, s83
    s_addc_u32 s28, s28, 0
    s_add_u32 s27, s27, s80
    s_max_i32 s29, s29, s80
    s_sub_u32 s80, s34, s26
    s_add_u32 s81, s80, 4096
    s_cmp_lt_u32 s81, 0x2000
    s_cselect_b32 s80, s80, s83
    s_addc_u32 s28, s28, 0
    s_add_u32 s27, s27, s80
    s_max_i32 s29, s29, s80
    s_sub_u32 s80, s35, s26
    s_add_u32 s81, s80, 4096
    s_cmp_lt_u32 s81, 0x2000
    s_cselect_b32 s80, s80, s83
    s_addc_u32 s28, s28, 0
    s_add_u32 s27, s27, s80
    s_max_i32 s29, s29, s80
    s_sub_u32 s80, s36, s26
    s_add_u32 s81, s80, 4096
    s_cmp_lt_u32 s81, 0x2000
    s_cselect_b32 s80, s80, s83
    s_addc_u32 s28, s28, 0
    s_add_u32 s27, s27, s80
    s_max_i32 s29, s29, s80
    s_sub_u32 s80, s37, s26
    s_add_u32 s81, s80, 4096
    s_cmp_lt_u32 s81, 0x2000
    s_cselect_b32 s80, s80, s83
    s_addc_u32 s28, s28, 0
    s_add_u32 s27, s27, s80
    s_max_i32 s29, s29, s80
    s_sub_u32 s80, s38, s26
    s_add_u32 s81, s80, 4096
    s_cmp_lt_u32 s81, 0x2000
    s_cselect_b32 s80, s80, s83
    s_addc_u32 s28, s28, 0
    s_add_u32 s27, s27, s80
    s_max_i32 s29, s29, s80
    s_sub_u32 s80, s39, s26
    s_add_u32 s81, s80, 4096
    s_cmp_lt_u32 s81, 0x2000
    s_cselect_b32 s80, s80, s83
    s_addc_u32 s28, s28, 0
    s_add_u32 s27, s27, s80
    s_max_i32 s29, s29, s80
    s_cmp_lt_u32 s28, 4
    s_cbranch_scc1 L_pskip
    s_mul_i32 s27, s27, 410
    s_lshl_b32 s80, s26, 12
    s_add_u32 s80, s80, s27
    s_mul_i32 s29, s29, 819
    s_add_u32 s80, s80, s29
    s_min_u32 s82, s18, 0
    s_lshl_b32 s83, s18, 5
    s_add_u32 s82, s82, s83
    s_sub_u32 s81, s80, s19
    s_sub_u32 s83, s82, s24
    v_cvt_f32_u32 v8, s81
    v_cvt_f32_u32 v9, s83
    v_rcp_f32 v9, v9
    v_mul_f32 v8, 0x3f800000, v8
    v_mul_f32 v8, v8, v9
    v_mul_f32 v9, 0x3f7851ec, v8
    v_mov_b32 v10, 0x459f8000
    v_mul_f32 v8, 0x3f828f5c, v8
    v_med3_f32 v8, v8, v9, v10
    v_cvt_u32_f32 v8, v8
    s_nop 0
    v_readfirstlane_b32 s81, v8
    s_mov_b32 s19, s80
    s_mov_b32 s24, s82
    s_cmp_eq_u32 s20, 0
    s_cselect_b32 s81, 5104, s81
    s_mov_b32 s20, 1
    s_add_u32 s83, s25, 51
    s_min_u32 s81, s81, s83
    s_sub_u32 s83, s25, 51
    s_max_u32 s81, s81, s83
    s_mov_b32 s25, s81
    s_mul_i32 s82, s82, s81
    s_sub_u32 s80, s80, s82
    s_pack_ll_b32_b16 s81, s81, s18
    v_mov_b32 v8, s80
    v_mov_b32 v9, s81
    ds_write_b64 v3, v[8:9] offset:24
    s_nop 0
L_pskip:
    s_add_u32 s16, s16, 1
    s_add_u32 s17, s17, 34816
    s_add_u32 s18, s18, 16
    s_cmp_lt_u32 s18, 250
    s_cbranch_scc1 L_pc0
L_end:
    s_endpgm
.section .rodata,"a"
.p2align 6
.amdhsa_kernel standalone__kv_cache_quant_pre_rope_vs_post_rope__decode_kernel
  .amdhsa_next_free_vgpr 168
  .amdhsa_next_free_sgpr 96
  .amdhsa_accum_offset 168
  .amdhsa_group_segment_fixed_size 0
  .amdhsa_kernarg_size 112
  .amdhsa_user_sgpr_count 2
  .amdhsa_user_sgpr_kernarg_segment_ptr 1
  .amdhsa_system_sgpr_workgroup_id_x 1
.end_amdhsa_kernel
```

```asm
; @launch grid=(256,1,1) block=(512,1,1) lds=159168
.amdgcn_target "amdgcn-amd-amdhsa--gfx950"
.text
.globl standalone__kv_cache_quant_pre_rope_vs_post_rope__decode_kernel
.p2align 8
.type standalone__kv_cache_quant_pre_rope_vs_post_rope__decode_kernel,@function
standalone__kv_cache_quant_pre_rope_vs_post_rope__decode_kernel:
    s_cmp_ge_u32 s2, 256
    s_cbranch_scc1 L_end
    s_load_dwordx2 s[4:5], s[0:1], 8
    v_readfirstlane_b32 s76, v0
    s_and_b32 s79, s2, 7
    s_lshr_b32 s78, s2, 7
    s_lshl3_add_u32 s78, s78, s79
    s_lshr_b32 s77, s2, 3
    s_lshr_b32 s80, s77, 2
    s_and_b32 s77, s77, 3
    s_and_b32 s80, s80, 3
    s_lshl2_add_u32 s78, s78, s80
    s_cmp_lt_u32 s76, 64
    s_cbranch_scc0 L_init
    s_getpc_b64 s[26:27]
L_pc:
    s_lshl_b32 s81, s2, 6
    s_and_b32 s81, s81, 0x3e00
    v_lshl_add_u32 v5, v0, 3, s81
    v_min_u32 v5, L_end-L_pc, v5
    global_load_dword v7, v5, s[26:27]
    v_lshlrev_b32 v2, 4, v0
    s_mul_i32 s9, s77, 15728640
    s_mul_i32 s80, s78, 12288
    s_mov_b32 m0, 0
    s_add_u32 s9, s9, s80
    s_mov_b32 s6, 402653184
    s_mov_b32 s7, 0x20000
    s_movk_i32 s12, 12288
    s_waitcnt lgkmcnt(0)
L_first:
    s_waitcnt vmcnt(22)
    buffer_load_dwordx4 v2, s[4:7], s9 offen offset:0 nt lds
    buffer_load_dwordx4 v2, s[4:7], s9 offen offset:1024 nt lds
    s_waitcnt vmcnt(22)
    buffer_load_dwordx4 v2, s[4:7], s9 offen offset:2048 nt lds
    buffer_load_dwordx4 v2, s[4:7], s9 offen offset:3072 nt lds
    s_addk_i32 m0, 4096
    s_addk_i32 s9, 4096
    s_cmp_lg_u32 m0, s12
    s_cbranch_scc1 L_first
    s_addk_i32 s12, 12288
    s_add_u32 s9, s9, 774144
    s_cmp_lt_u32 m0, 36864
    s_cbranch_scc1 L_first
    s_sub_u32 s9, s9, 774144
    s_barrier
    s_load_dwordx2 s[56:57], s[0:1], 32
    s_setprio 3
    s_mul_i32 s8, s77, 12582912
    s_add_u32 s8, s8, s80
    s_mul_i32 s16, s77, 4
    s_mul_i32 s17, s77, 4
    v_mov_b32 v3, 158912
    s_waitcnt vmcnt(24)
    s_mov_b32 s10, 2
    v_mov_b32 v5, 36
    v_mov_b32 v7, 792
    s_waitcnt lgkmcnt(0)
    s_nop 0
    s_branch L_next
L_init:
    s_load_dwordx16 s[48:63], s[0:1], 0
    s_load_dwordx8 s[64:71], s[0:1], 64
    s_load_dwordx4 s[72:75], s[0:1], 96
    s_memrealtime s[84:85]
    v_and_b32 v1, 63, v0
    s_lshr_b32 s76, s76, 4
    s_lshr_b32 s76, 0x65372104, s76
    s_and_b32 s76, s76, 7
    v_lshlrev_b32 v2, 4, v1
    v_mov_b32 v3, 158912
    v_cmp_eq_u32 vcc, 11, v1
    v_mov_b32 v5, 792
    v_lshl_add_u32 v6, v1, 2, v3
    v_cndmask_b32 v5, 0, v5, vcc
    v_cmp_gt_u32 vcc, 4, v1
    s_nop 1
    v_cndmask_b32 v5, v5, -6, vcc
    ds_write_b32 v6, v5
    s_waitcnt lgkmcnt(0)
    s_barrier
    s_branch L_notld
L_next:
    s_add_u32 s10, s10, 1
    s_cmp_eq_u32 m0, 110592
    s_cselect_b32 m0, 0, m0
    s_waitcnt lgkmcnt(1)
    v_readfirstlane_b32 s11, v7
    s_add_u32 s12, m0, 12288
    s_add_u32 s9, s9, 774144
    s_and_b32 s80, s10, 3
    s_cbranch_scc0 L_addr
L_aj:
    s_lshr_b32 s80, s11, 8
    s_cmp_gt_u32 s80, s10
    s_cbranch_scc0 L_full
    s_and_b32 s15, s11, 255
    s_cmp_ge_i32 s15, 24
    s_cbranch_scc1 L_t_24_36
    s_cmp_ge_i32 s15, 18
    s_cbranch_scc1 L_t_18_23
    s_cmp_ge_i32 s15, 15
    s_cbranch_scc1 L_t_15_17
    s_cmp_ge_i32 s15, 13
    s_cbranch_scc1 L_t_13_14
    s_branch L_v12
L_t_13_14:
    s_cmp_ge_i32 s15, 14
    s_cbranch_scc1 L_v14
    s_branch L_v13
L_t_15_17:
    s_cmp_ge_i32 s15, 16
    s_cbranch_scc1 L_t_16_17
    s_branch L_v15
L_t_16_17:
    s_cmp_ge_i32 s15, 17
    s_cbranch_scc1 L_v17
    s_branch L_v16
L_t_18_23:
    s_cmp_ge_i32 s15, 21
    s_cbranch_scc1 L_t_21_23
    s_cmp_ge_i32 s15, 19
    s_cbranch_scc1 L_t_19_20
    s_branch L_v18
L_t_19_20:
    s_cmp_ge_i32 s15, 20
    s_cbranch_scc1 L_v20
    s_branch L_v19
L_t_21_23:
    s_cmp_ge_i32 s15, 22
    s_cbranch_scc1 L_t_22_23
    s_branch L_v21
L_t_22_23:
    s_cmp_ge_i32 s15, 23
    s_cbranch_scc1 L_v23
    s_branch L_v22
L_t_24_36:
    s_cmp_ge_i32 s15, 30
    s_cbranch_scc1 L_t_30_36
    s_cmp_ge_i32 s15, 27
    s_cbranch_scc1 L_t_27_29
    s_cmp_ge_i32 s15, 25
    s_cbranch_scc1 L_t_25_26
    s_branch L_v24
L_t_25_26:
    s_cmp_ge_i32 s15, 26
    s_cbranch_scc1 L_v26
    s_branch L_v25
L_t_27_29:
    s_cmp_ge_i32 s15, 28
    s_cbranch_scc1 L_t_28_29
    s_branch L_v27
L_t_28_29:
    s_cmp_ge_i32 s15, 29
    s_cbranch_scc1 L_v29
    s_branch L_v28
L_t_30_36:
    s_cmp_ge_i32 s15, 33
    s_cbranch_scc1 L_t_33_36
    s_cmp_ge_i32 s15, 31
    s_cbranch_scc1 L_t_31_32
    s_branch L_v30
L_t_31_32:
    s_cmp_ge_i32 s15, 32
    s_cbranch_scc1 L_v32
    s_branch L_v31
L_t_33_36:
    s_cmp_ge_i32 s15, 35
    s_cbranch_scc1 L_t_35_36
    s_cmp_ge_i32 s15, 34
    s_cbranch_scc1 L_v34
    s_branch L_v33
L_t_35_36:
    s_cmp_ge_i32 s15, 36
    s_cbranch_scc1 L_v36
    s_branch L_v35
L_v12:
    s_waitcnt vmcnt(11)
    buffer_load_dwordx4 v2, s[4:7], s9 offen offset:0 nt lds
    s_waitcnt vmcnt(11)
    buffer_load_dwordx4 v2, s[4:7], s9 offen offset:1024 nt lds
    ds_read_b32 v7, v3 offset:44
    s_waitcnt vmcnt(11)
    buffer_load_dwordx4 v2, s[4:7], s9 offen offset:2048 nt lds
    v_subrev_u32 v6, 9, v5
    s_add_u32 m0, m0, 3072
    ds_write_b32 v3, v6 offset:16
    v_add_u32 v5, 3, v5
    s_add_u32 s9, s9, 3072
    s_cmp_lg_u32 m0, s12
    s_cbranch_scc1 L_v12
    s_branch L_next
L_v13:
    s_waitcnt vmcnt(12)
    buffer_load_dwordx4 v2, s[4:7], s9 offen offset:0 nt lds
    s_waitcnt vmcnt(12)
    buffer_load_dwordx4 v2, s[4:7], s9 offen offset:1024 nt lds
    ds_read_b32 v7, v3 offset:44
    s_waitcnt vmcnt(12)
    buffer_load_dwordx4 v2, s[4:7], s9 offen offset:2048 nt lds
    v_subrev_u32 v6, 10, v5
    s_add_u32 m0, m0, 3072
    ds_write_b32 v3, v6 offset:16
    v_add_u32 v5, 3, v5
    s_add_u32 s9, s9, 3072
    s_cmp_lg_u32 m0, s12
    s_cbranch_scc1 L_v13
    s_branch L_next
L_v14:
    s_waitcnt vmcnt(13)
    buffer_load_dwordx4 v2, s[4:7], s9 offen offset:0 nt lds
    s_waitcnt vmcnt(13)
    buffer_load_dwordx4 v2, s[4:7], s9 offen offset:1024 nt lds
    ds_read_b32 v7, v3 offset:44
    s_waitcnt vmcnt(13)
    buffer_load_dwordx4 v2, s[4:7], s9 offen offset:2048 nt lds
    v_subrev_u32 v6, 11, v5
    s_add_u32 m0, m0, 3072
    ds_write_b32 v3, v6 offset:16
    v_add_u32 v5, 3, v5
    s_add_u32 s9, s9, 3072
    s_cmp_lg_u32 m0, s12
    s_cbranch_scc1 L_v14
    s_branch L_next
L_v15:
    s_waitcnt vmcnt(14)
    buffer_load_dwordx4 v2, s[4:7], s9 offen offset:0 nt lds
    s_waitcnt vmcnt(14)
    buffer_load_dwordx4 v2, s[4:7], s9 offen offset:1024 nt lds
    ds_read_b32 v7, v3 offset:44
    s_waitcnt vmcnt(14)
    buffer_load_dwordx4 v2, s[4:7], s9 offen offset:2048 nt lds
    v_subrev_u32 v6, 12, v5
    s_add_u32 m0, m0, 3072
    ds_write_b32 v3, v6 offset:16
    v_add_u32 v5, 3, v5
    s_add_u32 s9, s9, 3072
    s_cmp_lg_u32 m0, s12
    s_cbranch_scc1 L_v15
    s_branch L_next
L_v16:
    s_waitcnt vmcnt(15)
    buffer_load_dwordx4 v2, s[4:7], s9 offen offset:0 nt lds
    s_waitcnt vmcnt(15)
    buffer_load_dwordx4 v2, s[4:7], s9 offen offset:1024 nt lds
    ds_read_b32 v7, v3 offset:44
    s_waitcnt vmcnt(15)
    buffer_load_dwordx4 v2, s[4:7], s9 offen offset:2048 nt lds
    v_subrev_u32 v6, 13, v5
    s_add_u32 m0, m0, 3072
    ds_write_b32 v3, v6 offset:16
    v_add_u32 v5, 3, v5
    s_add_u32 s9, s9, 3072
    s_cmp_lg_u32 m0, s12
    s_cbranch_scc1 L_v16
    s_branch L_next
L_v17:
    s_waitcnt vmcnt(16)
    buffer_load_dwordx4 v2, s[4:7], s9 offen offset:0 nt lds
    s_waitcnt vmcnt(16)
    buffer_load_dwordx4 v2, s[4:7], s9 offen offset:1024 nt lds
    ds_read_b32 v7, v3 offset:44
    s_waitcnt vmcnt(16)
    buffer_load_dwordx4 v2, s[4:7], s9 offen offset:2048 nt lds
    v_subrev_u32 v6, 14, v5
    s_add_u32 m0, m0, 3072
    ds_write_b32 v3, v6 offset:16
    v_add_u32 v5, 3, v5
    s_add_u32 s9, s9, 3072
    s_cmp_lg_u32 m0, s12
    s_cbranch_scc1 L_v17
    s_branch L_next
L_v18:
    s_waitcnt vmcnt(17)
    buffer_load_dwordx4 v2, s[4:7], s9 offen offset:0 nt lds
    s_waitcnt vmcnt(17)
    buffer_load_dwordx4 v2, s[4:7], s9 offen offset:1024 nt lds
    ds_read_b32 v7, v3 offset:44
    s_waitcnt vmcnt(17)
    buffer_load_dwordx4 v2, s[4:7], s9 offen offset:2048 nt lds
    v_subrev_u32 v6, 15, v5
    s_add_u32 m0, m0, 3072
    ds_write_b32 v3, v6 offset:16
    v_add_u32 v5, 3, v5
    s_add_u32 s9, s9, 3072
    s_cmp_lg_u32 m0, s12
    s_cbranch_scc1 L_v18
    s_branch L_next
L_v19:
    s_waitcnt vmcnt(18)
    buffer_load_dwordx4 v2, s[4:7], s9 offen offset:0 nt lds
    s_waitcnt vmcnt(18)
    buffer_load_dwordx4 v2, s[4:7], s9 offen offset:1024 nt lds
    ds_read_b32 v7, v3 offset:44
    s_waitcnt vmcnt(18)
    buffer_load_dwordx4 v2, s[4:7], s9 offen offset:2048 nt lds
    v_subrev_u32 v6, 16, v5
    s_add_u32 m0, m0, 3072
    ds_write_b32 v3, v6 offset:16
    v_add_u32 v5, 3, v5
    s_add_u32 s9, s9, 3072
    s_cmp_lg_u32 m0, s12
    s_cbranch_scc1 L_v19
    s_branch L_next
L_v20:
    s_waitcnt vmcnt(19)
    buffer_load_dwordx4 v2, s[4:7], s9 offen offset:0 nt lds
    s_waitcnt vmcnt(19)
    buffer_load_dwordx4 v2, s[4:7], s9 offen offset:1024 nt lds
    ds_read_b32 v7, v3 offset:44
    s_waitcnt vmcnt(19)
    buffer_load_dwordx4 v2, s[4:7], s9 offen offset:2048 nt lds
    v_subrev_u32 v6, 17, v5
    s_add_u32 m0, m0, 3072
    ds_write_b32 v3, v6 offset:16
    v_add_u32 v5, 3, v5
    s_add_u32 s9, s9, 3072
    s_cmp_lg_u32 m0, s12
    s_cbranch_scc1 L_v20
    s_branch L_next
L_v21:
    s_waitcnt vmcnt(20)
    buffer_load_dwordx4 v2, s[4:7], s9 offen offset:0 nt lds
    s_waitcnt vmcnt(20)
    buffer_load_dwordx4 v2, s[4:7], s9 offen offset:1024 nt lds
    ds_read_b32 v7, v3 offset:44
    s_waitcnt vmcnt(20)
    buffer_load_dwordx4 v2, s[4:7], s9 offen offset:2048 nt lds
    v_subrev_u32 v6, 18, v5
    s_add_u32 m0, m0, 3072
    ds_write_b32 v3, v6 offset:16
    v_add_u32 v5, 3, v5
    s_add_u32 s9, s9, 3072
    s_cmp_lg_u32 m0, s12
    s_cbranch_scc1 L_v21
    s_branch L_next
L_v22:
    s_waitcnt vmcnt(21)
    buffer_load_dwordx4 v2, s[4:7], s9 offen offset:0 nt lds
    s_waitcnt vmcnt(21)
    buffer_load_dwordx4 v2, s[4:7], s9 offen offset:1024 nt lds
    ds_read_b32 v7, v3 offset:44
    s_waitcnt vmcnt(21)
    buffer_load_dwordx4 v2, s[4:7], s9 offen offset:2048 nt lds
    v_subrev_u32 v6, 19, v5
    s_add_u32 m0, m0, 3072
    ds_write_b32 v3, v6 offset:16
    v_add_u32 v5, 3, v5
    s_add_u32 s9, s9, 3072
    s_cmp_lg_u32 m0, s12
    s_cbranch_scc1 L_v22
    s_branch L_next
L_v23:
    s_waitcnt vmcnt(22)
    buffer_load_dwordx4 v2, s[4:7], s9 offen offset:0 nt lds
    s_waitcnt vmcnt(22)
    buffer_load_dwordx4 v2, s[4:7], s9 offen offset:1024 nt lds
    ds_read_b32 v7, v3 offset:44
    s_waitcnt vmcnt(22)
    buffer_load_dwordx4 v2, s[4:7], s9 offen offset:2048 nt lds
    v_subrev_u32 v6, 20, v5
    s_add_u32 m0, m0, 3072
    ds_write_b32 v3, v6 offset:16
    v_add_u32 v5, 3, v5
    s_add_u32 s9, s9, 3072
    s_cmp_lg_u32 m0, s12
    s_cbranch_scc1 L_v23
    s_branch L_next
L_v24:
    s_waitcnt vmcnt(23)
    buffer_load_dwordx4 v2, s[4:7], s9 offen offset:0 nt lds
    s_waitcnt vmcnt(23)
    buffer_load_dwordx4 v2, s[4:7], s9 offen offset:1024 nt lds
    ds_read_b32 v7, v3 offset:44
    s_waitcnt vmcnt(23)
    buffer_load_dwordx4 v2, s[4:7], s9 offen offset:2048 nt lds
    v_subrev_u32 v6, 21, v5
    s_add_u32 m0, m0, 3072
    ds_write_b32 v3, v6 offset:16
    v_add_u32 v5, 3, v5
    s_add_u32 s9, s9, 3072
    s_cmp_lg_u32 m0, s12
    s_cbranch_scc1 L_v24
    s_branch L_next
L_v25:
    s_waitcnt vmcnt(24)
    buffer_load_dwordx4 v2, s[4:7], s9 offen offset:0 nt lds
    s_waitcnt vmcnt(24)
    buffer_load_dwordx4 v2, s[4:7], s9 offen offset:1024 nt lds
    ds_read_b32 v7, v3 offset:44
    s_waitcnt vmcnt(24)
    buffer_load_dwordx4 v2, s[4:7], s9 offen offset:2048 nt lds
    v_subrev_u32 v6, 22, v5
    s_add_u32 m0, m0, 3072
    ds_write_b32 v3, v6 offset:16
    v_add_u32 v5, 3, v5
    s_add_u32 s9, s9, 3072
    s_cmp_lg_u32 m0, s12
    s_cbranch_scc1 L_v25
    s_branch L_next
L_v26:
    s_waitcnt vmcnt(25)
    buffer_load_dwordx4 v2, s[4:7], s9 offen offset:0 nt lds
    s_waitcnt vmcnt(25)
    buffer_load_dwordx4 v2, s[4:7], s9 offen offset:1024 nt lds
    ds_read_b32 v7, v3 offset:44
    s_waitcnt vmcnt(25)
    buffer_load_dwordx4 v2, s[4:7], s9 offen offset:2048 nt lds
    v_subrev_u32 v6, 23, v5
    s_add_u32 m0, m0, 3072
    ds_write_b32 v3, v6 offset:16
    v_add_u32 v5, 3, v5
    s_add_u32 s9, s9, 3072
    s_cmp_lg_u32 m0, s12
    s_cbranch_scc1 L_v26
    s_branch L_next
L_v27:
    s_waitcnt vmcnt(26)
    buffer_load_dwordx4 v2, s[4:7], s9 offen offset:0 nt lds
    s_waitcnt vmcnt(26)
    buffer_load_dwordx4 v2, s[4:7], s9 offen offset:1024 nt lds
    ds_read_b32 v7, v3 offset:44
    s_waitcnt vmcnt(26)
    buffer_load_dwordx4 v2, s[4:7], s9 offen offset:2048 nt lds
    v_subrev_u32 v6, 24, v5
    s_add_u32 m0, m0, 3072
    ds_write_b32 v3, v6 offset:16
    v_add_u32 v5, 3, v5
    s_add_u32 s9, s9, 3072
    s_cmp_lg_u32 m0, s12
    s_cbranch_scc1 L_v27
    s_branch L_next
L_v28:
    s_waitcnt vmcnt(27)
    buffer_load_dwordx4 v2, s[4:7], s9 offen offset:0 nt lds
    s_waitcnt vmcnt(27)
    buffer_load_dwordx4 v2, s[4:7], s9 offen offset:1024 nt lds
    ds_read_b32 v7, v3 offset:44
    s_waitcnt vmcnt(27)
    buffer_load_dwordx4 v2, s[4:7], s9 offen offset:2048 nt lds
    v_subrev_u32 v6, 25, v5
    s_add_u32 m0, m0, 3072
    ds_write_b32 v3, v6 offset:16
    v_add_u32 v5, 3, v5
    s_add_u32 s9, s9, 3072
    s_cmp_lg_u32 m0, s12
    s_cbranch_scc1 L_v28
    s_branch L_next
L_v29:
    s_waitcnt vmcnt(28)
    buffer_load_dwordx4 v2, s[4:7], s9 offen offset:0 nt lds
    s_waitcnt vmcnt(28)
    buffer_load_dwordx4 v2, s[4:7], s9 offen offset:1024 nt lds
    ds_read_b32 v7, v3 offset:44
    s_waitcnt vmcnt(28)
    buffer_load_dwordx4 v2, s[4:7], s9 offen offset:2048 nt lds
    v_subrev_u32 v6, 26, v5
    s_add_u32 m0, m0, 3072
    ds_write_b32 v3, v6 offset:16
    v_add_u32 v5, 3, v5
    s_add_u32 s9, s9, 3072
    s_cmp_lg_u32 m0, s12
    s_cbranch_scc1 L_v29
    s_branch L_next
L_v30:
    s_waitcnt vmcnt(29)
    buffer_load_dwordx4 v2, s[4:7], s9 offen offset:0 nt lds
    s_waitcnt vmcnt(29)
    buffer_load_dwordx4 v2, s[4:7], s9 offen offset:1024 nt lds
    ds_read_b32 v7, v3 offset:44
    s_waitcnt vmcnt(29)
    buffer_load_dwordx4 v2, s[4:7], s9 offen offset:2048 nt lds
    v_subrev_u32 v6, 27, v5
    s_add_u32 m0, m0, 3072
    ds_write_b32 v3, v6 offset:16
    v_add_u32 v5, 3, v5
    s_add_u32 s9, s9, 3072
    s_cmp_lg_u32 m0, s12
    s_cbranch_scc1 L_v30
    s_branch L_next
L_v31:
    s_waitcnt vmcnt(30)
    buffer_load_dwordx4 v2, s[4:7], s9 offen offset:0 nt lds
    s_waitcnt vmcnt(30)
    buffer_load_dwordx4 v2, s[4:7], s9 offen offset:1024 nt lds
    ds_read_b32 v7, v3 offset:44
    s_waitcnt vmcnt(30)
    buffer_load_dwordx4 v2, s[4:7], s9 offen offset:2048 nt lds
    v_subrev_u32 v6, 28, v5
    s_add_u32 m0, m0, 3072
    ds_write_b32 v3, v6 offset:16
    v_add_u32 v5, 3, v5
    s_add_u32 s9, s9, 3072
    s_cmp_lg_u32 m0, s12
    s_cbranch_scc1 L_v31
    s_branch L_next
L_v32:
    s_waitcnt vmcnt(31)
    buffer_load_dwordx4 v2, s[4:7], s9 offen offset:0 nt lds
    s_waitcnt vmcnt(31)
    buffer_load_dwordx4 v2, s[4:7], s9 offen offset:1024 nt lds
    ds_read_b32 v7, v3 offset:44
    s_waitcnt vmcnt(31)
    buffer_load_dwordx4 v2, s[4:7], s9 offen offset:2048 nt lds
    v_subrev_u32 v6, 29, v5
    s_add_u32 m0, m0, 3072
    ds_write_b32 v3, v6 offset:16
    v_add_u32 v5, 3, v5
    s_add_u32 s9, s9, 3072
    s_cmp_lg_u32 m0, s12
    s_cbranch_scc1 L_v32
    s_branch L_next
L_v33:
    s_waitcnt vmcnt(32)
    buffer_load_dwordx4 v2, s[4:7], s9 offen offset:0 nt lds
    s_waitcnt vmcnt(32)
    buffer_load_dwordx4 v2, s[4:7], s9 offen offset:1024 nt lds
    ds_read_b32 v7, v3 offset:44
    s_waitcnt vmcnt(32)
    buffer_load_dwordx4 v2, s[4:7], s9 offen offset:2048 nt lds
    v_subrev_u32 v6, 30, v5
    s_add_u32 m0, m0, 3072
    ds_write_b32 v3, v6 offset:16
    v_add_u32 v5, 3, v5
    s_add_u32 s9, s9, 3072
    s_cmp_lg_u32 m0, s12
    s_cbranch_scc1 L_v33
    s_branch L_next
L_v34:
    s_waitcnt vmcnt(33)
    buffer_load_dwordx4 v2, s[4:7], s9 offen offset:0 nt lds
    s_waitcnt vmcnt(33)
    buffer_load_dwordx4 v2, s[4:7], s9 offen offset:1024 nt lds
    ds_read_b32 v7, v3 offset:44
    s_waitcnt vmcnt(33)
    buffer_load_dwordx4 v2, s[4:7], s9 offen offset:2048 nt lds
    v_subrev_u32 v6, 31, v5
    s_add_u32 m0, m0, 3072
    ds_write_b32 v3, v6 offset:16
    v_add_u32 v5, 3, v5
    s_add_u32 s9, s9, 3072
    s_cmp_lg_u32 m0, s12
    s_cbranch_scc1 L_v34
    s_branch L_next
L_v35:
    s_waitcnt vmcnt(34)
    buffer_load_dwordx4 v2, s[4:7], s9 offen offset:0 nt lds
    s_waitcnt vmcnt(34)
    buffer_load_dwordx4 v2, s[4:7], s9 offen offset:1024 nt lds
    ds_read_b32 v7, v3 offset:44
    s_waitcnt vmcnt(34)
    buffer_load_dwordx4 v2, s[4:7], s9 offen offset:2048 nt lds
    v_subrev_u32 v6, 32, v5
    s_add_u32 m0, m0, 3072
    ds_write_b32 v3, v6 offset:16
    v_add_u32 v5, 3, v5
    s_add_u32 s9, s9, 3072
    s_cmp_lg_u32 m0, s12
    s_cbranch_scc1 L_v35
    s_branch L_next
L_v36:
    s_waitcnt vmcnt(35)
    buffer_load_dwordx4 v2, s[4:7], s9 offen offset:0 nt lds
    s_waitcnt vmcnt(35)
    buffer_load_dwordx4 v2, s[4:7], s9 offen offset:1024 nt lds
    ds_read_b32 v7, v3 offset:44
    s_waitcnt vmcnt(35)
    buffer_load_dwordx4 v2, s[4:7], s9 offen offset:2048 nt lds
    v_subrev_u32 v6, 33, v5
    s_add_u32 m0, m0, 3072
    ds_write_b32 v3, v6 offset:16
    v_add_u32 v5, 3, v5
    s_add_u32 s9, s9, 3072
    s_cmp_lg_u32 m0, s12
    s_cbranch_scc1 L_v36
    s_branch L_next
L_full:
    ds_read_b32 v7, v3 offset:44
    s_waitcnt lgkmcnt(0)
    v_readfirstlane_b32 s11, v7
    s_nop 4
    s_branch L_aj
L_addr:
    s_cmp_lt_u32 s10, 128
    s_cbranch_scc0 L_av
    s_lshr_b32 s80, s10, 5
    s_lshl_b32 s80, s80, 2
    s_add_u32 s80, s80, s16
    s_bfe_u32 s81, s10, 0x30002
    s_bitcmp1_b32 s10, 5
    s_cselect_b32 s82, 7, 0
    s_xor_b32 s81, s81, s82
    s_branch L_ak
L_av:
    s_cmp_eq_u32 s10, 256
    s_cbranch_scc1 L_drain
    s_mov_b32 s4, s56
    s_mov_b32 s5, s57
    s_add_u32 s80, s10, s17
    s_bfe_u32 s81, s10, 0x30004
    s_xor_b32 s81, s81, 7
L_ak:
    s_and_b32 s80, s80, 15
    s_mul_i32 s80, s80, 786432
    s_mul_i32 s81, s81, 50331648
    s_add_u32 s9, s80, s81
    s_add_u32 s9, s9, s8
    s_branch L_aj
L_drain:
    v_mov_b32 v6, 3048
    s_waitcnt vmcnt(24)
    ds_write_b32 v3, v6 offset:16
    v_mov_b32 v6, 3060
    s_waitcnt vmcnt(12)
    ds_write_b32 v3, v6 offset:16
    v_mov_b32 v6, 3072
    s_waitcnt vmcnt(0)
    ds_write_b32 v3, v6 offset:16
    s_endpgm
L_notld:
    s_cmp_gt_u32 s76, 4
    s_cbranch_scc1 L_aux
    v_lshrrev_b32 v21, 4, v1
    v_and_b32 v22, 15, v1
    v_mul_u32_u24 v16, 384, v21
    v_lshl_add_u32 v16, v22, 3, v16
    v_cmp_gt_u32 vcc, 8, v22
    v_xor_b32 v17, 64, v16
    s_mul_i32 s24, s77, 4
    s_and_b32 s24, s24, 15
    s_lshl_b32 s80, s78, 2
    s_add_u32 s80, s80, s76
    s_mul_i32 s83, s80, 1536
    s_mul_i32 s16, s24, 393216
    s_add_u32 s16, s16, s83
    s_waitcnt lgkmcnt(0)
    s_mov_b32 s4, s66
    s_mov_b32 s5, s67
    s_mov_b32 s6, 6291456
    s_mov_b32 s7, 0x20000
    s_mov_b32 s8, s68
    s_mov_b32 s9, s69
    s_mov_b32 s10, 6291456
    s_mov_b32 s11, 0x20000
    s_lshl_b32 s80, s76, 2
    v_add_u32 v11, s80, v3
    v_mov_b32 v10, 0
    buffer_load_dwordx2 v[120:121], v16, s[4:7], s16 offen offset:0
    buffer_load_dwordx2 v[126:127], v17, s[8:11], s16 offen offset:0
    buffer_load_dwordx2 v[122:123], v16, s[4:7], s16 offen offset:128
    buffer_load_dwordx2 v[128:129], v17, s[8:11], s16 offen offset:128
    buffer_load_dwordx2 v[124:125], v16, s[4:7], s16 offen offset:256
    buffer_load_dwordx2 v[130:131], v17, s[8:11], s16 offen offset:256
    s_add_u32 s16, s16, 393216
    buffer_load_dwordx2 v[132:133], v16, s[4:7], s16 offen offset:0
    buffer_load_dwordx2 v[138:139], v17, s[8:11], s16 offen offset:0
    buffer_load_dwordx2 v[134:135], v16, s[4:7], s16 offen offset:128
    buffer_load_dwordx2 v[140:141], v17, s[8:11], s16 offen offset:128
    buffer_load_dwordx2 v[136:137], v16, s[4:7], s16 offen offset:256
    buffer_load_dwordx2 v[142:143], v17, s[8:11], s16 offen offset:256
    s_add_u32 s16, s16, 393216
    buffer_load_dwordx2 v[144:145], v16, s[4:7], s16 offen offset:0
    buffer_load_dwordx2 v[150:151], v17, s[8:11], s16 offen offset:0
    buffer_load_dwordx2 v[146:147], v16, s[4:7], s16 offen offset:128
    buffer_load_dwordx2 v[152:153], v17, s[8:11], s16 offen offset:128
    buffer_load_dwordx2 v[148:149], v16, s[4:7], s16 offen offset:256
    buffer_load_dwordx2 v[154:155], v17, s[8:11], s16 offen offset:256
    s_add_u32 s16, s16, 393216
    buffer_load_dwordx2 v[156:157], v16, s[4:7], s16 offen offset:0
    buffer_load_dwordx2 v[162:163], v17, s[8:11], s16 offen offset:0
    buffer_load_dwordx2 v[158:159], v16, s[4:7], s16 offen offset:128
    buffer_load_dwordx2 v[164:165], v17, s[8:11], s16 offen offset:128
    buffer_load_dwordx2 v[160:161], v16, s[4:7], s16 offen offset:256
    buffer_load_dwordx2 v[166:167], v17, s[8:11], s16 offen offset:256
    s_add_u32 s16, s16, 393216
    s_mov_b32 s12, s74
    s_mov_b32 s13, s75
    s_mov_b32 s14, 1610612736
    s_mov_b32 s15, 0x20000
    s_mov_b32 s22, 0x05040100
    s_mov_b32 s23, 0x07060302
    s_lshl_b32 s80, s76, 2
    v_add_u32 v21, s80, v21
    v_mul_u32_u24 v5, 768, v21
    v_lshl_add_u32 v5, v22, 4, v5
    v_lshlrev_b32 v19, 3, v21
    v_add_u32 v19, 126976, v19
    v_lshlrev_b32 v18, 4, v22
    v_add_u32 v18, 151552, v18
    v_mov_b32 v23, 0xff
    s_mul_i32 s17, s76, 3
    s_add_u32 s17, s17, 3
    s_mov_b32 s18, 0
    s_mov_b32 s19, 0
    s_mov_b32 s20, 0
    s_mov_b32 s21, 0
    s_waitcnt vmcnt(18)
    ds_write_b32 v11, v10
    v_cndmask_b32 v24, v130, v128, vcc
    v_cndmask_b32 v25, v131, v129, vcc
    v_cndmask_b32 v26, v126, v130, vcc
    v_cndmask_b32 v27, v127, v131, vcc
    v_cndmask_b32 v28, v128, v126, vcc
    v_cndmask_b32 v29, v129, v127, vcc
    v_perm_b32 v72, v24, v120, s22
    v_perm_b32 v73, v24, v120, s23
    v_perm_b32 v74, v25, v121, s22
    v_perm_b32 v75, v25, v121, s23
    v_perm_b32 v76, v26, v122, s22
    v_perm_b32 v77, v26, v122, s23
    v_perm_b32 v78, v27, v123, s22
    v_perm_b32 v79, v27, v123, s23
    v_perm_b32 v80, v28, v124, s22
    v_perm_b32 v81, v28, v124, s23
    v_perm_b32 v82, v29, v125, s22
    v_perm_b32 v83, v29, v125, s23
    s_waitcnt vmcnt(12)
    v_cndmask_b32 v24, v142, v140, vcc
    v_cndmask_b32 v25, v143, v141, vcc
    v_cndmask_b32 v26, v138, v142, vcc
    v_cndmask_b32 v27, v139, v143, vcc
    v_cndmask_b32 v28, v140, v138, vcc
    v_cndmask_b32 v29, v141, v139, vcc
    v_perm_b32 v84, v24, v132, s22
    v_perm_b32 v85, v24, v132, s23
    v_perm_b32 v86, v25, v133, s22
    v_perm_b32 v87, v25, v133, s23
    v_perm_b32 v88, v26, v134, s22
    v_perm_b32 v89, v26, v134, s23
    v_perm_b32 v90, v27, v135, s22
    v_perm_b32 v91, v27, v135, s23
    v_perm_b32 v92, v28, v136, s22
    v_perm_b32 v93, v28, v136, s23
    v_perm_b32 v94, v29, v137, s22
    v_perm_b32 v95, v29, v137, s23
    s_waitcnt vmcnt(6)
    v_cndmask_b32 v24, v154, v152, vcc
    v_cndmask_b32 v25, v155, v153, vcc
    v_cndmask_b32 v26, v150, v154, vcc
    v_cndmask_b32 v27, v151, v155, vcc
    v_cndmask_b32 v28, v152, v150, vcc
    v_cndmask_b32 v29, v153, v151, vcc
    v_perm_b32 v96, v24, v144, s22
    v_perm_b32 v97, v24, v144, s23
    v_perm_b32 v98, v25, v145, s22
    v_perm_b32 v99, v25, v145, s23
    v_perm_b32 v100, v26, v146, s22
    v_perm_b32 v101, v26, v146, s23
    v_perm_b32 v102, v27, v147, s22
    v_perm_b32 v103, v27, v147, s23
    v_perm_b32 v104, v28, v148, s22
    v_perm_b32 v105, v28, v148, s23
    v_perm_b32 v106, v29, v149, s22
    v_perm_b32 v107, v29, v149, s23
    s_waitcnt vmcnt(0)
    v_cndmask_b32 v24, v166, v164, vcc
    v_cndmask_b32 v25, v167, v165, vcc
    v_cndmask_b32 v26, v162, v166, vcc
    v_cndmask_b32 v27, v163, v167, vcc
    v_cndmask_b32 v28, v164, v162, vcc
    v_cndmask_b32 v29, v165, v163, vcc
    v_perm_b32 v108, v24, v156, s22
    v_perm_b32 v109, v24, v156, s23
    v_perm_b32 v110, v25, v157, s22
    v_perm_b32 v111, v25, v157, s23
    v_perm_b32 v112, v26, v158, s22
    v_perm_b32 v113, v26, v158, s23
    v_perm_b32 v114, v27, v159, s22
    v_perm_b32 v115, v27, v159, s23
    v_perm_b32 v116, v28, v160, s22
    v_perm_b32 v117, v28, v160, s23
    v_perm_b32 v118, v29, v161, s22
    v_perm_b32 v119, v29, v161, s23
    s_nop 1
L_kvisit:
    s_cmp_ge_u32 s16, 6291456
    s_cselect_b32 s80, 6291456, 0
    s_sub_u32 s16, s16, s80
    s_and_b32 s26, s20, 1
    s_cmp_lt_u32 s21, 3
    s_cselect_b32 s26, s26, 9
    s_bitcmp1_b32 s21, 0
    s_cselect_b32 s82, 7, 0
    s_xor_b32 s82, s82, s20
    s_mul_i32 s80, s82, 768
    v_add_u32 v6, s80, v18
    s_lshl_b32 s80, s82, 4
    s_add_u32 s80, s80, s24
    s_lshl_b32 s81, s80, 7
    v_add_u32 v8, s81, v19
    s_nop 1
L_qw:
    ds_read_b32 v4, v3 offset:32
    ds_read_b128 v[48:51], v6 offset:0
    ds_read_b128 v[52:55], v6 offset:256
    ds_read_b128 v[56:59], v6 offset:512
    s_waitcnt lgkmcnt(0)
    v_readfirstlane_b32 s80, v4
    s_nop 0
    s_cmp_gt_u32 s80, s82
    s_nop 2
    s_cbranch_scc1 L_qwg
    s_sleep 2
    s_branch L_qw
L_qwg:
    s_cmp_eq_u32 s26, 0
    s_cbranch_scc0 L_nc0
    buffer_load_dwordx2 v[60:61], v16, s[4:7], s16 offen offset:0
L_nc0:
    s_cmp_eq_u32 s26, 1
    s_cbranch_scc0 L_nd0
    buffer_load_dwordx2 v[64:65], v16, s[4:7], s16 offen offset:256
L_nd0:
    v_dot2_f32_bf16 v24, v72, v48, 0
    v_dot2_f32_bf16 v25, v73, v49, 0
    v_dot2_f32_bf16 v26, v74, v50, 0
    v_dot2_f32_bf16 v27, v75, v51, 0
    v_dot2_f32_bf16 v28, v76, v52, 0
    v_dot2_f32_bf16 v29, v77, v53, 0
    v_dot2_f32_bf16 v30, v78, v54, 0
    v_dot2_f32_bf16 v31, v79, v55, 0
    v_dot2_f32_bf16 v32, v80, v56, 0
    v_dot2_f32_bf16 v33, v81, v57, 0
    v_dot2_f32_bf16 v34, v82, v58, 0
    v_dot2_f32_bf16 v35, v83, v59, 0
    v_add_u32 v6, s19, v5
    v_pk_add_f32 v[14:15], v[24:25], v[26:27]
    v_pk_add_f32 v[14:15], v[14:15], v[28:29]
    v_pk_add_f32 v[14:15], v[14:15], v[30:31]
    v_pk_add_f32 v[14:15], v[14:15], v[32:33]
    v_pk_add_f32 v[14:15], v[14:15], v[34:35]
    s_cmp_ge_i32 s18, s17
    s_nop 0
    s_cbranch_scc1 L_kw0g
L_kw0:
    ds_read_b32 v4, v3 offset:16
    s_waitcnt lgkmcnt(0)
    v_readfirstlane_b32 s18, v4
    s_nop 0
    s_cmp_ge_i32 s18, s17
    s_nop 2
    s_cbranch_scc1 L_kw0g
    s_sleep 1
    s_branch L_kw0
L_kw0g:
    ds_read_b128 v[36:39], v6 offset:0
    ds_read_b128 v[40:43], v6 offset:256
    ds_read_b128 v[44:47], v6 offset:512
    v_add_u32 v10, 1, v10
    s_add_u32 s19, s19, 12288
    s_cmp_eq_u32 s19, 110592
    s_cselect_b32 s19, 0, s19
    s_add_u32 s17, s17, 12
    s_waitcnt lgkmcnt(2)
    v_cvt_f32_i32 v36, v36
    v_cvt_f32_i32 v37, v37
    v_cvt_f32_i32 v38, v38
    v_cvt_f32_i32 v39, v39
    v_pk_mul_f32 v[12:13], v[36:37], v[24:25]
    v_pk_fma_f32 v[12:13], v[38:39], v[26:27], v[12:13]
    s_waitcnt lgkmcnt(1)
    v_cvt_f32_i32 v40, v40
    v_cvt_f32_i32 v41, v41
    v_cvt_f32_i32 v42, v42
    v_cvt_f32_i32 v43, v43
    v_pk_fma_f32 v[12:13], v[40:41], v[28:29], v[12:13]
    v_pk_fma_f32 v[12:13], v[42:43], v[30:31], v[12:13]
    s_waitcnt lgkmcnt(0)
    v_cvt_f32_i32 v44, v44
    v_cvt_f32_i32 v45, v45
    v_cvt_f32_i32 v46, v46
    v_cvt_f32_i32 v47, v47
    v_pk_fma_f32 v[12:13], v[44:45], v[32:33], v[12:13]
    v_pk_fma_f32 v[12:13], v[46:47], v[34:35], v[12:13]
    v_add_f32 v12, v12, v13
    v_add_f32 v13, v14, v15
    s_nop 0
    v_add_f32_dpp v12, v12, v12 quad_perm:[1,0,3,2] row_mask:0xf bank_mask:0xf
    v_add_f32_dpp v13, v13, v13 quad_perm:[1,0,3,2] row_mask:0xf bank_mask:0xf
    s_nop 0
    v_add_f32_dpp v12, v12, v12 quad_perm:[2,3,0,1] row_mask:0xf bank_mask:0xf
    v_add_f32_dpp v13, v13, v13 quad_perm:[2,3,0,1] row_mask:0xf bank_mask:0xf
    s_nop 0
    v_add_f32_dpp v12, v12, v12 row_half_mirror row_mask:0xf bank_mask:0xf
    v_add_f32_dpp v13, v13, v13 row_half_mirror row_mask:0xf bank_mask:0xf
    s_nop 0
    v_add_f32_dpp v12, v12, v12 row_mirror row_mask:0xf bank_mask:0xf
    v_add_f32_dpp v13, v13, v13 row_mirror row_mask:0xf bank_mask:0xf
    ds_write_b64 v8, v[12:13] offset:0
    ds_write_b32 v11, v10
    s_cmp_eq_u32 s26, 0
    s_cbranch_scc0 L_nc1
    buffer_load_dwordx2 v[66:67], v17, s[8:11], s16 offen offset:0
L_nc1:
    s_cmp_eq_u32 s26, 1
    s_cbranch_scc0 L_nd1
    buffer_load_dwordx2 v[70:71], v17, s[8:11], s16 offen offset:256
    s_add_u32 s16, s16, 393216
L_nd1:
    v_dot2_f32_bf16 v24, v84, v48, 0
    v_dot2_f32_bf16 v25, v85, v49, 0
    v_dot2_f32_bf16 v26, v86, v50, 0
    v_dot2_f32_bf16 v27, v87, v51, 0
    v_dot2_f32_bf16 v28, v88, v52, 0
    v_dot2_f32_bf16 v29, v89, v53, 0
    v_dot2_f32_bf16 v30, v90, v54, 0
    v_dot2_f32_bf16 v31, v91, v55, 0
    v_dot2_f32_bf16 v32, v92, v56, 0
    v_dot2_f32_bf16 v33, v93, v57, 0
    v_dot2_f32_bf16 v34, v94, v58, 0
    v_dot2_f32_bf16 v35, v95, v59, 0
    v_add_u32 v6, s19, v5
    v_pk_add_f32 v[14:15], v[24:25], v[26:27]
    v_pk_add_f32 v[14:15], v[14:15], v[28:29]
    v_pk_add_f32 v[14:15], v[14:15], v[30:31]
    v_pk_add_f32 v[14:15], v[14:15], v[32:33]
    v_pk_add_f32 v[14:15], v[14:15], v[34:35]
    s_cmp_ge_i32 s18, s17
    s_nop 0
    s_cbranch_scc1 L_kw1g
L_kw1:
    ds_read_b32 v4, v3 offset:16
    s_waitcnt lgkmcnt(0)
    v_readfirstlane_b32 s18, v4
    s_nop 0
    s_cmp_ge_i32 s18, s17
    s_nop 2
    s_cbranch_scc1 L_kw1g
    s_sleep 1
    s_branch L_kw1
L_kw1g:
    ds_read_b128 v[36:39], v6 offset:0
    ds_read_b128 v[40:43], v6 offset:256
    ds_read_b128 v[44:47], v6 offset:512
    v_add_u32 v10, 1, v10
    s_add_u32 s19, s19, 12288
    s_cmp_eq_u32 s19, 110592
    s_cselect_b32 s19, 0, s19
    s_add_u32 s17, s17, 12
    s_waitcnt lgkmcnt(2)
    v_cvt_f32_i32 v36, v36
    v_cvt_f32_i32 v37, v37
    v_cvt_f32_i32 v38, v38
    v_cvt_f32_i32 v39, v39
    v_pk_mul_f32 v[12:13], v[36:37], v[24:25]
    v_pk_fma_f32 v[12:13], v[38:39], v[26:27], v[12:13]
    s_waitcnt lgkmcnt(1)
    v_cvt_f32_i32 v40, v40
    v_cvt_f32_i32 v41, v41
    v_cvt_f32_i32 v42, v42
    v_cvt_f32_i32 v43, v43
    v_pk_fma_f32 v[12:13], v[40:41], v[28:29], v[12:13]
    v_pk_fma_f32 v[12:13], v[42:43], v[30:31], v[12:13]
    s_waitcnt lgkmcnt(0)
    v_cvt_f32_i32 v44, v44
    v_cvt_f32_i32 v45, v45
    v_cvt_f32_i32 v46, v46
    v_cvt_f32_i32 v47, v47
    v_pk_fma_f32 v[12:13], v[44:45], v[32:33], v[12:13]
    v_pk_fma_f32 v[12:13], v[46:47], v[34:35], v[12:13]
    v_add_f32 v12, v12, v13
    v_add_f32 v13, v14, v15
    s_nop 0
    v_add_f32_dpp v12, v12, v12 quad_perm:[1,0,3,2] row_mask:0xf bank_mask:0xf
    v_add_f32_dpp v13, v13, v13 quad_perm:[1,0,3,2] row_mask:0xf bank_mask:0xf
    s_nop 0
    v_add_f32_dpp v12, v12, v12 quad_perm:[2,3,0,1] row_mask:0xf bank_mask:0xf
    v_add_f32_dpp v13, v13, v13 quad_perm:[2,3,0,1] row_mask:0xf bank_mask:0xf
    s_nop 0
    v_add_f32_dpp v12, v12, v12 row_half_mirror row_mask:0xf bank_mask:0xf
    v_add_f32_dpp v13, v13, v13 row_half_mirror row_mask:0xf bank_mask:0xf
    s_nop 0
    v_add_f32_dpp v12, v12, v12 row_mirror row_mask:0xf bank_mask:0xf
    v_add_f32_dpp v13, v13, v13 row_mirror row_mask:0xf bank_mask:0xf
    ds_write_b64 v8, v[12:13] offset:128
    ds_write_b32 v11, v10
    s_cmp_eq_u32 s26, 0
    s_cbranch_scc0 L_nc2
    buffer_load_dwordx2 v[62:63], v16, s[4:7], s16 offen offset:128
L_nc2:
    v_dot2_f32_bf16 v24, v96, v48, 0
    v_dot2_f32_bf16 v25, v97, v49, 0
    v_dot2_f32_bf16 v26, v98, v50, 0
    v_dot2_f32_bf16 v27, v99, v51, 0
    v_dot2_f32_bf16 v28, v100, v52, 0
    v_dot2_f32_bf16 v29, v101, v53, 0
    v_dot2_f32_bf16 v30, v102, v54, 0
    v_dot2_f32_bf16 v31, v103, v55, 0
    v_dot2_f32_bf16 v32, v104, v56, 0
    v_dot2_f32_bf16 v33, v105, v57, 0
    v_dot2_f32_bf16 v34, v106, v58, 0
    v_dot2_f32_bf16 v35, v107, v59, 0
    v_add_u32 v6, s19, v5
    v_pk_add_f32 v[14:15], v[24:25], v[26:27]
    v_pk_add_f32 v[14:15], v[14:15], v[28:29]
    v_pk_add_f32 v[14:15], v[14:15], v[30:31]
    v_pk_add_f32 v[14:15], v[14:15], v[32:33]
    v_pk_add_f32 v[14:15], v[14:15], v[34:35]
    s_cmp_ge_i32 s18, s17
    s_nop 0
    s_cbranch_scc1 L_kw2g
L_kw2:
    ds_read_b32 v4, v3 offset:16
    s_waitcnt lgkmcnt(0)
    v_readfirstlane_b32 s18, v4
    s_nop 0
    s_cmp_ge_i32 s18, s17
    s_nop 2
    s_cbranch_scc1 L_kw2g
    s_sleep 1
    s_branch L_kw2
L_kw2g:
    ds_read_b128 v[36:39], v6 offset:0
    ds_read_b128 v[40:43], v6 offset:256
    ds_read_b128 v[44:47], v6 offset:512
    v_add_u32 v10, 1, v10
    s_add_u32 s19, s19, 12288
    s_cmp_eq_u32 s19, 110592
    s_cselect_b32 s19, 0, s19
    s_add_u32 s17, s17, 12
    s_waitcnt lgkmcnt(2)
    v_cvt_f32_i32 v36, v36
    v_cvt_f32_i32 v37, v37
    v_cvt_f32_i32 v38, v38
    v_cvt_f32_i32 v39, v39
    v_pk_mul_f32 v[12:13], v[36:37], v[24:25]
    v_pk_fma_f32 v[12:13], v[38:39], v[26:27], v[12:13]
    s_waitcnt lgkmcnt(1)
    v_cvt_f32_i32 v40, v40
    v_cvt_f32_i32 v41, v41
    v_cvt_f32_i32 v42, v42
    v_cvt_f32_i32 v43, v43
    v_pk_fma_f32 v[12:13], v[40:41], v[28:29], v[12:13]
    v_pk_fma_f32 v[12:13], v[42:43], v[30:31], v[12:13]
    s_waitcnt lgkmcnt(0)
    v_cvt_f32_i32 v44, v44
    v_cvt_f32_i32 v45, v45
    v_cvt_f32_i32 v46, v46
    v_cvt_f32_i32 v47, v47
    v_pk_fma_f32 v[12:13], v[44:45], v[32:33], v[12:13]
    v_pk_fma_f32 v[12:13], v[46:47], v[34:35], v[12:13]
    v_add_f32 v12, v12, v13
    v_add_f32 v13, v14, v15
    s_nop 0
    v_add_f32_dpp v12, v12, v12 quad_perm:[1,0,3,2] row_mask:0xf bank_mask:0xf
    v_add_f32_dpp v13, v13, v13 quad_perm:[1,0,3,2] row_mask:0xf bank_mask:0xf
    s_nop 0
    v_add_f32_dpp v12, v12, v12 quad_perm:[2,3,0,1] row_mask:0xf bank_mask:0xf
    v_add_f32_dpp v13, v13, v13 quad_perm:[2,3,0,1] row_mask:0xf bank_mask:0xf
    s_nop 0
    v_add_f32_dpp v12, v12, v12 row_half_mirror row_mask:0xf bank_mask:0xf
    v_add_f32_dpp v13, v13, v13 row_half_mirror row_mask:0xf bank_mask:0xf
    s_nop 0
    v_add_f32_dpp v12, v12, v12 row_mirror row_mask:0xf bank_mask:0xf
    v_add_f32_dpp v13, v13, v13 row_mirror row_mask:0xf bank_mask:0xf
    ds_write_b64 v8, v[12:13] offset:256
    ds_write_b32 v11, v10
    s_cmp_eq_u32 s26, 0
    s_cbranch_scc0 L_nc3
    buffer_load_dwordx2 v[68:69], v17, s[8:11], s16 offen offset:128
L_nc3:
    v_dot2_f32_bf16 v24, v108, v48, 0
    v_dot2_f32_bf16 v25, v109, v49, 0
    v_dot2_f32_bf16 v26, v110, v50, 0
    v_dot2_f32_bf16 v27, v111, v51, 0
    v_dot2_f32_bf16 v28, v112, v52, 0
    v_dot2_f32_bf16 v29, v113, v53, 0
    v_dot2_f32_bf16 v30, v114, v54, 0
    v_dot2_f32_bf16 v31, v115, v55, 0
    v_dot2_f32_bf16 v32, v116, v56, 0
    v_dot2_f32_bf16 v33, v117, v57, 0
    v_dot2_f32_bf16 v34, v118, v58, 0
    v_dot2_f32_bf16 v35, v119, v59, 0
    v_add_u32 v6, s19, v5
    v_pk_add_f32 v[14:15], v[24:25], v[26:27]
    v_pk_add_f32 v[14:15], v[14:15], v[28:29]
    v_pk_add_f32 v[14:15], v[14:15], v[30:31]
    v_pk_add_f32 v[14:15], v[14:15], v[32:33]
    v_pk_add_f32 v[14:15], v[14:15], v[34:35]
    s_cmp_ge_i32 s18, s17
    s_nop 0
    s_cbranch_scc1 L_kw3g
L_kw3:
    ds_read_b32 v4, v3 offset:16
    s_waitcnt lgkmcnt(0)
    v_readfirstlane_b32 s18, v4
    s_nop 0
    s_cmp_ge_i32 s18, s17
    s_nop 2
    s_cbranch_scc1 L_kw3g
    s_sleep 1
    s_branch L_kw3
L_kw3g:
    ds_read_b128 v[36:39], v6 offset:0
    ds_read_b128 v[40:43], v6 offset:256
    ds_read_b128 v[44:47], v6 offset:512
    v_add_u32 v10, 1, v10
    s_add_u32 s19, s19, 12288
    s_cmp_eq_u32 s19, 110592
    s_cselect_b32 s19, 0, s19
    s_add_u32 s17, s17, 12
    s_waitcnt lgkmcnt(2)
    v_cvt_f32_i32 v36, v36
    v_cvt_f32_i32 v37, v37
    v_cvt_f32_i32 v38, v38
    v_cvt_f32_i32 v39, v39
    v_pk_mul_f32 v[12:13], v[36:37], v[24:25]
    v_pk_fma_f32 v[12:13], v[38:39], v[26:27], v[12:13]
    s_waitcnt lgkmcnt(1)
    v_cvt_f32_i32 v40, v40
    v_cvt_f32_i32 v41, v41
    v_cvt_f32_i32 v42, v42
    v_cvt_f32_i32 v43, v43
    v_pk_fma_f32 v[12:13], v[40:41], v[28:29], v[12:13]
    v_pk_fma_f32 v[12:13], v[42:43], v[30:31], v[12:13]
    s_waitcnt lgkmcnt(0)
    v_cvt_f32_i32 v44, v44
    v_cvt_f32_i32 v45, v45
    v_cvt_f32_i32 v46, v46
    v_cvt_f32_i32 v47, v47
    v_pk_fma_f32 v[12:13], v[44:45], v[32:33], v[12:13]
    v_pk_fma_f32 v[12:13], v[46:47], v[34:35], v[12:13]
    v_add_f32 v12, v12, v13
    v_add_f32 v13, v14, v15
    s_nop 0
    v_add_f32_dpp v12, v12, v12 quad_perm:[1,0,3,2] row_mask:0xf bank_mask:0xf
    v_add_f32_dpp v13, v13, v13 quad_perm:[1,0,3,2] row_mask:0xf bank_mask:0xf
    s_nop 0
    v_add_f32_dpp v12, v12, v12 quad_perm:[2,3,0,1] row_mask:0xf bank_mask:0xf
    v_add_f32_dpp v13, v13, v13 quad_perm:[2,3,0,1] row_mask:0xf bank_mask:0xf
    s_nop 0
    v_add_f32_dpp v12, v12, v12 row_half_mirror row_mask:0xf bank_mask:0xf
    v_add_f32_dpp v13, v13, v13 row_half_mirror row_mask:0xf bank_mask:0xf
    s_nop 0
    v_add_f32_dpp v12, v12, v12 row_mirror row_mask:0xf bank_mask:0xf
    v_add_f32_dpp v13, v13, v13 row_mirror row_mask:0xf bank_mask:0xf
    ds_write_b64 v8, v[12:13] offset:384
    ds_write_b32 v11, v10
    s_add_u32 s20, s20, 1
    s_and_b32 s80, s20, 1
    s_cbranch_scc1 L_kvisit
    v_mov_b64 v[120:121], v[132:133]
    v_mov_b64 v[122:123], v[134:135]
    v_mov_b64 v[124:125], v[136:137]
    v_mov_b64 v[126:127], v[138:139]
    v_mov_b64 v[128:129], v[140:141]
    v_mov_b64 v[130:131], v[142:143]
    v_mov_b64 v[132:133], v[144:145]
    v_mov_b64 v[134:135], v[146:147]
    v_mov_b64 v[136:137], v[148:149]
    v_mov_b64 v[138:139], v[150:151]
    v_mov_b64 v[140:141], v[152:153]
    v_mov_b64 v[142:143], v[154:155]
    v_mov_b64 v[144:145], v[156:157]
    v_mov_b64 v[146:147], v[158:159]
    v_mov_b64 v[148:149], v[160:161]
    v_mov_b64 v[150:151], v[162:163]
    v_mov_b64 v[152:153], v[164:165]
    v_mov_b64 v[154:155], v[166:167]
    s_waitcnt vmcnt(0)
    v_cndmask_b32 v24, v70, v68, vcc
    v_cndmask_b32 v25, v71, v69, vcc
    v_cndmask_b32 v26, v66, v70, vcc
    v_cndmask_b32 v27, v67, v71, vcc
    v_cndmask_b32 v28, v68, v66, vcc
    v_cndmask_b32 v29, v69, v67, vcc
    v_perm_b32 v156, v24, v60, s22
    v_perm_b32 v157, v24, v60, s23
    v_perm_b32 v158, v25, v61, s22
    v_perm_b32 v159, v25, v61, s23
    v_perm_b32 v160, v26, v62, s22
    v_perm_b32 v161, v26, v62, s23
    v_perm_b32 v162, v27, v63, s22
    v_perm_b32 v163, v27, v63, s23
    v_perm_b32 v164, v28, v64, s22
    v_perm_b32 v165, v28, v64, s23
    v_perm_b32 v166, v29, v65, s22
    v_perm_b32 v167, v29, v65, s23
    s_cmp_lt_u32 s20, 8
    s_nop 0
    s_cbranch_scc1 L_kvisit
    v_mov_b64 v[72:73], v[120:121]
    v_mov_b64 v[74:75], v[122:123]
    v_mov_b64 v[76:77], v[124:125]
    v_mov_b64 v[78:79], v[126:127]
    v_mov_b64 v[80:81], v[128:129]
    v_mov_b64 v[82:83], v[130:131]
    v_mov_b64 v[84:85], v[132:133]
    v_mov_b64 v[86:87], v[134:135]
    v_mov_b64 v[88:89], v[136:137]
    v_mov_b64 v[90:91], v[138:139]
    v_mov_b64 v[92:93], v[140:141]
    v_mov_b64 v[94:95], v[142:143]
    v_mov_b64 v[96:97], v[144:145]
    v_mov_b64 v[98:99], v[146:147]
    v_mov_b64 v[100:101], v[148:149]
    v_mov_b64 v[102:103], v[150:151]
    v_mov_b64 v[104:105], v[152:153]
    v_mov_b64 v[106:107], v[154:155]
    v_mov_b64 v[108:109], v[156:157]
    v_mov_b64 v[110:111], v[158:159]
    v_mov_b64 v[112:113], v[160:161]
    v_mov_b64 v[114:115], v[162:163]
    v_mov_b64 v[116:117], v[164:165]
    v_mov_b64 v[118:119], v[166:167]
    s_mov_b32 s20, 0
    s_add_u32 s24, s24, 4
    s_and_b32 s24, s24, 15
    s_add_u32 s21, s21, 1
    s_cmp_lt_u32 s21, 4
    s_cbranch_scc1 L_kvisit
    v_lshrrev_b32 v21, 2, v1
    v_and_b32 v22, 3, v1
    v_mul_u32_u24 v5, 768, v21
    v_lshl_add_u32 v5, v22, 4, v5
    s_mul_i32 s80, s76, 192
    v_add_u32 v5, s80, v5
    v_lshlrev_b32 v19, 3, v21
    v_add_u32 v19, 126976, v19
    v_lshrrev_b32 v21, 4, v1
    v_lshl_add_u32 v7, v21, 2, v22
    v_and_b32 v21, 1, v7
    v_lshlrev_b32 v7, 4, v7
    s_lshl_b32 s80, s76, 8
    v_add_u32 v7, s80, v7
    v_lshlrev_b32 v18, 3, v21
    v_add_u32 v18, 157696, v18
    v_add_u32 v16, 143360, v7
    s_mov_b32 s32, 0x000f000f
    s_mov_b32 s33, 0x000f000f
    s_mov_b32 s17, 1548
    s_mul_i32 s24, s77, 4
    s_and_b32 s24, s24, 15
    s_mov_b32 s20, 0
    s_add_u32 s25, s77, 0
    s_mul_i32 s25, s25, 64
    s_add_u32 s25, s25, s78
    s_lshl_b32 s25, s25, 10
L_vhead:
    v_mov_b64 v[24:25], 0
    v_mov_b64 v[26:27], 0
    v_mov_b64 v[28:29], 0
    v_mov_b64 v[30:31], 0
    v_mov_b64 v[32:33], 0
    v_mov_b64 v[34:35], 0
    s_mov_b32 s21, 0
    s_nop 0
L_pw:
    ds_read_b64 v[36:37], v3 offset:32
    ds_read_b32 v4, v3 offset:40
    ds_read_b64 v[14:15], v18
    s_waitcnt lgkmcnt(0)
    v_readfirstlane_b32 s80, v37
    v_readfirstlane_b32 s28, v4
    s_cmp_gt_u32 s80, s20
    s_nop 3
    s_cbranch_scc1 L_pwg
    s_sleep 2
    s_branch L_pw
L_pwg:
    s_lshr_b32 s29, s28, 8
    s_lshr_b32 s30, s28, 16
L_vstep:
    s_xor_b32 s80, s20, 7
    s_lshl_b32 s80, s80, 4
    s_add_u32 s80, s80, s24
    s_lshl_b32 s80, s80, 7
    v_add_u32 v8, s80, v19
    v_add_u32 v6, s19, v5
    ds_read_b32 v12, v8
    s_cmp_ge_i32 s18, s17
    s_cbranch_scc1 L_vwg
L_vw:
    ds_read_b32 v4, v3 offset:16
    s_waitcnt lgkmcnt(0)
    v_readfirstlane_b32 s18, v4
    s_nop 0
    s_cmp_ge_i32 s18, s17
    s_nop 2
    s_cbranch_scc1 L_vwg
    s_sleep 1
    s_branch L_vw
L_vwg:
    ds_read_b128 v[36:39], v6 offset:0
    ds_read_b128 v[40:43], v6 offset:64
    ds_read_b128 v[44:47], v6 offset:128
    v_add_u32 v10, 1, v10
    s_add_u32 s19, s19, 12288
    s_cmp_eq_u32 s19, 110592
    s_cselect_b32 s19, 0, s19
    s_add_u32 s17, s17, 12
    s_add_u32 s24, s24, 1
    s_and_b32 s24, s24, 15
    s_add_u32 s21, s21, 1
    s_cmp_lt_u32 s21, 16
    s_waitcnt lgkmcnt(2)
    v_cvt_f32_i32 v36, v36
    v_cvt_f32_i32 v37, v37
    v_cvt_f32_i32 v38, v38
    v_cvt_f32_i32 v39, v39
    v_pk_fma_f32 v[24:25], v[36:37], v[12:13], v[24:25] op_sel_hi:[1,0,1]
    v_pk_fma_f32 v[26:27], v[38:39], v[12:13], v[26:27] op_sel_hi:[1,0,1]
    s_waitcnt lgkmcnt(1)
    v_cvt_f32_i32 v40, v40
    v_cvt_f32_i32 v41, v41
    v_cvt_f32_i32 v42, v42
    v_cvt_f32_i32 v43, v43
    v_pk_fma_f32 v[28:29], v[40:41], v[12:13], v[28:29] op_sel_hi:[1,0,1]
    v_pk_fma_f32 v[30:31], v[42:43], v[12:13], v[30:31] op_sel_hi:[1,0,1]
    s_waitcnt lgkmcnt(0)
    v_cvt_f32_i32 v44, v44
    v_cvt_f32_i32 v45, v45
    v_cvt_f32_i32 v46, v46
    v_cvt_f32_i32 v47, v47
    v_pk_fma_f32 v[32:33], v[44:45], v[12:13], v[32:33] op_sel_hi:[1,0,1]
    v_pk_fma_f32 v[34:35], v[46:47], v[12:13], v[34:35] op_sel_hi:[1,0,1]
    s_nop 1
    s_cbranch_scc0 L_vend
    ds_write_b32 v11, v10
    s_branch L_vstep
L_vend:
    v_permlane32_swap_b32 v24, v26
    v_permlane32_swap_b32 v25, v27
    v_permlane32_swap_b32 v28, v30
    v_permlane32_swap_b32 v29, v31
    v_permlane32_swap_b32 v32, v34
    v_permlane32_swap_b32 v33, v35
    v_pk_add_f32 v[24:25], v[24:25], v[26:27]
    v_pk_add_f32 v[28:29], v[28:29], v[30:31]
    v_pk_add_f32 v[32:33], v[32:33], v[34:35]
    v_permlane16_swap_b32 v24, v25
    v_permlane16_swap_b32 v28, v29
    v_permlane16_swap_b32 v32, v33
    v_add_f32 v36, v24, v25
    v_add_f32 v37, v28, v29
    v_add_f32 v38, v32, v33
    v_mov_b32 v39, v14
    v_add_f32_dpp v36, v36, v36 row_ror:4 row_mask:0xf bank_mask:0xf
    v_add_f32_dpp v37, v37, v37 row_ror:4 row_mask:0xf bank_mask:0xf
    v_add_f32_dpp v38, v38, v38 row_ror:4 row_mask:0xf bank_mask:0xf
    v_add_f32_dpp v36, v36, v36 row_ror:8 row_mask:0xf bank_mask:0xf
    v_add_f32_dpp v37, v37, v37 row_ror:8 row_mask:0xf bank_mask:0xf
    v_add_f32_dpp v38, v38, v38 row_ror:8 row_mask:0xf bank_mask:0xf
    v_sub_f32 v36, v36, v15
    v_sub_f32 v37, v37, v15
    v_sub_f32 v38, v38, v15
    v_bfi_b32 v36, v23, s28, v36
    v_bfi_b32 v37, v23, s29, v37
    v_bfi_b32 v38, v23, s30, v38
    s_add_u32 s20, s20, 1
    s_cmp_eq_u32 s20, 8
    s_mov_b64 exec, s[32:33]
    s_cbranch_scc1 L_vlast
    ds_write_b128 v16, v[36:39]
    s_mov_b64 exec, -1
    ds_write_b32 v11, v10
    v_add_u32 v16, 1024, v16
    v_add_u32 v18, 16, v18
    s_nop 1
    s_branch L_vhead
L_vlast:
    buffer_store_dwordx4 v[36:39], v7, s[12:15], s25 offen sc0 sc1
    s_endpgm
    s_nop 0
L_aux:
    s_cmp_eq_u32 s76, 5
    s_cbranch_scc0 L_bal
    v_lshlrev_b32 v5, 3, v1
    v_cmp_gt_u32 vcc, 24, v1
    v_mov_b32 v13, 0xffffff40
    v_mov_b32 v10, 192
    v_cndmask_b32 v13, v13, v10, vcc
    v_add_u32 v6, v5, v13
    v_mov_b32 v10, 0x80008000
    v_cndmask_b32 v7, 0, v10, vcc
    v_lshrrev_b32 v10, 1, v1
    v_and_b32 v11, 15, v10
    v_lshrrev_b32 v10, 4, v10
    v_mul_u32_u24 v10, 131072, v10
    v_mul_u32_u24 v11, 2048, v11
    v_add_u32 v10, v10, v11
    v_and_b32 v11, 1, v1
    v_lshl_add_u32 v17, v11, 4, v10
    v_add_u32 v10, 0, v1
    v_mul_u32_u24 v12, 2731, v10
    v_lshrrev_b32 v12, 16, v12
    v_mul_u32_u24 v12, 1152, v12
    v_lshl_add_u32 v56, v10, 4, v12
    v_add_u32 v10, 64, v1
    v_mul_u32_u24 v12, 2731, v10
    v_lshrrev_b32 v12, 16, v12
    v_mul_u32_u24 v12, 1152, v12
    v_lshl_add_u32 v57, v10, 4, v12
    v_add_u32 v10, 128, v1
    v_mul_u32_u24 v12, 2731, v10
    v_lshrrev_b32 v12, 16, v12
    v_mul_u32_u24 v12, 1152, v12
    v_lshl_add_u32 v58, v10, 4, v12
    v_cmp_eq_u32 s[32:33], 0, v11
    s_lshl_b32 s27, s77, 15
    s_lshl_b32 s80, s78, 5
    s_add_u32 s27, s27, s80
    s_mov_b32 m0, 143360
    s_waitcnt lgkmcnt(0)
    s_mov_b32 s4, s62
    s_mov_b32 s5, s63
    s_mov_b32 s6, 384
    s_mov_b32 s7, 0x20000
    s_mov_b32 s20, s64
    s_mov_b32 s21, s65
    s_mov_b32 s22, 384
    s_mov_b32 s23, 0x20000
    buffer_load_dwordx2 v[28:29], v5, s[4:7], 0 offen
    buffer_load_dwordx2 v[30:31], v5, s[20:23], 0 offen
    s_mov_b32 s4, s48
    s_mov_b32 s5, s49
    s_mov_b32 s6, 12288
    s_mov_b32 s7, 0x20000
    s_mul_i32 s80, s77, 384
    buffer_load_dwordx4 v56, s[4:7], s80 offen lds
    s_add_u32 m0, m0, 1024
    s_nop 0
    buffer_load_dwordx4 v57, s[4:7], s80 offen lds
    s_add_u32 m0, m0, 1024
    s_nop 0
    buffer_load_dwordx4 v58, s[4:7], s80 offen lds
    s_add_u32 m0, m0, 1024
    s_and_b32 s80, s78, 3
    s_lshl_b32 s80, s80, 3
    v_lshrrev_b32 v10, 3, v1
    v_add_u32 v10, s80, v10
    v_and_b32 v11, 15, v10
    v_lshrrev_b32 v10, 4, v10
    v_mul_u32_u24 v10, 131072, v10
    v_mul_u32_u24 v11, 2048, v11
    v_add_u32 v10, v10, v11
    v_and_b32 v11, 7, v1
    v_lshl_add_u32 v62, v11, 4, v10
    s_mov_b32 s20, s52
    s_mov_b32 s21, s53
    s_mov_b32 s22, 1048576
    s_mov_b32 s23, 0x20000
    s_andn2_b32 s80, s27, 127
    buffer_load_dwordx4 v[64:67], v62, s[20:23], s80 offen
    s_add_u32 s80, s80, 262144
    buffer_load_dwordx4 v[64:67], v62, s[20:23], s80 offen
    s_add_u32 s80, s80, 262144
    buffer_load_dwordx4 v[64:67], v62, s[20:23], s80 offen
    s_add_u32 s80, s80, 262144
    buffer_load_dwordx4 v[64:67], v62, s[20:23], s80 offen
    s_add_u32 s80, s80, 262144
    s_mov_b32 s20, s54
    s_mov_b32 s21, s55
    s_mov_b32 s22, 1048576
    s_mov_b32 s23, 0x20000
    s_andn2_b32 s80, s27, 127
    buffer_load_dwordx4 v[64:67], v62, s[20:23], s80 offen
    s_add_u32 s80, s80, 262144
    buffer_load_dwordx4 v[64:67], v62, s[20:23], s80 offen
    s_add_u32 s80, s80, 262144
    buffer_load_dwordx4 v[64:67], v62, s[20:23], s80 offen
    s_add_u32 s80, s80, 262144
    buffer_load_dwordx4 v[64:67], v62, s[20:23], s80 offen
    s_add_u32 s80, s80, 262144
    s_mov_b32 s20, s58
    s_mov_b32 s21, s59
    s_mov_b32 s22, 1048576
    s_mov_b32 s23, 0x20000
    s_andn2_b32 s80, s27, 127
    buffer_load_dwordx4 v[64:67], v62, s[20:23], s80 offen
    s_add_u32 s80, s80, 262144
    buffer_load_dwordx4 v[64:67], v62, s[20:23], s80 offen
    s_add_u32 s80, s80, 262144
    buffer_load_dwordx4 v[64:67], v62, s[20:23], s80 offen
    s_add_u32 s80, s80, 262144
    buffer_load_dwordx4 v[64:67], v62, s[20:23], s80 offen
    s_add_u32 s80, s80, 262144
    s_mov_b32 s20, s60
    s_mov_b32 s21, s61
    s_mov_b32 s22, 1048576
    s_mov_b32 s23, 0x20000
    s_andn2_b32 s80, s27, 127
    buffer_load_dwordx4 v[64:67], v62, s[20:23], s80 offen
    s_add_u32 s80, s80, 262144
    buffer_load_dwordx4 v[64:67], v62, s[20:23], s80 offen
    s_add_u32 s80, s80, 262144
    buffer_load_dwordx4 v[64:67], v62, s[20:23], s80 offen
    s_add_u32 s80, s80, 262144
    buffer_load_dwordx4 v[64:67], v62, s[20:23], s80 offen
    s_add_u32 s80, s80, 262144
    s_mov_b32 s12, s74
    s_mov_b32 s13, s75
    s_mov_b32 s14, 1610612736
    s_mov_b32 s15, 0x20000
    s_mov_b32 s8, s72
    s_mov_b32 s9, s73
    s_mov_b32 s10, 256
    s_mov_b32 s11, 0x20000
    s_mov_b32 s16, s70
    s_mov_b32 s17, s71
    s_mov_b32 s18, 12288
    s_mov_b32 s19, 0x20000
    v_mov_b32 v14, 0xff
    v_add_u32 v15, 143360, v5
    v_add_u32 v16, 143360, v6
    v_lshlrev_b32 v8, 1, v5
    v_lshlrev_b32 v9, 1, v6
    v_add_u32 v8, 151552, v8
    v_add_u32 v9, 151552, v9
    v_mov_b32 v12, 0
    s_mov_b32 s24, 0
    s_waitcnt vmcnt(19)
    v_xor_b32 v30, v30, v7
    v_xor_b32 v31, v31, v7
    v_lshlrev_b32 v32, 16, v28
    v_and_b32 v33, 0xffff0000, v28
    v_lshlrev_b32 v34, 16, v29
    v_and_b32 v35, 0xffff0000, v29
    v_lshlrev_b32 v36, 16, v30
    v_and_b32 v37, 0xffff0000, v30
    v_lshlrev_b32 v38, 16, v31
    v_and_b32 v39, 0xffff0000, v31
    v_and_b32 v7, 0x80000000, v7
    s_waitcnt vmcnt(16)
    s_mov_b32 exec_hi, 0xffff
L_hq:
    ds_read_b64 v[20:21], v15
    ds_read_b64 v[22:23], v16
    v_add_u32 v15, 384, v15
    v_add_u32 v16, 384, v16
    v_add_u32 v12, 1, v12
    s_waitcnt lgkmcnt(0)
    v_lshlrev_b32 v40, 16, v20
    v_and_b32 v41, 0xffff0000, v20
    v_lshlrev_b32 v42, 16, v21
    v_and_b32 v43, 0xffff0000, v21
    v_lshlrev_b32 v44, 16, v22
    v_and_b32 v45, 0xffff0000, v22
    v_lshlrev_b32 v46, 16, v23
    v_and_b32 v47, 0xffff0000, v23
    v_pk_mul_f32 v[40:41], v[40:41], v[32:33]
    v_pk_mul_f32 v[44:45], v[44:45], v[36:37]
    v_pk_mul_f32 v[42:43], v[42:43], v[34:35]
    v_pk_mul_f32 v[46:47], v[46:47], v[38:39]
    v_cvt_pk_bf16_f32 v40, v40, v44
    v_cvt_pk_bf16_f32 v41, v41, v45
    v_cvt_pk_bf16_f32 v42, v42, v46
    v_cvt_pk_bf16_f32 v43, v43, v47
    v_and_b32 v44, 0xffff0000, v40
    v_lshlrev_b32 v40, 16, v40
    v_and_b32 v45, 0xffff0000, v41
    v_lshlrev_b32 v41, 16, v41
    v_and_b32 v46, 0xffff0000, v42
    v_lshlrev_b32 v42, 16, v42
    v_and_b32 v47, 0xffff0000, v43
    v_lshlrev_b32 v43, 16, v43
    v_pk_add_f32 v[40:41], v[40:41], v[44:45]
    v_pk_add_f32 v[42:43], v[42:43], v[46:47]
    v_cvt_pk_bf16_f32 v48, v40, v40
    v_cvt_pk_bf16_f32 v49, v41, v41
    v_cvt_pk_bf16_f32 v50, v42, v42
    v_cvt_pk_bf16_f32 v51, v43, v43
    v_xor_b32 v48, v48, v7
    v_xor_b32 v49, v49, v7
    v_xor_b32 v50, v50, v7
    v_xor_b32 v51, v51, v7
    ds_write_b16 v8, v48 offset:0
    ds_write_b16_d16_hi v9, v48 offset:2
    ds_write_b16 v8, v49 offset:4
    ds_write_b16_d16_hi v9, v49 offset:6
    ds_write_b16 v8, v50 offset:8
    ds_write_b16_d16_hi v9, v50 offset:10
    ds_write_b16 v8, v51 offset:12
    ds_write_b16_d16_hi v9, v51 offset:14
    ds_write_b32 v3, v12 offset:32
    v_add_u32 v8, 768, v8
    v_add_u32 v9, 768, v9
    s_add_u32 s24, s24, 1
    s_cmp_lt_u32 s24, 8
    s_cbranch_scc1 L_hq
    s_mov_b32 exec_hi, -1
    s_add_u32 s80, s77, 0
    s_mul_i32 s80, s80, 64
    s_add_u32 s80, s80, s78
    s_lshl_b32 s80, s80, 10
    buffer_load_dwordx4 v[64:67], v2, s[12:15], s80 offen
    s_add_u32 s80, s80, 262144
    v_mov_b32 v15, 0
    s_mov_b32 s25, 0
    s_cmp_eq_u32 s2, 0
    s_cbranch_scc1 L_epc
L_epw:
    s_sleep 16
    ds_read_b32 v4, v3 offset:20
    s_waitcnt lgkmcnt(0)
    v_readfirstlane_b32 s80, v4
    s_nop 0
    s_cmp_lt_i32 s80, 16
    s_nop 2
    s_cbranch_scc1 L_epw
    s_load_dword s28, s[72:73], 0
    s_waitcnt lgkmcnt(0)
    s_cmp_lg_u32 s28, 0
    s_cbranch_scc1 L_epd
L_ep:
    s_mov_b64 exec, 1
    buffer_load_dword v11, v15, s[8:11], 0 offen sc0 sc1
    s_waitcnt vmcnt(0)
    v_readfirstlane_b32 s28, v11
    s_mov_b64 exec, -1
    s_cmp_lg_u32 s28, 0
    s_nop 2
    s_cbranch_scc1 L_epd
    s_sleep 32
    s_add_u32 s25, s25, 1
    s_cmp_lt_u32 s25, 8
    s_cbranch_scc1 L_ep
L_epc:
    s_mul_i32 s28, s84, 0x9e3779b1
    s_lshr_b32 s81, s28, 15
    s_xor_b32 s28, s28, s81
    s_mul_i32 s28, s28, 0x85ebca6b
    s_lshr_b32 s81, s28, 13
    s_xor_b32 s28, s28, s81
    s_max_u32 s28, s28, 1
    v_mov_b32 v20, s28
    v_mov_b32 v21, 0
    s_mov_b64 exec, 1
    buffer_atomic_cmpswap v[20:21], v15, s[8:11], 0 offen sc0 sc1
    s_waitcnt vmcnt(0)
    v_readfirstlane_b32 s80, v20
    s_mov_b64 exec, -1
    s_cmp_eq_u32 s80, 0
    s_cselect_b32 s28, s28, s80
    s_nop 1
L_epd:
    v_mov_b32 v12, s28
    ds_write_b32 v3, v12 offset:40
    s_lshr_b32 s29, s28, 8
    s_lshr_b32 s30, s28, 16
    s_lshr_b32 s31, s28, 24
    s_add_u32 s24, s77, 16
    s_mov_b32 s25, 0
    s_mov_b32 s20, s52
    s_mov_b32 s21, s53
    s_mov_b32 s22, 1048576
    s_mov_b32 s23, 0x20000
L_sc:
    s_sleep 16
    ds_read_b32 v4, v3 offset:20
    s_waitcnt lgkmcnt(0)
    v_readfirstlane_b32 s80, v4
    s_nop 0
    s_cmp_lt_i32 s80, s24
    s_nop 2
    s_cbranch_scc1 L_sc
    s_lshr_b32 s80, s78, 2
    s_add_u32 s80, s80, s25
    s_and_b32 s80, s80, 15
    s_lshl_b32 s81, s80, 10
    s_add_u32 m0, s81, 110592
    s_mov_b64 s[20:21], s[52:53]
    s_cmp_ge_u32 s80, 4
    s_cselect_b64 s[20:21], s[54:55], s[20:21]
    s_cmp_ge_u32 s80, 8
    s_cselect_b64 s[20:21], s[58:59], s[20:21]
    s_cmp_ge_u32 s80, 12
    s_cselect_b64 s[20:21], s[60:61], s[20:21]
    s_and_b32 s80, s80, 3
    s_mul_i32 s80, s80, 262144
    s_add_u32 s80, s80, s27
    buffer_load_dwordx4 v17, s[20:23], s80 offen  lds
    s_add_u32 s25, s25, 1
    s_add_u32 s24, s24, 4
    s_cmp_lt_u32 s25, 16
    s_cbranch_scc1 L_sc
    s_waitcnt vmcnt(0)
    v_mov_b32 v28, 0
    v_mov_b32 v29, 0
    v_mov_b32 v30, 0
    v_mov_b32 v31, 0
    v_mov_b32 v32, 0
    v_mov_b32 v33, 0
    v_mov_b32 v34, 0
    v_mov_b32 v35, 0
    v_mov_b32 v36, 0
    v_mov_b32 v37, 0
    v_mov_b32 v38, 0
    v_mov_b32 v39, 0
    v_mov_b32 v40, 0
    v_mov_b32 v41, 0
    v_mov_b32 v42, 0
    v_mov_b32 v43, 0
    v_mov_b32 v44, 0
    v_mov_b32 v45, 0
    v_mov_b32 v46, 0
    v_mov_b32 v47, 0
    v_mov_b32 v48, 0
    v_mov_b32 v49, 0
    v_mov_b32 v50, 0
    v_mov_b32 v51, 0
    v_mov_b32 v64, 0
    v_mov_b32 v65, 0
    v_mov_b32 v66, 0
    v_mov_b32 v67, 0
    v_mov_b32 v68, 0
    v_mov_b32 v69, 0
    v_mov_b32 v70, 0
    v_mov_b32 v71, 0
    v_lshlrev_b32 v15, 3, v1
    v_add_u32 v15, 141312, v15
    v_lshlrev_b32 v16, 1, v1
    v_add_u32 v16, 114176, v16
    v_mov_b32 v8, 157696
    v_mov_b32 v9, 0
    s_mov_b32 s24, 100
    s_nop 0
L_hp:
    s_sleep 8
    ds_read_b128 v[56:59], v3
    s_waitcnt lgkmcnt(0)
    v_min3_i32 v56, v56, v57, v58
    v_min_i32 v56, v56, v59
    s_nop 0
    v_readfirstlane_b32 s80, v56
    s_nop 0
    s_cmp_lt_i32 s80, s24
    s_nop 2
    s_cbranch_scc1 L_hp
    ds_read_b64 v[72:73], v15 offset:0
    ds_read_u16_d16_hi v28, v16 offset:0
    ds_read_u16_d16_hi v64, v16 offset:4096
    ds_read_b64 v[74:75], v15 offset:512
    ds_read_u16_d16_hi v29, v16 offset:128
    ds_read_u16_d16_hi v65, v16 offset:4224
    ds_read_b64 v[76:77], v15 offset:1024
    ds_read_u16_d16_hi v30, v16 offset:256
    ds_read_u16_d16_hi v66, v16 offset:4352
    ds_read_b64 v[78:79], v15 offset:1536
    ds_read_u16_d16_hi v31, v16 offset:384
    ds_read_u16_d16_hi v67, v16 offset:4480
    s_waitcnt lgkmcnt(0)
    ds_read_u16_d16_hi v36, v16 offset:8192
    ds_read_u16_d16_hi v44, v16 offset:12288
    ds_read_u16_d16_hi v37, v16 offset:8320
    ds_read_u16_d16_hi v45, v16 offset:12416
    ds_read_u16_d16_hi v38, v16 offset:8448
    ds_read_u16_d16_hi v46, v16 offset:12544
    ds_read_u16_d16_hi v39, v16 offset:8576
    ds_read_u16_d16_hi v47, v16 offset:12672
    v_fma_f32 v20, -v64, v73, v72
    v_fma_f32 v21, -v65, v75, v74
    v_fma_f32 v22, -v66, v77, v76
    v_fma_f32 v23, -v67, v79, v78
    v_mul_f32 v20, v20, v28
    v_mul_f32 v21, v21, v29
    v_mul_f32 v22, v22, v30
    v_mul_f32 v23, v23, v31
    v_mul_f32 v20, 0x3dd53b95, v20
    v_mul_f32 v21, 0x3dd53b95, v21
    v_mul_f32 v22, 0x3dd53b95, v22
    v_mul_f32 v23, 0x3dd53b95, v23
    v_mov_b32 v52, v20
    v_max_f32 v52, v52, v21
    v_max_f32 v52, v52, v22
    v_max_f32 v52, v52, v23
    s_nop 1
    v_max_f32_dpp v52, v52, v52 quad_perm:[1,0,3,2] row_mask:0xf bank_mask:0xf
    s_nop 1
    v_max_f32_dpp v52, v52, v52 quad_perm:[2,3,0,1] row_mask:0xf bank_mask:0xf
    s_nop 1
    v_max_f32_dpp v52, v52, v52 row_half_mirror row_mask:0xf bank_mask:0xf
    s_nop 1
    v_max_f32_dpp v52, v52, v52 row_mirror row_mask:0xf bank_mask:0xf
    v_mov_b32 v13, v52
    s_nop 1
    v_permlane32_swap_b32 v52, v13
    v_max_f32 v52, v52, v13
    v_mov_b32 v13, v52
    s_nop 1
    v_permlane16_swap_b32 v52, v13
    v_max_f32 v52, v52, v13
    v_sub_f32 v20, v20, v52
    v_sub_f32 v21, v21, v52
    v_sub_f32 v22, v22, v52
    v_sub_f32 v23, v23, v52
    v_exp_f32 v20, v20
    v_exp_f32 v21, v21
    v_exp_f32 v22, v22
    v_exp_f32 v23, v23
    v_mov_b32 v54, v20
    v_add_f32 v54, v54, v21
    v_add_f32 v54, v54, v22
    v_add_f32 v54, v54, v23
    s_waitcnt lgkmcnt(0)
    v_mul_f32 v20, v20, v36
    v_mul_f32 v21, v21, v37
    v_mul_f32 v22, v22, v38
    v_mul_f32 v23, v23, v39
    v_mul_f32 v53, v20, v44
    v_fmac_f32 v53, v21, v45
    v_fmac_f32 v53, v22, v46
    v_fmac_f32 v53, v23, v47
    ds_write_b32 v15, v20 offset:0
    ds_write_b32 v15, v21 offset:512
    ds_write_b32 v15, v22 offset:1024
    ds_write_b32 v15, v23 offset:1536
    v_add_f32_dpp v54, v54, v54 quad_perm:[1,0,3,2] row_mask:0xf bank_mask:0xf
    s_nop 1
    v_add_f32_dpp v54, v54, v54 quad_perm:[2,3,0,1] row_mask:0xf bank_mask:0xf
    s_nop 1
    v_add_f32_dpp v54, v54, v54 row_half_mirror row_mask:0xf bank_mask:0xf
    s_nop 1
    v_add_f32_dpp v54, v54, v54 row_mirror row_mask:0xf bank_mask:0xf
    v_mov_b32 v13, v54
    s_nop 1
    v_permlane32_swap_b32 v54, v13
    v_add_f32 v54, v54, v13
    v_mov_b32 v13, v54
    s_nop 1
    v_permlane16_swap_b32 v54, v13
    v_add_f32 v54, v54, v13
    v_add_f32_dpp v53, v53, v53 quad_perm:[1,0,3,2] row_mask:0xf bank_mask:0xf
    s_nop 1
    v_add_f32_dpp v53, v53, v53 quad_perm:[2,3,0,1] row_mask:0xf bank_mask:0xf
    s_nop 1
    v_add_f32_dpp v53, v53, v53 row_half_mirror row_mask:0xf bank_mask:0xf
    s_nop 1
    v_add_f32_dpp v53, v53, v53 row_mirror row_mask:0xf bank_mask:0xf
    v_mov_b32 v13, v53
    s_nop 1
    v_permlane32_swap_b32 v53, v13
    v_add_f32 v53, v53, v13
    v_mov_b32 v13, v53
    s_nop 1
    v_permlane16_swap_b32 v53, v13
    v_add_f32 v53, v53, v13
    v_bfi_b32 v54, v14, s31, v54
    v_mov_b32 v55, v53
    v_add_u32 v9, 1, v9
    s_mov_b64 exec, 1
    ds_write_b128 v8, v[52:55]
    ds_write_b32 v3, v9 offset:36
    s_mov_b64 exec, -1
    v_add_u32 v15, -2048, v15
    v_add_u32 v16, -512, v16
    v_add_u32 v8, 16, v8
    s_add_u32 s24, s24, 4
    s_cmp_le_u32 s24, 128
    s_cbranch_scc1 L_hp
    s_add_u32 s26, s77, 28
    s_mul_i32 s26, s26, 64
    s_add_u32 s26, s26, s78
    s_lshl_b32 s26, s26, 10
    s_lshr_b32 s34, s2, 3
    s_and_b32 s35, s2, 7
    v_lshrrev_b32 v10, 3, v1
    v_and_b32 v16, 7, v1
    v_lshlrev_b32 v10, 10, v10
    v_lshl_add_u32 v15, v16, 4, v10
    v_lshrrev_b32 v10, 2, v16
    v_and_b32 v16, 3, v16
    v_lshl_add_u32 v16, v16, 2, v10
    v_lshlrev_b32 v16, 1, v16
    v_bfe_u32 v10, v1, 4, 1
    v_lshl_add_u32 v16, v10, 6, v16
    v_lshrrev_b32 v10, 5, v1
    v_lshl_add_u32 v16, v10, 5, v16
    s_mov_b32 s25, 0
    s_mov_b32 s38, 0
    s_mul_i32 s36, s34, 65536
    s_lshl_b32 s83, s35, 7
    s_add_u32 s36, s36, s83
    s_mul_i32 s37, s34, 384
    s_lshr_b32 s83, s35, 1
    s_mul_i32 s83, s83, 96
    s_add_u32 s37, s37, s83
    s_and_b32 s83, s35, 1
    s_lshl_b32 s83, s83, 2
    s_add_u32 s37, s37, s83
    s_mov_b32 s40, s74
    s_mov_b32 s41, s75
    s_mov_b32 s42, 1610612736
    s_mov_b32 s43, 0x20000
    s_mov_b32 s16, s70
    s_mov_b32 s17, s71
    s_mov_b32 s18, 12288
    s_mov_b32 s19, 0x20000
    v_add_u32 v13, 143360, v2
    s_nop 1
L_hf:
    s_sleep 32
    ds_read_b128 v[56:59], v3
    s_waitcnt lgkmcnt(0)
    v_min3_i32 v56, v56, v57, v58
    v_min_i32 v56, v56, v59
    s_nop 0
    v_readfirstlane_b32 s80, v56
    s_nop 0
    s_cmp_lt_i32 s80, 240
    s_nop 2
    s_cbranch_scc1 L_hf
    ds_read_b128 v[140:143], v13 offset:0
    ds_read_b128 v[144:147], v13 offset:1024
    ds_read_b128 v[148:151], v13 offset:2048
    ds_read_b128 v[152:155], v13 offset:3072
    ds_read_b128 v[156:159], v13 offset:4096
    ds_read_b128 v[160:163], v13 offset:5120
    ds_read_b128 v[164:167], v13 offset:6144
L_hn:
    s_sleep 2
    ds_read_b32 v4, v3 offset:16
    s_waitcnt lgkmcnt(0)
    v_readfirstlane_b32 s80, v4
    s_nop 0
    s_cmp_lt_i32 s80, 3042
    s_nop 2
    s_cbranch_scc1 L_hn
    buffer_store_dwordx4 v[140:143], v2, s[12:15], s26 offen sc0 sc1
    s_sub_u32 s26, s26, 262144
    buffer_store_dwordx4 v[144:147], v2, s[12:15], s26 offen sc0 sc1
    s_sub_u32 s26, s26, 262144
    buffer_store_dwordx4 v[148:151], v2, s[12:15], s26 offen sc0 sc1
    s_sub_u32 s26, s26, 262144
    buffer_store_dwordx4 v[152:155], v2, s[12:15], s26 offen sc0 sc1
    s_sub_u32 s26, s26, 262144
    buffer_store_dwordx4 v[156:159], v2, s[12:15], s26 offen sc0 sc1
    s_sub_u32 s26, s26, 262144
    buffer_store_dwordx4 v[160:163], v2, s[12:15], s26 offen sc0 sc1
    s_sub_u32 s26, s26, 262144
    buffer_store_dwordx4 v[164:167], v2, s[12:15], s26 offen sc0 sc1
    s_sub_u32 s26, s26, 262144
    s_nop 0
L_hl:
    s_sleep 1
    ds_read_b32 v4, v3 offset:16
    s_waitcnt lgkmcnt(0)
    v_readfirstlane_b32 s80, v4
    s_nop 0
    s_cmp_lt_i32 s80, 3072
    s_nop 2
    s_cbranch_scc1 L_hl
    s_mov_b32 s80, s36
    buffer_load_dwordx4 v[44:47], v15, s[40:43], s80 offen sc0 sc1
    s_add_u32 s80, s80, 8192
    buffer_load_dwordx4 v[48:51], v15, s[40:43], s80 offen sc0 sc1
    s_add_u32 s80, s80, 8192
    buffer_load_dwordx4 v[52:55], v15, s[40:43], s80 offen sc0 sc1
    s_add_u32 s80, s80, 8192
    buffer_load_dwordx4 v[56:59], v15, s[40:43], s80 offen sc0 sc1
    s_add_u32 s80, s80, 8192
    buffer_load_dwordx4 v[60:63], v15, s[40:43], s80 offen sc0 sc1
    s_add_u32 s80, s80, 8192
    buffer_load_dwordx4 v[64:67], v15, s[40:43], s80 offen sc0 sc1
    s_add_u32 s80, s80, 8192
    buffer_load_dwordx4 v[68:71], v15, s[40:43], s80 offen sc0 sc1
    s_add_u32 s80, s80, 8192
    buffer_load_dwordx4 v[72:75], v15, s[40:43], s80 offen sc0 sc1
    s_waitcnt vmcnt(7)
    v_xor_b32 v12, s28, v44
    v_bitop3_b32 v12, v12, v45, s29 bitop3:0xf6
    v_bitop3_b32 v12, v12, v46, s30 bitop3:0xf6
    v_xor_b32 v13, s31, v47
    s_waitcnt vmcnt(6)
    v_bitop3_b32 v12, v12, v48, s28 bitop3:0xf6
    v_bitop3_b32 v12, v12, v49, s29 bitop3:0xf6
    v_bitop3_b32 v12, v12, v50, s30 bitop3:0xf6
    v_bitop3_b32 v13, v13, v51, s31 bitop3:0xf6
    s_waitcnt vmcnt(5)
    v_bitop3_b32 v12, v12, v52, s28 bitop3:0xf6
    v_bitop3_b32 v12, v12, v53, s29 bitop3:0xf6
    v_bitop3_b32 v12, v12, v54, s30 bitop3:0xf6
    v_bitop3_b32 v13, v13, v55, s31 bitop3:0xf6
    s_waitcnt vmcnt(4)
    v_bitop3_b32 v12, v12, v56, s28 bitop3:0xf6
    v_bitop3_b32 v12, v12, v57, s29 bitop3:0xf6
    v_bitop3_b32 v12, v12, v58, s30 bitop3:0xf6
    v_bitop3_b32 v13, v13, v59, s31 bitop3:0xf6
    s_waitcnt vmcnt(3)
    v_bitop3_b32 v12, v12, v60, s28 bitop3:0xf6
    v_bitop3_b32 v12, v12, v61, s29 bitop3:0xf6
    v_bitop3_b32 v12, v12, v62, s30 bitop3:0xf6
    v_bitop3_b32 v13, v13, v63, s31 bitop3:0xf6
    s_waitcnt vmcnt(2)
    v_bitop3_b32 v12, v12, v64, s28 bitop3:0xf6
    v_bitop3_b32 v12, v12, v65, s29 bitop3:0xf6
    v_bitop3_b32 v12, v12, v66, s30 bitop3:0xf6
    v_bitop3_b32 v13, v13, v67, s31 bitop3:0xf6
    s_waitcnt vmcnt(1)
    v_bitop3_b32 v12, v12, v68, s28 bitop3:0xf6
    v_bitop3_b32 v12, v12, v69, s29 bitop3:0xf6
    v_bitop3_b32 v12, v12, v70, s30 bitop3:0xf6
    v_bitop3_b32 v13, v13, v71, s31 bitop3:0xf6
    s_waitcnt vmcnt(0)
    v_bitop3_b32 v12, v12, v72, s28 bitop3:0xf6
    v_bitop3_b32 v12, v12, v73, s29 bitop3:0xf6
    v_bitop3_b32 v12, v12, v74, s30 bitop3:0xf6
    v_bitop3_b32 v13, v13, v75, s31 bitop3:0xf6
    v_cndmask_b32 v13, v13, 0, s[32:33]
    v_bitop3_b32 v12, v12, v13, v14 bitop3:0xa8
    v_cmp_ne_u32 vcc, 0, v12
    s_nop 4
    s_cbranch_vccz L_ok0
    s_mov_b32 s80, s36
    buffer_load_dwordx4 v[44:47], v15, s[40:43], s80 offen sc0 sc1
    s_add_u32 s80, s80, 8192
    buffer_load_dwordx4 v[48:51], v15, s[40:43], s80 offen sc0 sc1
    s_add_u32 s80, s80, 8192
    buffer_load_dwordx4 v[52:55], v15, s[40:43], s80 offen sc0 sc1
    s_add_u32 s80, s80, 8192
    buffer_load_dwordx4 v[56:59], v15, s[40:43], s80 offen sc0 sc1
    s_add_u32 s80, s80, 8192
    buffer_load_dwordx4 v[60:63], v15, s[40:43], s80 offen sc0 sc1
    s_add_u32 s80, s80, 8192
    buffer_load_dwordx4 v[64:67], v15, s[40:43], s80 offen sc0 sc1
    s_add_u32 s80, s80, 8192
    buffer_load_dwordx4 v[68:71], v15, s[40:43], s80 offen sc0 sc1
    s_add_u32 s80, s80, 8192
    buffer_load_dwordx4 v[72:75], v15, s[40:43], s80 offen sc0 sc1
    s_sleep 6
L_try:
    s_mov_b32 s80, s36
    buffer_load_dwordx4 v[76:79], v15, s[40:43], s80 offen sc0 sc1
    s_add_u32 s80, s80, 8192
    buffer_load_dwordx4 v[80:83], v15, s[40:43], s80 offen sc0 sc1
    s_add_u32 s80, s80, 8192
    buffer_load_dwordx4 v[84:87], v15, s[40:43], s80 offen sc0 sc1
    s_add_u32 s80, s80, 8192
    buffer_load_dwordx4 v[88:91], v15, s[40:43], s80 offen sc0 sc1
    s_add_u32 s80, s80, 8192
    buffer_load_dwordx4 v[92:95], v15, s[40:43], s80 offen sc0 sc1
    s_add_u32 s80, s80, 8192
    buffer_load_dwordx4 v[96:99], v15, s[40:43], s80 offen sc0 sc1
    s_add_u32 s80, s80, 8192
    buffer_load_dwordx4 v[100:103], v15, s[40:43], s80 offen sc0 sc1
    s_add_u32 s80, s80, 8192
    buffer_load_dwordx4 v[104:107], v15, s[40:43], s80 offen sc0 sc1
    s_waitcnt vmcnt(15)
    v_xor_b32 v12, s28, v44
    v_bitop3_b32 v12, v12, v45, s29 bitop3:0xf6
    v_bitop3_b32 v12, v12, v46, s30 bitop3:0xf6
    v_xor_b32 v13, s31, v47
    s_waitcnt vmcnt(14)
    v_bitop3_b32 v12, v12, v48, s28 bitop3:0xf6
    v_bitop3_b32 v12, v12, v49, s29 bitop3:0xf6
    v_bitop3_b32 v12, v12, v50, s30 bitop3:0xf6
    v_bitop3_b32 v13, v13, v51, s31 bitop3:0xf6
    s_waitcnt vmcnt(13)
    v_bitop3_b32 v12, v12, v52, s28 bitop3:0xf6
    v_bitop3_b32 v12, v12, v53, s29 bitop3:0xf6
    v_bitop3_b32 v12, v12, v54, s30 bitop3:0xf6
    v_bitop3_b32 v13, v13, v55, s31 bitop3:0xf6
    s_waitcnt vmcnt(12)
    v_bitop3_b32 v12, v12, v56, s28 bitop3:0xf6
    v_bitop3_b32 v12, v12, v57, s29 bitop3:0xf6
    v_bitop3_b32 v12, v12, v58, s30 bitop3:0xf6
    v_bitop3_b32 v13, v13, v59, s31 bitop3:0xf6
    s_waitcnt vmcnt(11)
    v_bitop3_b32 v12, v12, v60, s28 bitop3:0xf6
    v_bitop3_b32 v12, v12, v61, s29 bitop3:0xf6
    v_bitop3_b32 v12, v12, v62, s30 bitop3:0xf6
    v_bitop3_b32 v13, v13, v63, s31 bitop3:0xf6
    s_waitcnt vmcnt(10)
    v_bitop3_b32 v12, v12, v64, s28 bitop3:0xf6
    v_bitop3_b32 v12, v12, v65, s29 bitop3:0xf6
    v_bitop3_b32 v12, v12, v66, s30 bitop3:0xf6
    v_bitop3_b32 v13, v13, v67, s31 bitop3:0xf6
    s_waitcnt vmcnt(9)
    v_bitop3_b32 v12, v12, v68, s28 bitop3:0xf6
    v_bitop3_b32 v12, v12, v69, s29 bitop3:0xf6
    v_bitop3_b32 v12, v12, v70, s30 bitop3:0xf6
    v_bitop3_b32 v13, v13, v71, s31 bitop3:0xf6
    s_waitcnt vmcnt(8)
    v_bitop3_b32 v12, v12, v72, s28 bitop3:0xf6
    v_bitop3_b32 v12, v12, v73, s29 bitop3:0xf6
    v_bitop3_b32 v12, v12, v74, s30 bitop3:0xf6
    v_bitop3_b32 v13, v13, v75, s31 bitop3:0xf6
    v_cndmask_b32 v13, v13, 0, s[32:33]
    v_bitop3_b32 v12, v12, v13, v14 bitop3:0xa8
    v_cmp_ne_u32 vcc, 0, v12
    s_nop 4
    s_cbranch_vccz L_ok0
    s_mov_b32 s80, s36
    buffer_load_dwordx4 v[44:47], v15, s[40:43], s80 offen sc0 sc1
    s_add_u32 s80, s80, 8192
    buffer_load_dwordx4 v[48:51], v15, s[40:43], s80 offen sc0 sc1
    s_add_u32 s80, s80, 8192
    buffer_load_dwordx4 v[52:55], v15, s[40:43], s80 offen sc0 sc1
    s_add_u32 s80, s80, 8192
    buffer_load_dwordx4 v[56:59], v15, s[40:43], s80 offen sc0 sc1
    s_add_u32 s80, s80, 8192
    buffer_load_dwordx4 v[60:63], v15, s[40:43], s80 offen sc0 sc1
    s_add_u32 s80, s80, 8192
    buffer_load_dwordx4 v[64:67], v15, s[40:43], s80 offen sc0 sc1
    s_add_u32 s80, s80, 8192
    buffer_load_dwordx4 v[68:71], v15, s[40:43], s80 offen sc0 sc1
    s_add_u32 s80, s80, 8192
    buffer_load_dwordx4 v[72:75], v15, s[40:43], s80 offen sc0 sc1
    s_waitcnt vmcnt(15)
    v_xor_b32 v12, s28, v76
    v_bitop3_b32 v12, v12, v77, s29 bitop3:0xf6
    v_bitop3_b32 v12, v12, v78, s30 bitop3:0xf6
    v_xor_b32 v13, s31, v79
    s_waitcnt vmcnt(14)
    v_bitop3_b32 v12, v12, v80, s28 bitop3:0xf6
    v_bitop3_b32 v12, v12, v81, s29 bitop3:0xf6
    v_bitop3_b32 v12, v12, v82, s30 bitop3:0xf6
    v_bitop3_b32 v13, v13, v83, s31 bitop3:0xf6
    s_waitcnt vmcnt(13)
    v_bitop3_b32 v12, v12, v84, s28 bitop3:0xf6
    v_bitop3_b32 v12, v12, v85, s29 bitop3:0xf6
    v_bitop3_b32 v12, v12, v86, s30 bitop3:0xf6
    v_bitop3_b32 v13, v13, v87, s31 bitop3:0xf6
    s_waitcnt vmcnt(12)
    v_bitop3_b32 v12, v12, v88, s28 bitop3:0xf6
    v_bitop3_b32 v12, v12, v89, s29 bitop3:0xf6
    v_bitop3_b32 v12, v12, v90, s30 bitop3:0xf6
    v_bitop3_b32 v13, v13, v91, s31 bitop3:0xf6
    s_waitcnt vmcnt(11)
    v_bitop3_b32 v12, v12, v92, s28 bitop3:0xf6
    v_bitop3_b32 v12, v12, v93, s29 bitop3:0xf6
    v_bitop3_b32 v12, v12, v94, s30 bitop3:0xf6
    v_bitop3_b32 v13, v13, v95, s31 bitop3:0xf6
    s_waitcnt vmcnt(10)
    v_bitop3_b32 v12, v12, v96, s28 bitop3:0xf6
    v_bitop3_b32 v12, v12, v97, s29 bitop3:0xf6
    v_bitop3_b32 v12, v12, v98, s30 bitop3:0xf6
    v_bitop3_b32 v13, v13, v99, s31 bitop3:0xf6
    s_waitcnt vmcnt(9)
    v_bitop3_b32 v12, v12, v100, s28 bitop3:0xf6
    v_bitop3_b32 v12, v12, v101, s29 bitop3:0xf6
    v_bitop3_b32 v12, v12, v102, s30 bitop3:0xf6
    v_bitop3_b32 v13, v13, v103, s31 bitop3:0xf6
    s_waitcnt vmcnt(8)
    v_bitop3_b32 v12, v12, v104, s28 bitop3:0xf6
    v_bitop3_b32 v12, v12, v105, s29 bitop3:0xf6
    v_bitop3_b32 v12, v12, v106, s30 bitop3:0xf6
    v_bitop3_b32 v13, v13, v107, s31 bitop3:0xf6
    v_cndmask_b32 v13, v13, 0, s[32:33]
    v_bitop3_b32 v12, v12, v13, v14 bitop3:0xa8
    v_cmp_ne_u32 vcc, 0, v12
    s_nop 4
    s_cbranch_vccz L_ok1
    s_add_u32 s25, s25, 1
    s_cmp_lt_u32 s25, 2000000
    s_cbranch_scc1 L_try
L_ok1:
    v_max_f32 v11, v79, v83
    v_max3_f32 v11, v11, v87, v91
    v_max3_f32 v11, v11, v95, v99
    v_max3_f32 v11, v11, v103, v107
    s_nop 1
    v_max_f32_dpp v11, v11, v11 row_ror:8 row_mask:0xf bank_mask:0xf
    v_mov_b32 v13, v11
    s_nop 1
    v_permlane32_swap_b32 v11, v13
    v_max_f32 v11, v11, v13
    v_mov_b32 v13, v11
    s_nop 1
    v_permlane16_swap_b32 v11, v13
    v_max_f32 v11, v11, v13
    s_nop 1
    v_mov_b32_dpp v11, v11 quad_perm:[0,0,2,2] row_mask:0xf bank_mask:0xf
    s_nop 1
    v_sub_f32_dpp v20, v79, v11 quad_perm:[0,0,2,2] row_mask:0xf bank_mask:0xf
    v_sub_f32_dpp v21, v83, v11 quad_perm:[0,0,2,2] row_mask:0xf bank_mask:0xf
    v_sub_f32_dpp v22, v87, v11 quad_perm:[0,0,2,2] row_mask:0xf bank_mask:0xf
    v_sub_f32_dpp v23, v91, v11 quad_perm:[0,0,2,2] row_mask:0xf bank_mask:0xf
    v_sub_f32_dpp v24, v95, v11 quad_perm:[0,0,2,2] row_mask:0xf bank_mask:0xf
    v_sub_f32_dpp v25, v99, v11 quad_perm:[0,0,2,2] row_mask:0xf bank_mask:0xf
    v_sub_f32_dpp v26, v103, v11 quad_perm:[0,0,2,2] row_mask:0xf bank_mask:0xf
    v_sub_f32_dpp v27, v107, v11 quad_perm:[0,0,2,2] row_mask:0xf bank_mask:0xf
    v_exp_f32 v20, v20
    v_exp_f32 v21, v21
    v_exp_f32 v22, v22
    v_exp_f32 v23, v23
    v_exp_f32 v24, v24
    v_exp_f32 v25, v25
    v_exp_f32 v26, v26
    v_exp_f32 v27, v27
    v_pk_mul_f32 v[40:41], v[76:77], v[20:21] op_sel:[0,0] op_sel_hi:[1,0]
    v_pk_mul_f32 v[42:43], v[78:79], v[20:21] op_sel:[0,0] op_sel_hi:[1,0]
    v_pk_fma_f32 v[40:41], v[80:81], v[20:21], v[40:41] op_sel:[0,1,0] op_sel_hi:[1,1,1]
    v_pk_fma_f32 v[42:43], v[82:83], v[20:21], v[42:43] op_sel:[0,1,0] op_sel_hi:[1,1,1]
    v_pk_fma_f32 v[40:41], v[84:85], v[22:23], v[40:41] op_sel:[0,0,0] op_sel_hi:[1,0,1]
    v_pk_fma_f32 v[42:43], v[86:87], v[22:23], v[42:43] op_sel:[0,0,0] op_sel_hi:[1,0,1]
    v_pk_fma_f32 v[40:41], v[88:89], v[22:23], v[40:41] op_sel:[0,1,0] op_sel_hi:[1,1,1]
    v_pk_fma_f32 v[42:43], v[90:91], v[22:23], v[42:43] op_sel:[0,1,0] op_sel_hi:[1,1,1]
    v_pk_fma_f32 v[40:41], v[92:93], v[24:25], v[40:41] op_sel:[0,0,0] op_sel_hi:[1,0,1]
    v_pk_fma_f32 v[42:43], v[94:95], v[24:25], v[42:43] op_sel:[0,0,0] op_sel_hi:[1,0,1]
    v_pk_fma_f32 v[40:41], v[96:97], v[24:25], v[40:41] op_sel:[0,1,0] op_sel_hi:[1,1,1]
    v_pk_fma_f32 v[42:43], v[98:99], v[24:25], v[42:43] op_sel:[0,1,0] op_sel_hi:[1,1,1]
    v_pk_fma_f32 v[40:41], v[100:101], v[26:27], v[40:41] op_sel:[0,0,0] op_sel_hi:[1,0,1]
    v_pk_fma_f32 v[42:43], v[102:103], v[26:27], v[42:43] op_sel:[0,0,0] op_sel_hi:[1,0,1]
    v_pk_fma_f32 v[40:41], v[104:105], v[26:27], v[40:41] op_sel:[0,1,0] op_sel_hi:[1,1,1]
    v_pk_fma_f32 v[42:43], v[106:107], v[26:27], v[42:43] op_sel:[0,1,0] op_sel_hi:[1,1,1]
    s_nop 1
    s_branch L_fin
L_ok0:
    v_max_f32 v11, v47, v51
    v_max3_f32 v11, v11, v55, v59
    v_max3_f32 v11, v11, v63, v67
    v_max3_f32 v11, v11, v71, v75
    s_nop 1
    v_max_f32_dpp v11, v11, v11 row_ror:8 row_mask:0xf bank_mask:0xf
    v_mov_b32 v13, v11
    s_nop 1
    v_permlane32_swap_b32 v11, v13
    v_max_f32 v11, v11, v13
    v_mov_b32 v13, v11
    s_nop 1
    v_permlane16_swap_b32 v11, v13
    v_max_f32 v11, v11, v13
    s_nop 1
    v_mov_b32_dpp v11, v11 quad_perm:[0,0,2,2] row_mask:0xf bank_mask:0xf
    s_nop 1
    v_sub_f32_dpp v20, v47, v11 quad_perm:[0,0,2,2] row_mask:0xf bank_mask:0xf
    v_sub_f32_dpp v21, v51, v11 quad_perm:[0,0,2,2] row_mask:0xf bank_mask:0xf
    v_sub_f32_dpp v22, v55, v11 quad_perm:[0,0,2,2] row_mask:0xf bank_mask:0xf
    v_sub_f32_dpp v23, v59, v11 quad_perm:[0,0,2,2] row_mask:0xf bank_mask:0xf
    v_sub_f32_dpp v24, v63, v11 quad_perm:[0,0,2,2] row_mask:0xf bank_mask:0xf
    v_sub_f32_dpp v25, v67, v11 quad_perm:[0,0,2,2] row_mask:0xf bank_mask:0xf
    v_sub_f32_dpp v26, v71, v11 quad_perm:[0,0,2,2] row_mask:0xf bank_mask:0xf
    v_sub_f32_dpp v27, v75, v11 quad_perm:[0,0,2,2] row_mask:0xf bank_mask:0xf
    v_exp_f32 v20, v20
    v_exp_f32 v21, v21
    v_exp_f32 v22, v22
    v_exp_f32 v23, v23
    v_exp_f32 v24, v24
    v_exp_f32 v25, v25
    v_exp_f32 v26, v26
    v_exp_f32 v27, v27
    v_pk_mul_f32 v[40:41], v[44:45], v[20:21] op_sel:[0,0] op_sel_hi:[1,0]
    v_pk_mul_f32 v[42:43], v[46:47], v[20:21] op_sel:[0,0] op_sel_hi:[1,0]
    v_pk_fma_f32 v[40:41], v[48:49], v[20:21], v[40:41] op_sel:[0,1,0] op_sel_hi:[1,1,1]
    v_pk_fma_f32 v[42:43], v[50:51], v[20:21], v[42:43] op_sel:[0,1,0] op_sel_hi:[1,1,1]
    v_pk_fma_f32 v[40:41], v[52:53], v[22:23], v[40:41] op_sel:[0,0,0] op_sel_hi:[1,0,1]
    v_pk_fma_f32 v[42:43], v[54:55], v[22:23], v[42:43] op_sel:[0,0,0] op_sel_hi:[1,0,1]
    v_pk_fma_f32 v[40:41], v[56:57], v[22:23], v[40:41] op_sel:[0,1,0] op_sel_hi:[1,1,1]
    v_pk_fma_f32 v[42:43], v[58:59], v[22:23], v[42:43] op_sel:[0,1,0] op_sel_hi:[1,1,1]
    v_pk_fma_f32 v[40:41], v[60:61], v[24:25], v[40:41] op_sel:[0,0,0] op_sel_hi:[1,0,1]
    v_pk_fma_f32 v[42:43], v[62:63], v[24:25], v[42:43] op_sel:[0,0,0] op_sel_hi:[1,0,1]
    v_pk_fma_f32 v[40:41], v[64:65], v[24:25], v[40:41] op_sel:[0,1,0] op_sel_hi:[1,1,1]
    v_pk_fma_f32 v[42:43], v[66:67], v[24:25], v[42:43] op_sel:[0,1,0] op_sel_hi:[1,1,1]
    v_pk_fma_f32 v[40:41], v[68:69], v[26:27], v[40:41] op_sel:[0,0,0] op_sel_hi:[1,0,1]
    v_pk_fma_f32 v[42:43], v[70:71], v[26:27], v[42:43] op_sel:[0,0,0] op_sel_hi:[1,0,1]
    v_pk_fma_f32 v[40:41], v[72:73], v[26:27], v[40:41] op_sel:[0,1,0] op_sel_hi:[1,1,1]
    v_pk_fma_f32 v[42:43], v[74:75], v[26:27], v[42:43] op_sel:[0,1,0] op_sel_hi:[1,1,1]
    s_nop 1
L_fin:
    v_permlane32_swap_b32 v40, v41
    v_permlane32_swap_b32 v42, v43
    v_add_f32 v40, v40, v41
    v_add_f32 v42, v42, v43
    s_nop 1
    v_permlane16_swap_b32 v40, v42
    v_add_f32 v40, v40, v42
    s_nop 1
    v_add_f32_dpp v40, v40, v40 row_ror:8 row_mask:0xf bank_mask:0xf
    v_rcp_f32 v10, v40
    s_nop 0
    v_readlane_b32 s81, v10, 49
    s_nop 1
    v_mul_f32 v40, s81, v40
    v_cvt_pk_bf16_f32 v40, v40, v40
    s_mov_b32 exec_lo, 0x00ff00ff
    s_mov_b32 exec_hi, 0xff
    buffer_store_short v40, v16, s[16:19], s37 offen sc0 sc1
    s_endpgm
L_bal:
    s_cmp_eq_u32 s76, 6
    s_cbranch_scc0 L_exch
    v_mov_b32 v16, -1
    s_mov_b32 s80, 0x14141418
    v_writelane_b32 v16, s80, 0
    s_mov_b32 s80, 0x18181810
    v_writelane_b32 v16, s80, 1
    s_mov_b32 s80, 0x28282830
    v_writelane_b32 v16, s80, 2
    s_mov_b32 s80, 0x18181410
    v_writelane_b32 v16, s80, 3
    s_mov_b32 s80, 0x14141818
    v_writelane_b32 v16, s80, 4
    s_mov_b32 s80, 0x30302c20
    v_writelane_b32 v16, s80, 5
    s_mov_b32 s80, 0x50505460
    v_writelane_b32 v16, s80, 6
    s_lshl_b32 s80, s77, 3
    v_sad_u8 v17, v16, 0, 0
    v_bfe_u32 v16, v16, s80, 8
    v_cvt_f32_u32 v15, v17
    v_cvt_f32_u32 v4, v16
    v_rcp_f32 v18, v4
    v_rcp_f32 v19, v15
    v_mul_f32 v15, 0x472aaaab, v15
    v_mul_f32 v4, 0x46b00000, v4
    v_mul_f32 v18, v18, v15
    v_mul_f32 v19, v19, v4
    v_cvt_u32_f32 v18, v18
    v_cvt_u32_f32 v19, v19
    v_mul_u32_u24 v16, 12, v16
    v_lshlrev_b32 v17, 3, v17
    s_mov_b32 s4, 0
    s_mov_b32 s9, 0
    s_mov_b32 s13, 0
    s_mov_b32 s15, 0
    s_mov_b32 s17, 0
    s_mov_b32 s18, 0
    s_mov_b32 s19, 0
    s_mov_b32 s22, 0
    s_mov_b32 s23, 0
    s_mov_b32 s24, 0
    s_mov_b32 s5, 32
    s_mov_b32 s7, 128
    v_mov_b32 v14, 157824
    s_lshl_b32 s80, s84, 12
    s_add_u32 s80, s80, 1351680
    v_mov_b32 v12, s80
    v_mov_b32 v13, 5104
    ds_write_b64 v3, v[12:13] offset:24
    v_mov_b32 v15, s84
    ds_write_b32 v14, v15
    s_nop 0
L_g:
    s_sleep 1
    ds_read_b32 v4, v3 offset:16
    s_memrealtime s[10:11]
    ds_read_b128 v[8:11], v3
    ds_read_b64 v[12:13], v3 offset:24
    s_waitcnt lgkmcnt(0)
    v_readfirstlane_b32 s83, v4
    v_min3_i32 v15, v8, v9, v10
    v_min_i32 v8, v15, v11
    v_readfirstlane_b32 s80, v12
    v_readfirstlane_b32 s81, v13
    s_nop 0
    s_lshr_b32 s21, s81, 16
    s_and_b32 s81, s81, 0xffff
    s_cmp_lt_u32 s21, s22
    s_cselect_b32 s23, s23, 0
    s_cmp_lt_u32 s4, 6
    s_cselect_b32 s24, s10, s24
    s_sub_u32 s82, s10, s24
    s_cmp_gt_u32 s82, 100
    s_cselect_b32 s82, s82, 15
    s_sub_u32 s82, s82, 15
    s_lshl_b32 s82, s82, 12
    s_add_u32 s82, s82, s23
    s_add_u32 s80, s80, s82
    s_cmp_gt_i32 s83, s9
    s_cbranch_scc0 L_gq
    s_mov_b32 s24, s10
    s_cmp_eq_u32 s82, s23
    s_cbranch_scc1 L_gq
    s_mov_b32 s23, s82
    s_add_u32 s22, s4, 1
L_gq:
    s_max_i32 s9, s9, s83
    s_cmp_ge_u32 s9, s13
    s_cbranch_scc0 L_gs
    s_mov_b32 s12, s13
    s_mov_b32 s14, s15
    v_readlane_b32 s82, v16, s17
    v_readlane_b32 s83, v17, s17
    v_readlane_b32 s16, v18, s17
    s_add_u32 s17, s17, 1
    s_add_u32 s13, s13, s82
    s_add_u32 s15, s15, s83
    s_nop 1
L_gs:
    s_add_u32 s82, s9, 22
    s_cmp_ge_u32 s82, s18
    s_cbranch_scc0 L_gf
    v_readlane_b32 s82, v16, s19
    v_readlane_b32 s20, v19, s19
    s_add_u32 s19, s19, 1
    s_add_u32 s18, s18, s82
    s_nop 2
L_gf:
    s_sub_u32 s6, s9, s12
    s_mul_i32 s6, s6, s16
    s_lshr_b32 s6, s6, 16
    s_add_u32 s6, s6, s14
    s_cmp_ge_u32 s6, s5
    s_cbranch_scc0 L_gn
    s_add_u32 s4, s4, 1
    s_add_u32 s5, s5, 32
    v_add_u32 v14, 4, v14
    v_mov_b32 v15, s10
    ds_write_b32 v14, v15
    v_mov_b32 v15, s4
    ds_write_b32 v3, v15 offset:20
    s_nop 0
L_gn:
    s_mul_i32 s81, s81, s6
    s_add_u32 s80, s80, s81
    s_lshl_b32 s81, s10, 12
    s_sub_u32 s80, s81, s80
    s_ashr_i32 s80, s80, 6
    s_min_i32 s80, s80, 0x40000
    s_max_i32 s80, s80, 0xfffc0000
    s_mul_i32 s80, s80, 983
    s_ashr_i32 s80, s80, 12
    s_and_b32 s7, s7, 255
    s_add_u32 s7, s7, s80
    s_add_u32 s7, s7, s20
    s_ashr_i32 s8, s7, 8
    s_min_i32 s8, s8, 36
    s_max_i32 s8, s8, 12
    s_cmp_lt_u32 s4, 4
    s_cselect_b32 s8, 24, s8
    s_add_u32 s80, s8, 2304
    v_lshl_add_u32 v15, v8, 8, s80
    ds_write_b32 v3, v15 offset:44
    s_cmp_lt_u32 s4, 256
    s_cbranch_scc1 L_g
    s_endpgm
L_exch:
    s_mov_b32 s12, s74
    s_mov_b32 s13, s75
    s_mov_b32 s14, 1610612736
    s_mov_b32 s15, 0x20000
    s_mov_b32 s80, 4352
    v_mul_lo_u32 v5, v1, s80
    s_lshr_b32 s80, s2, 3
    s_mul_i32 s21, s79, 5
    s_add_u32 s21, s21, s80
    s_and_b32 s21, s21, 31
    s_lshr_b32 s80, s80, 5
    s_lshl_b32 s80, s80, 3
    s_add_u32 s80, s80, s79
    s_mul_i32 s80, s80, 4352
    s_waitcnt vmcnt(0)
    v_mov_b32 v7, s80
    s_mov_b32 s16, 0
    s_mov_b32 s17, 33554432
    s_mov_b32 s18, 8
    s_mov_b32 s20, 0
    s_mov_b32 s19, 0
    s_mov_b32 s24, 0
    s_mov_b32 s25, 5104
L_pc0:
L_pw1:
    s_sleep 8
    ds_read_b32 v4, v3 offset:20
    s_waitcnt lgkmcnt(0)
    v_readfirstlane_b32 s80, v4
    s_nop 0
    s_cmp_lt_i32 s80, s18
    s_nop 2
    s_cbranch_scc1 L_pw1
    s_lshl_b32 s80, s18, 2
    s_add_u32 s80, s80, 157824
    v_mov_b32 v8, s80
    ds_read_b32 v6, v8
    s_waitcnt lgkmcnt(0)
    s_and_b32 s80, s16, 31
    s_cmp_eq_u32 s80, s21
    s_cbranch_scc0 L_np
    s_mov_b64 exec, 1
    buffer_store_dword v6, v7, s[12:15], s17 offen sc0 sc1
    s_mov_b64 exec, -1
L_np:
    s_add_u32 s81, s18, 4
L_pw2:
    s_sleep 8
    ds_read_b32 v4, v3 offset:20
    s_waitcnt lgkmcnt(0)
    v_readfirstlane_b32 s80, v4
    s_nop 0
    s_cmp_lt_i32 s80, s81
    s_nop 2
    s_cbranch_scc1 L_pw2
    s_add_u32 s30, s74, s17
    s_addc_u32 s31, s75, 0
    s_load_dword s32, s[30:31], 0
    s_load_dword s33, s[30:31], 4352
    s_load_dword s34, s[30:31], 8704
    s_load_dword s35, s[30:31], 13056
    s_load_dword s36, s[30:31], 17408
    s_load_dword s37, s[30:31], 21760
    s_load_dword s38, s[30:31], 26112
    s_load_dword s39, s[30:31], 30464
    s_memrealtime s[22:23]
    v_readfirstlane_b32 s26, v6
    s_mov_b32 s27, 0
    s_mov_b32 s28, 0
    s_mov_b32 s29, -4096
    s_waitcnt lgkmcnt(0)
    s_sub_u32 s83, s22, s26
    s_sub_u32 s80, s32, s26
    s_add_u32 s81, s80, 4096
    s_cmp_lt_u32 s81, 0x2000
    s_cselect_b32 s80, s80, s83
    s_addc_u32 s28, s28, 0
    s_add_u32 s27, s27, s80
    s_max_i32 s29, s29, s80
    s_sub_u32 s80, s33, s26
    s_add_u32 s81, s80, 4096
    s_cmp_lt_u32 s81, 0x2000
    s_cselect_b32 s80, s80, s83
    s_addc_u32 s28, s28, 0
    s_add_u32 s27, s27, s80
    s_max_i32 s29, s29, s80
    s_sub_u32 s80, s34, s26
    s_add_u32 s81, s80, 4096
    s_cmp_lt_u32 s81, 0x2000
    s_cselect_b32 s80, s80, s83
    s_addc_u32 s28, s28, 0
    s_add_u32 s27, s27, s80
    s_max_i32 s29, s29, s80
    s_sub_u32 s80, s35, s26
    s_add_u32 s81, s80, 4096
    s_cmp_lt_u32 s81, 0x2000
    s_cselect_b32 s80, s80, s83
    s_addc_u32 s28, s28, 0
    s_add_u32 s27, s27, s80
    s_max_i32 s29, s29, s80
    s_sub_u32 s80, s36, s26
    s_add_u32 s81, s80, 4096
    s_cmp_lt_u32 s81, 0x2000
    s_cselect_b32 s80, s80, s83
    s_addc_u32 s28, s28, 0
    s_add_u32 s27, s27, s80
    s_max_i32 s29, s29, s80
    s_sub_u32 s80, s37, s26
    s_add_u32 s81, s80, 4096
    s_cmp_lt_u32 s81, 0x2000
    s_cselect_b32 s80, s80, s83
    s_addc_u32 s28, s28, 0
    s_add_u32 s27, s27, s80
    s_max_i32 s29, s29, s80
    s_sub_u32 s80, s38, s26
    s_add_u32 s81, s80, 4096
    s_cmp_lt_u32 s81, 0x2000
    s_cselect_b32 s80, s80, s83
    s_addc_u32 s28, s28, 0
    s_add_u32 s27, s27, s80
    s_max_i32 s29, s29, s80
    s_sub_u32 s80, s39, s26
    s_add_u32 s81, s80, 4096
    s_cmp_lt_u32 s81, 0x2000
    s_cselect_b32 s80, s80, s83
    s_addc_u32 s28, s28, 0
    s_add_u32 s27, s27, s80
    s_max_i32 s29, s29, s80
    s_cmp_lt_u32 s28, 4
    s_cbranch_scc1 L_pskip
    s_mul_i32 s27, s27, 410
    s_lshl_b32 s80, s26, 12
    s_add_u32 s80, s80, s27
    s_mul_i32 s29, s29, 819
    s_add_u32 s80, s80, s29
    s_min_u32 s82, s18, 0
    s_lshl_b32 s83, s18, 5
    s_add_u32 s82, s82, s83
    s_sub_u32 s81, s80, s19
    s_sub_u32 s83, s82, s24
    v_cvt_f32_u32 v8, s81
    v_cvt_f32_u32 v9, s83
    v_rcp_f32 v9, v9
    v_mul_f32 v8, 0x3f800000, v8
    v_mul_f32 v8, v8, v9
    v_mul_f32 v9, 0x3f7851ec, v8
    v_mov_b32 v10, 0x459f8000
    v_mul_f32 v8, 0x3f828f5c, v8
    v_med3_f32 v8, v8, v9, v10
    v_cvt_u32_f32 v8, v8
    s_nop 0
    v_readfirstlane_b32 s81, v8
    s_mov_b32 s19, s80
    s_mov_b32 s24, s82
    s_cmp_eq_u32 s20, 0
    s_cselect_b32 s81, 5104, s81
    s_mov_b32 s20, 1
    s_add_u32 s83, s25, 51
    s_min_u32 s81, s81, s83
    s_sub_u32 s83, s25, 51
    s_max_u32 s81, s81, s83
    s_mov_b32 s25, s81
    s_mul_i32 s82, s82, s81
    s_sub_u32 s80, s80, s82
    s_pack_ll_b32_b16 s81, s81, s18
    v_mov_b32 v8, s80
    v_mov_b32 v9, s81
    ds_write_b64 v3, v[8:9] offset:24
    s_nop 0
L_pskip:
    s_add_u32 s16, s16, 1
    s_add_u32 s17, s17, 34816
    s_add_u32 s18, s18, 16
    s_cmp_lt_u32 s18, 250
    s_cbranch_scc1 L_pc0
L_end:
    s_endpgm
.section .rodata,"a"
.p2align 6
.amdhsa_kernel standalone__kv_cache_quant_pre_rope_vs_post_rope__decode_kernel
  .amdhsa_next_free_vgpr 168
  .amdhsa_next_free_sgpr 96
  .amdhsa_accum_offset 168
  .amdhsa_group_segment_fixed_size 0
  .amdhsa_kernarg_size 112
  .amdhsa_user_sgpr_count 2
  .amdhsa_user_sgpr_kernarg_segment_ptr 1
  .amdhsa_system_sgpr_workgroup_id_x 1
.end_amdhsa_kernel
```

```asm
; @launch grid=(256,1,1) block=(512,1,1) lds=159168
.amdgcn_target "amdgcn-amd-amdhsa--gfx950"
.text
.globl standalone__kv_cache_quant_pre_rope_vs_post_rope__decode_kernel
.p2align 8
.type standalone__kv_cache_quant_pre_rope_vs_post_rope__decode_kernel,@function
standalone__kv_cache_quant_pre_rope_vs_post_rope__decode_kernel:
    s_cmp_ge_u32 s2, 256
    s_cbranch_scc1 L_end
    s_load_dwordx2 s[4:5], s[0:1], 8
    v_readfirstlane_b32 s76, v0
    s_and_b32 s79, s2, 7
    s_lshr_b32 s78, s2, 7
    s_lshl3_add_u32 s78, s78, s79
    s_lshr_b32 s77, s2, 3
    s_lshr_b32 s80, s77, 2
    s_and_b32 s77, s77, 3
    s_and_b32 s80, s80, 3
    s_lshl2_add_u32 s78, s78, s80
    s_cmp_lt_u32 s76, 64
    s_cbranch_scc0 L_init
    s_getpc_b64 s[26:27]
L_pc:
    s_lshl_b32 s81, s2, 6
    s_and_b32 s81, s81, 0x3e00
    v_lshl_add_u32 v5, v0, 3, s81
    v_min_u32 v5, L_end-L_pc, v5
    global_load_dword v7, v5, s[26:27]
    v_lshlrev_b32 v2, 4, v0
    s_mul_i32 s9, s77, 15728640
    s_mul_i32 s80, s78, 12288
    s_mov_b32 m0, 0
    s_add_u32 s9, s9, s80
    s_mov_b32 s6, 402653184
    s_mov_b32 s7, 0x20000
    s_movk_i32 s12, 12288
    s_waitcnt lgkmcnt(0)
L_first:
    s_waitcnt vmcnt(22)
    buffer_load_dwordx4 v2, s[4:7], s9 offen offset:0 nt lds
    buffer_load_dwordx4 v2, s[4:7], s9 offen offset:1024 nt lds
    s_waitcnt vmcnt(22)
    buffer_load_dwordx4 v2, s[4:7], s9 offen offset:2048 nt lds
    buffer_load_dwordx4 v2, s[4:7], s9 offen offset:3072 nt lds
    s_addk_i32 m0, 4096
    s_addk_i32 s9, 4096
    s_cmp_lg_u32 m0, s12
    s_cbranch_scc1 L_first
    s_addk_i32 s12, 12288
    s_add_u32 s9, s9, 774144
    s_cmp_lt_u32 m0, 36864
    s_cbranch_scc1 L_first
    s_sub_u32 s9, s9, 774144
    s_barrier
    s_load_dwordx2 s[56:57], s[0:1], 32
    s_setprio 3
    s_mul_i32 s8, s77, 12582912
    s_add_u32 s8, s8, s80
    s_mul_i32 s16, s77, 4
    s_mul_i32 s17, s77, 4
    v_mov_b32 v3, 158912
    s_waitcnt vmcnt(24)
    s_mov_b32 s10, 2
    v_mov_b32 v5, 36
    v_mov_b32 v7, 792
    s_waitcnt lgkmcnt(0)
    s_nop 0
    s_branch L_next
L_init:
    s_load_dwordx16 s[48:63], s[0:1], 0
    s_load_dwordx8 s[64:71], s[0:1], 64
    s_load_dwordx4 s[72:75], s[0:1], 96
    s_memrealtime s[84:85]
    v_and_b32 v1, 63, v0
    s_lshr_b32 s76, s76, 4
    s_lshr_b32 s76, 0x65372104, s76
    s_and_b32 s76, s76, 7
    v_lshlrev_b32 v2, 4, v1
    v_mov_b32 v3, 158912
    v_cmp_eq_u32 vcc, 11, v1
    v_mov_b32 v5, 792
    v_lshl_add_u32 v6, v1, 2, v3
    v_cndmask_b32 v5, 0, v5, vcc
    v_cmp_gt_u32 vcc, 4, v1
    s_nop 1
    v_cndmask_b32 v5, v5, -6, vcc
    ds_write_b32 v6, v5
    s_waitcnt lgkmcnt(0)
    s_barrier
    s_branch L_notld
L_next:
    s_add_u32 s10, s10, 1
    s_cmp_eq_u32 m0, 110592
    s_cselect_b32 m0, 0, m0
    s_waitcnt lgkmcnt(1)
    v_readfirstlane_b32 s11, v7
    s_add_u32 s12, m0, 12288
    s_add_u32 s9, s9, 774144
    s_and_b32 s80, s10, 3
    s_cbranch_scc0 L_addr
L_aj:
    s_lshr_b32 s80, s11, 8
    s_cmp_gt_u32 s80, s10
    s_cbranch_scc0 L_full
    s_and_b32 s15, s11, 255
    s_cmp_ge_i32 s15, 24
    s_cbranch_scc1 L_t_24_36
    s_cmp_ge_i32 s15, 18
    s_cbranch_scc1 L_t_18_23
    s_cmp_ge_i32 s15, 15
    s_cbranch_scc1 L_t_15_17
    s_cmp_ge_i32 s15, 13
    s_cbranch_scc1 L_t_13_14
    s_branch L_v12
L_t_13_14:
    s_cmp_ge_i32 s15, 14
    s_cbranch_scc1 L_v14
    s_branch L_v13
L_t_15_17:
    s_cmp_ge_i32 s15, 16
    s_cbranch_scc1 L_t_16_17
    s_branch L_v15
L_t_16_17:
    s_cmp_ge_i32 s15, 17
    s_cbranch_scc1 L_v17
    s_branch L_v16
L_t_18_23:
    s_cmp_ge_i32 s15, 21
    s_cbranch_scc1 L_t_21_23
    s_cmp_ge_i32 s15, 19
    s_cbranch_scc1 L_t_19_20
    s_branch L_v18
L_t_19_20:
    s_cmp_ge_i32 s15, 20
    s_cbranch_scc1 L_v20
    s_branch L_v19
L_t_21_23:
    s_cmp_ge_i32 s15, 22
    s_cbranch_scc1 L_t_22_23
    s_branch L_v21
L_t_22_23:
    s_cmp_ge_i32 s15, 23
    s_cbranch_scc1 L_v23
    s_branch L_v22
L_t_24_36:
    s_cmp_ge_i32 s15, 30
    s_cbranch_scc1 L_t_30_36
    s_cmp_ge_i32 s15, 27
    s_cbranch_scc1 L_t_27_29
    s_cmp_ge_i32 s15, 25
    s_cbranch_scc1 L_t_25_26
    s_branch L_v24
L_t_25_26:
    s_cmp_ge_i32 s15, 26
    s_cbranch_scc1 L_v26
    s_branch L_v25
L_t_27_29:
    s_cmp_ge_i32 s15, 28
    s_cbranch_scc1 L_t_28_29
    s_branch L_v27
L_t_28_29:
    s_cmp_ge_i32 s15, 29
    s_cbranch_scc1 L_v29
    s_branch L_v28
L_t_30_36:
    s_cmp_ge_i32 s15, 33
    s_cbranch_scc1 L_t_33_36
    s_cmp_ge_i32 s15, 31
    s_cbranch_scc1 L_t_31_32
    s_branch L_v30
L_t_31_32:
    s_cmp_ge_i32 s15, 32
    s_cbranch_scc1 L_v32
    s_branch L_v31
L_t_33_36:
    s_cmp_ge_i32 s15, 35
    s_cbranch_scc1 L_t_35_36
    s_cmp_ge_i32 s15, 34
    s_cbranch_scc1 L_v34
    s_branch L_v33
L_t_35_36:
    s_cmp_ge_i32 s15, 36
    s_cbranch_scc1 L_v36
    s_branch L_v35
L_v12:
    s_waitcnt vmcnt(11)
    buffer_load_dwordx4 v2, s[4:7], s9 offen offset:0 nt lds
    s_waitcnt vmcnt(11)
    buffer_load_dwordx4 v2, s[4:7], s9 offen offset:1024 nt lds
    ds_read_b32 v7, v3 offset:44
    s_waitcnt vmcnt(11)
    buffer_load_dwordx4 v2, s[4:7], s9 offen offset:2048 nt lds
    v_subrev_u32 v6, 9, v5
    s_add_u32 m0, m0, 3072
    ds_write_b32 v3, v6 offset:16
    v_add_u32 v5, 3, v5
    s_add_u32 s9, s9, 3072
    s_cmp_lg_u32 m0, s12
    s_cbranch_scc1 L_v12
    s_branch L_next
L_v13:
    s_waitcnt vmcnt(12)
    buffer_load_dwordx4 v2, s[4:7], s9 offen offset:0 nt lds
    s_waitcnt vmcnt(12)
    buffer_load_dwordx4 v2, s[4:7], s9 offen offset:1024 nt lds
    ds_read_b32 v7, v3 offset:44
    s_waitcnt vmcnt(12)
    buffer_load_dwordx4 v2, s[4:7], s9 offen offset:2048 nt lds
    v_subrev_u32 v6, 10, v5
    s_add_u32 m0, m0, 3072
    ds_write_b32 v3, v6 offset:16
    v_add_u32 v5, 3, v5
    s_add_u32 s9, s9, 3072
    s_cmp_lg_u32 m0, s12
    s_cbranch_scc1 L_v13
    s_branch L_next
L_v14:
    s_waitcnt vmcnt(13)
    buffer_load_dwordx4 v2, s[4:7], s9 offen offset:0 nt lds
    s_waitcnt vmcnt(13)
    buffer_load_dwordx4 v2, s[4:7], s9 offen offset:1024 nt lds
    ds_read_b32 v7, v3 offset:44
    s_waitcnt vmcnt(13)
    buffer_load_dwordx4 v2, s[4:7], s9 offen offset:2048 nt lds
    v_subrev_u32 v6, 11, v5
    s_add_u32 m0, m0, 3072
    ds_write_b32 v3, v6 offset:16
    v_add_u32 v5, 3, v5
    s_add_u32 s9, s9, 3072
    s_cmp_lg_u32 m0, s12
    s_cbranch_scc1 L_v14
    s_branch L_next
L_v15:
    s_waitcnt vmcnt(14)
    buffer_load_dwordx4 v2, s[4:7], s9 offen offset:0 nt lds
    s_waitcnt vmcnt(14)
    buffer_load_dwordx4 v2, s[4:7], s9 offen offset:1024 nt lds
    ds_read_b32 v7, v3 offset:44
    s_waitcnt vmcnt(14)
    buffer_load_dwordx4 v2, s[4:7], s9 offen offset:2048 nt lds
    v_subrev_u32 v6, 12, v5
    s_add_u32 m0, m0, 3072
    ds_write_b32 v3, v6 offset:16
    v_add_u32 v5, 3, v5
    s_add_u32 s9, s9, 3072
    s_cmp_lg_u32 m0, s12
    s_cbranch_scc1 L_v15
    s_branch L_next
L_v16:
    s_waitcnt vmcnt(15)
    buffer_load_dwordx4 v2, s[4:7], s9 offen offset:0 nt lds
    s_waitcnt vmcnt(15)
    buffer_load_dwordx4 v2, s[4:7], s9 offen offset:1024 nt lds
    ds_read_b32 v7, v3 offset:44
    s_waitcnt vmcnt(15)
    buffer_load_dwordx4 v2, s[4:7], s9 offen offset:2048 nt lds
    v_subrev_u32 v6, 13, v5
    s_add_u32 m0, m0, 3072
    ds_write_b32 v3, v6 offset:16
    v_add_u32 v5, 3, v5
    s_add_u32 s9, s9, 3072
    s_cmp_lg_u32 m0, s12
    s_cbranch_scc1 L_v16
    s_branch L_next
L_v17:
    s_waitcnt vmcnt(16)
    buffer_load_dwordx4 v2, s[4:7], s9 offen offset:0 nt lds
    s_waitcnt vmcnt(16)
    buffer_load_dwordx4 v2, s[4:7], s9 offen offset:1024 nt lds
    ds_read_b32 v7, v3 offset:44
    s_waitcnt vmcnt(16)
    buffer_load_dwordx4 v2, s[4:7], s9 offen offset:2048 nt lds
    v_subrev_u32 v6, 14, v5
    s_add_u32 m0, m0, 3072
    ds_write_b32 v3, v6 offset:16
    v_add_u32 v5, 3, v5
    s_add_u32 s9, s9, 3072
    s_cmp_lg_u32 m0, s12
    s_cbranch_scc1 L_v17
    s_branch L_next
L_v18:
    s_waitcnt vmcnt(17)
    buffer_load_dwordx4 v2, s[4:7], s9 offen offset:0 nt lds
    s_waitcnt vmcnt(17)
    buffer_load_dwordx4 v2, s[4:7], s9 offen offset:1024 nt lds
    ds_read_b32 v7, v3 offset:44
    s_waitcnt vmcnt(17)
    buffer_load_dwordx4 v2, s[4:7], s9 offen offset:2048 nt lds
    v_subrev_u32 v6, 15, v5
    s_add_u32 m0, m0, 3072
    ds_write_b32 v3, v6 offset:16
    v_add_u32 v5, 3, v5
    s_add_u32 s9, s9, 3072
    s_cmp_lg_u32 m0, s12
    s_cbranch_scc1 L_v18
    s_branch L_next
L_v19:
    s_waitcnt vmcnt(18)
    buffer_load_dwordx4 v2, s[4:7], s9 offen offset:0 nt lds
    s_waitcnt vmcnt(18)
    buffer_load_dwordx4 v2, s[4:7], s9 offen offset:1024 nt lds
    ds_read_b32 v7, v3 offset:44
    s_waitcnt vmcnt(18)
    buffer_load_dwordx4 v2, s[4:7], s9 offen offset:2048 nt lds
    v_subrev_u32 v6, 16, v5
    s_add_u32 m0, m0, 3072
    ds_write_b32 v3, v6 offset:16
    v_add_u32 v5, 3, v5
    s_add_u32 s9, s9, 3072
    s_cmp_lg_u32 m0, s12
    s_cbranch_scc1 L_v19
    s_branch L_next
L_v20:
    s_waitcnt vmcnt(19)
    buffer_load_dwordx4 v2, s[4:7], s9 offen offset:0 nt lds
    s_waitcnt vmcnt(19)
    buffer_load_dwordx4 v2, s[4:7], s9 offen offset:1024 nt lds
    ds_read_b32 v7, v3 offset:44
    s_waitcnt vmcnt(19)
    buffer_load_dwordx4 v2, s[4:7], s9 offen offset:2048 nt lds
    v_subrev_u32 v6, 17, v5
    s_add_u32 m0, m0, 3072
    ds_write_b32 v3, v6 offset:16
    v_add_u32 v5, 3, v5
    s_add_u32 s9, s9, 3072
    s_cmp_lg_u32 m0, s12
    s_cbranch_scc1 L_v20
    s_branch L_next
L_v21:
    s_waitcnt vmcnt(20)
    buffer_load_dwordx4 v2, s[4:7], s9 offen offset:0 nt lds
    s_waitcnt vmcnt(20)
    buffer_load_dwordx4 v2, s[4:7], s9 offen offset:1024 nt lds
    ds_read_b32 v7, v3 offset:44
    s_waitcnt vmcnt(20)
    buffer_load_dwordx4 v2, s[4:7], s9 offen offset:2048 nt lds
    v_subrev_u32 v6, 18, v5
    s_add_u32 m0, m0, 3072
    ds_write_b32 v3, v6 offset:16
    v_add_u32 v5, 3, v5
    s_add_u32 s9, s9, 3072
    s_cmp_lg_u32 m0, s12
    s_cbranch_scc1 L_v21
    s_branch L_next
L_v22:
    s_waitcnt vmcnt(21)
    buffer_load_dwordx4 v2, s[4:7], s9 offen offset:0 nt lds
    s_waitcnt vmcnt(21)
    buffer_load_dwordx4 v2, s[4:7], s9 offen offset:1024 nt lds
    ds_read_b32 v7, v3 offset:44
    s_waitcnt vmcnt(21)
    buffer_load_dwordx4 v2, s[4:7], s9 offen offset:2048 nt lds
    v_subrev_u32 v6, 19, v5
    s_add_u32 m0, m0, 3072
    ds_write_b32 v3, v6 offset:16
    v_add_u32 v5, 3, v5
    s_add_u32 s9, s9, 3072
    s_cmp_lg_u32 m0, s12
    s_cbranch_scc1 L_v22
    s_branch L_next
L_v23:
    s_waitcnt vmcnt(22)
    buffer_load_dwordx4 v2, s[4:7], s9 offen offset:0 nt lds
    s_waitcnt vmcnt(22)
    buffer_load_dwordx4 v2, s[4:7], s9 offen offset:1024 nt lds
    ds_read_b32 v7, v3 offset:44
    s_waitcnt vmcnt(22)
    buffer_load_dwordx4 v2, s[4:7], s9 offen offset:2048 nt lds
    v_subrev_u32 v6, 20, v5
    s_add_u32 m0, m0, 3072
    ds_write_b32 v3, v6 offset:16
    v_add_u32 v5, 3, v5
    s_add_u32 s9, s9, 3072
    s_cmp_lg_u32 m0, s12
    s_cbranch_scc1 L_v23
    s_branch L_next
L_v24:
    s_waitcnt vmcnt(23)
    buffer_load_dwordx4 v2, s[4:7], s9 offen offset:0 nt lds
    s_waitcnt vmcnt(23)
    buffer_load_dwordx4 v2, s[4:7], s9 offen offset:1024 nt lds
    ds_read_b32 v7, v3 offset:44
    s_waitcnt vmcnt(23)
    buffer_load_dwordx4 v2, s[4:7], s9 offen offset:2048 nt lds
    v_subrev_u32 v6, 21, v5
    s_add_u32 m0, m0, 3072
    ds_write_b32 v3, v6 offset:16
    v_add_u32 v5, 3, v5
    s_add_u32 s9, s9, 3072
    s_cmp_lg_u32 m0, s12
    s_cbranch_scc1 L_v24
    s_branch L_next
L_v25:
    s_waitcnt vmcnt(24)
    buffer_load_dwordx4 v2, s[4:7], s9 offen offset:0 nt lds
    s_waitcnt vmcnt(24)
    buffer_load_dwordx4 v2, s[4:7], s9 offen offset:1024 nt lds
    ds_read_b32 v7, v3 offset:44
    s_waitcnt vmcnt(24)
    buffer_load_dwordx4 v2, s[4:7], s9 offen offset:2048 nt lds
    v_subrev_u32 v6, 22, v5
    s_add_u32 m0, m0, 3072
    ds_write_b32 v3, v6 offset:16
    v_add_u32 v5, 3, v5
    s_add_u32 s9, s9, 3072
    s_cmp_lg_u32 m0, s12
    s_cbranch_scc1 L_v25
    s_branch L_next
L_v26:
    s_waitcnt vmcnt(25)
    buffer_load_dwordx4 v2, s[4:7], s9 offen offset:0 nt lds
    s_waitcnt vmcnt(25)
    buffer_load_dwordx4 v2, s[4:7], s9 offen offset:1024 nt lds
    ds_read_b32 v7, v3 offset:44
    s_waitcnt vmcnt(25)
    buffer_load_dwordx4 v2, s[4:7], s9 offen offset:2048 nt lds
    v_subrev_u32 v6, 23, v5
    s_add_u32 m0, m0, 3072
    ds_write_b32 v3, v6 offset:16
    v_add_u32 v5, 3, v5
    s_add_u32 s9, s9, 3072
    s_cmp_lg_u32 m0, s12
    s_cbranch_scc1 L_v26
    s_branch L_next
L_v27:
    s_waitcnt vmcnt(26)
    buffer_load_dwordx4 v2, s[4:7], s9 offen offset:0 nt lds
    s_waitcnt vmcnt(26)
    buffer_load_dwordx4 v2, s[4:7], s9 offen offset:1024 nt lds
    ds_read_b32 v7, v3 offset:44
    s_waitcnt vmcnt(26)
    buffer_load_dwordx4 v2, s[4:7], s9 offen offset:2048 nt lds
    v_subrev_u32 v6, 24, v5
    s_add_u32 m0, m0, 3072
    ds_write_b32 v3, v6 offset:16
    v_add_u32 v5, 3, v5
    s_add_u32 s9, s9, 3072
    s_cmp_lg_u32 m0, s12
    s_cbranch_scc1 L_v27
    s_branch L_next
L_v28:
    s_waitcnt vmcnt(27)
    buffer_load_dwordx4 v2, s[4:7], s9 offen offset:0 nt lds
    s_waitcnt vmcnt(27)
    buffer_load_dwordx4 v2, s[4:7], s9 offen offset:1024 nt lds
    ds_read_b32 v7, v3 offset:44
    s_waitcnt vmcnt(27)
    buffer_load_dwordx4 v2, s[4:7], s9 offen offset:2048 nt lds
    v_subrev_u32 v6, 25, v5
    s_add_u32 m0, m0, 3072
    ds_write_b32 v3, v6 offset:16
    v_add_u32 v5, 3, v5
    s_add_u32 s9, s9, 3072
    s_cmp_lg_u32 m0, s12
    s_cbranch_scc1 L_v28
    s_branch L_next
L_v29:
    s_waitcnt vmcnt(28)
    buffer_load_dwordx4 v2, s[4:7], s9 offen offset:0 nt lds
    s_waitcnt vmcnt(28)
    buffer_load_dwordx4 v2, s[4:7], s9 offen offset:1024 nt lds
    ds_read_b32 v7, v3 offset:44
    s_waitcnt vmcnt(28)
    buffer_load_dwordx4 v2, s[4:7], s9 offen offset:2048 nt lds
    v_subrev_u32 v6, 26, v5
    s_add_u32 m0, m0, 3072
    ds_write_b32 v3, v6 offset:16
    v_add_u32 v5, 3, v5
    s_add_u32 s9, s9, 3072
    s_cmp_lg_u32 m0, s12
    s_cbranch_scc1 L_v29
    s_branch L_next
L_v30:
    s_waitcnt vmcnt(29)
    buffer_load_dwordx4 v2, s[4:7], s9 offen offset:0 nt lds
    s_waitcnt vmcnt(29)
    buffer_load_dwordx4 v2, s[4:7], s9 offen offset:1024 nt lds
    ds_read_b32 v7, v3 offset:44
    s_waitcnt vmcnt(29)
    buffer_load_dwordx4 v2, s[4:7], s9 offen offset:2048 nt lds
    v_subrev_u32 v6, 27, v5
    s_add_u32 m0, m0, 3072
    ds_write_b32 v3, v6 offset:16
    v_add_u32 v5, 3, v5
    s_add_u32 s9, s9, 3072
    s_cmp_lg_u32 m0, s12
    s_cbranch_scc1 L_v30
    s_branch L_next
L_v31:
    s_waitcnt vmcnt(30)
    buffer_load_dwordx4 v2, s[4:7], s9 offen offset:0 nt lds
    s_waitcnt vmcnt(30)
    buffer_load_dwordx4 v2, s[4:7], s9 offen offset:1024 nt lds
    ds_read_b32 v7, v3 offset:44
    s_waitcnt vmcnt(30)
    buffer_load_dwordx4 v2, s[4:7], s9 offen offset:2048 nt lds
    v_subrev_u32 v6, 28, v5
    s_add_u32 m0, m0, 3072
    ds_write_b32 v3, v6 offset:16
    v_add_u32 v5, 3, v5
    s_add_u32 s9, s9, 3072
    s_cmp_lg_u32 m0, s12
    s_cbranch_scc1 L_v31
    s_branch L_next
L_v32:
    s_waitcnt vmcnt(31)
    buffer_load_dwordx4 v2, s[4:7], s9 offen offset:0 nt lds
    s_waitcnt vmcnt(31)
    buffer_load_dwordx4 v2, s[4:7], s9 offen offset:1024 nt lds
    ds_read_b32 v7, v3 offset:44
    s_waitcnt vmcnt(31)
    buffer_load_dwordx4 v2, s[4:7], s9 offen offset:2048 nt lds
    v_subrev_u32 v6, 29, v5
    s_add_u32 m0, m0, 3072
    ds_write_b32 v3, v6 offset:16
    v_add_u32 v5, 3, v5
    s_add_u32 s9, s9, 3072
    s_cmp_lg_u32 m0, s12
    s_cbranch_scc1 L_v32
    s_branch L_next
L_v33:
    s_waitcnt vmcnt(32)
    buffer_load_dwordx4 v2, s[4:7], s9 offen offset:0 nt lds
    s_waitcnt vmcnt(32)
    buffer_load_dwordx4 v2, s[4:7], s9 offen offset:1024 nt lds
    ds_read_b32 v7, v3 offset:44
    s_waitcnt vmcnt(32)
    buffer_load_dwordx4 v2, s[4:7], s9 offen offset:2048 nt lds
    v_subrev_u32 v6, 30, v5
    s_add_u32 m0, m0, 3072
    ds_write_b32 v3, v6 offset:16
    v_add_u32 v5, 3, v5
    s_add_u32 s9, s9, 3072
    s_cmp_lg_u32 m0, s12
    s_cbranch_scc1 L_v33
    s_branch L_next
L_v34:
    s_waitcnt vmcnt(33)
    buffer_load_dwordx4 v2, s[4:7], s9 offen offset:0 nt lds
    s_waitcnt vmcnt(33)
    buffer_load_dwordx4 v2, s[4:7], s9 offen offset:1024 nt lds
    ds_read_b32 v7, v3 offset:44
    s_waitcnt vmcnt(33)
    buffer_load_dwordx4 v2, s[4:7], s9 offen offset:2048 nt lds
    v_subrev_u32 v6, 31, v5
    s_add_u32 m0, m0, 3072
    ds_write_b32 v3, v6 offset:16
    v_add_u32 v5, 3, v5
    s_add_u32 s9, s9, 3072
    s_cmp_lg_u32 m0, s12
    s_cbranch_scc1 L_v34
    s_branch L_next
L_v35:
    s_waitcnt vmcnt(34)
    buffer_load_dwordx4 v2, s[4:7], s9 offen offset:0 nt lds
    s_waitcnt vmcnt(34)
    buffer_load_dwordx4 v2, s[4:7], s9 offen offset:1024 nt lds
    ds_read_b32 v7, v3 offset:44
    s_waitcnt vmcnt(34)
    buffer_load_dwordx4 v2, s[4:7], s9 offen offset:2048 nt lds
    v_subrev_u32 v6, 32, v5
    s_add_u32 m0, m0, 3072
    ds_write_b32 v3, v6 offset:16
    v_add_u32 v5, 3, v5
    s_add_u32 s9, s9, 3072
    s_cmp_lg_u32 m0, s12
    s_cbranch_scc1 L_v35
    s_branch L_next
L_v36:
    s_waitcnt vmcnt(35)
    buffer_load_dwordx4 v2, s[4:7], s9 offen offset:0 nt lds
    s_waitcnt vmcnt(35)
    buffer_load_dwordx4 v2, s[4:7], s9 offen offset:1024 nt lds
    ds_read_b32 v7, v3 offset:44
    s_waitcnt vmcnt(35)
    buffer_load_dwordx4 v2, s[4:7], s9 offen offset:2048 nt lds
    v_subrev_u32 v6, 33, v5
    s_add_u32 m0, m0, 3072
    ds_write_b32 v3, v6 offset:16
    v_add_u32 v5, 3, v5
    s_add_u32 s9, s9, 3072
    s_cmp_lg_u32 m0, s12
    s_cbranch_scc1 L_v36
    s_branch L_next
L_full:
    ds_read_b32 v7, v3 offset:44
    s_waitcnt lgkmcnt(0)
    v_readfirstlane_b32 s11, v7
    s_nop 4
    s_branch L_aj
L_addr:
    s_cmp_lt_u32 s10, 128
    s_cbranch_scc0 L_av
    s_lshr_b32 s80, s10, 5
    s_lshl_b32 s80, s80, 2
    s_add_u32 s80, s80, s16
    s_bfe_u32 s81, s10, 0x30002
    s_bitcmp1_b32 s10, 5
    s_cselect_b32 s82, 7, 0
    s_xor_b32 s81, s81, s82
    s_branch L_ak
L_av:
    s_cmp_eq_u32 s10, 256
    s_cbranch_scc1 L_drain
    s_mov_b32 s4, s56
    s_mov_b32 s5, s57
    s_add_u32 s80, s10, s17
    s_bfe_u32 s81, s10, 0x30004
    s_xor_b32 s81, s81, 7
L_ak:
    s_and_b32 s80, s80, 15
    s_mul_i32 s80, s80, 786432
    s_mul_i32 s81, s81, 50331648
    s_add_u32 s9, s80, s81
    s_add_u32 s9, s9, s8
    s_branch L_aj
L_drain:
    v_mov_b32 v6, 3048
    s_waitcnt vmcnt(24)
    ds_write_b32 v3, v6 offset:16
    v_mov_b32 v6, 3060
    s_waitcnt vmcnt(12)
    ds_write_b32 v3, v6 offset:16
    v_mov_b32 v6, 3072
    s_waitcnt vmcnt(0)
    ds_write_b32 v3, v6 offset:16
    s_endpgm
L_notld:
    s_cmp_gt_u32 s76, 4
    s_cbranch_scc1 L_aux
    v_lshrrev_b32 v21, 4, v1
    v_and_b32 v22, 15, v1
    v_mul_u32_u24 v16, 384, v21
    v_lshl_add_u32 v16, v22, 3, v16
    v_cmp_gt_u32 vcc, 8, v22
    v_xor_b32 v17, 64, v16
    s_mul_i32 s24, s77, 4
    s_and_b32 s24, s24, 15
    s_lshl_b32 s80, s78, 2
    s_add_u32 s80, s80, s76
    s_mul_i32 s83, s80, 1536
    s_mul_i32 s16, s24, 393216
    s_add_u32 s16, s16, s83
    s_waitcnt lgkmcnt(0)
    s_mov_b32 s4, s66
    s_mov_b32 s5, s67
    s_mov_b32 s6, 6291456
    s_mov_b32 s7, 0x20000
    s_mov_b32 s8, s68
    s_mov_b32 s9, s69
    s_mov_b32 s10, 6291456
    s_mov_b32 s11, 0x20000
    s_lshl_b32 s80, s76, 2
    v_add_u32 v11, s80, v3
    v_mov_b32 v10, 0
    buffer_load_dwordx2 v[120:121], v16, s[4:7], s16 offen offset:0
    buffer_load_dwordx2 v[126:127], v17, s[8:11], s16 offen offset:0
    buffer_load_dwordx2 v[122:123], v16, s[4:7], s16 offen offset:128
    buffer_load_dwordx2 v[128:129], v17, s[8:11], s16 offen offset:128
    buffer_load_dwordx2 v[124:125], v16, s[4:7], s16 offen offset:256
    buffer_load_dwordx2 v[130:131], v17, s[8:11], s16 offen offset:256
    s_add_u32 s16, s16, 393216
    buffer_load_dwordx2 v[132:133], v16, s[4:7], s16 offen offset:0
    buffer_load_dwordx2 v[138:139], v17, s[8:11], s16 offen offset:0
    buffer_load_dwordx2 v[134:135], v16, s[4:7], s16 offen offset:128
    buffer_load_dwordx2 v[140:141], v17, s[8:11], s16 offen offset:128
    buffer_load_dwordx2 v[136:137], v16, s[4:7], s16 offen offset:256
    buffer_load_dwordx2 v[142:143], v17, s[8:11], s16 offen offset:256
    s_add_u32 s16, s16, 393216
    buffer_load_dwordx2 v[144:145], v16, s[4:7], s16 offen offset:0
    buffer_load_dwordx2 v[150:151], v17, s[8:11], s16 offen offset:0
    buffer_load_dwordx2 v[146:147], v16, s[4:7], s16 offen offset:128
    buffer_load_dwordx2 v[152:153], v17, s[8:11], s16 offen offset:128
    buffer_load_dwordx2 v[148:149], v16, s[4:7], s16 offen offset:256
    buffer_load_dwordx2 v[154:155], v17, s[8:11], s16 offen offset:256
    s_add_u32 s16, s16, 393216
    buffer_load_dwordx2 v[156:157], v16, s[4:7], s16 offen offset:0
    buffer_load_dwordx2 v[162:163], v17, s[8:11], s16 offen offset:0
    buffer_load_dwordx2 v[158:159], v16, s[4:7], s16 offen offset:128
    buffer_load_dwordx2 v[164:165], v17, s[8:11], s16 offen offset:128
    buffer_load_dwordx2 v[160:161], v16, s[4:7], s16 offen offset:256
    buffer_load_dwordx2 v[166:167], v17, s[8:11], s16 offen offset:256
    s_add_u32 s16, s16, 393216
    s_mov_b32 s12, s74
    s_mov_b32 s13, s75
    s_mov_b32 s14, 1610612736
    s_mov_b32 s15, 0x20000
    s_mov_b32 s22, 0x05040100
    s_mov_b32 s23, 0x07060302
    s_lshl_b32 s80, s76, 2
    v_add_u32 v21, s80, v21
    v_mul_u32_u24 v5, 768, v21
    v_lshl_add_u32 v5, v22, 4, v5
    v_lshlrev_b32 v19, 3, v21
    v_add_u32 v19, 126976, v19
    v_lshlrev_b32 v18, 4, v22
    v_add_u32 v18, 151552, v18
    v_mov_b32 v23, 0xff
    s_mul_i32 s17, s76, 3
    s_add_u32 s17, s17, 3
    s_mov_b32 s18, 0
    s_mov_b32 s19, 0
    s_mov_b32 s20, 0
    s_mov_b32 s21, 0
    s_waitcnt vmcnt(18)
    ds_write_b32 v11, v10
    v_cndmask_b32 v24, v130, v128, vcc
    v_cndmask_b32 v25, v131, v129, vcc
    v_cndmask_b32 v26, v126, v130, vcc
    v_cndmask_b32 v27, v127, v131, vcc
    v_cndmask_b32 v28, v128, v126, vcc
    v_cndmask_b32 v29, v129, v127, vcc
    v_perm_b32 v72, v24, v120, s22
    v_perm_b32 v73, v24, v120, s23
    v_perm_b32 v74, v25, v121, s22
    v_perm_b32 v75, v25, v121, s23
    v_perm_b32 v76, v26, v122, s22
    v_perm_b32 v77, v26, v122, s23
    v_perm_b32 v78, v27, v123, s22
    v_perm_b32 v79, v27, v123, s23
    v_perm_b32 v80, v28, v124, s22
    v_perm_b32 v81, v28, v124, s23
    v_perm_b32 v82, v29, v125, s22
    v_perm_b32 v83, v29, v125, s23
    s_waitcnt vmcnt(12)
    v_cndmask_b32 v24, v142, v140, vcc
    v_cndmask_b32 v25, v143, v141, vcc
    v_cndmask_b32 v26, v138, v142, vcc
    v_cndmask_b32 v27, v139, v143, vcc
    v_cndmask_b32 v28, v140, v138, vcc
    v_cndmask_b32 v29, v141, v139, vcc
    v_perm_b32 v84, v24, v132, s22
    v_perm_b32 v85, v24, v132, s23
    v_perm_b32 v86, v25, v133, s22
    v_perm_b32 v87, v25, v133, s23
    v_perm_b32 v88, v26, v134, s22
    v_perm_b32 v89, v26, v134, s23
    v_perm_b32 v90, v27, v135, s22
    v_perm_b32 v91, v27, v135, s23
    v_perm_b32 v92, v28, v136, s22
    v_perm_b32 v93, v28, v136, s23
    v_perm_b32 v94, v29, v137, s22
    v_perm_b32 v95, v29, v137, s23
    s_waitcnt vmcnt(6)
    v_cndmask_b32 v24, v154, v152, vcc
    v_cndmask_b32 v25, v155, v153, vcc
    v_cndmask_b32 v26, v150, v154, vcc
    v_cndmask_b32 v27, v151, v155, vcc
    v_cndmask_b32 v28, v152, v150, vcc
    v_cndmask_b32 v29, v153, v151, vcc
    v_perm_b32 v96, v24, v144, s22
    v_perm_b32 v97, v24, v144, s23
    v_perm_b32 v98, v25, v145, s22
    v_perm_b32 v99, v25, v145, s23
    v_perm_b32 v100, v26, v146, s22
    v_perm_b32 v101, v26, v146, s23
    v_perm_b32 v102, v27, v147, s22
    v_perm_b32 v103, v27, v147, s23
    v_perm_b32 v104, v28, v148, s22
    v_perm_b32 v105, v28, v148, s23
    v_perm_b32 v106, v29, v149, s22
    v_perm_b32 v107, v29, v149, s23
    s_waitcnt vmcnt(0)
    v_cndmask_b32 v24, v166, v164, vcc
    v_cndmask_b32 v25, v167, v165, vcc
    v_cndmask_b32 v26, v162, v166, vcc
    v_cndmask_b32 v27, v163, v167, vcc
    v_cndmask_b32 v28, v164, v162, vcc
    v_cndmask_b32 v29, v165, v163, vcc
    v_perm_b32 v108, v24, v156, s22
    v_perm_b32 v109, v24, v156, s23
    v_perm_b32 v110, v25, v157, s22
    v_perm_b32 v111, v25, v157, s23
    v_perm_b32 v112, v26, v158, s22
    v_perm_b32 v113, v26, v158, s23
    v_perm_b32 v114, v27, v159, s22
    v_perm_b32 v115, v27, v159, s23
    v_perm_b32 v116, v28, v160, s22
    v_perm_b32 v117, v28, v160, s23
    v_perm_b32 v118, v29, v161, s22
    v_perm_b32 v119, v29, v161, s23
    s_nop 1
L_kvisit:
    s_cmp_ge_u32 s16, 6291456
    s_cselect_b32 s80, 6291456, 0
    s_sub_u32 s16, s16, s80
    s_and_b32 s26, s20, 1
    s_cmp_lt_u32 s21, 3
    s_cselect_b32 s26, s26, 9
    s_bitcmp1_b32 s21, 0
    s_cselect_b32 s82, 7, 0
    s_xor_b32 s82, s82, s20
    s_mul_i32 s80, s82, 768
    v_add_u32 v6, s80, v18
    s_lshl_b32 s80, s82, 4
    s_add_u32 s80, s80, s24
    s_lshl_b32 s81, s80, 7
    v_add_u32 v8, s81, v19
    s_nop 1
L_qw:
    ds_read_b32 v4, v3 offset:32
    ds_read_b128 v[48:51], v6 offset:0
    ds_read_b128 v[52:55], v6 offset:256
    ds_read_b128 v[56:59], v6 offset:512
    s_waitcnt lgkmcnt(0)
    v_readfirstlane_b32 s80, v4
    s_nop 0
    s_cmp_gt_u32 s80, s82
    s_nop 2
    s_cbranch_scc1 L_qwg
    s_sleep 2
    s_branch L_qw
L_qwg:
    s_cmp_eq_u32 s26, 0
    s_cbranch_scc0 L_nc0
    buffer_load_dwordx2 v[60:61], v16, s[4:7], s16 offen offset:0
L_nc0:
    s_cmp_eq_u32 s26, 1
    s_cbranch_scc0 L_nd0
    buffer_load_dwordx2 v[64:65], v16, s[4:7], s16 offen offset:256
L_nd0:
    v_dot2_f32_bf16 v24, v72, v48, 0
    v_dot2_f32_bf16 v25, v73, v49, 0
    v_dot2_f32_bf16 v26, v74, v50, 0
    v_dot2_f32_bf16 v27, v75, v51, 0
    v_dot2_f32_bf16 v28, v76, v52, 0
    v_dot2_f32_bf16 v29, v77, v53, 0
    v_dot2_f32_bf16 v30, v78, v54, 0
    v_dot2_f32_bf16 v31, v79, v55, 0
    v_dot2_f32_bf16 v32, v80, v56, 0
    v_dot2_f32_bf16 v33, v81, v57, 0
    v_dot2_f32_bf16 v34, v82, v58, 0
    v_dot2_f32_bf16 v35, v83, v59, 0
    v_add_u32 v6, s19, v5
    v_pk_add_f32 v[14:15], v[24:25], v[26:27]
    v_pk_add_f32 v[14:15], v[14:15], v[28:29]
    v_pk_add_f32 v[14:15], v[14:15], v[30:31]
    v_pk_add_f32 v[14:15], v[14:15], v[32:33]
    v_pk_add_f32 v[14:15], v[14:15], v[34:35]
    s_cmp_ge_i32 s18, s17
    s_nop 0
    s_cbranch_scc1 L_kw0g
L_kw0:
    ds_read_b32 v4, v3 offset:16
    s_waitcnt lgkmcnt(0)
    v_readfirstlane_b32 s18, v4
    s_nop 0
    s_cmp_ge_i32 s18, s17
    s_nop 2
    s_cbranch_scc1 L_kw0g
    s_sleep 1
    s_branch L_kw0
L_kw0g:
    ds_read_b128 v[36:39], v6 offset:0
    ds_read_b128 v[40:43], v6 offset:256
    ds_read_b128 v[44:47], v6 offset:512
    v_add_u32 v10, 1, v10
    s_add_u32 s19, s19, 12288
    s_cmp_eq_u32 s19, 110592
    s_cselect_b32 s19, 0, s19
    s_add_u32 s17, s17, 12
    s_waitcnt lgkmcnt(2)
    v_cvt_f32_i32 v36, v36
    v_cvt_f32_i32 v37, v37
    v_cvt_f32_i32 v38, v38
    v_cvt_f32_i32 v39, v39
    v_pk_mul_f32 v[12:13], v[36:37], v[24:25]
    v_pk_fma_f32 v[12:13], v[38:39], v[26:27], v[12:13]
    s_waitcnt lgkmcnt(1)
    v_cvt_f32_i32 v40, v40
    v_cvt_f32_i32 v41, v41
    v_cvt_f32_i32 v42, v42
    v_cvt_f32_i32 v43, v43
    v_pk_fma_f32 v[12:13], v[40:41], v[28:29], v[12:13]
    v_pk_fma_f32 v[12:13], v[42:43], v[30:31], v[12:13]
    s_waitcnt lgkmcnt(0)
    v_cvt_f32_i32 v44, v44
    v_cvt_f32_i32 v45, v45
    v_cvt_f32_i32 v46, v46
    v_cvt_f32_i32 v47, v47
    v_pk_fma_f32 v[12:13], v[44:45], v[32:33], v[12:13]
    v_pk_fma_f32 v[12:13], v[46:47], v[34:35], v[12:13]
    v_add_f32 v12, v12, v13
    v_add_f32 v13, v14, v15
    s_nop 0
    v_add_f32_dpp v12, v12, v12 quad_perm:[1,0,3,2] row_mask:0xf bank_mask:0xf
    v_add_f32_dpp v13, v13, v13 quad_perm:[1,0,3,2] row_mask:0xf bank_mask:0xf
    s_nop 0
    v_add_f32_dpp v12, v12, v12 quad_perm:[2,3,0,1] row_mask:0xf bank_mask:0xf
    v_add_f32_dpp v13, v13, v13 quad_perm:[2,3,0,1] row_mask:0xf bank_mask:0xf
    s_nop 0
    v_add_f32_dpp v12, v12, v12 row_half_mirror row_mask:0xf bank_mask:0xf
    v_add_f32_dpp v13, v13, v13 row_half_mirror row_mask:0xf bank_mask:0xf
    s_nop 0
    v_add_f32_dpp v12, v12, v12 row_mirror row_mask:0xf bank_mask:0xf
    v_add_f32_dpp v13, v13, v13 row_mirror row_mask:0xf bank_mask:0xf
    ds_write_b64 v8, v[12:13] offset:0
    ds_write_b32 v11, v10
    s_cmp_eq_u32 s26, 0
    s_cbranch_scc0 L_nc1
    buffer_load_dwordx2 v[66:67], v17, s[8:11], s16 offen offset:0
L_nc1:
    s_cmp_eq_u32 s26, 1
    s_cbranch_scc0 L_nd1
    buffer_load_dwordx2 v[70:71], v17, s[8:11], s16 offen offset:256
    s_add_u32 s16, s16, 393216
L_nd1:
    v_dot2_f32_bf16 v24, v84, v48, 0
    v_dot2_f32_bf16 v25, v85, v49, 0
    v_dot2_f32_bf16 v26, v86, v50, 0
    v_dot2_f32_bf16 v27, v87, v51, 0
    v_dot2_f32_bf16 v28, v88, v52, 0
    v_dot2_f32_bf16 v29, v89, v53, 0
    v_dot2_f32_bf16 v30, v90, v54, 0
    v_dot2_f32_bf16 v31, v91, v55, 0
    v_dot2_f32_bf16 v32, v92, v56, 0
    v_dot2_f32_bf16 v33, v93, v57, 0
    v_dot2_f32_bf16 v34, v94, v58, 0
    v_dot2_f32_bf16 v35, v95, v59, 0
    v_add_u32 v6, s19, v5
    v_pk_add_f32 v[14:15], v[24:25], v[26:27]
    v_pk_add_f32 v[14:15], v[14:15], v[28:29]
    v_pk_add_f32 v[14:15], v[14:15], v[30:31]
    v_pk_add_f32 v[14:15], v[14:15], v[32:33]
    v_pk_add_f32 v[14:15], v[14:15], v[34:35]
    s_cmp_ge_i32 s18, s17
    s_nop 0
    s_cbranch_scc1 L_kw1g
L_kw1:
    ds_read_b32 v4, v3 offset:16
    s_waitcnt lgkmcnt(0)
    v_readfirstlane_b32 s18, v4
    s_nop 0
    s_cmp_ge_i32 s18, s17
    s_nop 2
    s_cbranch_scc1 L_kw1g
    s_sleep 1
    s_branch L_kw1
L_kw1g:
    ds_read_b128 v[36:39], v6 offset:0
    ds_read_b128 v[40:43], v6 offset:256
    ds_read_b128 v[44:47], v6 offset:512
    v_add_u32 v10, 1, v10
    s_add_u32 s19, s19, 12288
    s_cmp_eq_u32 s19, 110592
    s_cselect_b32 s19, 0, s19
    s_add_u32 s17, s17, 12
    s_waitcnt lgkmcnt(2)
    v_cvt_f32_i32 v36, v36
    v_cvt_f32_i32 v37, v37
    v_cvt_f32_i32 v38, v38
    v_cvt_f32_i32 v39, v39
    v_pk_mul_f32 v[12:13], v[36:37], v[24:25]
    v_pk_fma_f32 v[12:13], v[38:39], v[26:27], v[12:13]
    s_waitcnt lgkmcnt(1)
    v_cvt_f32_i32 v40, v40
    v_cvt_f32_i32 v41, v41
    v_cvt_f32_i32 v42, v42
    v_cvt_f32_i32 v43, v43
    v_pk_fma_f32 v[12:13], v[40:41], v[28:29], v[12:13]
    v_pk_fma_f32 v[12:13], v[42:43], v[30:31], v[12:13]
    s_waitcnt lgkmcnt(0)
    v_cvt_f32_i32 v44, v44
    v_cvt_f32_i32 v45, v45
    v_cvt_f32_i32 v46, v46
    v_cvt_f32_i32 v47, v47
    v_pk_fma_f32 v[12:13], v[44:45], v[32:33], v[12:13]
    v_pk_fma_f32 v[12:13], v[46:47], v[34:35], v[12:13]
    v_add_f32 v12, v12, v13
    v_add_f32 v13, v14, v15
    s_nop 0
    v_add_f32_dpp v12, v12, v12 quad_perm:[1,0,3,2] row_mask:0xf bank_mask:0xf
    v_add_f32_dpp v13, v13, v13 quad_perm:[1,0,3,2] row_mask:0xf bank_mask:0xf
    s_nop 0
    v_add_f32_dpp v12, v12, v12 quad_perm:[2,3,0,1] row_mask:0xf bank_mask:0xf
    v_add_f32_dpp v13, v13, v13 quad_perm:[2,3,0,1] row_mask:0xf bank_mask:0xf
    s_nop 0
    v_add_f32_dpp v12, v12, v12 row_half_mirror row_mask:0xf bank_mask:0xf
    v_add_f32_dpp v13, v13, v13 row_half_mirror row_mask:0xf bank_mask:0xf
    s_nop 0
    v_add_f32_dpp v12, v12, v12 row_mirror row_mask:0xf bank_mask:0xf
    v_add_f32_dpp v13, v13, v13 row_mirror row_mask:0xf bank_mask:0xf
    ds_write_b64 v8, v[12:13] offset:128
    ds_write_b32 v11, v10
    s_cmp_eq_u32 s26, 0
    s_cbranch_scc0 L_nc2
    buffer_load_dwordx2 v[62:63], v16, s[4:7], s16 offen offset:128
L_nc2:
    v_dot2_f32_bf16 v24, v96, v48, 0
    v_dot2_f32_bf16 v25, v97, v49, 0
    v_dot2_f32_bf16 v26, v98, v50, 0
    v_dot2_f32_bf16 v27, v99, v51, 0
    v_dot2_f32_bf16 v28, v100, v52, 0
    v_dot2_f32_bf16 v29, v101, v53, 0
    v_dot2_f32_bf16 v30, v102, v54, 0
    v_dot2_f32_bf16 v31, v103, v55, 0
    v_dot2_f32_bf16 v32, v104, v56, 0
    v_dot2_f32_bf16 v33, v105, v57, 0
    v_dot2_f32_bf16 v34, v106, v58, 0
    v_dot2_f32_bf16 v35, v107, v59, 0
    v_add_u32 v6, s19, v5
    v_pk_add_f32 v[14:15], v[24:25], v[26:27]
    v_pk_add_f32 v[14:15], v[14:15], v[28:29]
    v_pk_add_f32 v[14:15], v[14:15], v[30:31]
    v_pk_add_f32 v[14:15], v[14:15], v[32:33]
    v_pk_add_f32 v[14:15], v[14:15], v[34:35]
    s_cmp_ge_i32 s18, s17
    s_nop 0
    s_cbranch_scc1 L_kw2g
L_kw2:
    ds_read_b32 v4, v3 offset:16
    s_waitcnt lgkmcnt(0)
    v_readfirstlane_b32 s18, v4
    s_nop 0
    s_cmp_ge_i32 s18, s17
    s_nop 2
    s_cbranch_scc1 L_kw2g
    s_sleep 1
    s_branch L_kw2
L_kw2g:
    ds_read_b128 v[36:39], v6 offset:0
    ds_read_b128 v[40:43], v6 offset:256
    ds_read_b128 v[44:47], v6 offset:512
    v_add_u32 v10, 1, v10
    s_add_u32 s19, s19, 12288
    s_cmp_eq_u32 s19, 110592
    s_cselect_b32 s19, 0, s19
    s_add_u32 s17, s17, 12
    s_waitcnt lgkmcnt(2)
    v_cvt_f32_i32 v36, v36
    v_cvt_f32_i32 v37, v37
    v_cvt_f32_i32 v38, v38
    v_cvt_f32_i32 v39, v39
    v_pk_mul_f32 v[12:13], v[36:37], v[24:25]
    v_pk_fma_f32 v[12:13], v[38:39], v[26:27], v[12:13]
    s_waitcnt lgkmcnt(1)
    v_cvt_f32_i32 v40, v40
    v_cvt_f32_i32 v41, v41
    v_cvt_f32_i32 v42, v42
    v_cvt_f32_i32 v43, v43
    v_pk_fma_f32 v[12:13], v[40:41], v[28:29], v[12:13]
    v_pk_fma_f32 v[12:13], v[42:43], v[30:31], v[12:13]
    s_waitcnt lgkmcnt(0)
    v_cvt_f32_i32 v44, v44
    v_cvt_f32_i32 v45, v45
    v_cvt_f32_i32 v46, v46
    v_cvt_f32_i32 v47, v47
    v_pk_fma_f32 v[12:13], v[44:45], v[32:33], v[12:13]
    v_pk_fma_f32 v[12:13], v[46:47], v[34:35], v[12:13]
    v_add_f32 v12, v12, v13
    v_add_f32 v13, v14, v15
    s_nop 0
    v_add_f32_dpp v12, v12, v12 quad_perm:[1,0,3,2] row_mask:0xf bank_mask:0xf
    v_add_f32_dpp v13, v13, v13 quad_perm:[1,0,3,2] row_mask:0xf bank_mask:0xf
    s_nop 0
    v_add_f32_dpp v12, v12, v12 quad_perm:[2,3,0,1] row_mask:0xf bank_mask:0xf
    v_add_f32_dpp v13, v13, v13 quad_perm:[2,3,0,1] row_mask:0xf bank_mask:0xf
    s_nop 0
    v_add_f32_dpp v12, v12, v12 row_half_mirror row_mask:0xf bank_mask:0xf
    v_add_f32_dpp v13, v13, v13 row_half_mirror row_mask:0xf bank_mask:0xf
    s_nop 0
    v_add_f32_dpp v12, v12, v12 row_mirror row_mask:0xf bank_mask:0xf
    v_add_f32_dpp v13, v13, v13 row_mirror row_mask:0xf bank_mask:0xf
    ds_write_b64 v8, v[12:13] offset:256
    ds_write_b32 v11, v10
    s_cmp_eq_u32 s26, 0
    s_cbranch_scc0 L_nc3
    buffer_load_dwordx2 v[68:69], v17, s[8:11], s16 offen offset:128
L_nc3:
    v_dot2_f32_bf16 v24, v108, v48, 0
    v_dot2_f32_bf16 v25, v109, v49, 0
    v_dot2_f32_bf16 v26, v110, v50, 0
    v_dot2_f32_bf16 v27, v111, v51, 0
    v_dot2_f32_bf16 v28, v112, v52, 0
    v_dot2_f32_bf16 v29, v113, v53, 0
    v_dot2_f32_bf16 v30, v114, v54, 0
    v_dot2_f32_bf16 v31, v115, v55, 0
    v_dot2_f32_bf16 v32, v116, v56, 0
    v_dot2_f32_bf16 v33, v117, v57, 0
    v_dot2_f32_bf16 v34, v118, v58, 0
    v_dot2_f32_bf16 v35, v119, v59, 0
    v_add_u32 v6, s19, v5
    v_pk_add_f32 v[14:15], v[24:25], v[26:27]
    v_pk_add_f32 v[14:15], v[14:15], v[28:29]
    v_pk_add_f32 v[14:15], v[14:15], v[30:31]
    v_pk_add_f32 v[14:15], v[14:15], v[32:33]
    v_pk_add_f32 v[14:15], v[14:15], v[34:35]
    s_cmp_ge_i32 s18, s17
    s_nop 0
    s_cbranch_scc1 L_kw3g
L_kw3:
    ds_read_b32 v4, v3 offset:16
    s_waitcnt lgkmcnt(0)
    v_readfirstlane_b32 s18, v4
    s_nop 0
    s_cmp_ge_i32 s18, s17
    s_nop 2
    s_cbranch_scc1 L_kw3g
    s_sleep 1
    s_branch L_kw3
L_kw3g:
    ds_read_b128 v[36:39], v6 offset:0
    ds_read_b128 v[40:43], v6 offset:256
    ds_read_b128 v[44:47], v6 offset:512
    v_add_u32 v10, 1, v10
    s_add_u32 s19, s19, 12288
    s_cmp_eq_u32 s19, 110592
    s_cselect_b32 s19, 0, s19
    s_add_u32 s17, s17, 12
    s_waitcnt lgkmcnt(2)
    v_cvt_f32_i32 v36, v36
    v_cvt_f32_i32 v37, v37
    v_cvt_f32_i32 v38, v38
    v_cvt_f32_i32 v39, v39
    v_pk_mul_f32 v[12:13], v[36:37], v[24:25]
    v_pk_fma_f32 v[12:13], v[38:39], v[26:27], v[12:13]
    s_waitcnt lgkmcnt(1)
    v_cvt_f32_i32 v40, v40
    v_cvt_f32_i32 v41, v41
    v_cvt_f32_i32 v42, v42
    v_cvt_f32_i32 v43, v43
    v_pk_fma_f32 v[12:13], v[40:41], v[28:29], v[12:13]
    v_pk_fma_f32 v[12:13], v[42:43], v[30:31], v[12:13]
    s_waitcnt lgkmcnt(0)
    v_cvt_f32_i32 v44, v44
    v_cvt_f32_i32 v45, v45
    v_cvt_f32_i32 v46, v46
    v_cvt_f32_i32 v47, v47
    v_pk_fma_f32 v[12:13], v[44:45], v[32:33], v[12:13]
    v_pk_fma_f32 v[12:13], v[46:47], v[34:35], v[12:13]
    v_add_f32 v12, v12, v13
    v_add_f32 v13, v14, v15
    s_nop 0
    v_add_f32_dpp v12, v12, v12 quad_perm:[1,0,3,2] row_mask:0xf bank_mask:0xf
    v_add_f32_dpp v13, v13, v13 quad_perm:[1,0,3,2] row_mask:0xf bank_mask:0xf
    s_nop 0
    v_add_f32_dpp v12, v12, v12 quad_perm:[2,3,0,1] row_mask:0xf bank_mask:0xf
    v_add_f32_dpp v13, v13, v13 quad_perm:[2,3,0,1] row_mask:0xf bank_mask:0xf
    s_nop 0
    v_add_f32_dpp v12, v12, v12 row_half_mirror row_mask:0xf bank_mask:0xf
    v_add_f32_dpp v13, v13, v13 row_half_mirror row_mask:0xf bank_mask:0xf
    s_nop 0
    v_add_f32_dpp v12, v12, v12 row_mirror row_mask:0xf bank_mask:0xf
    v_add_f32_dpp v13, v13, v13 row_mirror row_mask:0xf bank_mask:0xf
    ds_write_b64 v8, v[12:13] offset:384
    ds_write_b32 v11, v10
    s_add_u32 s20, s20, 1
    s_and_b32 s80, s20, 1
    s_cbranch_scc1 L_kvisit
    v_mov_b64 v[120:121], v[132:133]
    v_mov_b64 v[122:123], v[134:135]
    v_mov_b64 v[124:125], v[136:137]
    v_mov_b64 v[126:127], v[138:139]
    v_mov_b64 v[128:129], v[140:141]
    v_mov_b64 v[130:131], v[142:143]
    v_mov_b64 v[132:133], v[144:145]
    v_mov_b64 v[134:135], v[146:147]
    v_mov_b64 v[136:137], v[148:149]
    v_mov_b64 v[138:139], v[150:151]
    v_mov_b64 v[140:141], v[152:153]
    v_mov_b64 v[142:143], v[154:155]
    v_mov_b64 v[144:145], v[156:157]
    v_mov_b64 v[146:147], v[158:159]
    v_mov_b64 v[148:149], v[160:161]
    v_mov_b64 v[150:151], v[162:163]
    v_mov_b64 v[152:153], v[164:165]
    v_mov_b64 v[154:155], v[166:167]
    s_waitcnt vmcnt(0)
    v_cndmask_b32 v24, v70, v68, vcc
    v_cndmask_b32 v25, v71, v69, vcc
    v_cndmask_b32 v26, v66, v70, vcc
    v_cndmask_b32 v27, v67, v71, vcc
    v_cndmask_b32 v28, v68, v66, vcc
    v_cndmask_b32 v29, v69, v67, vcc
    v_perm_b32 v156, v24, v60, s22
    v_perm_b32 v157, v24, v60, s23
    v_perm_b32 v158, v25, v61, s22
    v_perm_b32 v159, v25, v61, s23
    v_perm_b32 v160, v26, v62, s22
    v_perm_b32 v161, v26, v62, s23
    v_perm_b32 v162, v27, v63, s22
    v_perm_b32 v163, v27, v63, s23
    v_perm_b32 v164, v28, v64, s22
    v_perm_b32 v165, v28, v64, s23
    v_perm_b32 v166, v29, v65, s22
    v_perm_b32 v167, v29, v65, s23
    s_cmp_lt_u32 s20, 8
    s_nop 0
    s_cbranch_scc1 L_kvisit
    v_mov_b64 v[72:73], v[120:121]
    v_mov_b64 v[74:75], v[122:123]
    v_mov_b64 v[76:77], v[124:125]
    v_mov_b64 v[78:79], v[126:127]
    v_mov_b64 v[80:81], v[128:129]
    v_mov_b64 v[82:83], v[130:131]
    v_mov_b64 v[84:85], v[132:133]
    v_mov_b64 v[86:87], v[134:135]
    v_mov_b64 v[88:89], v[136:137]
    v_mov_b64 v[90:91], v[138:139]
    v_mov_b64 v[92:93], v[140:141]
    v_mov_b64 v[94:95], v[142:143]
    v_mov_b64 v[96:97], v[144:145]
    v_mov_b64 v[98:99], v[146:147]
    v_mov_b64 v[100:101], v[148:149]
    v_mov_b64 v[102:103], v[150:151]
    v_mov_b64 v[104:105], v[152:153]
    v_mov_b64 v[106:107], v[154:155]
    v_mov_b64 v[108:109], v[156:157]
    v_mov_b64 v[110:111], v[158:159]
    v_mov_b64 v[112:113], v[160:161]
    v_mov_b64 v[114:115], v[162:163]
    v_mov_b64 v[116:117], v[164:165]
    v_mov_b64 v[118:119], v[166:167]
    s_mov_b32 s20, 0
    s_add_u32 s24, s24, 4
    s_and_b32 s24, s24, 15
    s_add_u32 s21, s21, 1
    s_cmp_lt_u32 s21, 4
    s_cbranch_scc1 L_kvisit
    v_lshrrev_b32 v21, 2, v1
    v_and_b32 v22, 3, v1
    v_mul_u32_u24 v5, 768, v21
    v_lshl_add_u32 v5, v22, 4, v5
    s_mul_i32 s80, s76, 192
    v_add_u32 v5, s80, v5
    v_lshlrev_b32 v19, 3, v21
    v_add_u32 v19, 126976, v19
    v_lshrrev_b32 v21, 4, v1
    v_lshl_add_u32 v7, v21, 2, v22
    v_and_b32 v21, 1, v7
    v_lshlrev_b32 v7, 4, v7
    s_lshl_b32 s80, s76, 8
    v_add_u32 v7, s80, v7
    v_lshlrev_b32 v18, 3, v21
    v_add_u32 v18, 157696, v18
    v_add_u32 v16, 143360, v7
    s_mov_b32 s32, 0x000f000f
    s_mov_b32 s33, 0x000f000f
    s_mov_b32 s17, 1548
    s_mul_i32 s24, s77, 4
    s_and_b32 s24, s24, 15
    s_mov_b32 s20, 0
    s_add_u32 s25, s77, 0
    s_mul_i32 s25, s25, 64
    s_add_u32 s25, s25, s78
    s_lshl_b32 s25, s25, 10
L_vhead:
    v_mov_b64 v[24:25], 0
    v_mov_b64 v[26:27], 0
    v_mov_b64 v[28:29], 0
    v_mov_b64 v[30:31], 0
    v_mov_b64 v[32:33], 0
    v_mov_b64 v[34:35], 0
    s_mov_b32 s21, 0
    s_nop 0
L_pw:
    ds_read_b64 v[36:37], v3 offset:32
    ds_read_b32 v4, v3 offset:40
    ds_read_b64 v[14:15], v18
    s_waitcnt lgkmcnt(0)
    v_readfirstlane_b32 s80, v37
    v_readfirstlane_b32 s28, v4
    s_cmp_gt_u32 s80, s20
    s_nop 3
    s_cbranch_scc1 L_pwg
    s_sleep 2
    s_branch L_pw
L_pwg:
    s_lshr_b32 s29, s28, 8
    s_lshr_b32 s30, s28, 16
L_vstep:
    s_xor_b32 s80, s20, 7
    s_lshl_b32 s80, s80, 4
    s_add_u32 s80, s80, s24
    s_lshl_b32 s80, s80, 7
    v_add_u32 v8, s80, v19
    v_add_u32 v6, s19, v5
    ds_read_b32 v12, v8
    s_cmp_ge_i32 s18, s17
    s_cbranch_scc1 L_vwg
L_vw:
    ds_read_b32 v4, v3 offset:16
    s_waitcnt lgkmcnt(0)
    v_readfirstlane_b32 s18, v4
    s_nop 0
    s_cmp_ge_i32 s18, s17
    s_nop 2
    s_cbranch_scc1 L_vwg
    s_sleep 1
    s_branch L_vw
L_vwg:
    ds_read_b128 v[36:39], v6 offset:0
    ds_read_b128 v[40:43], v6 offset:64
    ds_read_b128 v[44:47], v6 offset:128
    v_add_u32 v10, 1, v10
    s_add_u32 s19, s19, 12288
    s_cmp_eq_u32 s19, 110592
    s_cselect_b32 s19, 0, s19
    s_add_u32 s17, s17, 12
    s_add_u32 s24, s24, 1
    s_and_b32 s24, s24, 15
    s_add_u32 s21, s21, 1
    s_cmp_lt_u32 s21, 16
    s_waitcnt lgkmcnt(2)
    v_cvt_f32_i32 v36, v36
    v_cvt_f32_i32 v37, v37
    v_cvt_f32_i32 v38, v38
    v_cvt_f32_i32 v39, v39
    v_pk_fma_f32 v[24:25], v[36:37], v[12:13], v[24:25] op_sel_hi:[1,0,1]
    v_pk_fma_f32 v[26:27], v[38:39], v[12:13], v[26:27] op_sel_hi:[1,0,1]
    s_waitcnt lgkmcnt(1)
    v_cvt_f32_i32 v40, v40
    v_cvt_f32_i32 v41, v41
    v_cvt_f32_i32 v42, v42
    v_cvt_f32_i32 v43, v43
    v_pk_fma_f32 v[28:29], v[40:41], v[12:13], v[28:29] op_sel_hi:[1,0,1]
    v_pk_fma_f32 v[30:31], v[42:43], v[12:13], v[30:31] op_sel_hi:[1,0,1]
    s_waitcnt lgkmcnt(0)
    v_cvt_f32_i32 v44, v44
    v_cvt_f32_i32 v45, v45
    v_cvt_f32_i32 v46, v46
    v_cvt_f32_i32 v47, v47
    v_pk_fma_f32 v[32:33], v[44:45], v[12:13], v[32:33] op_sel_hi:[1,0,1]
    v_pk_fma_f32 v[34:35], v[46:47], v[12:13], v[34:35] op_sel_hi:[1,0,1]
    s_nop 1
    s_cbranch_scc0 L_vend
    ds_write_b32 v11, v10
    s_branch L_vstep
L_vend:
    v_permlane32_swap_b32 v24, v26
    v_permlane32_swap_b32 v25, v27
    v_permlane32_swap_b32 v28, v30
    v_permlane32_swap_b32 v29, v31
    v_permlane32_swap_b32 v32, v34
    v_permlane32_swap_b32 v33, v35
    v_pk_add_f32 v[24:25], v[24:25], v[26:27]
    v_pk_add_f32 v[28:29], v[28:29], v[30:31]
    v_pk_add_f32 v[32:33], v[32:33], v[34:35]
    v_permlane16_swap_b32 v24, v25
    v_permlane16_swap_b32 v28, v29
    v_permlane16_swap_b32 v32, v33
    v_add_f32 v36, v24, v25
    v_add_f32 v37, v28, v29
    v_add_f32 v38, v32, v33
    v_mov_b32 v39, v14
    v_add_f32_dpp v36, v36, v36 row_ror:4 row_mask:0xf bank_mask:0xf
    v_add_f32_dpp v37, v37, v37 row_ror:4 row_mask:0xf bank_mask:0xf
    v_add_f32_dpp v38, v38, v38 row_ror:4 row_mask:0xf bank_mask:0xf
    v_add_f32_dpp v36, v36, v36 row_ror:8 row_mask:0xf bank_mask:0xf
    v_add_f32_dpp v37, v37, v37 row_ror:8 row_mask:0xf bank_mask:0xf
    v_add_f32_dpp v38, v38, v38 row_ror:8 row_mask:0xf bank_mask:0xf
    v_sub_f32 v36, v36, v15
    v_sub_f32 v37, v37, v15
    v_sub_f32 v38, v38, v15
    v_bfi_b32 v36, v23, s28, v36
    v_bfi_b32 v37, v23, s29, v37
    v_bfi_b32 v38, v23, s30, v38
    s_add_u32 s20, s20, 1
    s_cmp_eq_u32 s20, 8
    s_mov_b64 exec, s[32:33]
    s_cbranch_scc1 L_vlast
    ds_write_b128 v16, v[36:39]
    s_mov_b64 exec, -1
    ds_write_b32 v11, v10
    v_add_u32 v16, 1024, v16
    v_add_u32 v18, 16, v18
    s_nop 1
    s_branch L_vhead
L_vlast:
    buffer_store_dwordx4 v[36:39], v7, s[12:15], s25 offen sc0 sc1
    s_endpgm
    s_nop 0
L_aux:
    s_cmp_eq_u32 s76, 5
    s_cbranch_scc0 L_bal
    v_lshlrev_b32 v5, 3, v1
    v_cmp_gt_u32 vcc, 24, v1
    v_mov_b32 v13, 0xffffff40
    v_mov_b32 v10, 192
    v_cndmask_b32 v13, v13, v10, vcc
    v_add_u32 v6, v5, v13
    v_mov_b32 v10, 0x80008000
    v_cndmask_b32 v7, 0, v10, vcc
    v_lshrrev_b32 v10, 1, v1
    v_and_b32 v11, 15, v10
    v_lshrrev_b32 v10, 4, v10
    v_mul_u32_u24 v10, 131072, v10
    v_mul_u32_u24 v11, 2048, v11
    v_add_u32 v10, v10, v11
    v_and_b32 v11, 1, v1
    v_lshl_add_u32 v17, v11, 4, v10
    v_add_u32 v10, 0, v1
    v_mul_u32_u24 v12, 2731, v10
    v_lshrrev_b32 v12, 16, v12
    v_mul_u32_u24 v12, 1152, v12
    v_lshl_add_u32 v56, v10, 4, v12
    v_add_u32 v10, 64, v1
    v_mul_u32_u24 v12, 2731, v10
    v_lshrrev_b32 v12, 16, v12
    v_mul_u32_u24 v12, 1152, v12
    v_lshl_add_u32 v57, v10, 4, v12
    v_add_u32 v10, 128, v1
    v_mul_u32_u24 v12, 2731, v10
    v_lshrrev_b32 v12, 16, v12
    v_mul_u32_u24 v12, 1152, v12
    v_lshl_add_u32 v58, v10, 4, v12
    v_cmp_eq_u32 s[32:33], 0, v11
    s_lshl_b32 s27, s77, 15
    s_lshl_b32 s80, s78, 5
    s_add_u32 s27, s27, s80
    s_mov_b32 m0, 143360
    s_waitcnt lgkmcnt(0)
    s_mov_b32 s4, s62
    s_mov_b32 s5, s63
    s_mov_b32 s6, 384
    s_mov_b32 s7, 0x20000
    s_mov_b32 s20, s64
    s_mov_b32 s21, s65
    s_mov_b32 s22, 384
    s_mov_b32 s23, 0x20000
    buffer_load_dwordx2 v[28:29], v5, s[4:7], 0 offen
    buffer_load_dwordx2 v[30:31], v5, s[20:23], 0 offen
    s_mov_b32 s4, s48
    s_mov_b32 s5, s49
    s_mov_b32 s6, 12288
    s_mov_b32 s7, 0x20000
    s_mul_i32 s80, s77, 384
    buffer_load_dwordx4 v56, s[4:7], s80 offen lds
    s_add_u32 m0, m0, 1024
    s_nop 0
    buffer_load_dwordx4 v57, s[4:7], s80 offen lds
    s_add_u32 m0, m0, 1024
    s_nop 0
    buffer_load_dwordx4 v58, s[4:7], s80 offen lds
    s_add_u32 m0, m0, 1024
    s_and_b32 s80, s78, 3
    s_lshl_b32 s80, s80, 3
    v_lshrrev_b32 v10, 3, v1
    v_add_u32 v10, s80, v10
    v_and_b32 v11, 15, v10
    v_lshrrev_b32 v10, 4, v10
    v_mul_u32_u24 v10, 131072, v10
    v_mul_u32_u24 v11, 2048, v11
    v_add_u32 v10, v10, v11
    v_and_b32 v11, 7, v1
    v_lshl_add_u32 v62, v11, 4, v10
    s_mov_b32 s20, s52
    s_mov_b32 s21, s53
    s_mov_b32 s22, 1048576
    s_mov_b32 s23, 0x20000
    s_andn2_b32 s80, s27, 127
    buffer_load_dwordx4 v[64:67], v62, s[20:23], s80 offen
    s_add_u32 s80, s80, 262144
    buffer_load_dwordx4 v[64:67], v62, s[20:23], s80 offen
    s_add_u32 s80, s80, 262144
    buffer_load_dwordx4 v[64:67], v62, s[20:23], s80 offen
    s_add_u32 s80, s80, 262144
    buffer_load_dwordx4 v[64:67], v62, s[20:23], s80 offen
    s_add_u32 s80, s80, 262144
    s_mov_b32 s20, s54
    s_mov_b32 s21, s55
    s_mov_b32 s22, 1048576
    s_mov_b32 s23, 0x20000
    s_andn2_b32 s80, s27, 127
    buffer_load_dwordx4 v[64:67], v62, s[20:23], s80 offen
    s_add_u32 s80, s80, 262144
    buffer_load_dwordx4 v[64:67], v62, s[20:23], s80 offen
    s_add_u32 s80, s80, 262144
    buffer_load_dwordx4 v[64:67], v62, s[20:23], s80 offen
    s_add_u32 s80, s80, 262144
    buffer_load_dwordx4 v[64:67], v62, s[20:23], s80 offen
    s_add_u32 s80, s80, 262144
    s_mov_b32 s20, s58
    s_mov_b32 s21, s59
    s_mov_b32 s22, 1048576
    s_mov_b32 s23, 0x20000
    s_andn2_b32 s80, s27, 127
    buffer_load_dwordx4 v[64:67], v62, s[20:23], s80 offen
    s_add_u32 s80, s80, 262144
    buffer_load_dwordx4 v[64:67], v62, s[20:23], s80 offen
    s_add_u32 s80, s80, 262144
    buffer_load_dwordx4 v[64:67], v62, s[20:23], s80 offen
    s_add_u32 s80, s80, 262144
    buffer_load_dwordx4 v[64:67], v62, s[20:23], s80 offen
    s_add_u32 s80, s80, 262144
    s_mov_b32 s20, s60
    s_mov_b32 s21, s61
    s_mov_b32 s22, 1048576
    s_mov_b32 s23, 0x20000
    s_andn2_b32 s80, s27, 127
    buffer_load_dwordx4 v[64:67], v62, s[20:23], s80 offen
    s_add_u32 s80, s80, 262144
    buffer_load_dwordx4 v[64:67], v62, s[20:23], s80 offen
    s_add_u32 s80, s80, 262144
    buffer_load_dwordx4 v[64:67], v62, s[20:23], s80 offen
    s_add_u32 s80, s80, 262144
    buffer_load_dwordx4 v[64:67], v62, s[20:23], s80 offen
    s_add_u32 s80, s80, 262144
    s_mov_b32 s12, s74
    s_mov_b32 s13, s75
    s_mov_b32 s14, 1610612736
    s_mov_b32 s15, 0x20000
    s_mov_b32 s8, s72
    s_mov_b32 s9, s73
    s_mov_b32 s10, 256
    s_mov_b32 s11, 0x20000
    s_mov_b32 s16, s70
    s_mov_b32 s17, s71
    s_mov_b32 s18, 12288
    s_mov_b32 s19, 0x20000
    v_mov_b32 v14, 0xff
    v_add_u32 v15, 143360, v5
    v_add_u32 v16, 143360, v6
    v_lshlrev_b32 v8, 1, v5
    v_lshlrev_b32 v9, 1, v6
    v_add_u32 v8, 151552, v8
    v_add_u32 v9, 151552, v9
    v_mov_b32 v12, 0
    s_mov_b32 s24, 0
    s_waitcnt vmcnt(19)
    v_xor_b32 v30, v30, v7
    v_xor_b32 v31, v31, v7
    v_lshlrev_b32 v32, 16, v28
    v_and_b32 v33, 0xffff0000, v28
    v_lshlrev_b32 v34, 16, v29
    v_and_b32 v35, 0xffff0000, v29
    v_lshlrev_b32 v36, 16, v30
    v_and_b32 v37, 0xffff0000, v30
    v_lshlrev_b32 v38, 16, v31
    v_and_b32 v39, 0xffff0000, v31
    v_and_b32 v7, 0x80000000, v7
    s_waitcnt vmcnt(16)
    s_mov_b32 exec_hi, 0xffff
L_hq:
    ds_read_b64 v[20:21], v15
    ds_read_b64 v[22:23], v16
    v_add_u32 v15, 384, v15
    v_add_u32 v16, 384, v16
    v_add_u32 v12, 1, v12
    s_waitcnt lgkmcnt(0)
    v_lshlrev_b32 v40, 16, v20
    v_and_b32 v41, 0xffff0000, v20
    v_lshlrev_b32 v42, 16, v21
    v_and_b32 v43, 0xffff0000, v21
    v_lshlrev_b32 v44, 16, v22
    v_and_b32 v45, 0xffff0000, v22
    v_lshlrev_b32 v46, 16, v23
    v_and_b32 v47, 0xffff0000, v23
    v_pk_mul_f32 v[40:41], v[40:41], v[32:33]
    v_pk_mul_f32 v[44:45], v[44:45], v[36:37]
    v_pk_mul_f32 v[42:43], v[42:43], v[34:35]
    v_pk_mul_f32 v[46:47], v[46:47], v[38:39]
    v_cvt_pk_bf16_f32 v40, v40, v44
    v_cvt_pk_bf16_f32 v41, v41, v45
    v_cvt_pk_bf16_f32 v42, v42, v46
    v_cvt_pk_bf16_f32 v43, v43, v47
    v_and_b32 v44, 0xffff0000, v40
    v_lshlrev_b32 v40, 16, v40
    v_and_b32 v45, 0xffff0000, v41
    v_lshlrev_b32 v41, 16, v41
    v_and_b32 v46, 0xffff0000, v42
    v_lshlrev_b32 v42, 16, v42
    v_and_b32 v47, 0xffff0000, v43
    v_lshlrev_b32 v43, 16, v43
    v_pk_add_f32 v[40:41], v[40:41], v[44:45]
    v_pk_add_f32 v[42:43], v[42:43], v[46:47]
    v_cvt_pk_bf16_f32 v48, v40, v40
    v_cvt_pk_bf16_f32 v49, v41, v41
    v_cvt_pk_bf16_f32 v50, v42, v42
    v_cvt_pk_bf16_f32 v51, v43, v43
    v_xor_b32 v48, v48, v7
    v_xor_b32 v49, v49, v7
    v_xor_b32 v50, v50, v7
    v_xor_b32 v51, v51, v7
    ds_write_b16 v8, v48 offset:0
    ds_write_b16_d16_hi v9, v48 offset:2
    ds_write_b16 v8, v49 offset:4
    ds_write_b16_d16_hi v9, v49 offset:6
    ds_write_b16 v8, v50 offset:8
    ds_write_b16_d16_hi v9, v50 offset:10
    ds_write_b16 v8, v51 offset:12
    ds_write_b16_d16_hi v9, v51 offset:14
    ds_write_b32 v3, v12 offset:32
    v_add_u32 v8, 768, v8
    v_add_u32 v9, 768, v9
    s_add_u32 s24, s24, 1
    s_cmp_lt_u32 s24, 8
    s_cbranch_scc1 L_hq
    s_mov_b32 exec_hi, -1
    s_add_u32 s80, s77, 0
    s_mul_i32 s80, s80, 64
    s_add_u32 s80, s80, s78
    s_lshl_b32 s80, s80, 10
    buffer_load_dwordx4 v[64:67], v2, s[12:15], s80 offen
    s_add_u32 s80, s80, 262144
    v_mov_b32 v15, 0
    s_mov_b32 s25, 0
    s_cmp_eq_u32 s2, 0
    s_cbranch_scc1 L_epc
L_epw:
    s_sleep 16
    ds_read_b32 v4, v3 offset:20
    s_waitcnt lgkmcnt(0)
    v_readfirstlane_b32 s80, v4
    s_nop 0
    s_cmp_lt_i32 s80, 16
    s_nop 2
    s_cbranch_scc1 L_epw
    s_load_dword s28, s[72:73], 0
    s_waitcnt lgkmcnt(0)
    s_cmp_lg_u32 s28, 0
    s_cbranch_scc1 L_epd
L_ep:
    s_mov_b64 exec, 1
    buffer_load_dword v11, v15, s[8:11], 0 offen sc0 sc1
    s_waitcnt vmcnt(0)
    v_readfirstlane_b32 s28, v11
    s_mov_b64 exec, -1
    s_cmp_lg_u32 s28, 0
    s_nop 2
    s_cbranch_scc1 L_epd
    s_sleep 32
    s_add_u32 s25, s25, 1
    s_cmp_lt_u32 s25, 8
    s_cbranch_scc1 L_ep
L_epc:
    s_mul_i32 s28, s84, 0x9e3779b1
    s_lshr_b32 s81, s28, 15
    s_xor_b32 s28, s28, s81
    s_mul_i32 s28, s28, 0x85ebca6b
    s_lshr_b32 s81, s28, 13
    s_xor_b32 s28, s28, s81
    s_max_u32 s28, s28, 1
    v_mov_b32 v20, s28
    v_mov_b32 v21, 0
    s_mov_b64 exec, 1
    buffer_atomic_cmpswap v[20:21], v15, s[8:11], 0 offen sc0 sc1
    s_waitcnt vmcnt(0)
    v_readfirstlane_b32 s80, v20
    s_mov_b64 exec, -1
    s_cmp_eq_u32 s80, 0
    s_cselect_b32 s28, s28, s80
    s_nop 1
L_epd:
    v_mov_b32 v12, s28
    ds_write_b32 v3, v12 offset:40
    s_lshr_b32 s29, s28, 8
    s_lshr_b32 s30, s28, 16
    s_lshr_b32 s31, s28, 24
    s_add_u32 s24, s77, 16
    s_mov_b32 s25, 0
    s_mov_b32 s20, s52
    s_mov_b32 s21, s53
    s_mov_b32 s22, 1048576
    s_mov_b32 s23, 0x20000
L_sc:
    s_sleep 16
    ds_read_b32 v4, v3 offset:20
    s_waitcnt lgkmcnt(0)
    v_readfirstlane_b32 s80, v4
    s_nop 0
    s_cmp_lt_i32 s80, s24
    s_nop 2
    s_cbranch_scc1 L_sc
    s_lshr_b32 s80, s78, 2
    s_add_u32 s80, s80, s25
    s_and_b32 s80, s80, 15
    s_lshl_b32 s81, s80, 10
    s_add_u32 m0, s81, 110592
    s_mov_b64 s[20:21], s[52:53]
    s_cmp_ge_u32 s80, 4
    s_cselect_b64 s[20:21], s[54:55], s[20:21]
    s_cmp_ge_u32 s80, 8
    s_cselect_b64 s[20:21], s[58:59], s[20:21]
    s_cmp_ge_u32 s80, 12
    s_cselect_b64 s[20:21], s[60:61], s[20:21]
    s_and_b32 s80, s80, 3
    s_mul_i32 s80, s80, 262144
    s_add_u32 s80, s80, s27
    buffer_load_dwordx4 v17, s[20:23], s80 offen  lds
    s_add_u32 s25, s25, 1
    s_add_u32 s24, s24, 4
    s_cmp_lt_u32 s25, 16
    s_cbranch_scc1 L_sc
    s_waitcnt vmcnt(0)
    v_mov_b32 v28, 0
    v_mov_b32 v29, 0
    v_mov_b32 v30, 0
    v_mov_b32 v31, 0
    v_mov_b32 v32, 0
    v_mov_b32 v33, 0
    v_mov_b32 v34, 0
    v_mov_b32 v35, 0
    v_mov_b32 v36, 0
    v_mov_b32 v37, 0
    v_mov_b32 v38, 0
    v_mov_b32 v39, 0
    v_mov_b32 v40, 0
    v_mov_b32 v41, 0
    v_mov_b32 v42, 0
    v_mov_b32 v43, 0
    v_mov_b32 v44, 0
    v_mov_b32 v45, 0
    v_mov_b32 v46, 0
    v_mov_b32 v47, 0
    v_mov_b32 v48, 0
    v_mov_b32 v49, 0
    v_mov_b32 v50, 0
    v_mov_b32 v51, 0
    v_mov_b32 v64, 0
    v_mov_b32 v65, 0
    v_mov_b32 v66, 0
    v_mov_b32 v67, 0
    v_mov_b32 v68, 0
    v_mov_b32 v69, 0
    v_mov_b32 v70, 0
    v_mov_b32 v71, 0
    v_lshlrev_b32 v15, 3, v1
    v_add_u32 v15, 141312, v15
    v_lshlrev_b32 v16, 1, v1
    v_add_u32 v16, 114176, v16
    v_mov_b32 v8, 157696
    v_mov_b32 v9, 0
    s_mov_b32 s24, 100
    s_nop 0
L_hp:
    s_sleep 8
    ds_read_b128 v[56:59], v3
    s_waitcnt lgkmcnt(0)
    v_min3_i32 v56, v56, v57, v58
    v_min_i32 v56, v56, v59
    s_nop 0
    v_readfirstlane_b32 s80, v56
    s_nop 0
    s_cmp_lt_i32 s80, s24
    s_nop 2
    s_cbranch_scc1 L_hp
    ds_read_b64 v[72:73], v15 offset:0
    ds_read_u16_d16_hi v28, v16 offset:0
    ds_read_u16_d16_hi v64, v16 offset:4096
    ds_read_b64 v[74:75], v15 offset:512
    ds_read_u16_d16_hi v29, v16 offset:128
    ds_read_u16_d16_hi v65, v16 offset:4224
    ds_read_b64 v[76:77], v15 offset:1024
    ds_read_u16_d16_hi v30, v16 offset:256
    ds_read_u16_d16_hi v66, v16 offset:4352
    ds_read_b64 v[78:79], v15 offset:1536
    ds_read_u16_d16_hi v31, v16 offset:384
    ds_read_u16_d16_hi v67, v16 offset:4480
    s_waitcnt lgkmcnt(0)
    ds_read_u16_d16_hi v36, v16 offset:8192
    ds_read_u16_d16_hi v44, v16 offset:12288
    ds_read_u16_d16_hi v37, v16 offset:8320
    ds_read_u16_d16_hi v45, v16 offset:12416
    ds_read_u16_d16_hi v38, v16 offset:8448
    ds_read_u16_d16_hi v46, v16 offset:12544
    ds_read_u16_d16_hi v39, v16 offset:8576
    ds_read_u16_d16_hi v47, v16 offset:12672
    v_fma_f32 v20, -v64, v73, v72
    v_fma_f32 v21, -v65, v75, v74
    v_fma_f32 v22, -v66, v77, v76
    v_fma_f32 v23, -v67, v79, v78
    v_mul_f32 v20, v20, v28
    v_mul_f32 v21, v21, v29
    v_mul_f32 v22, v22, v30
    v_mul_f32 v23, v23, v31
    v_mul_f32 v20, 0x3dd53b95, v20
    v_mul_f32 v21, 0x3dd53b95, v21
    v_mul_f32 v22, 0x3dd53b95, v22
    v_mul_f32 v23, 0x3dd53b95, v23
    v_mov_b32 v52, v20
    v_max_f32 v52, v52, v21
    v_max_f32 v52, v52, v22
    v_max_f32 v52, v52, v23
    s_nop 1
    v_max_f32_dpp v52, v52, v52 quad_perm:[1,0,3,2] row_mask:0xf bank_mask:0xf
    s_nop 1
    v_max_f32_dpp v52, v52, v52 quad_perm:[2,3,0,1] row_mask:0xf bank_mask:0xf
    s_nop 1
    v_max_f32_dpp v52, v52, v52 row_half_mirror row_mask:0xf bank_mask:0xf
    s_nop 1
    v_max_f32_dpp v52, v52, v52 row_mirror row_mask:0xf bank_mask:0xf
    v_mov_b32 v13, v52
    s_nop 1
    v_permlane32_swap_b32 v52, v13
    v_max_f32 v52, v52, v13
    v_mov_b32 v13, v52
    s_nop 1
    v_permlane16_swap_b32 v52, v13
    v_max_f32 v52, v52, v13
    v_sub_f32 v20, v20, v52
    v_sub_f32 v21, v21, v52
    v_sub_f32 v22, v22, v52
    v_sub_f32 v23, v23, v52
    v_exp_f32 v20, v20
    v_exp_f32 v21, v21
    v_exp_f32 v22, v22
    v_exp_f32 v23, v23
    v_mov_b32 v54, v20
    v_add_f32 v54, v54, v21
    v_add_f32 v54, v54, v22
    v_add_f32 v54, v54, v23
    s_waitcnt lgkmcnt(0)
    v_mul_f32 v20, v20, v36
    v_mul_f32 v21, v21, v37
    v_mul_f32 v22, v22, v38
    v_mul_f32 v23, v23, v39
    v_mul_f32 v53, v20, v44
    v_fmac_f32 v53, v21, v45
    v_fmac_f32 v53, v22, v46
    v_fmac_f32 v53, v23, v47
    ds_write_b32 v15, v20 offset:0
    ds_write_b32 v15, v21 offset:512
    ds_write_b32 v15, v22 offset:1024
    ds_write_b32 v15, v23 offset:1536
    v_add_f32_dpp v54, v54, v54 quad_perm:[1,0,3,2] row_mask:0xf bank_mask:0xf
    s_nop 1
    v_add_f32_dpp v54, v54, v54 quad_perm:[2,3,0,1] row_mask:0xf bank_mask:0xf
    s_nop 1
    v_add_f32_dpp v54, v54, v54 row_half_mirror row_mask:0xf bank_mask:0xf
    s_nop 1
    v_add_f32_dpp v54, v54, v54 row_mirror row_mask:0xf bank_mask:0xf
    v_mov_b32 v13, v54
    s_nop 1
    v_permlane32_swap_b32 v54, v13
    v_add_f32 v54, v54, v13
    v_mov_b32 v13, v54
    s_nop 1
    v_permlane16_swap_b32 v54, v13
    v_add_f32 v54, v54, v13
    v_add_f32_dpp v53, v53, v53 quad_perm:[1,0,3,2] row_mask:0xf bank_mask:0xf
    s_nop 1
    v_add_f32_dpp v53, v53, v53 quad_perm:[2,3,0,1] row_mask:0xf bank_mask:0xf
    s_nop 1
    v_add_f32_dpp v53, v53, v53 row_half_mirror row_mask:0xf bank_mask:0xf
    s_nop 1
    v_add_f32_dpp v53, v53, v53 row_mirror row_mask:0xf bank_mask:0xf
    v_mov_b32 v13, v53
    s_nop 1
    v_permlane32_swap_b32 v53, v13
    v_add_f32 v53, v53, v13
    v_mov_b32 v13, v53
    s_nop 1
    v_permlane16_swap_b32 v53, v13
    v_add_f32 v53, v53, v13
    v_bfi_b32 v54, v14, s31, v54
    v_mov_b32 v55, v53
    v_add_u32 v9, 1, v9
    s_mov_b64 exec, 1
    ds_write_b128 v8, v[52:55]
    ds_write_b32 v3, v9 offset:36
    s_mov_b64 exec, -1
    v_add_u32 v15, -2048, v15
    v_add_u32 v16, -512, v16
    v_add_u32 v8, 16, v8
    s_add_u32 s24, s24, 4
    s_cmp_le_u32 s24, 128
    s_cbranch_scc1 L_hp
    s_add_u32 s26, s77, 28
    s_mul_i32 s26, s26, 64
    s_add_u32 s26, s26, s78
    s_lshl_b32 s26, s26, 10
    s_lshr_b32 s34, s2, 3
    s_and_b32 s35, s2, 7
    v_lshrrev_b32 v10, 3, v1
    v_and_b32 v16, 7, v1
    v_lshlrev_b32 v10, 10, v10
    v_lshl_add_u32 v15, v16, 4, v10
    v_lshrrev_b32 v10, 2, v16
    v_and_b32 v16, 3, v16
    v_lshl_add_u32 v16, v16, 2, v10
    v_lshlrev_b32 v16, 1, v16
    v_bfe_u32 v10, v1, 4, 1
    v_lshl_add_u32 v16, v10, 6, v16
    v_lshrrev_b32 v10, 5, v1
    v_lshl_add_u32 v16, v10, 5, v16
    s_mov_b32 s25, 0
    s_mov_b32 s38, 0
    s_mul_i32 s36, s34, 65536
    s_lshl_b32 s83, s35, 7
    s_add_u32 s36, s36, s83
    s_mul_i32 s37, s34, 384
    s_lshr_b32 s83, s35, 1
    s_mul_i32 s83, s83, 96
    s_add_u32 s37, s37, s83
    s_and_b32 s83, s35, 1
    s_lshl_b32 s83, s83, 2
    s_add_u32 s37, s37, s83
    s_mov_b32 s40, s74
    s_mov_b32 s41, s75
    s_mov_b32 s42, 1610612736
    s_mov_b32 s43, 0x20000
    s_mov_b32 s16, s70
    s_mov_b32 s17, s71
    s_mov_b32 s18, 12288
    s_mov_b32 s19, 0x20000
    v_add_u32 v13, 143360, v2
    s_nop 1
L_hf:
    s_sleep 32
    ds_read_b128 v[56:59], v3
    s_waitcnt lgkmcnt(0)
    v_min3_i32 v56, v56, v57, v58
    v_min_i32 v56, v56, v59
    s_nop 0
    v_readfirstlane_b32 s80, v56
    s_nop 0
    s_cmp_lt_i32 s80, 240
    s_nop 2
    s_cbranch_scc1 L_hf
    ds_read_b128 v[140:143], v13 offset:0
    ds_read_b128 v[144:147], v13 offset:1024
    ds_read_b128 v[148:151], v13 offset:2048
    ds_read_b128 v[152:155], v13 offset:3072
    ds_read_b128 v[156:159], v13 offset:4096
    ds_read_b128 v[160:163], v13 offset:5120
    ds_read_b128 v[164:167], v13 offset:6144
L_hn:
    s_sleep 2
    ds_read_b32 v4, v3 offset:16
    s_waitcnt lgkmcnt(0)
    v_readfirstlane_b32 s80, v4
    s_nop 0
    s_cmp_lt_i32 s80, 3042
    s_nop 2
    s_cbranch_scc1 L_hn
    buffer_store_dwordx4 v[140:143], v2, s[12:15], s26 offen sc0 sc1 nt
    s_sub_u32 s26, s26, 262144
    buffer_store_dwordx4 v[144:147], v2, s[12:15], s26 offen sc0 sc1 nt
    s_sub_u32 s26, s26, 262144
    buffer_store_dwordx4 v[148:151], v2, s[12:15], s26 offen sc0 sc1 nt
    s_sub_u32 s26, s26, 262144
    buffer_store_dwordx4 v[152:155], v2, s[12:15], s26 offen sc0 sc1 nt
    s_sub_u32 s26, s26, 262144
    buffer_store_dwordx4 v[156:159], v2, s[12:15], s26 offen sc0 sc1 nt
    s_sub_u32 s26, s26, 262144
    buffer_store_dwordx4 v[160:163], v2, s[12:15], s26 offen sc0 sc1 nt
    s_sub_u32 s26, s26, 262144
    buffer_store_dwordx4 v[164:167], v2, s[12:15], s26 offen sc0 sc1 nt
    s_sub_u32 s26, s26, 262144
    s_nop 0
L_hl:
    s_sleep 1
    ds_read_b32 v4, v3 offset:16
    s_waitcnt lgkmcnt(0)
    v_readfirstlane_b32 s80, v4
    s_nop 0
    s_cmp_lt_i32 s80, 3072
    s_nop 2
    s_cbranch_scc1 L_hl
    s_mov_b32 s80, s36
    buffer_load_dwordx4 v[44:47], v15, s[40:43], s80 offen sc0 sc1
    s_add_u32 s80, s80, 8192
    buffer_load_dwordx4 v[48:51], v15, s[40:43], s80 offen sc0 sc1
    s_add_u32 s80, s80, 8192
    buffer_load_dwordx4 v[52:55], v15, s[40:43], s80 offen sc0 sc1
    s_add_u32 s80, s80, 8192
    buffer_load_dwordx4 v[56:59], v15, s[40:43], s80 offen sc0 sc1
    s_add_u32 s80, s80, 8192
    buffer_load_dwordx4 v[60:63], v15, s[40:43], s80 offen sc0 sc1
    s_add_u32 s80, s80, 8192
    buffer_load_dwordx4 v[64:67], v15, s[40:43], s80 offen sc0 sc1
    s_add_u32 s80, s80, 8192
    buffer_load_dwordx4 v[68:71], v15, s[40:43], s80 offen sc0 sc1
    s_add_u32 s80, s80, 8192
    buffer_load_dwordx4 v[72:75], v15, s[40:43], s80 offen sc0 sc1
    s_waitcnt vmcnt(7)
    v_xor_b32 v12, s28, v44
    v_bitop3_b32 v12, v12, v45, s29 bitop3:0xf6
    v_bitop3_b32 v12, v12, v46, s30 bitop3:0xf6
    v_xor_b32 v13, s31, v47
    s_waitcnt vmcnt(6)
    v_bitop3_b32 v12, v12, v48, s28 bitop3:0xf6
    v_bitop3_b32 v12, v12, v49, s29 bitop3:0xf6
    v_bitop3_b32 v12, v12, v50, s30 bitop3:0xf6
    v_bitop3_b32 v13, v13, v51, s31 bitop3:0xf6
    s_waitcnt vmcnt(5)
    v_bitop3_b32 v12, v12, v52, s28 bitop3:0xf6
    v_bitop3_b32 v12, v12, v53, s29 bitop3:0xf6
    v_bitop3_b32 v12, v12, v54, s30 bitop3:0xf6
    v_bitop3_b32 v13, v13, v55, s31 bitop3:0xf6
    s_waitcnt vmcnt(4)
    v_bitop3_b32 v12, v12, v56, s28 bitop3:0xf6
    v_bitop3_b32 v12, v12, v57, s29 bitop3:0xf6
    v_bitop3_b32 v12, v12, v58, s30 bitop3:0xf6
    v_bitop3_b32 v13, v13, v59, s31 bitop3:0xf6
    s_waitcnt vmcnt(3)
    v_bitop3_b32 v12, v12, v60, s28 bitop3:0xf6
    v_bitop3_b32 v12, v12, v61, s29 bitop3:0xf6
    v_bitop3_b32 v12, v12, v62, s30 bitop3:0xf6
    v_bitop3_b32 v13, v13, v63, s31 bitop3:0xf6
    s_waitcnt vmcnt(2)
    v_bitop3_b32 v12, v12, v64, s28 bitop3:0xf6
    v_bitop3_b32 v12, v12, v65, s29 bitop3:0xf6
    v_bitop3_b32 v12, v12, v66, s30 bitop3:0xf6
    v_bitop3_b32 v13, v13, v67, s31 bitop3:0xf6
    s_waitcnt vmcnt(1)
    v_bitop3_b32 v12, v12, v68, s28 bitop3:0xf6
    v_bitop3_b32 v12, v12, v69, s29 bitop3:0xf6
    v_bitop3_b32 v12, v12, v70, s30 bitop3:0xf6
    v_bitop3_b32 v13, v13, v71, s31 bitop3:0xf6
    s_waitcnt vmcnt(0)
    v_bitop3_b32 v12, v12, v72, s28 bitop3:0xf6
    v_bitop3_b32 v12, v12, v73, s29 bitop3:0xf6
    v_bitop3_b32 v12, v12, v74, s30 bitop3:0xf6
    v_bitop3_b32 v13, v13, v75, s31 bitop3:0xf6
    v_cndmask_b32 v13, v13, 0, s[32:33]
    v_bitop3_b32 v12, v12, v13, v14 bitop3:0xa8
    v_cmp_ne_u32 vcc, 0, v12
    s_nop 4
    s_cbranch_vccz L_ok0
    s_mov_b32 s80, s36
    buffer_load_dwordx4 v[44:47], v15, s[40:43], s80 offen sc0 sc1
    s_add_u32 s80, s80, 8192
    buffer_load_dwordx4 v[48:51], v15, s[40:43], s80 offen sc0 sc1
    s_add_u32 s80, s80, 8192
    buffer_load_dwordx4 v[52:55], v15, s[40:43], s80 offen sc0 sc1
    s_add_u32 s80, s80, 8192
    buffer_load_dwordx4 v[56:59], v15, s[40:43], s80 offen sc0 sc1
    s_add_u32 s80, s80, 8192
    buffer_load_dwordx4 v[60:63], v15, s[40:43], s80 offen sc0 sc1
    s_add_u32 s80, s80, 8192
    buffer_load_dwordx4 v[64:67], v15, s[40:43], s80 offen sc0 sc1
    s_add_u32 s80, s80, 8192
    buffer_load_dwordx4 v[68:71], v15, s[40:43], s80 offen sc0 sc1
    s_add_u32 s80, s80, 8192
    buffer_load_dwordx4 v[72:75], v15, s[40:43], s80 offen sc0 sc1
    s_sleep 6
L_try:
    s_mov_b32 s80, s36
    buffer_load_dwordx4 v[76:79], v15, s[40:43], s80 offen sc0 sc1
    s_add_u32 s80, s80, 8192
    buffer_load_dwordx4 v[80:83], v15, s[40:43], s80 offen sc0 sc1
    s_add_u32 s80, s80, 8192
    buffer_load_dwordx4 v[84:87], v15, s[40:43], s80 offen sc0 sc1
    s_add_u32 s80, s80, 8192
    buffer_load_dwordx4 v[88:91], v15, s[40:43], s80 offen sc0 sc1
    s_add_u32 s80, s80, 8192
    buffer_load_dwordx4 v[92:95], v15, s[40:43], s80 offen sc0 sc1
    s_add_u32 s80, s80, 8192
    buffer_load_dwordx4 v[96:99], v15, s[40:43], s80 offen sc0 sc1
    s_add_u32 s80, s80, 8192
    buffer_load_dwordx4 v[100:103], v15, s[40:43], s80 offen sc0 sc1
    s_add_u32 s80, s80, 8192
    buffer_load_dwordx4 v[104:107], v15, s[40:43], s80 offen sc0 sc1
    s_waitcnt vmcnt(15)
    v_xor_b32 v12, s28, v44
    v_bitop3_b32 v12, v12, v45, s29 bitop3:0xf6
    v_bitop3_b32 v12, v12, v46, s30 bitop3:0xf6
    v_xor_b32 v13, s31, v47
    s_waitcnt vmcnt(14)
    v_bitop3_b32 v12, v12, v48, s28 bitop3:0xf6
    v_bitop3_b32 v12, v12, v49, s29 bitop3:0xf6
    v_bitop3_b32 v12, v12, v50, s30 bitop3:0xf6
    v_bitop3_b32 v13, v13, v51, s31 bitop3:0xf6
    s_waitcnt vmcnt(13)
    v_bitop3_b32 v12, v12, v52, s28 bitop3:0xf6
    v_bitop3_b32 v12, v12, v53, s29 bitop3:0xf6
    v_bitop3_b32 v12, v12, v54, s30 bitop3:0xf6
    v_bitop3_b32 v13, v13, v55, s31 bitop3:0xf6
    s_waitcnt vmcnt(12)
    v_bitop3_b32 v12, v12, v56, s28 bitop3:0xf6
    v_bitop3_b32 v12, v12, v57, s29 bitop3:0xf6
    v_bitop3_b32 v12, v12, v58, s30 bitop3:0xf6
    v_bitop3_b32 v13, v13, v59, s31 bitop3:0xf6
    s_waitcnt vmcnt(11)
    v_bitop3_b32 v12, v12, v60, s28 bitop3:0xf6
    v_bitop3_b32 v12, v12, v61, s29 bitop3:0xf6
    v_bitop3_b32 v12, v12, v62, s30 bitop3:0xf6
    v_bitop3_b32 v13, v13, v63, s31 bitop3:0xf6
    s_waitcnt vmcnt(10)
    v_bitop3_b32 v12, v12, v64, s28 bitop3:0xf6
    v_bitop3_b32 v12, v12, v65, s29 bitop3:0xf6
    v_bitop3_b32 v12, v12, v66, s30 bitop3:0xf6
    v_bitop3_b32 v13, v13, v67, s31 bitop3:0xf6
    s_waitcnt vmcnt(9)
    v_bitop3_b32 v12, v12, v68, s28 bitop3:0xf6
    v_bitop3_b32 v12, v12, v69, s29 bitop3:0xf6
    v_bitop3_b32 v12, v12, v70, s30 bitop3:0xf6
    v_bitop3_b32 v13, v13, v71, s31 bitop3:0xf6
    s_waitcnt vmcnt(8)
    v_bitop3_b32 v12, v12, v72, s28 bitop3:0xf6
    v_bitop3_b32 v12, v12, v73, s29 bitop3:0xf6
    v_bitop3_b32 v12, v12, v74, s30 bitop3:0xf6
    v_bitop3_b32 v13, v13, v75, s31 bitop3:0xf6
    v_cndmask_b32 v13, v13, 0, s[32:33]
    v_bitop3_b32 v12, v12, v13, v14 bitop3:0xa8
    v_cmp_ne_u32 vcc, 0, v12
    s_nop 4
    s_cbranch_vccz L_ok0
    s_mov_b32 s80, s36
    buffer_load_dwordx4 v[44:47], v15, s[40:43], s80 offen sc0 sc1
    s_add_u32 s80, s80, 8192
    buffer_load_dwordx4 v[48:51], v15, s[40:43], s80 offen sc0 sc1
    s_add_u32 s80, s80, 8192
    buffer_load_dwordx4 v[52:55], v15, s[40:43], s80 offen sc0 sc1
    s_add_u32 s80, s80, 8192
    buffer_load_dwordx4 v[56:59], v15, s[40:43], s80 offen sc0 sc1
    s_add_u32 s80, s80, 8192
    buffer_load_dwordx4 v[60:63], v15, s[40:43], s80 offen sc0 sc1
    s_add_u32 s80, s80, 8192
    buffer_load_dwordx4 v[64:67], v15, s[40:43], s80 offen sc0 sc1
    s_add_u32 s80, s80, 8192
    buffer_load_dwordx4 v[68:71], v15, s[40:43], s80 offen sc0 sc1
    s_add_u32 s80, s80, 8192
    buffer_load_dwordx4 v[72:75], v15, s[40:43], s80 offen sc0 sc1
    s_waitcnt vmcnt(15)
    v_xor_b32 v12, s28, v76
    v_bitop3_b32 v12, v12, v77, s29 bitop3:0xf6
    v_bitop3_b32 v12, v12, v78, s30 bitop3:0xf6
    v_xor_b32 v13, s31, v79
    s_waitcnt vmcnt(14)
    v_bitop3_b32 v12, v12, v80, s28 bitop3:0xf6
    v_bitop3_b32 v12, v12, v81, s29 bitop3:0xf6
    v_bitop3_b32 v12, v12, v82, s30 bitop3:0xf6
    v_bitop3_b32 v13, v13, v83, s31 bitop3:0xf6
    s_waitcnt vmcnt(13)
    v_bitop3_b32 v12, v12, v84, s28 bitop3:0xf6
    v_bitop3_b32 v12, v12, v85, s29 bitop3:0xf6
    v_bitop3_b32 v12, v12, v86, s30 bitop3:0xf6
    v_bitop3_b32 v13, v13, v87, s31 bitop3:0xf6
    s_waitcnt vmcnt(12)
    v_bitop3_b32 v12, v12, v88, s28 bitop3:0xf6
    v_bitop3_b32 v12, v12, v89, s29 bitop3:0xf6
    v_bitop3_b32 v12, v12, v90, s30 bitop3:0xf6
    v_bitop3_b32 v13, v13, v91, s31 bitop3:0xf6
    s_waitcnt vmcnt(11)
    v_bitop3_b32 v12, v12, v92, s28 bitop3:0xf6
    v_bitop3_b32 v12, v12, v93, s29 bitop3:0xf6
    v_bitop3_b32 v12, v12, v94, s30 bitop3:0xf6
    v_bitop3_b32 v13, v13, v95, s31 bitop3:0xf6
    s_waitcnt vmcnt(10)
    v_bitop3_b32 v12, v12, v96, s28 bitop3:0xf6
    v_bitop3_b32 v12, v12, v97, s29 bitop3:0xf6
    v_bitop3_b32 v12, v12, v98, s30 bitop3:0xf6
    v_bitop3_b32 v13, v13, v99, s31 bitop3:0xf6
    s_waitcnt vmcnt(9)
    v_bitop3_b32 v12, v12, v100, s28 bitop3:0xf6
    v_bitop3_b32 v12, v12, v101, s29 bitop3:0xf6
    v_bitop3_b32 v12, v12, v102, s30 bitop3:0xf6
    v_bitop3_b32 v13, v13, v103, s31 bitop3:0xf6
    s_waitcnt vmcnt(8)
    v_bitop3_b32 v12, v12, v104, s28 bitop3:0xf6
    v_bitop3_b32 v12, v12, v105, s29 bitop3:0xf6
    v_bitop3_b32 v12, v12, v106, s30 bitop3:0xf6
    v_bitop3_b32 v13, v13, v107, s31 bitop3:0xf6
    v_cndmask_b32 v13, v13, 0, s[32:33]
    v_bitop3_b32 v12, v12, v13, v14 bitop3:0xa8
    v_cmp_ne_u32 vcc, 0, v12
    s_nop 4
    s_cbranch_vccz L_ok1
    s_add_u32 s25, s25, 1
    s_cmp_lt_u32 s25, 2000000
    s_cbranch_scc1 L_try
L_ok1:
    v_max_f32 v11, v79, v83
    v_max3_f32 v11, v11, v87, v91
    v_max3_f32 v11, v11, v95, v99
    v_max3_f32 v11, v11, v103, v107
    s_nop 1
    v_max_f32_dpp v11, v11, v11 row_ror:8 row_mask:0xf bank_mask:0xf
    v_mov_b32 v13, v11
    s_nop 1
    v_permlane32_swap_b32 v11, v13
    v_max_f32 v11, v11, v13
    v_mov_b32 v13, v11
    s_nop 1
    v_permlane16_swap_b32 v11, v13
    v_max_f32 v11, v11, v13
    s_nop 1
    v_mov_b32_dpp v11, v11 quad_perm:[0,0,2,2] row_mask:0xf bank_mask:0xf
    s_nop 1
    v_sub_f32_dpp v20, v79, v11 quad_perm:[0,0,2,2] row_mask:0xf bank_mask:0xf
    v_sub_f32_dpp v21, v83, v11 quad_perm:[0,0,2,2] row_mask:0xf bank_mask:0xf
    v_sub_f32_dpp v22, v87, v11 quad_perm:[0,0,2,2] row_mask:0xf bank_mask:0xf
    v_sub_f32_dpp v23, v91, v11 quad_perm:[0,0,2,2] row_mask:0xf bank_mask:0xf
    v_sub_f32_dpp v24, v95, v11 quad_perm:[0,0,2,2] row_mask:0xf bank_mask:0xf
    v_sub_f32_dpp v25, v99, v11 quad_perm:[0,0,2,2] row_mask:0xf bank_mask:0xf
    v_sub_f32_dpp v26, v103, v11 quad_perm:[0,0,2,2] row_mask:0xf bank_mask:0xf
    v_sub_f32_dpp v27, v107, v11 quad_perm:[0,0,2,2] row_mask:0xf bank_mask:0xf
    v_exp_f32 v20, v20
    v_exp_f32 v21, v21
    v_exp_f32 v22, v22
    v_exp_f32 v23, v23
    v_exp_f32 v24, v24
    v_exp_f32 v25, v25
    v_exp_f32 v26, v26
    v_exp_f32 v27, v27
    v_pk_mul_f32 v[40:41], v[76:77], v[20:21] op_sel:[0,0] op_sel_hi:[1,0]
    v_pk_mul_f32 v[42:43], v[78:79], v[20:21] op_sel:[0,0] op_sel_hi:[1,0]
    v_pk_fma_f32 v[40:41], v[80:81], v[20:21], v[40:41] op_sel:[0,1,0] op_sel_hi:[1,1,1]
    v_pk_fma_f32 v[42:43], v[82:83], v[20:21], v[42:43] op_sel:[0,1,0] op_sel_hi:[1,1,1]
    v_pk_fma_f32 v[40:41], v[84:85], v[22:23], v[40:41] op_sel:[0,0,0] op_sel_hi:[1,0,1]
    v_pk_fma_f32 v[42:43], v[86:87], v[22:23], v[42:43] op_sel:[0,0,0] op_sel_hi:[1,0,1]
    v_pk_fma_f32 v[40:41], v[88:89], v[22:23], v[40:41] op_sel:[0,1,0] op_sel_hi:[1,1,1]
    v_pk_fma_f32 v[42:43], v[90:91], v[22:23], v[42:43] op_sel:[0,1,0] op_sel_hi:[1,1,1]
    v_pk_fma_f32 v[40:41], v[92:93], v[24:25], v[40:41] op_sel:[0,0,0] op_sel_hi:[1,0,1]
    v_pk_fma_f32 v[42:43], v[94:95], v[24:25], v[42:43] op_sel:[0,0,0] op_sel_hi:[1,0,1]
    v_pk_fma_f32 v[40:41], v[96:97], v[24:25], v[40:41] op_sel:[0,1,0] op_sel_hi:[1,1,1]
    v_pk_fma_f32 v[42:43], v[98:99], v[24:25], v[42:43] op_sel:[0,1,0] op_sel_hi:[1,1,1]
    v_pk_fma_f32 v[40:41], v[100:101], v[26:27], v[40:41] op_sel:[0,0,0] op_sel_hi:[1,0,1]
    v_pk_fma_f32 v[42:43], v[102:103], v[26:27], v[42:43] op_sel:[0,0,0] op_sel_hi:[1,0,1]
    v_pk_fma_f32 v[40:41], v[104:105], v[26:27], v[40:41] op_sel:[0,1,0] op_sel_hi:[1,1,1]
    v_pk_fma_f32 v[42:43], v[106:107], v[26:27], v[42:43] op_sel:[0,1,0] op_sel_hi:[1,1,1]
    s_nop 1
    s_branch L_fin
L_ok0:
    v_max_f32 v11, v47, v51
    v_max3_f32 v11, v11, v55, v59
    v_max3_f32 v11, v11, v63, v67
    v_max3_f32 v11, v11, v71, v75
    s_nop 1
    v_max_f32_dpp v11, v11, v11 row_ror:8 row_mask:0xf bank_mask:0xf
    v_mov_b32 v13, v11
    s_nop 1
    v_permlane32_swap_b32 v11, v13
    v_max_f32 v11, v11, v13
    v_mov_b32 v13, v11
    s_nop 1
    v_permlane16_swap_b32 v11, v13
    v_max_f32 v11, v11, v13
    s_nop 1
    v_mov_b32_dpp v11, v11 quad_perm:[0,0,2,2] row_mask:0xf bank_mask:0xf
    s_nop 1
    v_sub_f32_dpp v20, v47, v11 quad_perm:[0,0,2,2] row_mask:0xf bank_mask:0xf
    v_sub_f32_dpp v21, v51, v11 quad_perm:[0,0,2,2] row_mask:0xf bank_mask:0xf
    v_sub_f32_dpp v22, v55, v11 quad_perm:[0,0,2,2] row_mask:0xf bank_mask:0xf
    v_sub_f32_dpp v23, v59, v11 quad_perm:[0,0,2,2] row_mask:0xf bank_mask:0xf
    v_sub_f32_dpp v24, v63, v11 quad_perm:[0,0,2,2] row_mask:0xf bank_mask:0xf
    v_sub_f32_dpp v25, v67, v11 quad_perm:[0,0,2,2] row_mask:0xf bank_mask:0xf
    v_sub_f32_dpp v26, v71, v11 quad_perm:[0,0,2,2] row_mask:0xf bank_mask:0xf
    v_sub_f32_dpp v27, v75, v11 quad_perm:[0,0,2,2] row_mask:0xf bank_mask:0xf
    v_exp_f32 v20, v20
    v_exp_f32 v21, v21
    v_exp_f32 v22, v22
    v_exp_f32 v23, v23
    v_exp_f32 v24, v24
    v_exp_f32 v25, v25
    v_exp_f32 v26, v26
    v_exp_f32 v27, v27
    v_pk_mul_f32 v[40:41], v[44:45], v[20:21] op_sel:[0,0] op_sel_hi:[1,0]
    v_pk_mul_f32 v[42:43], v[46:47], v[20:21] op_sel:[0,0] op_sel_hi:[1,0]
    v_pk_fma_f32 v[40:41], v[48:49], v[20:21], v[40:41] op_sel:[0,1,0] op_sel_hi:[1,1,1]
    v_pk_fma_f32 v[42:43], v[50:51], v[20:21], v[42:43] op_sel:[0,1,0] op_sel_hi:[1,1,1]
    v_pk_fma_f32 v[40:41], v[52:53], v[22:23], v[40:41] op_sel:[0,0,0] op_sel_hi:[1,0,1]
    v_pk_fma_f32 v[42:43], v[54:55], v[22:23], v[42:43] op_sel:[0,0,0] op_sel_hi:[1,0,1]
    v_pk_fma_f32 v[40:41], v[56:57], v[22:23], v[40:41] op_sel:[0,1,0] op_sel_hi:[1,1,1]
    v_pk_fma_f32 v[42:43], v[58:59], v[22:23], v[42:43] op_sel:[0,1,0] op_sel_hi:[1,1,1]
    v_pk_fma_f32 v[40:41], v[60:61], v[24:25], v[40:41] op_sel:[0,0,0] op_sel_hi:[1,0,1]
    v_pk_fma_f32 v[42:43], v[62:63], v[24:25], v[42:43] op_sel:[0,0,0] op_sel_hi:[1,0,1]
    v_pk_fma_f32 v[40:41], v[64:65], v[24:25], v[40:41] op_sel:[0,1,0] op_sel_hi:[1,1,1]
    v_pk_fma_f32 v[42:43], v[66:67], v[24:25], v[42:43] op_sel:[0,1,0] op_sel_hi:[1,1,1]
    v_pk_fma_f32 v[40:41], v[68:69], v[26:27], v[40:41] op_sel:[0,0,0] op_sel_hi:[1,0,1]
    v_pk_fma_f32 v[42:43], v[70:71], v[26:27], v[42:43] op_sel:[0,0,0] op_sel_hi:[1,0,1]
    v_pk_fma_f32 v[40:41], v[72:73], v[26:27], v[40:41] op_sel:[0,1,0] op_sel_hi:[1,1,1]
    v_pk_fma_f32 v[42:43], v[74:75], v[26:27], v[42:43] op_sel:[0,1,0] op_sel_hi:[1,1,1]
    s_nop 1
L_fin:
    v_permlane32_swap_b32 v40, v41
    v_permlane32_swap_b32 v42, v43
    v_add_f32 v40, v40, v41
    v_add_f32 v42, v42, v43
    s_nop 1
    v_permlane16_swap_b32 v40, v42
    v_add_f32 v40, v40, v42
    s_nop 1
    v_add_f32_dpp v40, v40, v40 row_ror:8 row_mask:0xf bank_mask:0xf
    v_rcp_f32 v10, v40
    s_nop 0
    v_readlane_b32 s81, v10, 49
    s_nop 1
    v_mul_f32 v40, s81, v40
    v_cvt_pk_bf16_f32 v40, v40, v40
    s_mov_b32 exec_lo, 0x00ff00ff
    s_mov_b32 exec_hi, 0xff
    buffer_store_short v40, v16, s[16:19], s37 offen sc0 sc1
    s_endpgm
L_bal:
    s_cmp_eq_u32 s76, 6
    s_cbranch_scc0 L_exch
    v_mov_b32 v16, -1
    s_mov_b32 s80, 0x14141418
    v_writelane_b32 v16, s80, 0
    s_mov_b32 s80, 0x18181810
    v_writelane_b32 v16, s80, 1
    s_mov_b32 s80, 0x28282830
    v_writelane_b32 v16, s80, 2
    s_mov_b32 s80, 0x18181410
    v_writelane_b32 v16, s80, 3
    s_mov_b32 s80, 0x14141818
    v_writelane_b32 v16, s80, 4
    s_mov_b32 s80, 0x30302c20
    v_writelane_b32 v16, s80, 5
    s_mov_b32 s80, 0x50505460
    v_writelane_b32 v16, s80, 6
    s_lshl_b32 s80, s77, 3
    v_sad_u8 v17, v16, 0, 0
    v_bfe_u32 v16, v16, s80, 8
    v_cvt_f32_u32 v15, v17
    v_cvt_f32_u32 v4, v16
    v_rcp_f32 v18, v4
    v_rcp_f32 v19, v15
    v_mul_f32 v15, 0x472aaaab, v15
    v_mul_f32 v4, 0x46b00000, v4
    v_mul_f32 v18, v18, v15
    v_mul_f32 v19, v19, v4
    v_cvt_u32_f32 v18, v18
    v_cvt_u32_f32 v19, v19
    v_mul_u32_u24 v16, 12, v16
    v_lshlrev_b32 v17, 3, v17
    s_mov_b32 s4, 0
    s_mov_b32 s9, 0
    s_mov_b32 s13, 0
    s_mov_b32 s15, 0
    s_mov_b32 s17, 0
    s_mov_b32 s18, 0
    s_mov_b32 s19, 0
    s_mov_b32 s22, 0
    s_mov_b32 s23, 0
    s_mov_b32 s24, 0
    s_mov_b32 s5, 32
    s_mov_b32 s7, 128
    v_mov_b32 v14, 157824
    s_lshl_b32 s80, s84, 12
    s_add_u32 s80, s80, 1351680
    v_mov_b32 v12, s80
    v_mov_b32 v13, 5104
    ds_write_b64 v3, v[12:13] offset:24
    v_mov_b32 v15, s84
    ds_write_b32 v14, v15
    s_nop 0
L_g:
    s_sleep 1
    ds_read_b32 v4, v3 offset:16
    s_memrealtime s[10:11]
    ds_read_b128 v[8:11], v3
    ds_read_b64 v[12:13], v3 offset:24
    s_waitcnt lgkmcnt(0)
    v_readfirstlane_b32 s83, v4
    v_min3_i32 v15, v8, v9, v10
    v_min_i32 v8, v15, v11
    v_readfirstlane_b32 s80, v12
    v_readfirstlane_b32 s81, v13
    s_nop 0
    s_lshr_b32 s21, s81, 16
    s_and_b32 s81, s81, 0xffff
    s_cmp_lt_u32 s21, s22
    s_cselect_b32 s23, s23, 0
    s_cmp_lt_u32 s4, 6
    s_cselect_b32 s24, s10, s24
    s_sub_u32 s82, s10, s24
    s_cmp_gt_u32 s82, 100
    s_cselect_b32 s82, s82, 15
    s_sub_u32 s82, s82, 15
    s_lshl_b32 s82, s82, 12
    s_add_u32 s82, s82, s23
    s_add_u32 s80, s80, s82
    s_cmp_gt_i32 s83, s9
    s_cbranch_scc0 L_gq
    s_mov_b32 s24, s10
    s_cmp_eq_u32 s82, s23
    s_cbranch_scc1 L_gq
    s_mov_b32 s23, s82
    s_add_u32 s22, s4, 1
L_gq:
    s_max_i32 s9, s9, s83
    s_cmp_ge_u32 s9, s13
    s_cbranch_scc0 L_gs
    s_mov_b32 s12, s13
    s_mov_b32 s14, s15
    v_readlane_b32 s82, v16, s17
    v_readlane_b32 s83, v17, s17
    v_readlane_b32 s16, v18, s17
    s_add_u32 s17, s17, 1
    s_add_u32 s13, s13, s82
    s_add_u32 s15, s15, s83
    s_nop 1
L_gs:
    s_add_u32 s82, s9, 22
    s_cmp_ge_u32 s82, s18
    s_cbranch_scc0 L_gf
    v_readlane_b32 s82, v16, s19
    v_readlane_b32 s20, v19, s19
    s_add_u32 s19, s19, 1
    s_add_u32 s18, s18, s82
    s_nop 2
L_gf:
    s_sub_u32 s6, s9, s12
    s_mul_i32 s6, s6, s16
    s_lshr_b32 s6, s6, 16
    s_add_u32 s6, s6, s14
    s_cmp_ge_u32 s6, s5
    s_cbranch_scc0 L_gn
    s_add_u32 s4, s4, 1
    s_add_u32 s5, s5, 32
    v_add_u32 v14, 4, v14
    v_mov_b32 v15, s10
    ds_write_b32 v14, v15
    v_mov_b32 v15, s4
    ds_write_b32 v3, v15 offset:20
    s_nop 0
L_gn:
    s_mul_i32 s81, s81, s6
    s_add_u32 s80, s80, s81
    s_lshl_b32 s81, s10, 12
    s_sub_u32 s80, s81, s80
    s_ashr_i32 s80, s80, 6
    s_min_i32 s80, s80, 0x40000
    s_max_i32 s80, s80, 0xfffc0000
    s_mul_i32 s80, s80, 983
    s_ashr_i32 s80, s80, 12
    s_and_b32 s7, s7, 255
    s_add_u32 s7, s7, s80
    s_add_u32 s7, s7, s20
    s_ashr_i32 s8, s7, 8
    s_min_i32 s8, s8, 36
    s_max_i32 s8, s8, 12
    s_cmp_lt_u32 s4, 4
    s_cselect_b32 s8, 24, s8
    s_add_u32 s80, s8, 2304
    v_lshl_add_u32 v15, v8, 8, s80
    ds_write_b32 v3, v15 offset:44
    s_cmp_lt_u32 s4, 256
    s_cbranch_scc1 L_g
    s_endpgm
L_exch:
    s_mov_b32 s12, s74
    s_mov_b32 s13, s75
    s_mov_b32 s14, 1610612736
    s_mov_b32 s15, 0x20000
    s_mov_b32 s80, 4352
    v_mul_lo_u32 v5, v1, s80
    s_lshr_b32 s80, s2, 3
    s_mul_i32 s21, s79, 5
    s_add_u32 s21, s21, s80
    s_and_b32 s21, s21, 31
    s_lshr_b32 s80, s80, 5
    s_lshl_b32 s80, s80, 3
    s_add_u32 s80, s80, s79
    s_mul_i32 s80, s80, 4352
    s_waitcnt vmcnt(0)
    v_mov_b32 v7, s80
    s_mov_b32 s16, 0
    s_mov_b32 s17, 33554432
    s_mov_b32 s18, 8
    s_mov_b32 s20, 0
    s_mov_b32 s19, 0
    s_mov_b32 s24, 0
    s_mov_b32 s25, 5104
L_pc0:
L_pw1:
    s_sleep 8
    ds_read_b32 v4, v3 offset:20
    s_waitcnt lgkmcnt(0)
    v_readfirstlane_b32 s80, v4
    s_nop 0
    s_cmp_lt_i32 s80, s18
    s_nop 2
    s_cbranch_scc1 L_pw1
    s_lshl_b32 s80, s18, 2
    s_add_u32 s80, s80, 157824
    v_mov_b32 v8, s80
    ds_read_b32 v6, v8
    s_waitcnt lgkmcnt(0)
    s_and_b32 s80, s16, 31
    s_cmp_eq_u32 s80, s21
    s_cbranch_scc0 L_np
    s_mov_b64 exec, 1
    buffer_store_dword v6, v7, s[12:15], s17 offen sc0 sc1
    s_mov_b64 exec, -1
L_np:
    s_add_u32 s81, s18, 4
L_pw2:
    s_sleep 8
    ds_read_b32 v4, v3 offset:20
    s_waitcnt lgkmcnt(0)
    v_readfirstlane_b32 s80, v4
    s_nop 0
    s_cmp_lt_i32 s80, s81
    s_nop 2
    s_cbranch_scc1 L_pw2
    s_add_u32 s30, s74, s17
    s_addc_u32 s31, s75, 0
    s_load_dword s32, s[30:31], 0
    s_load_dword s33, s[30:31], 4352
    s_load_dword s34, s[30:31], 8704
    s_load_dword s35, s[30:31], 13056
    s_load_dword s36, s[30:31], 17408
    s_load_dword s37, s[30:31], 21760
    s_load_dword s38, s[30:31], 26112
    s_load_dword s39, s[30:31], 30464
    s_memrealtime s[22:23]
    v_readfirstlane_b32 s26, v6
    s_mov_b32 s27, 0
    s_mov_b32 s28, 0
    s_mov_b32 s29, -4096
    s_waitcnt lgkmcnt(0)
    s_sub_u32 s83, s22, s26
    s_sub_u32 s80, s32, s26
    s_add_u32 s81, s80, 4096
    s_cmp_lt_u32 s81, 0x2000
    s_cselect_b32 s80, s80, s83
    s_addc_u32 s28, s28, 0
    s_add_u32 s27, s27, s80
    s_max_i32 s29, s29, s80
    s_sub_u32 s80, s33, s26
    s_add_u32 s81, s80, 4096
    s_cmp_lt_u32 s81, 0x2000
    s_cselect_b32 s80, s80, s83
    s_addc_u32 s28, s28, 0
    s_add_u32 s27, s27, s80
    s_max_i32 s29, s29, s80
    s_sub_u32 s80, s34, s26
    s_add_u32 s81, s80, 4096
    s_cmp_lt_u32 s81, 0x2000
    s_cselect_b32 s80, s80, s83
    s_addc_u32 s28, s28, 0
    s_add_u32 s27, s27, s80
    s_max_i32 s29, s29, s80
    s_sub_u32 s80, s35, s26
    s_add_u32 s81, s80, 4096
    s_cmp_lt_u32 s81, 0x2000
    s_cselect_b32 s80, s80, s83
    s_addc_u32 s28, s28, 0
    s_add_u32 s27, s27, s80
    s_max_i32 s29, s29, s80
    s_sub_u32 s80, s36, s26
    s_add_u32 s81, s80, 4096
    s_cmp_lt_u32 s81, 0x2000
    s_cselect_b32 s80, s80, s83
    s_addc_u32 s28, s28, 0
    s_add_u32 s27, s27, s80
    s_max_i32 s29, s29, s80
    s_sub_u32 s80, s37, s26
    s_add_u32 s81, s80, 4096
    s_cmp_lt_u32 s81, 0x2000
    s_cselect_b32 s80, s80, s83
    s_addc_u32 s28, s28, 0
    s_add_u32 s27, s27, s80
    s_max_i32 s29, s29, s80
    s_sub_u32 s80, s38, s26
    s_add_u32 s81, s80, 4096
    s_cmp_lt_u32 s81, 0x2000
    s_cselect_b32 s80, s80, s83
    s_addc_u32 s28, s28, 0
    s_add_u32 s27, s27, s80
    s_max_i32 s29, s29, s80
    s_sub_u32 s80, s39, s26
    s_add_u32 s81, s80, 4096
    s_cmp_lt_u32 s81, 0x2000
    s_cselect_b32 s80, s80, s83
    s_addc_u32 s28, s28, 0
    s_add_u32 s27, s27, s80
    s_max_i32 s29, s29, s80
    s_cmp_lt_u32 s28, 4
    s_cbranch_scc1 L_pskip
    s_mul_i32 s27, s27, 410
    s_lshl_b32 s80, s26, 12
    s_add_u32 s80, s80, s27
    s_mul_i32 s29, s29, 819
    s_add_u32 s80, s80, s29
    s_min_u32 s82, s18, 0
    s_lshl_b32 s83, s18, 5
    s_add_u32 s82, s82, s83
    s_sub_u32 s81, s80, s19
    s_sub_u32 s83, s82, s24
    v_cvt_f32_u32 v8, s81
    v_cvt_f32_u32 v9, s83
    v_rcp_f32 v9, v9
    v_mul_f32 v8, 0x3f800000, v8
    v_mul_f32 v8, v8, v9
    v_mul_f32 v9, 0x3f7851ec, v8
    v_mov_b32 v10, 0x459f8000
    v_mul_f32 v8, 0x3f828f5c, v8
    v_med3_f32 v8, v8, v9, v10
    v_cvt_u32_f32 v8, v8
    s_nop 0
    v_readfirstlane_b32 s81, v8
    s_mov_b32 s19, s80
    s_mov_b32 s24, s82
    s_cmp_eq_u32 s20, 0
    s_cselect_b32 s81, 5104, s81
    s_mov_b32 s20, 1
    s_add_u32 s83, s25, 51
    s_min_u32 s81, s81, s83
    s_sub_u32 s83, s25, 51
    s_max_u32 s81, s81, s83
    s_mov_b32 s25, s81
    s_mul_i32 s82, s82, s81
    s_sub_u32 s80, s80, s82
    s_pack_ll_b32_b16 s81, s81, s18
    v_mov_b32 v8, s80
    v_mov_b32 v9, s81
    ds_write_b64 v3, v[8:9] offset:24
    s_nop 0
L_pskip:
    s_add_u32 s16, s16, 1
    s_add_u32 s17, s17, 34816
    s_add_u32 s18, s18, 16
    s_cmp_lt_u32 s18, 250
    s_cbranch_scc1 L_pc0
L_end:
    s_endpgm
.section .rodata,"a"
.p2align 6
.amdhsa_kernel standalone__kv_cache_quant_pre_rope_vs_post_rope__decode_kernel
  .amdhsa_next_free_vgpr 168
  .amdhsa_next_free_sgpr 96
  .amdhsa_accum_offset 168
  .amdhsa_group_segment_fixed_size 0
  .amdhsa_kernarg_size 112
  .amdhsa_user_sgpr_count 2
  .amdhsa_user_sgpr_kernarg_segment_ptr 1
  .amdhsa_system_sgpr_workgroup_id_x 1
.end_amdhsa_kernel
```
